```python
import torch

def _softmax(x, axis=-1):
    return torch.softmax(x, dim=axis)
def _gelu(x):
    return torch.nn.functional.gelu(x, approximate="tanh")
def _silu(x):
    return torch.nn.functional.silu(x)
def _sigmoid(x):
    return torch.sigmoid(x)
def _layernorm(x, axis=-1, eps=1e-5):
    m = x.mean(dim=axis, keepdim=True)
    v = x.var(dim=axis, keepdim=True, unbiased=False)
    return (x - m) / torch.sqrt(v + eps)
def _scatter_add(tgt, idx, src, axis=0):
    return tgt.clone().index_add_(axis, idx, src)
def _segment_sum(src, seg, n):
    out = torch.zeros((n,) + src.shape[1:], dtype=src.dtype)
    return out.index_add_(0, seg, src)
def _pad(x, pw):
    flat = tuple(v for pair in reversed(pw) for v in pair)
    return torch.nn.functional.pad(x, flat)

kernel_name = 'standalone__modern_conv_block_slak__vision'

def setup_inputs():

    _w = (lambda a: (lambda t: t.to(torch.bfloat16) if t.is_floating_point() else t)(torch.as_tensor(a)))
    H = W = 256
    C = 384
    K = 1
    return {
        "x": _w((lambda *s: torch.randn(*s, dtype=torch.bfloat16) * 0.05)(1, H, W, C)),
        "dw": _w((lambda *s: torch.randn(*s, dtype=torch.bfloat16) * 0.05)(K, K, C)),
        "w1": _w((lambda *s: torch.randn(*s, dtype=torch.bfloat16) * 0.05)(C, 4 * C)),
        "w2": _w((lambda *s: torch.randn(*s, dtype=torch.bfloat16) * 0.05)(4 * C, C)),
        "grn_g": _w((lambda *s: torch.randn(*s, dtype=torch.bfloat16) * 0.05)(4 * C)),
        "grn_b": _w((lambda *s: torch.randn(*s, dtype=torch.bfloat16) * 0.05)(4 * C)),
    }

def reference(x, dw, w1, w2, grn_g, grn_b):
    B, H, W, C = x.shape
    K = dw.shape[0]
    pad = K // 2
    xp = _pad(x, ((0,0),(pad,pad),(pad,pad),(0,0)))
    out = torch.zeros_like(x)
    for i in range(K):
        for j in range(K):
            out = out + xp[:, i:i+H, j:j+W, :] * dw[i, j][None, None, None, :]
    h = _layernorm(out, axis=-1)
    h = _gelu(h @ w1)
    gx = torch.sqrt((h * h).sum(axis=(1, 2), keepdims=True) + 1e-6)
    nx = gx / (gx.mean(axis=-1, keepdims=True) + 1e-6)
    h = grn_g[None, None, None, :] * (h * nx) + grn_b[None, None, None, :] + h
    return x + h @ w2
```

```asm
; @launch grid=(256,1,1) block=(256,1,1) lds=163840
.amdgcn_target "amdgcn-amd-amdhsa--gfx950"
.text
.globl standalone__modern_conv_block_slak__vision_kernel
.p2align 8
.type standalone__modern_conv_block_slak__vision_kernel,@function
standalone__modern_conv_block_slak__vision_kernel:
 s_cmp_ge_u32 s2, 256
 s_cbranch_scc0 L_go
 s_endpgm
 s_nop 0
L_go:
 s_load_dwordx16 s[64:79], s[0:1], 0
 s_load_dwordx2 s[80:81], s[0:1], 64
 v_lshrrev_b32 v2, 6, v0
 v_and_b32 v3, 63, v0
 v_readfirstlane_b32 s16, v2
 v_lshlrev_b32 v0, 4, v3
 s_bfe_u32 s95, s2, 0x30003
 s_lshl_b32 s95, s95, 2
 s_add_u32 s95, s95, s16
 s_lshl_b32 s95, s95, 10
 s_getpc_b64 s[26:27]
L_pc1:
 s_add_u32 s26, s26, L_head-L_pc1
 s_addc_u32 s27, s27, 0
 v_and_b32 v16, 0xf0, v0
 v_lshl_add_u32 v16, v16, 2, s95
 v_min_u32 v16, L_end-L_head, v16
 v_add_co_u32 v16, vcc, s26, v16
 v_mov_b32 v17, s27
 v_mov_b32 v17, s27
 v_addc_co_u32 v17, vcc, 0, v17, vcc
 global_load_dword v20, v[16:17], off
L_head:
 v_lshrrev_b32 v4, 4, v3
 v_and_b32 v5, 15, v3
 v_lshlrev_b32 v6, 4, v4
 s_lshl_b32 s18, s2, 2
 s_add_u32 s18, s18, s16
 s_mul_i32 s60, s18, 49152
 s_add_u32 s61, s60, 12288
 s_add_u32 s62, s60, 24576
 s_add_u32 s63, s60, 36864
 s_mov_b32 s83, s2
 s_mov_b32 s82, s16
 s_mov_b32 s84, 0x120000
 s_cmp_lt_u32 s16, 2
 s_cbranch_scc1 L_task_ok
 s_lshr_b32 s83, s2, 3
 s_add_u32 s83, s83, 256
 s_bfe_u32 s82, s2, 0x10002
 s_and_b32 s25, s2, 3
 s_sub_u32 s26, s16, 2
 s_or_b32 s25, s25, s26
 s_cmp_eq_u32 s25, 0
 s_cselect_b32 s84, s84, 0
L_task_ok:
 s_cmp_eq_u32 s82, 0
 s_cbranch_scc0 L_task_w2
 s_mul_hi_u32 s25, s83, 0x15555556
 s_mul_i32 s26, s25, 12
 s_sub_u32 s26, s83, s26
 s_mov_b32 s85, 3072
 s_mul_i32 s87, s25, 49152
 s_lshl_b32 s27, s26, 10
 s_add_u32 s87, s87, s27
 s_mov_b32 s88, 12288
 s_mov_b32 s89, 24576
 s_branch L_task_j
L_task_w2:
 s_mul_hi_u32 s26, s83, 0x2AAAAAAB
 s_mul_i32 s25, s26, 6
 s_sub_u32 s25, s83, s25
 s_mov_b32 s85, 768
 s_lshr_b32 s27, s26, 1
 s_add_u32 s27, s27, 1
 s_cmp_eq_u32 s27, 24
 s_cselect_b32 s27, 0, s27
 s_mul_i32 s87, s27, 49152
 s_and_b32 s27, s26, 1
 s_lshl_b32 s27, s27, 10
 s_add_u32 s87, s87, s27
 s_lshl_b32 s27, s25, 13
 s_add_u32 s87, s87, s27
 s_mov_b32 s88, 2048
 s_mov_b32 s89, 4096
L_task_j:
 s_lshl_b32 s92, s26, 6
 s_lshl_b32 s3, s25, 8
 s_add_u32 s3, s3, 12288
 s_mul_i32 s27, s82, s84
 s_cmp_eq_u32 s27, 0
 s_cselect_b32 s3, 0x100000, s3
 s_mul_i32 s86, s26, s85
 s_lshl_b32 s86, s86, 5
 s_lshl_b32 s25, s25, 7
 s_add_u32 s86, s86, s25
 s_lshl_b32 s25, s85, 3
 v_mul_lo_u32 v7, v4, s25
 v_lshl_add_u32 v7, v5, 3, v7
 v_lshrrev_b32 v8, 3, v3
 v_and_b32 v9, 7, v3
 v_xor_b32 v9, v8, v9
 v_mul_u32_u24 v11, 768, v8
 v_lshl_add_u32 v11, v9, 4, v11
 s_lshl_b32 s90, s16, 11
 s_waitcnt lgkmcnt(0)
 s_mov_b32 s4, s64
 s_mov_b32 s5, s65
 s_mov_b32 s6, 0x3000000
 s_mov_b32 s7, 0x20000
 s_cmp_eq_u32 s82, 0
 s_cselect_b32 s40, s68, s70
 s_cselect_b32 s41, s69, s71
 s_cselect_b32 s27, 0, 0x120000
 s_mov_b32 s42, s84
 s_mov_b32 s43, 0x20000
 buffer_load_dwordx2 v[112:113], v7, s[40:43], s86 offen
 s_add_u32 s86, s86, s85
 buffer_load_dwordx2 v[114:115], v7, s[40:43], s86 offen
 s_add_u32 s86, s86, s85
 buffer_load_dwordx2 v[116:117], v7, s[40:43], s86 offen
 s_add_u32 s86, s86, s85
 buffer_load_dwordx2 v[118:119], v7, s[40:43], s86 offen
 s_add_u32 s86, s86, s85
 buffer_load_dwordx2 v[120:121], v7, s[40:43], s86 offen
 s_add_u32 s86, s86, s85
 buffer_load_dwordx2 v[122:123], v7, s[40:43], s86 offen
 s_add_u32 s86, s86, s85
 buffer_load_dwordx2 v[124:125], v7, s[40:43], s86 offen
 s_add_u32 s86, s86, s85
 buffer_load_dwordx2 v[126:127], v7, s[40:43], s86 offen
 s_add_u32 m0, s90, 0x1c000
 s_add_u32 s91, s60, 0
 buffer_load_dwordx4 v11, s[4:7], s91 offen nt lds
 s_add_u32 m0, s90, 0x1c400
 s_add_u32 s91, s60, 6144
 buffer_load_dwordx4 v11, s[4:7], s91 offen nt lds
 s_add_u32 m0, s90, 0x1e000
 s_add_u32 s91, s60, 128
 buffer_load_dwordx4 v11, s[4:7], s91 offen nt lds
 s_add_u32 m0, s90, 0x1e400
 s_add_u32 s91, s60, 6272
 buffer_load_dwordx4 v11, s[4:7], s91 offen nt lds
 s_add_u32 m0, s90, 0x20000
 s_add_u32 s91, s60, 256
 buffer_load_dwordx4 v11, s[4:7], s91 offen nt lds
 s_add_u32 m0, s90, 0x20400
 s_add_u32 s91, s60, 6400
 buffer_load_dwordx4 v11, s[4:7], s91 offen nt lds
 s_mov_b32 s56, s74
 s_mov_b32 s57, s75
 s_mov_b32 s58, 0xc00
 s_mov_b32 s59, 0x20000
 buffer_load_dwordx4 v[160:163], v6, s[56:59], s92 offen
 s_mov_b32 s12, s66
 s_mov_b32 s13, s67
 s_mov_b32 s14, 0x300
 s_mov_b32 s15, 0x20000
 buffer_load_dwordx4 v[64:67], v6, s[12:15], 0 offen offset:0
 buffer_load_dwordx4 v[68:71], v6, s[12:15], 0 offen offset:64
 buffer_load_dwordx4 v[72:75], v6, s[12:15], 0 offen offset:128
 buffer_load_dwordx4 v[76:79], v6, s[12:15], 0 offen offset:192
 buffer_load_dwordx4 v[80:83], v6, s[12:15], 0 offen offset:256
 buffer_load_dwordx4 v[84:87], v6, s[12:15], 0 offen offset:320
 buffer_load_dwordx4 v[88:91], v6, s[12:15], 0 offen offset:384
 buffer_load_dwordx4 v[92:95], v6, s[12:15], 0 offen offset:448
 buffer_load_dwordx4 v[96:99], v6, s[12:15], 0 offen offset:512
 buffer_load_dwordx4 v[100:103], v6, s[12:15], 0 offen offset:576
 buffer_load_dwordx4 v[104:107], v6, s[12:15], 0 offen offset:640
 buffer_load_dwordx4 v[108:111], v6, s[12:15], 0 offen offset:704
 s_mov_b32 s8, s80
 s_mov_b32 s9, s81
 s_mov_b32 s10, 0x10000000
 s_mov_b32 s11, 0x20000
 s_mul_i32 s25, s2, 0xc3000
 s_add_u32 s32, s80, s25
 s_addc_u32 s33, s81, 0
 s_mov_b32 s34, 0x0
 s_mov_b32 s35, 0x20000
 s_add_u32 s36, s80, 0xc400000
 s_addc_u32 s37, s81, 0
 s_mov_b32 s38, 0x360000
 s_mov_b32 s39, 0x20000
 s_mov_b32 s44, s76
 s_mov_b32 s45, s77
 s_mov_b32 s46, 0x3000000
 s_mov_b32 s47, 0x20000
 s_mov_b32 s48, s78
 s_mov_b32 s49, s79
 s_mov_b32 s50, 0x100
 s_mov_b32 s51, 0x20000
 s_mov_b32 s52, s72
 s_mov_b32 s53, s73
 s_mov_b32 s54, 0xc00
 s_mov_b32 s55, 0x20000
 s_add_u32 s40, s36, s27
 s_addc_u32 s41, s37, 0
 s_add_u32 s12, s80, 0xc780000
 s_addc_u32 s13, s81, 0
 s_mov_b32 s14, 0x4800
 s_mov_b32 s15, 0x20000
 s_lshl_b32 s25, s16, 10
 s_sub_u32 s28, s25, 0x8000
 s_sub_u32 s29, s25, 0x7000
 s_sub_u32 s30, s25, 0xa000
 s_sub_u32 s31, s25, 0x9000
 s_mul_i32 s24, s16, 6144
 s_mov_b32 s17, s24
 s_mov_b32 s20, 0x409d30fc
 s_mov_b32 s21, 0x409d30fc
 s_mov_b32 s22, 0x3eeff558
 s_mov_b32 s23, 0x3eeff558
 v_lshrrev_b32 v8, 3, v5
 v_and_b32 v9, 1, v5
 v_lshl_add_u32 v8, v8, 1, v9
 v_lshlrev_b32 v8, 10, v8
 v_lshl_add_u32 v8, v4, 8, v8
 v_bfe_u32 v9, v5, 1, 2
 v_lshl_add_u32 v8, v9, 6, v8
 s_lshl_b32 s25, s16, 12
 s_add_u32 s25, s25, 0x18000
 v_add_u32 v8, s25, v8
 v_add_u32 v9, s25, v0
 s_lshl_b32 s25, s18, 10
 v_add_u32 v10, s25, v0
 s_mov_b32 s25, 0x05040100
 s_mov_b32 s26, 0x07060302
 v_mov_b32 v12, 0
 v_mov_b32 v13, 0
 v_mov_b32 v14, 0
 v_mov_b32 v15, 0
 s_waitcnt vmcnt(19)
 v_perm_b32 v128, v114, v112, s25
 v_perm_b32 v129, v118, v116, s25
 v_perm_b32 v130, v122, v120, s25
 v_perm_b32 v131, v126, v124, s25
 ds_write_b128 v8, v[128:131] offset:0
 v_perm_b32 v132, v114, v112, s26
 v_perm_b32 v133, v118, v116, s26
 v_perm_b32 v134, v122, v120, s26
 v_perm_b32 v135, v126, v124, s26
 ds_write_b128 v8, v[132:135] offset:16
 v_perm_b32 v136, v115, v113, s25
 v_perm_b32 v137, v119, v117, s25
 v_perm_b32 v138, v123, v121, s25
 v_perm_b32 v139, v127, v125, s25
 ds_write_b128 v8, v[136:139] offset:32
 v_perm_b32 v140, v115, v113, s26
 v_perm_b32 v141, v119, v117, s26
 v_perm_b32 v142, v123, v121, s26
 v_perm_b32 v143, v127, v125, s26
 ds_write_b128 v8, v[140:143] offset:48
 s_waitcnt lgkmcnt(0)
 ds_read_b128 v[144:147], v9 offset:0
 ds_read_b128 v[148:151], v9 offset:1024
 ds_read_b128 v[152:155], v9 offset:2048
 ds_read_b128 v[156:159], v9 offset:3072
 buffer_store_dwordx4 v[12:15], v10, s[12:15], 0 offen sc1
 s_add_u32 s25, s87, s88
 s_add_u32 s26, s87, s89
 s_add_u32 s27, s26, s88
 s_waitcnt lgkmcnt(3)
 buffer_store_dwordx4 v[144:147], v0, s[40:43], s87 offen sc1
 s_waitcnt lgkmcnt(2)
 buffer_store_dwordx4 v[148:151], v0, s[40:43], s25 offen sc1
 s_waitcnt lgkmcnt(1)
 buffer_store_dwordx4 v[152:155], v0, s[40:43], s26 offen sc1
 s_waitcnt lgkmcnt(0)
 buffer_store_dwordx4 v[156:159], v0, s[40:43], s27 offen sc1
 s_add_u32 m0, s90, 0x22000
 s_add_u32 s91, s60, 384
 buffer_load_dwordx4 v11, s[4:7], s91 offen nt lds
 s_add_u32 m0, s90, 0x22400
 s_add_u32 s91, s60, 6528
 buffer_load_dwordx4 v11, s[4:7], s91 offen nt lds
 s_add_u32 m0, s90, 0x24000
 s_add_u32 s91, s60, 512
 buffer_load_dwordx4 v11, s[4:7], s91 offen nt lds
 s_add_u32 m0, s90, 0x24400
 s_add_u32 s91, s60, 6656
 buffer_load_dwordx4 v11, s[4:7], s91 offen nt lds
 s_add_u32 m0, s90, 0x26000
 s_add_u32 s91, s60, 640
 buffer_load_dwordx4 v11, s[4:7], s91 offen nt lds
 s_add_u32 m0, s90, 0x26400
 s_add_u32 s91, s60, 6784
 buffer_load_dwordx4 v11, s[4:7], s91 offen nt lds
 s_waitcnt vmcnt(23)
 v_dot2_f32_bf16 v164, v128, v160, 0
 v_dot2_f32_bf16 v165, v132, v160, 0
 v_dot2_f32_bf16 v166, v136, v160, 0
 v_dot2_f32_bf16 v167, v140, v160, 0
 v_dot2_f32_bf16 v164, v129, v161, v164
 v_dot2_f32_bf16 v165, v133, v161, v165
 v_dot2_f32_bf16 v166, v137, v161, v166
 v_dot2_f32_bf16 v167, v141, v161, v167
 v_dot2_f32_bf16 v164, v130, v162, v164
 v_dot2_f32_bf16 v165, v134, v162, v165
 v_dot2_f32_bf16 v166, v138, v162, v166
 v_dot2_f32_bf16 v167, v142, v162, v167
 v_dot2_f32_bf16 v164, v131, v163, v164
 v_dot2_f32_bf16 v165, v135, v163, v165
 v_dot2_f32_bf16 v166, v139, v163, v166
 v_dot2_f32_bf16 v167, v143, v163, v167
 s_nop 3
 v_permlane16_swap_b32 v164, v165
 v_permlane16_swap_b32 v166, v167
 s_nop 1
 v_add_f32 v164, v164, v165
 v_add_f32 v166, v166, v167
 s_nop 1
 v_permlane32_swap_b32 v164, v166
 s_nop 1
 v_add_f32 v164, v164, v166
 v_accvgpr_write_b32 a192, v164
 s_waitcnt vmcnt(11)
 v_and_b32 v16, 0xffff, v64
 v_and_b32 v64, 0xffff0000, v64
 v_and_b32 v17, 0xffff, v65
 v_and_b32 v65, 0xffff0000, v65
 v_and_b32 v18, 0xffff, v66
 v_and_b32 v66, 0xffff0000, v66
 v_and_b32 v19, 0xffff, v67
 v_and_b32 v67, 0xffff0000, v67
 v_and_b32 v20, 0xffff, v68
 v_and_b32 v68, 0xffff0000, v68
 v_and_b32 v21, 0xffff, v69
 v_and_b32 v69, 0xffff0000, v69
 v_and_b32 v22, 0xffff, v70
 v_and_b32 v70, 0xffff0000, v70
 v_and_b32 v23, 0xffff, v71
 v_and_b32 v71, 0xffff0000, v71
 v_and_b32 v24, 0xffff, v72
 v_and_b32 v72, 0xffff0000, v72
 v_and_b32 v25, 0xffff, v73
 v_and_b32 v73, 0xffff0000, v73
 v_and_b32 v26, 0xffff, v74
 v_and_b32 v74, 0xffff0000, v74
 v_and_b32 v27, 0xffff, v75
 v_and_b32 v75, 0xffff0000, v75
 v_and_b32 v28, 0xffff, v76
 v_and_b32 v76, 0xffff0000, v76
 v_and_b32 v29, 0xffff, v77
 v_and_b32 v77, 0xffff0000, v77
 v_and_b32 v30, 0xffff, v78
 v_and_b32 v78, 0xffff0000, v78
 v_and_b32 v31, 0xffff, v79
 v_and_b32 v79, 0xffff0000, v79
 v_and_b32 v32, 0xffff, v80
 v_and_b32 v80, 0xffff0000, v80
 v_and_b32 v33, 0xffff, v81
 v_and_b32 v81, 0xffff0000, v81
 v_and_b32 v34, 0xffff, v82
 v_and_b32 v82, 0xffff0000, v82
 v_and_b32 v35, 0xffff, v83
 v_and_b32 v83, 0xffff0000, v83
 v_and_b32 v36, 0xffff, v84
 v_and_b32 v84, 0xffff0000, v84
 v_and_b32 v37, 0xffff, v85
 v_and_b32 v85, 0xffff0000, v85
 v_and_b32 v38, 0xffff, v86
 v_and_b32 v86, 0xffff0000, v86
 v_and_b32 v39, 0xffff, v87
 v_and_b32 v87, 0xffff0000, v87
 v_and_b32 v40, 0xffff, v88
 v_and_b32 v88, 0xffff0000, v88
 v_and_b32 v41, 0xffff, v89
 v_and_b32 v89, 0xffff0000, v89
 v_and_b32 v42, 0xffff, v90
 v_and_b32 v90, 0xffff0000, v90
 v_and_b32 v43, 0xffff, v91
 v_and_b32 v91, 0xffff0000, v91
 v_and_b32 v44, 0xffff, v92
 v_and_b32 v92, 0xffff0000, v92
 v_and_b32 v45, 0xffff, v93
 v_and_b32 v93, 0xffff0000, v93
 v_and_b32 v46, 0xffff, v94
 v_and_b32 v94, 0xffff0000, v94
 v_and_b32 v47, 0xffff, v95
 v_and_b32 v95, 0xffff0000, v95
 v_and_b32 v48, 0xffff, v96
 v_and_b32 v96, 0xffff0000, v96
 v_and_b32 v49, 0xffff, v97
 v_and_b32 v97, 0xffff0000, v97
 v_and_b32 v50, 0xffff, v98
 v_and_b32 v98, 0xffff0000, v98
 v_and_b32 v51, 0xffff, v99
 v_and_b32 v99, 0xffff0000, v99
 v_and_b32 v52, 0xffff, v100
 v_and_b32 v100, 0xffff0000, v100
 v_and_b32 v53, 0xffff, v101
 v_and_b32 v101, 0xffff0000, v101
 v_and_b32 v54, 0xffff, v102
 v_and_b32 v102, 0xffff0000, v102
 v_and_b32 v55, 0xffff, v103
 v_and_b32 v103, 0xffff0000, v103
 v_and_b32 v56, 0xffff, v104
 v_and_b32 v104, 0xffff0000, v104
 v_and_b32 v57, 0xffff, v105
 v_and_b32 v105, 0xffff0000, v105
 v_and_b32 v58, 0xffff, v106
 v_and_b32 v106, 0xffff0000, v106
 v_and_b32 v59, 0xffff, v107
 v_and_b32 v107, 0xffff0000, v107
 v_and_b32 v60, 0xffff, v108
 v_and_b32 v108, 0xffff0000, v108
 v_and_b32 v61, 0xffff, v109
 v_and_b32 v109, 0xffff0000, v109
 v_and_b32 v62, 0xffff, v110
 v_and_b32 v110, 0xffff0000, v110
 v_and_b32 v63, 0xffff, v111
 v_and_b32 v111, 0xffff0000, v111
 s_waitcnt vmcnt(6)
 s_barrier
 s_cmp_lg_u32 s16, 0
 s_cbranch_scc1 L_sigA_nosig
 s_lshr_b32 s25, s2, 3
 s_and_b32 s25, s25, 3
 s_lshl_b32 s25, s25, 6
 v_mov_b32 v208, 1
 v_mov_b32 v209, s25
 s_mov_b64 exec, 1
 buffer_atomic_add v208, v209, s[48:51], 0 offen sc1
 s_mov_b64 exec, -1
L_sigA_nosig:
 s_add_u32 m0, s90, 0xc000
 s_add_u32 s91, s61, 0
 buffer_load_dwordx4 v11, s[4:7], s91 offen nt lds
 s_add_u32 m0, s90, 0xc400
 s_add_u32 s91, s61, 6144
 buffer_load_dwordx4 v11, s[4:7], s91 offen nt lds
 s_add_u32 m0, s90, 0xe000
 s_add_u32 s91, s61, 128
 buffer_load_dwordx4 v11, s[4:7], s91 offen nt lds
 s_add_u32 m0, s90, 0xe400
 s_add_u32 s91, s61, 6272
 buffer_load_dwordx4 v11, s[4:7], s91 offen nt lds
 s_add_u32 m0, s90, 0x10000
 s_add_u32 s91, s61, 256
 buffer_load_dwordx4 v11, s[4:7], s91 offen nt lds
 s_add_u32 m0, s90, 0x10400
 s_add_u32 s91, s61, 6400
 buffer_load_dwordx4 v11, s[4:7], s91 offen nt lds
 v_and_b32 v8, 7, v5
 v_xor_b32 v9, v8, v4
 v_lshlrev_b32 v9, 4, v9
 v_lshl_add_u32 v9, v5, 7, v9
 v_add_u32 v12, s90, v9
 v_xor_b32 v13, 64, v12
 v_add_u32 v14, 0x1c000, v12
 v_add_u32 v15, 0x1c000, v13
 ds_read_b128 v[208:211], v14 offset:0
 ds_read_b128 v[212:215], v15 offset:0
 ds_read_b128 v[216:219], v14 offset:8192
 ds_read_b128 v[220:223], v15 offset:8192
 s_waitcnt lgkmcnt(3)
 v_dot2_f32_bf16 v112, v208, v16, 0
 v_dot2_f32_bf16 v113, v208, v64, 0
 v_dot2_f32_bf16 v114, v209, v17, 0
 v_dot2_f32_bf16 v115, v209, v65, 0
 v_dot2_f32_bf16 v116, v210, v18, 0
 v_dot2_f32_bf16 v117, v210, v66, 0
 v_dot2_f32_bf16 v118, v211, v19, 0
 v_dot2_f32_bf16 v119, v211, v67, 0
 s_nop 2
 v_pk_add_f32 v[2:3], v[112:113], v[116:117]
 v_pk_mul_f32 v[6:7], v[112:113], v[112:113]
 v_pk_add_f32 v[4:5], v[114:115], v[118:119]
 v_pk_mul_f32 v[8:9], v[114:115], v[114:115]
 v_pk_fma_f32 v[6:7], v[116:117], v[116:117], v[6:7]
 v_pk_fma_f32 v[8:9], v[118:119], v[118:119], v[8:9]
 s_waitcnt lgkmcnt(2)
 v_dot2_f32_bf16 v120, v212, v20, 0
 v_dot2_f32_bf16 v121, v212, v68, 0
 v_dot2_f32_bf16 v122, v213, v21, 0
 v_dot2_f32_bf16 v123, v213, v69, 0
 v_dot2_f32_bf16 v124, v214, v22, 0
 v_dot2_f32_bf16 v125, v214, v70, 0
 v_dot2_f32_bf16 v126, v215, v23, 0
 v_dot2_f32_bf16 v127, v215, v71, 0
 v_pk_add_f32 v[2:3], v[2:3], v[120:121]
 v_pk_fma_f32 v[6:7], v[120:121], v[120:121], v[6:7]
 v_pk_add_f32 v[4:5], v[4:5], v[122:123]
 v_pk_fma_f32 v[8:9], v[122:123], v[122:123], v[8:9]
 v_pk_add_f32 v[2:3], v[2:3], v[124:125]
 v_pk_fma_f32 v[6:7], v[124:125], v[124:125], v[6:7]
 v_pk_add_f32 v[4:5], v[4:5], v[126:127]
 v_pk_fma_f32 v[8:9], v[126:127], v[126:127], v[8:9]
 ds_read_b128 v[224:227], v14 offset:16384
 ds_read_b128 v[228:231], v15 offset:16384
 s_waitcnt lgkmcnt(3)
 v_dot2_f32_bf16 v128, v216, v24, 0
 v_dot2_f32_bf16 v129, v216, v72, 0
 v_dot2_f32_bf16 v130, v217, v25, 0
 v_dot2_f32_bf16 v131, v217, v73, 0
 v_dot2_f32_bf16 v132, v218, v26, 0
 v_dot2_f32_bf16 v133, v218, v74, 0
 v_dot2_f32_bf16 v134, v219, v27, 0
 v_dot2_f32_bf16 v135, v219, v75, 0
 v_pk_add_f32 v[2:3], v[2:3], v[128:129]
 v_pk_fma_f32 v[6:7], v[128:129], v[128:129], v[6:7]
 v_pk_add_f32 v[4:5], v[4:5], v[130:131]
 v_pk_fma_f32 v[8:9], v[130:131], v[130:131], v[8:9]
 v_pk_add_f32 v[2:3], v[2:3], v[132:133]
 v_pk_fma_f32 v[6:7], v[132:133], v[132:133], v[6:7]
 v_pk_add_f32 v[4:5], v[4:5], v[134:135]
 v_pk_fma_f32 v[8:9], v[134:135], v[134:135], v[8:9]
 s_waitcnt lgkmcnt(2)
 v_dot2_f32_bf16 v136, v220, v28, 0
 v_dot2_f32_bf16 v137, v220, v76, 0
 v_dot2_f32_bf16 v138, v221, v29, 0
 v_dot2_f32_bf16 v139, v221, v77, 0
 v_dot2_f32_bf16 v140, v222, v30, 0
 v_dot2_f32_bf16 v141, v222, v78, 0
 v_dot2_f32_bf16 v142, v223, v31, 0
 v_dot2_f32_bf16 v143, v223, v79, 0
 v_pk_add_f32 v[2:3], v[2:3], v[136:137]
 v_pk_fma_f32 v[6:7], v[136:137], v[136:137], v[6:7]
 v_pk_add_f32 v[4:5], v[4:5], v[138:139]
 v_pk_fma_f32 v[8:9], v[138:139], v[138:139], v[8:9]
 v_pk_add_f32 v[2:3], v[2:3], v[140:141]
 v_pk_fma_f32 v[6:7], v[140:141], v[140:141], v[6:7]
 v_pk_add_f32 v[4:5], v[4:5], v[142:143]
 v_pk_fma_f32 v[8:9], v[142:143], v[142:143], v[8:9]
 s_waitcnt vmcnt(10)
 ds_read_b128 v[232:235], v14 offset:24576
 ds_read_b128 v[236:239], v15 offset:24576
 s_add_u32 m0, s90, 0x12000
 s_add_u32 s91, s61, 384
 buffer_load_dwordx4 v11, s[4:7], s91 offen nt lds
 s_add_u32 m0, s90, 0x12400
 s_add_u32 s91, s61, 6528
 buffer_load_dwordx4 v11, s[4:7], s91 offen nt lds
 s_waitcnt lgkmcnt(3)
 v_dot2_f32_bf16 v144, v224, v32, 0
 v_dot2_f32_bf16 v145, v224, v80, 0
 v_dot2_f32_bf16 v146, v225, v33, 0
 v_dot2_f32_bf16 v147, v225, v81, 0
 v_dot2_f32_bf16 v148, v226, v34, 0
 v_dot2_f32_bf16 v149, v226, v82, 0
 v_dot2_f32_bf16 v150, v227, v35, 0
 v_dot2_f32_bf16 v151, v227, v83, 0
 v_pk_add_f32 v[2:3], v[2:3], v[144:145]
 v_pk_fma_f32 v[6:7], v[144:145], v[144:145], v[6:7]
 v_pk_add_f32 v[4:5], v[4:5], v[146:147]
 v_pk_fma_f32 v[8:9], v[146:147], v[146:147], v[8:9]
 v_pk_add_f32 v[2:3], v[2:3], v[148:149]
 v_pk_fma_f32 v[6:7], v[148:149], v[148:149], v[6:7]
 v_pk_add_f32 v[4:5], v[4:5], v[150:151]
 v_pk_fma_f32 v[8:9], v[150:151], v[150:151], v[8:9]
 s_waitcnt lgkmcnt(2)
 v_dot2_f32_bf16 v152, v228, v36, 0
 v_dot2_f32_bf16 v153, v228, v84, 0
 v_dot2_f32_bf16 v154, v229, v37, 0
 v_dot2_f32_bf16 v155, v229, v85, 0
 v_dot2_f32_bf16 v156, v230, v38, 0
 v_dot2_f32_bf16 v157, v230, v86, 0
 v_dot2_f32_bf16 v158, v231, v39, 0
 v_dot2_f32_bf16 v159, v231, v87, 0
 v_pk_add_f32 v[2:3], v[2:3], v[152:153]
 v_pk_fma_f32 v[6:7], v[152:153], v[152:153], v[6:7]
 v_pk_add_f32 v[4:5], v[4:5], v[154:155]
 v_pk_fma_f32 v[8:9], v[154:155], v[154:155], v[8:9]
 v_pk_add_f32 v[2:3], v[2:3], v[156:157]
 v_pk_fma_f32 v[6:7], v[156:157], v[156:157], v[6:7]
 v_pk_add_f32 v[4:5], v[4:5], v[158:159]
 v_pk_fma_f32 v[8:9], v[158:159], v[158:159], v[8:9]
 s_waitcnt vmcnt(10)
 ds_read_b128 v[240:243], v14 offset:32768
 ds_read_b128 v[244:247], v15 offset:32768
 s_add_u32 m0, s90, 0x14000
 s_add_u32 s91, s61, 512
 buffer_load_dwordx4 v11, s[4:7], s91 offen nt lds
 s_add_u32 m0, s90, 0x14400
 s_add_u32 s91, s61, 6656
 buffer_load_dwordx4 v11, s[4:7], s91 offen nt lds
 s_waitcnt lgkmcnt(3)
 v_dot2_f32_bf16 v160, v232, v40, 0
 v_dot2_f32_bf16 v161, v232, v88, 0
 v_dot2_f32_bf16 v162, v233, v41, 0
 v_dot2_f32_bf16 v163, v233, v89, 0
 v_dot2_f32_bf16 v164, v234, v42, 0
 v_dot2_f32_bf16 v165, v234, v90, 0
 v_dot2_f32_bf16 v166, v235, v43, 0
 v_dot2_f32_bf16 v167, v235, v91, 0
 v_pk_add_f32 v[2:3], v[2:3], v[160:161]
 v_pk_fma_f32 v[6:7], v[160:161], v[160:161], v[6:7]
 v_pk_add_f32 v[4:5], v[4:5], v[162:163]
 v_pk_fma_f32 v[8:9], v[162:163], v[162:163], v[8:9]
 v_pk_add_f32 v[2:3], v[2:3], v[164:165]
 v_pk_fma_f32 v[6:7], v[164:165], v[164:165], v[6:7]
 v_pk_add_f32 v[4:5], v[4:5], v[166:167]
 v_pk_fma_f32 v[8:9], v[166:167], v[166:167], v[8:9]
 s_waitcnt lgkmcnt(2)
 v_dot2_f32_bf16 v168, v236, v44, 0
 v_dot2_f32_bf16 v169, v236, v92, 0
 v_dot2_f32_bf16 v170, v237, v45, 0
 v_dot2_f32_bf16 v171, v237, v93, 0
 v_dot2_f32_bf16 v172, v238, v46, 0
 v_dot2_f32_bf16 v173, v238, v94, 0
 v_dot2_f32_bf16 v174, v239, v47, 0
 v_dot2_f32_bf16 v175, v239, v95, 0
 v_pk_add_f32 v[2:3], v[2:3], v[168:169]
 v_pk_fma_f32 v[6:7], v[168:169], v[168:169], v[6:7]
 v_pk_add_f32 v[4:5], v[4:5], v[170:171]
 v_pk_fma_f32 v[8:9], v[170:171], v[170:171], v[8:9]
 v_pk_add_f32 v[2:3], v[2:3], v[172:173]
 v_pk_fma_f32 v[6:7], v[172:173], v[172:173], v[6:7]
 v_pk_add_f32 v[4:5], v[4:5], v[174:175]
 v_pk_fma_f32 v[8:9], v[174:175], v[174:175], v[8:9]
 s_waitcnt vmcnt(10)
 ds_read_b128 v[248:251], v14 offset:40960
 ds_read_b128 v[252:255], v15 offset:40960
 s_add_u32 m0, s90, 0x16000
 s_add_u32 s91, s61, 640
 buffer_load_dwordx4 v11, s[4:7], s91 offen nt lds
 s_add_u32 m0, s90, 0x16400
 s_add_u32 s91, s61, 6784
 buffer_load_dwordx4 v11, s[4:7], s91 offen nt lds
 s_waitcnt lgkmcnt(3)
 v_dot2_f32_bf16 v176, v240, v48, 0
 v_dot2_f32_bf16 v177, v240, v96, 0
 v_dot2_f32_bf16 v178, v241, v49, 0
 v_dot2_f32_bf16 v179, v241, v97, 0
 v_dot2_f32_bf16 v180, v242, v50, 0
 v_dot2_f32_bf16 v181, v242, v98, 0
 v_dot2_f32_bf16 v182, v243, v51, 0
 v_dot2_f32_bf16 v183, v243, v99, 0
 v_pk_add_f32 v[2:3], v[2:3], v[176:177]
 v_pk_fma_f32 v[6:7], v[176:177], v[176:177], v[6:7]
 v_pk_add_f32 v[4:5], v[4:5], v[178:179]
 v_pk_fma_f32 v[8:9], v[178:179], v[178:179], v[8:9]
 v_pk_add_f32 v[2:3], v[2:3], v[180:181]
 v_pk_fma_f32 v[6:7], v[180:181], v[180:181], v[6:7]
 v_pk_add_f32 v[4:5], v[4:5], v[182:183]
 v_pk_fma_f32 v[8:9], v[182:183], v[182:183], v[8:9]
 s_waitcnt lgkmcnt(2)
 v_dot2_f32_bf16 v184, v244, v52, 0
 v_dot2_f32_bf16 v185, v244, v100, 0
 v_dot2_f32_bf16 v186, v245, v53, 0
 v_dot2_f32_bf16 v187, v245, v101, 0
 v_dot2_f32_bf16 v188, v246, v54, 0
 v_dot2_f32_bf16 v189, v246, v102, 0
 v_dot2_f32_bf16 v190, v247, v55, 0
 v_dot2_f32_bf16 v191, v247, v103, 0
 v_pk_add_f32 v[2:3], v[2:3], v[184:185]
 v_pk_fma_f32 v[6:7], v[184:185], v[184:185], v[6:7]
 v_pk_add_f32 v[4:5], v[4:5], v[186:187]
 v_pk_fma_f32 v[8:9], v[186:187], v[186:187], v[8:9]
 v_pk_add_f32 v[2:3], v[2:3], v[188:189]
 v_pk_fma_f32 v[6:7], v[188:189], v[188:189], v[6:7]
 v_pk_add_f32 v[4:5], v[4:5], v[190:191]
 v_pk_fma_f32 v[8:9], v[190:191], v[190:191], v[8:9]
 s_waitcnt lgkmcnt(1)
 v_dot2_f32_bf16 v192, v248, v56, 0
 v_dot2_f32_bf16 v193, v248, v104, 0
 v_dot2_f32_bf16 v194, v249, v57, 0
 v_dot2_f32_bf16 v195, v249, v105, 0
 v_dot2_f32_bf16 v196, v250, v58, 0
 v_dot2_f32_bf16 v197, v250, v106, 0
 v_dot2_f32_bf16 v198, v251, v59, 0
 v_dot2_f32_bf16 v199, v251, v107, 0
 v_pk_add_f32 v[2:3], v[2:3], v[192:193]
 v_pk_fma_f32 v[6:7], v[192:193], v[192:193], v[6:7]
 v_pk_add_f32 v[4:5], v[4:5], v[194:195]
 v_pk_fma_f32 v[8:9], v[194:195], v[194:195], v[8:9]
 v_pk_add_f32 v[2:3], v[2:3], v[196:197]
 v_pk_fma_f32 v[6:7], v[196:197], v[196:197], v[6:7]
 v_pk_add_f32 v[4:5], v[4:5], v[198:199]
 v_pk_fma_f32 v[8:9], v[198:199], v[198:199], v[8:9]
 s_waitcnt lgkmcnt(0)
 v_dot2_f32_bf16 v200, v252, v60, 0
 v_dot2_f32_bf16 v201, v252, v108, 0
 v_dot2_f32_bf16 v202, v253, v61, 0
 v_dot2_f32_bf16 v203, v253, v109, 0
 v_dot2_f32_bf16 v204, v254, v62, 0
 v_dot2_f32_bf16 v205, v254, v110, 0
 v_dot2_f32_bf16 v206, v255, v63, 0
 v_dot2_f32_bf16 v207, v255, v111, 0
 v_pk_add_f32 v[2:3], v[2:3], v[200:201]
 v_pk_fma_f32 v[6:7], v[200:201], v[200:201], v[6:7]
 v_pk_add_f32 v[4:5], v[4:5], v[202:203]
 v_pk_fma_f32 v[8:9], v[202:203], v[202:203], v[8:9]
 v_pk_add_f32 v[2:3], v[2:3], v[204:205]
 v_pk_fma_f32 v[6:7], v[204:205], v[204:205], v[6:7]
 v_pk_add_f32 v[4:5], v[4:5], v[206:207]
 v_pk_fma_f32 v[8:9], v[206:207], v[206:207], v[8:9]
 v_pk_add_f32 v[2:3], v[2:3], v[4:5]
 v_pk_add_f32 v[6:7], v[6:7], v[8:9]
 v_add_f32 v2, v2, v3
 v_add_f32 v6, v6, v7
 v_mov_b32 v4, v2
 v_mov_b32 v8, v6
 s_nop 1
 v_permlane16_swap_b32 v2, v4
 v_permlane16_swap_b32 v6, v8
 s_nop 1
 v_add_f32 v2, v2, v4
 v_add_f32 v6, v6, v8
 v_mov_b32 v4, v2
 v_mov_b32 v8, v6
 s_nop 1
 v_permlane32_swap_b32 v2, v4
 v_permlane32_swap_b32 v6, v8
 s_nop 1
 v_add_f32 v2, v2, v4
 v_add_f32 v6, v6, v8
 v_mul_f32 v2, 0x3b2aaaab, v2
 v_mul_f32 v6, 0x3b2aaaab, v6
 v_fma_f32 v6, -v2, v2, v6
 v_max_f32 v6, 0, v6
 v_cvt_pk_bf16_f32 v4, v2, v6
 v_lshlrev_b32 v2, 16, v4
 v_and_b32 v6, 0xffff0000, v4
 v_add_f32 v6, 0x3727c5ac, v6
 v_cvt_pk_bf16_f32 v6, v6, v6
 v_and_b32 v6, 0xffff0000, v6
 v_sqrt_f32 v6, v6
 s_nop 0
 v_cvt_pk_bf16_f32 v6, v6, v6
 v_and_b32 v6, 0xffff0000, v6
 v_rcp_f32 v6, v6
 s_nop 0
 v_mul_f32 v8, s22, v6
 v_mul_f32_e64 v9, -v2, v8
 s_nop 0
 v_pk_fma_f32 v[112:113], v[112:113], v[8:9], v[8:9] op_sel:[0,0,1] op_sel_hi:[1,0,1]
 v_pk_fma_f32 v[114:115], v[114:115], v[8:9], v[8:9] op_sel:[0,0,1] op_sel_hi:[1,0,1]
 v_pk_fma_f32 v[116:117], v[116:117], v[8:9], v[8:9] op_sel:[0,0,1] op_sel_hi:[1,0,1]
 v_pk_fma_f32 v[118:119], v[118:119], v[8:9], v[8:9] op_sel:[0,0,1] op_sel_hi:[1,0,1]
 v_cvt_pk_bf16_f32 v2, v112, v113
 v_cvt_pk_bf16_f32 v3, v114, v115
 v_cvt_pk_bf16_f32 v4, v116, v117
 v_cvt_pk_bf16_f32 v5, v118, v119
 v_accvgpr_write_b32 a0, v2
 v_accvgpr_write_b32 a1, v3
 v_accvgpr_write_b32 a2, v4
 v_accvgpr_write_b32 a3, v5
 v_pk_fma_f32 v[120:121], v[120:121], v[8:9], v[8:9] op_sel:[0,0,1] op_sel_hi:[1,0,1]
 v_pk_fma_f32 v[122:123], v[122:123], v[8:9], v[8:9] op_sel:[0,0,1] op_sel_hi:[1,0,1]
 v_pk_fma_f32 v[124:125], v[124:125], v[8:9], v[8:9] op_sel:[0,0,1] op_sel_hi:[1,0,1]
 v_pk_fma_f32 v[126:127], v[126:127], v[8:9], v[8:9] op_sel:[0,0,1] op_sel_hi:[1,0,1]
 v_cvt_pk_bf16_f32 v2, v120, v121
 v_cvt_pk_bf16_f32 v3, v122, v123
 v_cvt_pk_bf16_f32 v4, v124, v125
 v_cvt_pk_bf16_f32 v5, v126, v127
 v_accvgpr_write_b32 a4, v2
 v_accvgpr_write_b32 a5, v3
 v_accvgpr_write_b32 a6, v4
 v_accvgpr_write_b32 a7, v5
 v_pk_fma_f32 v[128:129], v[128:129], v[8:9], v[8:9] op_sel:[0,0,1] op_sel_hi:[1,0,1]
 v_pk_fma_f32 v[130:131], v[130:131], v[8:9], v[8:9] op_sel:[0,0,1] op_sel_hi:[1,0,1]
 v_pk_fma_f32 v[132:133], v[132:133], v[8:9], v[8:9] op_sel:[0,0,1] op_sel_hi:[1,0,1]
 v_pk_fma_f32 v[134:135], v[134:135], v[8:9], v[8:9] op_sel:[0,0,1] op_sel_hi:[1,0,1]
 v_cvt_pk_bf16_f32 v2, v128, v129
 v_cvt_pk_bf16_f32 v3, v130, v131
 v_cvt_pk_bf16_f32 v4, v132, v133
 v_cvt_pk_bf16_f32 v5, v134, v135
 v_accvgpr_write_b32 a8, v2
 v_accvgpr_write_b32 a9, v3
 v_accvgpr_write_b32 a10, v4
 v_accvgpr_write_b32 a11, v5
 v_pk_fma_f32 v[136:137], v[136:137], v[8:9], v[8:9] op_sel:[0,0,1] op_sel_hi:[1,0,1]
 v_pk_fma_f32 v[138:139], v[138:139], v[8:9], v[8:9] op_sel:[0,0,1] op_sel_hi:[1,0,1]
 v_pk_fma_f32 v[140:141], v[140:141], v[8:9], v[8:9] op_sel:[0,0,1] op_sel_hi:[1,0,1]
 v_pk_fma_f32 v[142:143], v[142:143], v[8:9], v[8:9] op_sel:[0,0,1] op_sel_hi:[1,0,1]
 v_cvt_pk_bf16_f32 v2, v136, v137
 v_cvt_pk_bf16_f32 v3, v138, v139
 v_cvt_pk_bf16_f32 v4, v140, v141
 v_cvt_pk_bf16_f32 v5, v142, v143
 v_accvgpr_write_b32 a12, v2
 v_accvgpr_write_b32 a13, v3
 v_accvgpr_write_b32 a14, v4
 v_accvgpr_write_b32 a15, v5
 v_pk_fma_f32 v[144:145], v[144:145], v[8:9], v[8:9] op_sel:[0,0,1] op_sel_hi:[1,0,1]
 v_pk_fma_f32 v[146:147], v[146:147], v[8:9], v[8:9] op_sel:[0,0,1] op_sel_hi:[1,0,1]
 v_pk_fma_f32 v[148:149], v[148:149], v[8:9], v[8:9] op_sel:[0,0,1] op_sel_hi:[1,0,1]
 v_pk_fma_f32 v[150:151], v[150:151], v[8:9], v[8:9] op_sel:[0,0,1] op_sel_hi:[1,0,1]
 v_cvt_pk_bf16_f32 v2, v144, v145
 v_cvt_pk_bf16_f32 v3, v146, v147
 v_cvt_pk_bf16_f32 v4, v148, v149
 v_cvt_pk_bf16_f32 v5, v150, v151
 v_accvgpr_write_b32 a16, v2
 v_accvgpr_write_b32 a17, v3
 v_accvgpr_write_b32 a18, v4
 v_accvgpr_write_b32 a19, v5
 v_pk_fma_f32 v[152:153], v[152:153], v[8:9], v[8:9] op_sel:[0,0,1] op_sel_hi:[1,0,1]
 v_pk_fma_f32 v[154:155], v[154:155], v[8:9], v[8:9] op_sel:[0,0,1] op_sel_hi:[1,0,1]
 v_pk_fma_f32 v[156:157], v[156:157], v[8:9], v[8:9] op_sel:[0,0,1] op_sel_hi:[1,0,1]
 v_pk_fma_f32 v[158:159], v[158:159], v[8:9], v[8:9] op_sel:[0,0,1] op_sel_hi:[1,0,1]
 v_cvt_pk_bf16_f32 v2, v152, v153
 v_cvt_pk_bf16_f32 v3, v154, v155
 v_cvt_pk_bf16_f32 v4, v156, v157
 v_cvt_pk_bf16_f32 v5, v158, v159
 v_accvgpr_write_b32 a20, v2
 v_accvgpr_write_b32 a21, v3
 v_accvgpr_write_b32 a22, v4
 v_accvgpr_write_b32 a23, v5
 v_pk_fma_f32 v[160:161], v[160:161], v[8:9], v[8:9] op_sel:[0,0,1] op_sel_hi:[1,0,1]
 v_pk_fma_f32 v[162:163], v[162:163], v[8:9], v[8:9] op_sel:[0,0,1] op_sel_hi:[1,0,1]
 v_pk_fma_f32 v[164:165], v[164:165], v[8:9], v[8:9] op_sel:[0,0,1] op_sel_hi:[1,0,1]
 v_pk_fma_f32 v[166:167], v[166:167], v[8:9], v[8:9] op_sel:[0,0,1] op_sel_hi:[1,0,1]
 v_cvt_pk_bf16_f32 v2, v160, v161
 v_cvt_pk_bf16_f32 v3, v162, v163
 v_cvt_pk_bf16_f32 v4, v164, v165
 v_cvt_pk_bf16_f32 v5, v166, v167
 v_accvgpr_write_b32 a24, v2
 v_accvgpr_write_b32 a25, v3
 v_accvgpr_write_b32 a26, v4
 v_accvgpr_write_b32 a27, v5
 v_pk_fma_f32 v[168:169], v[168:169], v[8:9], v[8:9] op_sel:[0,0,1] op_sel_hi:[1,0,1]
 v_pk_fma_f32 v[170:171], v[170:171], v[8:9], v[8:9] op_sel:[0,0,1] op_sel_hi:[1,0,1]
 v_pk_fma_f32 v[172:173], v[172:173], v[8:9], v[8:9] op_sel:[0,0,1] op_sel_hi:[1,0,1]
 v_pk_fma_f32 v[174:175], v[174:175], v[8:9], v[8:9] op_sel:[0,0,1] op_sel_hi:[1,0,1]
 v_cvt_pk_bf16_f32 v2, v168, v169
 v_cvt_pk_bf16_f32 v3, v170, v171
 v_cvt_pk_bf16_f32 v4, v172, v173
 v_cvt_pk_bf16_f32 v5, v174, v175
 v_accvgpr_write_b32 a28, v2
 v_accvgpr_write_b32 a29, v3
 v_accvgpr_write_b32 a30, v4
 v_accvgpr_write_b32 a31, v5
 v_pk_fma_f32 v[176:177], v[176:177], v[8:9], v[8:9] op_sel:[0,0,1] op_sel_hi:[1,0,1]
 v_pk_fma_f32 v[178:179], v[178:179], v[8:9], v[8:9] op_sel:[0,0,1] op_sel_hi:[1,0,1]
 v_pk_fma_f32 v[180:181], v[180:181], v[8:9], v[8:9] op_sel:[0,0,1] op_sel_hi:[1,0,1]
 v_pk_fma_f32 v[182:183], v[182:183], v[8:9], v[8:9] op_sel:[0,0,1] op_sel_hi:[1,0,1]
 v_cvt_pk_bf16_f32 v2, v176, v177
 v_cvt_pk_bf16_f32 v3, v178, v179
 v_cvt_pk_bf16_f32 v4, v180, v181
 v_cvt_pk_bf16_f32 v5, v182, v183
 v_accvgpr_write_b32 a32, v2
 v_accvgpr_write_b32 a33, v3
 v_accvgpr_write_b32 a34, v4
 v_accvgpr_write_b32 a35, v5
 v_pk_fma_f32 v[184:185], v[184:185], v[8:9], v[8:9] op_sel:[0,0,1] op_sel_hi:[1,0,1]
 v_pk_fma_f32 v[186:187], v[186:187], v[8:9], v[8:9] op_sel:[0,0,1] op_sel_hi:[1,0,1]
 v_pk_fma_f32 v[188:189], v[188:189], v[8:9], v[8:9] op_sel:[0,0,1] op_sel_hi:[1,0,1]
 v_pk_fma_f32 v[190:191], v[190:191], v[8:9], v[8:9] op_sel:[0,0,1] op_sel_hi:[1,0,1]
 v_cvt_pk_bf16_f32 v2, v184, v185
 v_cvt_pk_bf16_f32 v3, v186, v187
 v_cvt_pk_bf16_f32 v4, v188, v189
 v_cvt_pk_bf16_f32 v5, v190, v191
 v_accvgpr_write_b32 a36, v2
 v_accvgpr_write_b32 a37, v3
 v_accvgpr_write_b32 a38, v4
 v_accvgpr_write_b32 a39, v5
 v_pk_fma_f32 v[192:193], v[192:193], v[8:9], v[8:9] op_sel:[0,0,1] op_sel_hi:[1,0,1]
 v_pk_fma_f32 v[194:195], v[194:195], v[8:9], v[8:9] op_sel:[0,0,1] op_sel_hi:[1,0,1]
 v_pk_fma_f32 v[196:197], v[196:197], v[8:9], v[8:9] op_sel:[0,0,1] op_sel_hi:[1,0,1]
 v_pk_fma_f32 v[198:199], v[198:199], v[8:9], v[8:9] op_sel:[0,0,1] op_sel_hi:[1,0,1]
 v_cvt_pk_bf16_f32 v2, v192, v193
 v_cvt_pk_bf16_f32 v3, v194, v195
 v_cvt_pk_bf16_f32 v4, v196, v197
 v_cvt_pk_bf16_f32 v5, v198, v199
 v_accvgpr_write_b32 a40, v2
 v_accvgpr_write_b32 a41, v3
 v_accvgpr_write_b32 a42, v4
 v_accvgpr_write_b32 a43, v5
 v_pk_fma_f32 v[200:201], v[200:201], v[8:9], v[8:9] op_sel:[0,0,1] op_sel_hi:[1,0,1]
 v_pk_fma_f32 v[202:203], v[202:203], v[8:9], v[8:9] op_sel:[0,0,1] op_sel_hi:[1,0,1]
 v_pk_fma_f32 v[204:205], v[204:205], v[8:9], v[8:9] op_sel:[0,0,1] op_sel_hi:[1,0,1]
 v_pk_fma_f32 v[206:207], v[206:207], v[8:9], v[8:9] op_sel:[0,0,1] op_sel_hi:[1,0,1]
 v_cvt_pk_bf16_f32 v2, v200, v201
 v_cvt_pk_bf16_f32 v3, v202, v203
 v_cvt_pk_bf16_f32 v4, v204, v205
 v_cvt_pk_bf16_f32 v5, v206, v207
 v_accvgpr_write_b32 a44, v2
 v_accvgpr_write_b32 a45, v3
 v_accvgpr_write_b32 a46, v4
 v_accvgpr_write_b32 a47, v5
 v_add_u32 v12, 49152, v12
 v_add_u32 v13, 49152, v13
 s_waitcnt vmcnt(10)
 ds_read_b128 a[208:211], v12 offset:0
 ds_read_b128 v[208:211], v12 offset:0
 ds_read_b128 a[212:215], v13 offset:0
 ds_read_b128 v[212:215], v13 offset:0
 s_add_u32 m0, s90, 0x0
 s_add_u32 s91, s62, 0
 buffer_load_dwordx4 v11, s[4:7], s91 offen nt lds
 s_add_u32 m0, s90, 0x400
 s_add_u32 s91, s62, 6144
 buffer_load_dwordx4 v11, s[4:7], s91 offen nt lds
 s_waitcnt vmcnt(10)
 ds_read_b128 a[216:219], v12 offset:8192
 ds_read_b128 v[216:219], v12 offset:8192
 ds_read_b128 a[220:223], v13 offset:8192
 ds_read_b128 v[220:223], v13 offset:8192
 s_add_u32 m0, s90, 0x2000
 s_add_u32 s91, s62, 128
 buffer_load_dwordx4 v11, s[4:7], s91 offen nt lds
 s_add_u32 m0, s90, 0x2400
 s_add_u32 s91, s62, 6272
 buffer_load_dwordx4 v11, s[4:7], s91 offen nt lds
 s_waitcnt lgkmcnt(6)
 v_dot2_f32_bf16 v112, v208, v16, 0
 v_dot2_f32_bf16 v113, v208, v64, 0
 v_dot2_f32_bf16 v114, v209, v17, 0
 v_dot2_f32_bf16 v115, v209, v65, 0
 v_dot2_f32_bf16 v116, v210, v18, 0
 v_dot2_f32_bf16 v117, v210, v66, 0
 v_dot2_f32_bf16 v118, v211, v19, 0
 v_dot2_f32_bf16 v119, v211, v67, 0
 s_nop 2
 v_pk_add_f32 v[2:3], v[112:113], v[116:117]
 v_pk_mul_f32 v[6:7], v[112:113], v[112:113]
 v_pk_add_f32 v[4:5], v[114:115], v[118:119]
 v_pk_mul_f32 v[8:9], v[114:115], v[114:115]
 v_pk_fma_f32 v[6:7], v[116:117], v[116:117], v[6:7]
 v_pk_fma_f32 v[8:9], v[118:119], v[118:119], v[8:9]
 s_waitcnt lgkmcnt(4)
 v_dot2_f32_bf16 v120, v212, v20, 0
 v_dot2_f32_bf16 v121, v212, v68, 0
 v_dot2_f32_bf16 v122, v213, v21, 0
 v_dot2_f32_bf16 v123, v213, v69, 0
 v_dot2_f32_bf16 v124, v214, v22, 0
 v_dot2_f32_bf16 v125, v214, v70, 0
 v_dot2_f32_bf16 v126, v215, v23, 0
 v_dot2_f32_bf16 v127, v215, v71, 0
 v_pk_add_f32 v[2:3], v[2:3], v[120:121]
 v_pk_fma_f32 v[6:7], v[120:121], v[120:121], v[6:7]
 v_pk_add_f32 v[4:5], v[4:5], v[122:123]
 v_pk_fma_f32 v[8:9], v[122:123], v[122:123], v[8:9]
 v_pk_add_f32 v[2:3], v[2:3], v[124:125]
 v_pk_fma_f32 v[6:7], v[124:125], v[124:125], v[6:7]
 v_pk_add_f32 v[4:5], v[4:5], v[126:127]
 v_pk_fma_f32 v[8:9], v[126:127], v[126:127], v[8:9]
 s_waitcnt vmcnt(10)
 ds_read_b128 a[224:227], v12 offset:16384
 ds_read_b128 v[224:227], v12 offset:16384
 ds_read_b128 a[228:231], v13 offset:16384
 ds_read_b128 v[228:231], v13 offset:16384
 s_add_u32 m0, s90, 0x4000
 s_add_u32 s91, s62, 256
 buffer_load_dwordx4 v11, s[4:7], s91 offen nt lds
 s_add_u32 m0, s90, 0x4400
 s_add_u32 s91, s62, 6400
 buffer_load_dwordx4 v11, s[4:7], s91 offen nt lds
 s_waitcnt lgkmcnt(6)
 v_dot2_f32_bf16 v128, v216, v24, 0
 v_dot2_f32_bf16 v129, v216, v72, 0
 v_dot2_f32_bf16 v130, v217, v25, 0
 v_dot2_f32_bf16 v131, v217, v73, 0
 v_dot2_f32_bf16 v132, v218, v26, 0
 v_dot2_f32_bf16 v133, v218, v74, 0
 v_dot2_f32_bf16 v134, v219, v27, 0
 v_dot2_f32_bf16 v135, v219, v75, 0
 v_pk_add_f32 v[2:3], v[2:3], v[128:129]
 v_pk_fma_f32 v[6:7], v[128:129], v[128:129], v[6:7]
 v_pk_add_f32 v[4:5], v[4:5], v[130:131]
 v_pk_fma_f32 v[8:9], v[130:131], v[130:131], v[8:9]
 v_pk_add_f32 v[2:3], v[2:3], v[132:133]
 v_pk_fma_f32 v[6:7], v[132:133], v[132:133], v[6:7]
 v_pk_add_f32 v[4:5], v[4:5], v[134:135]
 v_pk_fma_f32 v[8:9], v[134:135], v[134:135], v[8:9]
 s_waitcnt lgkmcnt(4)
 v_dot2_f32_bf16 v136, v220, v28, 0
 v_dot2_f32_bf16 v137, v220, v76, 0
 v_dot2_f32_bf16 v138, v221, v29, 0
 v_dot2_f32_bf16 v139, v221, v77, 0
 v_dot2_f32_bf16 v140, v222, v30, 0
 v_dot2_f32_bf16 v141, v222, v78, 0
 v_dot2_f32_bf16 v142, v223, v31, 0
 v_dot2_f32_bf16 v143, v223, v79, 0
 v_pk_add_f32 v[2:3], v[2:3], v[136:137]
 v_pk_fma_f32 v[6:7], v[136:137], v[136:137], v[6:7]
 v_pk_add_f32 v[4:5], v[4:5], v[138:139]
 v_pk_fma_f32 v[8:9], v[138:139], v[138:139], v[8:9]
 v_pk_add_f32 v[2:3], v[2:3], v[140:141]
 v_pk_fma_f32 v[6:7], v[140:141], v[140:141], v[6:7]
 v_pk_add_f32 v[4:5], v[4:5], v[142:143]
 v_pk_fma_f32 v[8:9], v[142:143], v[142:143], v[8:9]
 s_waitcnt vmcnt(10)
 ds_read_b128 a[232:235], v12 offset:24576
 ds_read_b128 v[232:235], v12 offset:24576
 ds_read_b128 a[236:239], v13 offset:24576
 ds_read_b128 v[236:239], v13 offset:24576
 s_add_u32 m0, s90, 0x6000
 s_add_u32 s91, s62, 384
 buffer_load_dwordx4 v11, s[4:7], s91 offen nt lds
 s_add_u32 m0, s90, 0x6400
 s_add_u32 s91, s62, 6528
 buffer_load_dwordx4 v11, s[4:7], s91 offen nt lds
 s_waitcnt lgkmcnt(6)
 v_dot2_f32_bf16 v144, v224, v32, 0
 v_dot2_f32_bf16 v145, v224, v80, 0
 v_dot2_f32_bf16 v146, v225, v33, 0
 v_dot2_f32_bf16 v147, v225, v81, 0
 v_dot2_f32_bf16 v148, v226, v34, 0
 v_dot2_f32_bf16 v149, v226, v82, 0
 v_dot2_f32_bf16 v150, v227, v35, 0
 v_dot2_f32_bf16 v151, v227, v83, 0
 v_pk_add_f32 v[2:3], v[2:3], v[144:145]
 v_pk_fma_f32 v[6:7], v[144:145], v[144:145], v[6:7]
 v_pk_add_f32 v[4:5], v[4:5], v[146:147]
 v_pk_fma_f32 v[8:9], v[146:147], v[146:147], v[8:9]
 v_pk_add_f32 v[2:3], v[2:3], v[148:149]
 v_pk_fma_f32 v[6:7], v[148:149], v[148:149], v[6:7]
 v_pk_add_f32 v[4:5], v[4:5], v[150:151]
 v_pk_fma_f32 v[8:9], v[150:151], v[150:151], v[8:9]
 s_waitcnt lgkmcnt(4)
 v_dot2_f32_bf16 v152, v228, v36, 0
 v_dot2_f32_bf16 v153, v228, v84, 0
 v_dot2_f32_bf16 v154, v229, v37, 0
 v_dot2_f32_bf16 v155, v229, v85, 0
 v_dot2_f32_bf16 v156, v230, v38, 0
 v_dot2_f32_bf16 v157, v230, v86, 0
 v_dot2_f32_bf16 v158, v231, v39, 0
 v_dot2_f32_bf16 v159, v231, v87, 0
 v_pk_add_f32 v[2:3], v[2:3], v[152:153]
 v_pk_fma_f32 v[6:7], v[152:153], v[152:153], v[6:7]
 v_pk_add_f32 v[4:5], v[4:5], v[154:155]
 v_pk_fma_f32 v[8:9], v[154:155], v[154:155], v[8:9]
 v_pk_add_f32 v[2:3], v[2:3], v[156:157]
 v_pk_fma_f32 v[6:7], v[156:157], v[156:157], v[6:7]
 v_pk_add_f32 v[4:5], v[4:5], v[158:159]
 v_pk_fma_f32 v[8:9], v[158:159], v[158:159], v[8:9]
 s_waitcnt vmcnt(10)
 ds_read_b128 a[240:243], v12 offset:32768
 ds_read_b128 v[240:243], v12 offset:32768
 ds_read_b128 a[244:247], v13 offset:32768
 ds_read_b128 v[244:247], v13 offset:32768
 s_add_u32 m0, s90, 0x8000
 s_add_u32 s91, s62, 512
 buffer_load_dwordx4 v11, s[4:7], s91 offen nt lds
 s_add_u32 m0, s90, 0x8400
 s_add_u32 s91, s62, 6656
 buffer_load_dwordx4 v11, s[4:7], s91 offen nt lds
 s_waitcnt lgkmcnt(6)
 v_dot2_f32_bf16 v160, v232, v40, 0
 v_dot2_f32_bf16 v161, v232, v88, 0
 v_dot2_f32_bf16 v162, v233, v41, 0
 v_dot2_f32_bf16 v163, v233, v89, 0
 v_dot2_f32_bf16 v164, v234, v42, 0
 v_dot2_f32_bf16 v165, v234, v90, 0
 v_dot2_f32_bf16 v166, v235, v43, 0
 v_dot2_f32_bf16 v167, v235, v91, 0
 v_pk_add_f32 v[2:3], v[2:3], v[160:161]
 v_pk_fma_f32 v[6:7], v[160:161], v[160:161], v[6:7]
 v_pk_add_f32 v[4:5], v[4:5], v[162:163]
 v_pk_fma_f32 v[8:9], v[162:163], v[162:163], v[8:9]
 v_pk_add_f32 v[2:3], v[2:3], v[164:165]
 v_pk_fma_f32 v[6:7], v[164:165], v[164:165], v[6:7]
 v_pk_add_f32 v[4:5], v[4:5], v[166:167]
 v_pk_fma_f32 v[8:9], v[166:167], v[166:167], v[8:9]
 s_waitcnt lgkmcnt(4)
 v_dot2_f32_bf16 v168, v236, v44, 0
 v_dot2_f32_bf16 v169, v236, v92, 0
 v_dot2_f32_bf16 v170, v237, v45, 0
 v_dot2_f32_bf16 v171, v237, v93, 0
 v_dot2_f32_bf16 v172, v238, v46, 0
 v_dot2_f32_bf16 v173, v238, v94, 0
 v_dot2_f32_bf16 v174, v239, v47, 0
 v_dot2_f32_bf16 v175, v239, v95, 0
 v_pk_add_f32 v[2:3], v[2:3], v[168:169]
 v_pk_fma_f32 v[6:7], v[168:169], v[168:169], v[6:7]
 v_pk_add_f32 v[4:5], v[4:5], v[170:171]
 v_pk_fma_f32 v[8:9], v[170:171], v[170:171], v[8:9]
 v_pk_add_f32 v[2:3], v[2:3], v[172:173]
 v_pk_fma_f32 v[6:7], v[172:173], v[172:173], v[6:7]
 v_pk_add_f32 v[4:5], v[4:5], v[174:175]
 v_pk_fma_f32 v[8:9], v[174:175], v[174:175], v[8:9]
 s_waitcnt vmcnt(10)
 ds_read_b128 a[248:251], v12 offset:40960
 ds_read_b128 v[248:251], v12 offset:40960
 ds_read_b128 a[252:255], v13 offset:40960
 ds_read_b128 v[252:255], v13 offset:40960
 s_add_u32 m0, s90, 0xa000
 s_add_u32 s91, s62, 640
 buffer_load_dwordx4 v11, s[4:7], s91 offen nt lds
 s_add_u32 m0, s90, 0xa400
 s_add_u32 s91, s62, 6784
 buffer_load_dwordx4 v11, s[4:7], s91 offen nt lds
 s_waitcnt lgkmcnt(6)
 v_dot2_f32_bf16 v176, v240, v48, 0
 v_dot2_f32_bf16 v177, v240, v96, 0
 v_dot2_f32_bf16 v178, v241, v49, 0
 v_dot2_f32_bf16 v179, v241, v97, 0
 v_dot2_f32_bf16 v180, v242, v50, 0
 v_dot2_f32_bf16 v181, v242, v98, 0
 v_dot2_f32_bf16 v182, v243, v51, 0
 v_dot2_f32_bf16 v183, v243, v99, 0
 v_pk_add_f32 v[2:3], v[2:3], v[176:177]
 v_pk_fma_f32 v[6:7], v[176:177], v[176:177], v[6:7]
 v_pk_add_f32 v[4:5], v[4:5], v[178:179]
 v_pk_fma_f32 v[8:9], v[178:179], v[178:179], v[8:9]
 v_pk_add_f32 v[2:3], v[2:3], v[180:181]
 v_pk_fma_f32 v[6:7], v[180:181], v[180:181], v[6:7]
 v_pk_add_f32 v[4:5], v[4:5], v[182:183]
 v_pk_fma_f32 v[8:9], v[182:183], v[182:183], v[8:9]
 s_waitcnt lgkmcnt(4)
 v_dot2_f32_bf16 v184, v244, v52, 0
 v_dot2_f32_bf16 v185, v244, v100, 0
 v_dot2_f32_bf16 v186, v245, v53, 0
 v_dot2_f32_bf16 v187, v245, v101, 0
 v_dot2_f32_bf16 v188, v246, v54, 0
 v_dot2_f32_bf16 v189, v246, v102, 0
 v_dot2_f32_bf16 v190, v247, v55, 0
 v_dot2_f32_bf16 v191, v247, v103, 0
 v_pk_add_f32 v[2:3], v[2:3], v[184:185]
 v_pk_fma_f32 v[6:7], v[184:185], v[184:185], v[6:7]
 v_pk_add_f32 v[4:5], v[4:5], v[186:187]
 v_pk_fma_f32 v[8:9], v[186:187], v[186:187], v[8:9]
 v_pk_add_f32 v[2:3], v[2:3], v[188:189]
 v_pk_fma_f32 v[6:7], v[188:189], v[188:189], v[6:7]
 v_pk_add_f32 v[4:5], v[4:5], v[190:191]
 v_pk_fma_f32 v[8:9], v[190:191], v[190:191], v[8:9]
 s_waitcnt lgkmcnt(2)
 v_dot2_f32_bf16 v192, v248, v56, 0
 v_dot2_f32_bf16 v193, v248, v104, 0
 v_dot2_f32_bf16 v194, v249, v57, 0
 v_dot2_f32_bf16 v195, v249, v105, 0
 v_dot2_f32_bf16 v196, v250, v58, 0
 v_dot2_f32_bf16 v197, v250, v106, 0
 v_dot2_f32_bf16 v198, v251, v59, 0
 v_dot2_f32_bf16 v199, v251, v107, 0
 v_pk_add_f32 v[2:3], v[2:3], v[192:193]
 v_pk_fma_f32 v[6:7], v[192:193], v[192:193], v[6:7]
 v_pk_add_f32 v[4:5], v[4:5], v[194:195]
 v_pk_fma_f32 v[8:9], v[194:195], v[194:195], v[8:9]
 v_pk_add_f32 v[2:3], v[2:3], v[196:197]
 v_pk_fma_f32 v[6:7], v[196:197], v[196:197], v[6:7]
 v_pk_add_f32 v[4:5], v[4:5], v[198:199]
 v_pk_fma_f32 v[8:9], v[198:199], v[198:199], v[8:9]
 s_waitcnt lgkmcnt(0)
 v_dot2_f32_bf16 v200, v252, v60, 0
 v_dot2_f32_bf16 v201, v252, v108, 0
 v_dot2_f32_bf16 v202, v253, v61, 0
 v_dot2_f32_bf16 v203, v253, v109, 0
 v_dot2_f32_bf16 v204, v254, v62, 0
 v_dot2_f32_bf16 v205, v254, v110, 0
 v_dot2_f32_bf16 v206, v255, v63, 0
 v_dot2_f32_bf16 v207, v255, v111, 0
 v_pk_add_f32 v[2:3], v[2:3], v[200:201]
 v_pk_fma_f32 v[6:7], v[200:201], v[200:201], v[6:7]
 v_pk_add_f32 v[4:5], v[4:5], v[202:203]
 v_pk_fma_f32 v[8:9], v[202:203], v[202:203], v[8:9]
 v_pk_add_f32 v[2:3], v[2:3], v[204:205]
 v_pk_fma_f32 v[6:7], v[204:205], v[204:205], v[6:7]
 v_pk_add_f32 v[4:5], v[4:5], v[206:207]
 v_pk_fma_f32 v[8:9], v[206:207], v[206:207], v[8:9]
 s_load_dword s82, s[48:49], 0
 s_load_dword s83, s[48:49], 64
 s_load_dword s84, s[48:49], 128
 s_load_dword s85, s[48:49], 192
 v_pk_add_f32 v[2:3], v[2:3], v[4:5]
 v_pk_add_f32 v[6:7], v[6:7], v[8:9]
 v_add_f32 v2, v2, v3
 v_add_f32 v6, v6, v7
 v_mov_b32 v4, v2
 v_mov_b32 v8, v6
 s_nop 1
 v_permlane16_swap_b32 v2, v4
 v_permlane16_swap_b32 v6, v8
 s_nop 1
 v_add_f32 v2, v2, v4
 v_add_f32 v6, v6, v8
 v_mov_b32 v4, v2
 v_mov_b32 v8, v6
 s_nop 1
 v_permlane32_swap_b32 v2, v4
 v_permlane32_swap_b32 v6, v8
 s_nop 1
 v_add_f32 v2, v2, v4
 v_add_f32 v6, v6, v8
 v_mul_f32 v2, 0x3b2aaaab, v2
 v_mul_f32 v6, 0x3b2aaaab, v6
 v_fma_f32 v6, -v2, v2, v6
 v_max_f32 v6, 0, v6
 v_cvt_pk_bf16_f32 v4, v2, v6
 v_lshlrev_b32 v2, 16, v4
 v_and_b32 v6, 0xffff0000, v4
 v_add_f32 v6, 0x3727c5ac, v6
 v_cvt_pk_bf16_f32 v6, v6, v6
 v_and_b32 v6, 0xffff0000, v6
 v_sqrt_f32 v6, v6
 s_nop 0
 v_cvt_pk_bf16_f32 v6, v6, v6
 v_and_b32 v6, 0xffff0000, v6
 v_rcp_f32 v6, v6
 s_nop 0
 v_mul_f32 v8, s22, v6
 v_mul_f32_e64 v9, -v2, v8
 v_pk_fma_f32 v[112:113], v[112:113], v[8:9], v[8:9] op_sel:[0,0,1] op_sel_hi:[1,0,1]
 v_pk_fma_f32 v[114:115], v[114:115], v[8:9], v[8:9] op_sel:[0,0,1] op_sel_hi:[1,0,1]
 v_pk_fma_f32 v[116:117], v[116:117], v[8:9], v[8:9] op_sel:[0,0,1] op_sel_hi:[1,0,1]
 v_pk_fma_f32 v[118:119], v[118:119], v[8:9], v[8:9] op_sel:[0,0,1] op_sel_hi:[1,0,1]
 v_cvt_pk_bf16_f32 v2, v112, v113
 v_cvt_pk_bf16_f32 v3, v114, v115
 v_cvt_pk_bf16_f32 v4, v116, v117
 v_cvt_pk_bf16_f32 v5, v118, v119
 v_accvgpr_write_b32 a48, v2
 v_accvgpr_write_b32 a49, v3
 v_accvgpr_write_b32 a50, v4
 v_accvgpr_write_b32 a51, v5
 v_pk_fma_f32 v[120:121], v[120:121], v[8:9], v[8:9] op_sel:[0,0,1] op_sel_hi:[1,0,1]
 v_pk_fma_f32 v[122:123], v[122:123], v[8:9], v[8:9] op_sel:[0,0,1] op_sel_hi:[1,0,1]
 v_pk_fma_f32 v[124:125], v[124:125], v[8:9], v[8:9] op_sel:[0,0,1] op_sel_hi:[1,0,1]
 v_pk_fma_f32 v[126:127], v[126:127], v[8:9], v[8:9] op_sel:[0,0,1] op_sel_hi:[1,0,1]
 v_cvt_pk_bf16_f32 v2, v120, v121
 v_cvt_pk_bf16_f32 v3, v122, v123
 v_cvt_pk_bf16_f32 v4, v124, v125
 v_cvt_pk_bf16_f32 v5, v126, v127
 v_accvgpr_write_b32 a52, v2
 v_accvgpr_write_b32 a53, v3
 v_accvgpr_write_b32 a54, v4
 v_accvgpr_write_b32 a55, v5
 v_pk_fma_f32 v[128:129], v[128:129], v[8:9], v[8:9] op_sel:[0,0,1] op_sel_hi:[1,0,1]
 v_pk_fma_f32 v[130:131], v[130:131], v[8:9], v[8:9] op_sel:[0,0,1] op_sel_hi:[1,0,1]
 v_pk_fma_f32 v[132:133], v[132:133], v[8:9], v[8:9] op_sel:[0,0,1] op_sel_hi:[1,0,1]
 v_pk_fma_f32 v[134:135], v[134:135], v[8:9], v[8:9] op_sel:[0,0,1] op_sel_hi:[1,0,1]
 v_cvt_pk_bf16_f32 v2, v128, v129
 v_cvt_pk_bf16_f32 v3, v130, v131
 v_cvt_pk_bf16_f32 v4, v132, v133
 v_cvt_pk_bf16_f32 v5, v134, v135
 v_accvgpr_write_b32 a56, v2
 v_accvgpr_write_b32 a57, v3
 v_accvgpr_write_b32 a58, v4
 v_accvgpr_write_b32 a59, v5
 v_pk_fma_f32 v[136:137], v[136:137], v[8:9], v[8:9] op_sel:[0,0,1] op_sel_hi:[1,0,1]
 v_pk_fma_f32 v[138:139], v[138:139], v[8:9], v[8:9] op_sel:[0,0,1] op_sel_hi:[1,0,1]
 v_pk_fma_f32 v[140:141], v[140:141], v[8:9], v[8:9] op_sel:[0,0,1] op_sel_hi:[1,0,1]
 v_pk_fma_f32 v[142:143], v[142:143], v[8:9], v[8:9] op_sel:[0,0,1] op_sel_hi:[1,0,1]
 v_cvt_pk_bf16_f32 v2, v136, v137
 v_cvt_pk_bf16_f32 v3, v138, v139
 v_cvt_pk_bf16_f32 v4, v140, v141
 v_cvt_pk_bf16_f32 v5, v142, v143
 v_accvgpr_write_b32 a60, v2
 v_accvgpr_write_b32 a61, v3
 v_accvgpr_write_b32 a62, v4
 v_accvgpr_write_b32 a63, v5
 v_pk_fma_f32 v[144:145], v[144:145], v[8:9], v[8:9] op_sel:[0,0,1] op_sel_hi:[1,0,1]
 v_pk_fma_f32 v[146:147], v[146:147], v[8:9], v[8:9] op_sel:[0,0,1] op_sel_hi:[1,0,1]
 v_pk_fma_f32 v[148:149], v[148:149], v[8:9], v[8:9] op_sel:[0,0,1] op_sel_hi:[1,0,1]
 v_pk_fma_f32 v[150:151], v[150:151], v[8:9], v[8:9] op_sel:[0,0,1] op_sel_hi:[1,0,1]
 v_cvt_pk_bf16_f32 v2, v144, v145
 v_cvt_pk_bf16_f32 v3, v146, v147
 v_cvt_pk_bf16_f32 v4, v148, v149
 v_cvt_pk_bf16_f32 v5, v150, v151
 v_accvgpr_write_b32 a64, v2
 v_accvgpr_write_b32 a65, v3
 v_accvgpr_write_b32 a66, v4
 v_accvgpr_write_b32 a67, v5
 v_pk_fma_f32 v[152:153], v[152:153], v[8:9], v[8:9] op_sel:[0,0,1] op_sel_hi:[1,0,1]
 v_pk_fma_f32 v[154:155], v[154:155], v[8:9], v[8:9] op_sel:[0,0,1] op_sel_hi:[1,0,1]
 v_pk_fma_f32 v[156:157], v[156:157], v[8:9], v[8:9] op_sel:[0,0,1] op_sel_hi:[1,0,1]
 v_pk_fma_f32 v[158:159], v[158:159], v[8:9], v[8:9] op_sel:[0,0,1] op_sel_hi:[1,0,1]
 v_cvt_pk_bf16_f32 v2, v152, v153
 v_cvt_pk_bf16_f32 v3, v154, v155
 v_cvt_pk_bf16_f32 v4, v156, v157
 v_cvt_pk_bf16_f32 v5, v158, v159
 v_accvgpr_write_b32 a68, v2
 v_accvgpr_write_b32 a69, v3
 v_accvgpr_write_b32 a70, v4
 v_accvgpr_write_b32 a71, v5
 v_pk_fma_f32 v[160:161], v[160:161], v[8:9], v[8:9] op_sel:[0,0,1] op_sel_hi:[1,0,1]
 v_pk_fma_f32 v[162:163], v[162:163], v[8:9], v[8:9] op_sel:[0,0,1] op_sel_hi:[1,0,1]
 v_pk_fma_f32 v[164:165], v[164:165], v[8:9], v[8:9] op_sel:[0,0,1] op_sel_hi:[1,0,1]
 v_pk_fma_f32 v[166:167], v[166:167], v[8:9], v[8:9] op_sel:[0,0,1] op_sel_hi:[1,0,1]
 v_cvt_pk_bf16_f32 v2, v160, v161
 v_cvt_pk_bf16_f32 v3, v162, v163
 v_cvt_pk_bf16_f32 v4, v164, v165
 v_cvt_pk_bf16_f32 v5, v166, v167
 v_accvgpr_write_b32 a72, v2
 v_accvgpr_write_b32 a73, v3
 v_accvgpr_write_b32 a74, v4
 v_accvgpr_write_b32 a75, v5
 v_pk_fma_f32 v[168:169], v[168:169], v[8:9], v[8:9] op_sel:[0,0,1] op_sel_hi:[1,0,1]
 v_pk_fma_f32 v[170:171], v[170:171], v[8:9], v[8:9] op_sel:[0,0,1] op_sel_hi:[1,0,1]
 v_pk_fma_f32 v[172:173], v[172:173], v[8:9], v[8:9] op_sel:[0,0,1] op_sel_hi:[1,0,1]
 v_pk_fma_f32 v[174:175], v[174:175], v[8:9], v[8:9] op_sel:[0,0,1] op_sel_hi:[1,0,1]
 v_cvt_pk_bf16_f32 v2, v168, v169
 v_cvt_pk_bf16_f32 v3, v170, v171
 v_cvt_pk_bf16_f32 v4, v172, v173
 v_cvt_pk_bf16_f32 v5, v174, v175
 v_accvgpr_write_b32 a76, v2
 v_accvgpr_write_b32 a77, v3
 v_accvgpr_write_b32 a78, v4
 v_accvgpr_write_b32 a79, v5
 v_pk_fma_f32 v[176:177], v[176:177], v[8:9], v[8:9] op_sel:[0,0,1] op_sel_hi:[1,0,1]
 v_pk_fma_f32 v[178:179], v[178:179], v[8:9], v[8:9] op_sel:[0,0,1] op_sel_hi:[1,0,1]
 v_pk_fma_f32 v[180:181], v[180:181], v[8:9], v[8:9] op_sel:[0,0,1] op_sel_hi:[1,0,1]
 v_pk_fma_f32 v[182:183], v[182:183], v[8:9], v[8:9] op_sel:[0,0,1] op_sel_hi:[1,0,1]
 v_cvt_pk_bf16_f32 v2, v176, v177
 v_cvt_pk_bf16_f32 v3, v178, v179
 v_cvt_pk_bf16_f32 v4, v180, v181
 v_cvt_pk_bf16_f32 v5, v182, v183
 v_accvgpr_write_b32 a80, v2
 v_accvgpr_write_b32 a81, v3
 v_accvgpr_write_b32 a82, v4
 v_accvgpr_write_b32 a83, v5
 v_pk_fma_f32 v[184:185], v[184:185], v[8:9], v[8:9] op_sel:[0,0,1] op_sel_hi:[1,0,1]
 v_pk_fma_f32 v[186:187], v[186:187], v[8:9], v[8:9] op_sel:[0,0,1] op_sel_hi:[1,0,1]
 v_pk_fma_f32 v[188:189], v[188:189], v[8:9], v[8:9] op_sel:[0,0,1] op_sel_hi:[1,0,1]
 v_pk_fma_f32 v[190:191], v[190:191], v[8:9], v[8:9] op_sel:[0,0,1] op_sel_hi:[1,0,1]
 v_cvt_pk_bf16_f32 v2, v184, v185
 v_cvt_pk_bf16_f32 v3, v186, v187
 v_cvt_pk_bf16_f32 v4, v188, v189
 v_cvt_pk_bf16_f32 v5, v190, v191
 v_accvgpr_write_b32 a84, v2
 v_accvgpr_write_b32 a85, v3
 v_accvgpr_write_b32 a86, v4
 v_accvgpr_write_b32 a87, v5
 v_pk_fma_f32 v[192:193], v[192:193], v[8:9], v[8:9] op_sel:[0,0,1] op_sel_hi:[1,0,1]
 v_pk_fma_f32 v[194:195], v[194:195], v[8:9], v[8:9] op_sel:[0,0,1] op_sel_hi:[1,0,1]
 v_pk_fma_f32 v[196:197], v[196:197], v[8:9], v[8:9] op_sel:[0,0,1] op_sel_hi:[1,0,1]
 v_pk_fma_f32 v[198:199], v[198:199], v[8:9], v[8:9] op_sel:[0,0,1] op_sel_hi:[1,0,1]
 v_cvt_pk_bf16_f32 v2, v192, v193
 v_cvt_pk_bf16_f32 v3, v194, v195
 v_cvt_pk_bf16_f32 v4, v196, v197
 v_cvt_pk_bf16_f32 v5, v198, v199
 v_accvgpr_write_b32 a88, v2
 v_accvgpr_write_b32 a89, v3
 v_accvgpr_write_b32 a90, v4
 v_accvgpr_write_b32 a91, v5
 v_pk_fma_f32 v[200:201], v[200:201], v[8:9], v[8:9] op_sel:[0,0,1] op_sel_hi:[1,0,1]
 v_pk_fma_f32 v[202:203], v[202:203], v[8:9], v[8:9] op_sel:[0,0,1] op_sel_hi:[1,0,1]
 v_pk_fma_f32 v[204:205], v[204:205], v[8:9], v[8:9] op_sel:[0,0,1] op_sel_hi:[1,0,1]
 v_pk_fma_f32 v[206:207], v[206:207], v[8:9], v[8:9] op_sel:[0,0,1] op_sel_hi:[1,0,1]
 v_cvt_pk_bf16_f32 v2, v200, v201
 v_cvt_pk_bf16_f32 v3, v202, v203
 v_cvt_pk_bf16_f32 v4, v204, v205
 v_cvt_pk_bf16_f32 v5, v206, v207
 v_accvgpr_write_b32 a92, v2
 v_accvgpr_write_b32 a93, v3
 v_accvgpr_write_b32 a94, v4
 v_accvgpr_write_b32 a95, v5
 s_getpc_b64 s[64:65]
L_pc2:
 s_add_u32 s64, s64, L_k1_pre0-L_pc2
 s_addc_u32 s65, s65, 0
 v_and_b32 v2, 0xf0, v0
 v_lshl_add_u32 v2, v2, 2, s95
 v_min_u32 v2, L_end-L_k1_pre0, v2
 v_add_co_u32 v2, vcc, s64, v2
 v_mov_b32 v3, s65
 v_mov_b32 v3, s65
 v_addc_co_u32 v3, vcc, 0, v3, vcc
 global_load_dword v1, v[2:3], off
 v_subrev_u32 v12, 49152, v12
 v_subrev_u32 v13, 49152, v13
 s_waitcnt vmcnt(11)
 ds_read_b128 v[208:211], v12 offset:0
 ds_read_b128 v[212:215], v13 offset:0
 s_add_u32 m0, s90, 0xc000
 s_add_u32 s91, s63, 0
 buffer_load_dwordx4 v11, s[4:7], s91 offen nt lds
 s_add_u32 m0, s90, 0xc400
 s_add_u32 s91, s63, 6144
 buffer_load_dwordx4 v11, s[4:7], s91 offen nt lds
 s_waitcnt vmcnt(11)
 ds_read_b128 v[216:219], v12 offset:8192
 ds_read_b128 v[220:223], v13 offset:8192
 s_add_u32 m0, s90, 0xe000
 s_add_u32 s91, s63, 128
 buffer_load_dwordx4 v11, s[4:7], s91 offen nt lds
 s_add_u32 m0, s90, 0xe400
 s_add_u32 s91, s63, 6272
 buffer_load_dwordx4 v11, s[4:7], s91 offen nt lds
 s_waitcnt lgkmcnt(3)
 v_dot2_f32_bf16 v112, v208, v16, 0
 v_dot2_f32_bf16 v113, v208, v64, 0
 v_dot2_f32_bf16 v114, v209, v17, 0
 v_dot2_f32_bf16 v115, v209, v65, 0
 v_dot2_f32_bf16 v116, v210, v18, 0
 v_dot2_f32_bf16 v117, v210, v66, 0
 v_dot2_f32_bf16 v118, v211, v19, 0
 v_dot2_f32_bf16 v119, v211, v67, 0
 s_nop 2
 v_pk_add_f32 v[2:3], v[112:113], v[116:117]
 v_pk_mul_f32 v[6:7], v[112:113], v[112:113]
 v_pk_add_f32 v[4:5], v[114:115], v[118:119]
 v_pk_mul_f32 v[8:9], v[114:115], v[114:115]
 v_pk_fma_f32 v[6:7], v[116:117], v[116:117], v[6:7]
 v_pk_fma_f32 v[8:9], v[118:119], v[118:119], v[8:9]
 s_waitcnt lgkmcnt(2)
 v_dot2_f32_bf16 v120, v212, v20, 0
 v_dot2_f32_bf16 v121, v212, v68, 0
 v_dot2_f32_bf16 v122, v213, v21, 0
 v_dot2_f32_bf16 v123, v213, v69, 0
 v_dot2_f32_bf16 v124, v214, v22, 0
 v_dot2_f32_bf16 v125, v214, v70, 0
 v_dot2_f32_bf16 v126, v215, v23, 0
 v_dot2_f32_bf16 v127, v215, v71, 0
 v_pk_add_f32 v[2:3], v[2:3], v[120:121]
 v_pk_fma_f32 v[6:7], v[120:121], v[120:121], v[6:7]
 v_pk_add_f32 v[4:5], v[4:5], v[122:123]
 v_pk_fma_f32 v[8:9], v[122:123], v[122:123], v[8:9]
 v_pk_add_f32 v[2:3], v[2:3], v[124:125]
 v_pk_fma_f32 v[6:7], v[124:125], v[124:125], v[6:7]
 v_pk_add_f32 v[4:5], v[4:5], v[126:127]
 v_pk_fma_f32 v[8:9], v[126:127], v[126:127], v[8:9]
 s_waitcnt vmcnt(11)
 ds_read_b128 v[224:227], v12 offset:16384
 ds_read_b128 v[228:231], v13 offset:16384
 s_add_u32 m0, s90, 0x10000
 s_add_u32 s91, s63, 256
 buffer_load_dwordx4 v11, s[4:7], s91 offen nt lds
 s_add_u32 m0, s90, 0x10400
 s_add_u32 s91, s63, 6400
 buffer_load_dwordx4 v11, s[4:7], s91 offen nt lds
 s_waitcnt lgkmcnt(3)
 v_dot2_f32_bf16 v128, v216, v24, 0
 v_dot2_f32_bf16 v129, v216, v72, 0
 v_dot2_f32_bf16 v130, v217, v25, 0
 v_dot2_f32_bf16 v131, v217, v73, 0
 v_dot2_f32_bf16 v132, v218, v26, 0
 v_dot2_f32_bf16 v133, v218, v74, 0
 v_dot2_f32_bf16 v134, v219, v27, 0
 v_dot2_f32_bf16 v135, v219, v75, 0
 v_pk_add_f32 v[2:3], v[2:3], v[128:129]
 v_pk_fma_f32 v[6:7], v[128:129], v[128:129], v[6:7]
 v_pk_add_f32 v[4:5], v[4:5], v[130:131]
 v_pk_fma_f32 v[8:9], v[130:131], v[130:131], v[8:9]
 v_pk_add_f32 v[2:3], v[2:3], v[132:133]
 v_pk_fma_f32 v[6:7], v[132:133], v[132:133], v[6:7]
 v_pk_add_f32 v[4:5], v[4:5], v[134:135]
 v_pk_fma_f32 v[8:9], v[134:135], v[134:135], v[8:9]
 s_waitcnt lgkmcnt(2)
 v_dot2_f32_bf16 v136, v220, v28, 0
 v_dot2_f32_bf16 v137, v220, v76, 0
 v_dot2_f32_bf16 v138, v221, v29, 0
 v_dot2_f32_bf16 v139, v221, v77, 0
 v_dot2_f32_bf16 v140, v222, v30, 0
 v_dot2_f32_bf16 v141, v222, v78, 0
 v_dot2_f32_bf16 v142, v223, v31, 0
 v_dot2_f32_bf16 v143, v223, v79, 0
 v_pk_add_f32 v[2:3], v[2:3], v[136:137]
 v_pk_fma_f32 v[6:7], v[136:137], v[136:137], v[6:7]
 v_pk_add_f32 v[4:5], v[4:5], v[138:139]
 v_pk_fma_f32 v[8:9], v[138:139], v[138:139], v[8:9]
 v_pk_add_f32 v[2:3], v[2:3], v[140:141]
 v_pk_fma_f32 v[6:7], v[140:141], v[140:141], v[6:7]
 v_pk_add_f32 v[4:5], v[4:5], v[142:143]
 v_pk_fma_f32 v[8:9], v[142:143], v[142:143], v[8:9]
 s_waitcnt vmcnt(11)
 ds_read_b128 v[232:235], v12 offset:24576
 ds_read_b128 v[236:239], v13 offset:24576
 s_add_u32 m0, s90, 0x12000
 s_add_u32 s91, s63, 384
 buffer_load_dwordx4 v11, s[4:7], s91 offen nt lds
 s_add_u32 m0, s90, 0x12400
 s_add_u32 s91, s63, 6528
 buffer_load_dwordx4 v11, s[4:7], s91 offen nt lds
 s_waitcnt lgkmcnt(3)
 v_dot2_f32_bf16 v144, v224, v32, 0
 v_dot2_f32_bf16 v145, v224, v80, 0
 v_dot2_f32_bf16 v146, v225, v33, 0
 v_dot2_f32_bf16 v147, v225, v81, 0
 v_dot2_f32_bf16 v148, v226, v34, 0
 v_dot2_f32_bf16 v149, v226, v82, 0
 v_dot2_f32_bf16 v150, v227, v35, 0
 v_dot2_f32_bf16 v151, v227, v83, 0
 v_pk_add_f32 v[2:3], v[2:3], v[144:145]
 v_pk_fma_f32 v[6:7], v[144:145], v[144:145], v[6:7]
 v_pk_add_f32 v[4:5], v[4:5], v[146:147]
 v_pk_fma_f32 v[8:9], v[146:147], v[146:147], v[8:9]
 v_pk_add_f32 v[2:3], v[2:3], v[148:149]
 v_pk_fma_f32 v[6:7], v[148:149], v[148:149], v[6:7]
 v_pk_add_f32 v[4:5], v[4:5], v[150:151]
 v_pk_fma_f32 v[8:9], v[150:151], v[150:151], v[8:9]
 s_waitcnt lgkmcnt(2)
 v_dot2_f32_bf16 v152, v228, v36, 0
 v_dot2_f32_bf16 v153, v228, v84, 0
 v_dot2_f32_bf16 v154, v229, v37, 0
 v_dot2_f32_bf16 v155, v229, v85, 0
 v_dot2_f32_bf16 v156, v230, v38, 0
 v_dot2_f32_bf16 v157, v230, v86, 0
 v_dot2_f32_bf16 v158, v231, v39, 0
 v_dot2_f32_bf16 v159, v231, v87, 0
 v_pk_add_f32 v[2:3], v[2:3], v[152:153]
 v_pk_fma_f32 v[6:7], v[152:153], v[152:153], v[6:7]
 v_pk_add_f32 v[4:5], v[4:5], v[154:155]
 v_pk_fma_f32 v[8:9], v[154:155], v[154:155], v[8:9]
 v_pk_add_f32 v[2:3], v[2:3], v[156:157]
 v_pk_fma_f32 v[6:7], v[156:157], v[156:157], v[6:7]
 v_pk_add_f32 v[4:5], v[4:5], v[158:159]
 v_pk_fma_f32 v[8:9], v[158:159], v[158:159], v[8:9]
 s_waitcnt vmcnt(11)
 ds_read_b128 v[240:243], v12 offset:32768
 ds_read_b128 v[244:247], v13 offset:32768
 s_add_u32 m0, s90, 0x14000
 s_add_u32 s91, s63, 512
 buffer_load_dwordx4 v11, s[4:7], s91 offen nt lds
 s_add_u32 m0, s90, 0x14400
 s_add_u32 s91, s63, 6656
 buffer_load_dwordx4 v11, s[4:7], s91 offen nt lds
 s_waitcnt lgkmcnt(3)
 v_dot2_f32_bf16 v160, v232, v40, 0
 v_dot2_f32_bf16 v161, v232, v88, 0
 v_dot2_f32_bf16 v162, v233, v41, 0
 v_dot2_f32_bf16 v163, v233, v89, 0
 v_dot2_f32_bf16 v164, v234, v42, 0
 v_dot2_f32_bf16 v165, v234, v90, 0
 v_dot2_f32_bf16 v166, v235, v43, 0
 v_dot2_f32_bf16 v167, v235, v91, 0
 v_pk_add_f32 v[2:3], v[2:3], v[160:161]
 v_pk_fma_f32 v[6:7], v[160:161], v[160:161], v[6:7]
 v_pk_add_f32 v[4:5], v[4:5], v[162:163]
 v_pk_fma_f32 v[8:9], v[162:163], v[162:163], v[8:9]
 v_pk_add_f32 v[2:3], v[2:3], v[164:165]
 v_pk_fma_f32 v[6:7], v[164:165], v[164:165], v[6:7]
 v_pk_add_f32 v[4:5], v[4:5], v[166:167]
 v_pk_fma_f32 v[8:9], v[166:167], v[166:167], v[8:9]
 s_waitcnt lgkmcnt(2)
 v_dot2_f32_bf16 v168, v236, v44, 0
 v_dot2_f32_bf16 v169, v236, v92, 0
 v_dot2_f32_bf16 v170, v237, v45, 0
 v_dot2_f32_bf16 v171, v237, v93, 0
 v_dot2_f32_bf16 v172, v238, v46, 0
 v_dot2_f32_bf16 v173, v238, v94, 0
 v_dot2_f32_bf16 v174, v239, v47, 0
 v_dot2_f32_bf16 v175, v239, v95, 0
 v_pk_add_f32 v[2:3], v[2:3], v[168:169]
 v_pk_fma_f32 v[6:7], v[168:169], v[168:169], v[6:7]
 v_pk_add_f32 v[4:5], v[4:5], v[170:171]
 v_pk_fma_f32 v[8:9], v[170:171], v[170:171], v[8:9]
 v_pk_add_f32 v[2:3], v[2:3], v[172:173]
 v_pk_fma_f32 v[6:7], v[172:173], v[172:173], v[6:7]
 v_pk_add_f32 v[4:5], v[4:5], v[174:175]
 v_pk_fma_f32 v[8:9], v[174:175], v[174:175], v[8:9]
 s_waitcnt vmcnt(11)
 ds_read_b128 v[248:251], v12 offset:40960
 ds_read_b128 v[252:255], v13 offset:40960
 s_add_u32 m0, s90, 0x16000
 s_add_u32 s91, s63, 640
 buffer_load_dwordx4 v11, s[4:7], s91 offen nt lds
 s_add_u32 m0, s90, 0x16400
 s_add_u32 s91, s63, 6784
 buffer_load_dwordx4 v11, s[4:7], s91 offen nt lds
 s_waitcnt lgkmcnt(3)
 v_dot2_f32_bf16 v176, v240, v48, 0
 v_dot2_f32_bf16 v177, v240, v96, 0
 v_dot2_f32_bf16 v178, v241, v49, 0
 v_dot2_f32_bf16 v179, v241, v97, 0
 v_dot2_f32_bf16 v180, v242, v50, 0
 v_dot2_f32_bf16 v181, v242, v98, 0
 v_dot2_f32_bf16 v182, v243, v51, 0
 v_dot2_f32_bf16 v183, v243, v99, 0
 v_pk_add_f32 v[2:3], v[2:3], v[176:177]
 v_pk_fma_f32 v[6:7], v[176:177], v[176:177], v[6:7]
 v_pk_add_f32 v[4:5], v[4:5], v[178:179]
 v_pk_fma_f32 v[8:9], v[178:179], v[178:179], v[8:9]
 v_pk_add_f32 v[2:3], v[2:3], v[180:181]
 v_pk_fma_f32 v[6:7], v[180:181], v[180:181], v[6:7]
 v_pk_add_f32 v[4:5], v[4:5], v[182:183]
 v_pk_fma_f32 v[8:9], v[182:183], v[182:183], v[8:9]
 s_waitcnt lgkmcnt(2)
 v_dot2_f32_bf16 v184, v244, v52, 0
 v_dot2_f32_bf16 v185, v244, v100, 0
 v_dot2_f32_bf16 v186, v245, v53, 0
 v_dot2_f32_bf16 v187, v245, v101, 0
 v_dot2_f32_bf16 v188, v246, v54, 0
 v_dot2_f32_bf16 v189, v246, v102, 0
 v_dot2_f32_bf16 v190, v247, v55, 0
 v_dot2_f32_bf16 v191, v247, v103, 0
 v_pk_add_f32 v[2:3], v[2:3], v[184:185]
 v_pk_fma_f32 v[6:7], v[184:185], v[184:185], v[6:7]
 v_pk_add_f32 v[4:5], v[4:5], v[186:187]
 v_pk_fma_f32 v[8:9], v[186:187], v[186:187], v[8:9]
 v_pk_add_f32 v[2:3], v[2:3], v[188:189]
 v_pk_fma_f32 v[6:7], v[188:189], v[188:189], v[6:7]
 v_pk_add_f32 v[4:5], v[4:5], v[190:191]
 v_pk_fma_f32 v[8:9], v[190:191], v[190:191], v[8:9]
 s_waitcnt lgkmcnt(1)
 v_dot2_f32_bf16 v192, v248, v56, 0
 v_dot2_f32_bf16 v193, v248, v104, 0
 v_dot2_f32_bf16 v194, v249, v57, 0
 v_dot2_f32_bf16 v195, v249, v105, 0
 v_dot2_f32_bf16 v196, v250, v58, 0
 v_dot2_f32_bf16 v197, v250, v106, 0
 v_dot2_f32_bf16 v198, v251, v59, 0
 v_dot2_f32_bf16 v199, v251, v107, 0
 v_pk_add_f32 v[2:3], v[2:3], v[192:193]
 v_pk_fma_f32 v[6:7], v[192:193], v[192:193], v[6:7]
 v_pk_add_f32 v[4:5], v[4:5], v[194:195]
 v_pk_fma_f32 v[8:9], v[194:195], v[194:195], v[8:9]
 v_pk_add_f32 v[2:3], v[2:3], v[196:197]
 v_pk_fma_f32 v[6:7], v[196:197], v[196:197], v[6:7]
 v_pk_add_f32 v[4:5], v[4:5], v[198:199]
 v_pk_fma_f32 v[8:9], v[198:199], v[198:199], v[8:9]
 s_waitcnt lgkmcnt(0)
 v_dot2_f32_bf16 v200, v252, v60, 0
 v_dot2_f32_bf16 v201, v252, v108, 0
 v_dot2_f32_bf16 v202, v253, v61, 0
 v_dot2_f32_bf16 v203, v253, v109, 0
 v_dot2_f32_bf16 v204, v254, v62, 0
 v_dot2_f32_bf16 v205, v254, v110, 0
 v_dot2_f32_bf16 v206, v255, v63, 0
 v_dot2_f32_bf16 v207, v255, v111, 0
 v_pk_add_f32 v[2:3], v[2:3], v[200:201]
 v_pk_fma_f32 v[6:7], v[200:201], v[200:201], v[6:7]
 v_pk_add_f32 v[4:5], v[4:5], v[202:203]
 v_pk_fma_f32 v[8:9], v[202:203], v[202:203], v[8:9]
 v_pk_add_f32 v[2:3], v[2:3], v[204:205]
 v_pk_fma_f32 v[6:7], v[204:205], v[204:205], v[6:7]
 v_pk_add_f32 v[4:5], v[4:5], v[206:207]
 v_pk_fma_f32 v[8:9], v[206:207], v[206:207], v[8:9]
 s_waitcnt lgkmcnt(0)
 s_min_u32 s82, s82, s83
 s_min_u32 s84, s84, s85
 s_min_u32 s82, s82, s84
 s_cmp_ge_u32 s82, 64
 s_cbranch_scc1 L_pollA_ok
 s_mov_b32 s25, 65536
 v_and_b32 v10, 48, v0
 v_lshlrev_b32 v10, 2, v10
L_pollA_spin:
 buffer_load_dword v11, v10, s[48:51], 0 offen sc1
 s_sub_u32 s25, s25, 1
 s_waitcnt vmcnt(0)
 s_cbranch_scc1 L_pollA_ok
 v_cmp_gt_u32 vcc, 64, v11
 s_nop 4
 s_cbranch_vccz L_pollA_ok
 s_sleep 16
 s_branch L_pollA_spin
L_pollA_ok:
 s_barrier
 v_and_b32 v10, 0xf0, v0
 v_lshrrev_b32 v11, 8, v0
 v_lshl_add_u32 v10, v11, 2, v10
 v_add_u32 v10, s3, v10
 buffer_atomic_add_f32 a192, v10, s[12:15], 0 offen sc1
 v_pk_add_f32 v[2:3], v[2:3], v[4:5]
 v_pk_add_f32 v[6:7], v[6:7], v[8:9]
 v_add_f32 v2, v2, v3
 v_add_f32 v6, v6, v7
 v_mov_b32 v4, v2
 v_mov_b32 v8, v6
 s_nop 1
 v_permlane16_swap_b32 v2, v4
 v_permlane16_swap_b32 v6, v8
 s_nop 1
 v_add_f32 v2, v2, v4
 v_add_f32 v6, v6, v8
 v_mov_b32 v4, v2
 v_mov_b32 v8, v6
 s_nop 1
 v_permlane32_swap_b32 v2, v4
 v_permlane32_swap_b32 v6, v8
 s_nop 1
 v_add_f32 v2, v2, v4
 v_add_f32 v6, v6, v8
 v_mul_f32 v2, 0x3b2aaaab, v2
 v_mul_f32 v6, 0x3b2aaaab, v6
 v_fma_f32 v6, -v2, v2, v6
 v_max_f32 v6, 0, v6
 v_cvt_pk_bf16_f32 v4, v2, v6
 v_lshlrev_b32 v2, 16, v4
 v_and_b32 v6, 0xffff0000, v4
 v_add_f32 v6, 0x3727c5ac, v6
 v_cvt_pk_bf16_f32 v6, v6, v6
 v_and_b32 v6, 0xffff0000, v6
 v_sqrt_f32 v6, v6
 s_nop 0
 v_cvt_pk_bf16_f32 v6, v6, v6
 v_and_b32 v6, 0xffff0000, v6
 v_rcp_f32 v6, v6
 s_nop 0
 v_mul_f32 v8, s22, v6
 v_mul_f32_e64 v9, -v2, v8
 v_pk_fma_f32 v[112:113], v[112:113], v[8:9], v[8:9] op_sel:[0,0,1] op_sel_hi:[1,0,1]
 v_pk_fma_f32 v[114:115], v[114:115], v[8:9], v[8:9] op_sel:[0,0,1] op_sel_hi:[1,0,1]
 v_pk_fma_f32 v[116:117], v[116:117], v[8:9], v[8:9] op_sel:[0,0,1] op_sel_hi:[1,0,1]
 v_pk_fma_f32 v[118:119], v[118:119], v[8:9], v[8:9] op_sel:[0,0,1] op_sel_hi:[1,0,1]
 v_cvt_pk_bf16_f32 v2, v112, v113
 v_cvt_pk_bf16_f32 v3, v114, v115
 v_cvt_pk_bf16_f32 v4, v116, v117
 v_cvt_pk_bf16_f32 v5, v118, v119
 v_accvgpr_write_b32 a96, v2
 v_accvgpr_write_b32 a97, v3
 v_accvgpr_write_b32 a98, v4
 v_accvgpr_write_b32 a99, v5
 v_pk_fma_f32 v[120:121], v[120:121], v[8:9], v[8:9] op_sel:[0,0,1] op_sel_hi:[1,0,1]
 v_pk_fma_f32 v[122:123], v[122:123], v[8:9], v[8:9] op_sel:[0,0,1] op_sel_hi:[1,0,1]
 v_pk_fma_f32 v[124:125], v[124:125], v[8:9], v[8:9] op_sel:[0,0,1] op_sel_hi:[1,0,1]
 v_pk_fma_f32 v[126:127], v[126:127], v[8:9], v[8:9] op_sel:[0,0,1] op_sel_hi:[1,0,1]
 v_cvt_pk_bf16_f32 v2, v120, v121
 v_cvt_pk_bf16_f32 v3, v122, v123
 v_cvt_pk_bf16_f32 v4, v124, v125
 v_cvt_pk_bf16_f32 v5, v126, v127
 v_accvgpr_write_b32 a100, v2
 v_accvgpr_write_b32 a101, v3
 v_accvgpr_write_b32 a102, v4
 v_accvgpr_write_b32 a103, v5
 v_pk_fma_f32 v[128:129], v[128:129], v[8:9], v[8:9] op_sel:[0,0,1] op_sel_hi:[1,0,1]
 v_pk_fma_f32 v[130:131], v[130:131], v[8:9], v[8:9] op_sel:[0,0,1] op_sel_hi:[1,0,1]
 v_pk_fma_f32 v[132:133], v[132:133], v[8:9], v[8:9] op_sel:[0,0,1] op_sel_hi:[1,0,1]
 v_pk_fma_f32 v[134:135], v[134:135], v[8:9], v[8:9] op_sel:[0,0,1] op_sel_hi:[1,0,1]
 v_cvt_pk_bf16_f32 v2, v128, v129
 v_cvt_pk_bf16_f32 v3, v130, v131
 v_cvt_pk_bf16_f32 v4, v132, v133
 v_cvt_pk_bf16_f32 v5, v134, v135
 v_accvgpr_write_b32 a104, v2
 v_accvgpr_write_b32 a105, v3
 v_accvgpr_write_b32 a106, v4
 v_accvgpr_write_b32 a107, v5
 v_pk_fma_f32 v[136:137], v[136:137], v[8:9], v[8:9] op_sel:[0,0,1] op_sel_hi:[1,0,1]
 v_pk_fma_f32 v[138:139], v[138:139], v[8:9], v[8:9] op_sel:[0,0,1] op_sel_hi:[1,0,1]
 v_pk_fma_f32 v[140:141], v[140:141], v[8:9], v[8:9] op_sel:[0,0,1] op_sel_hi:[1,0,1]
 v_pk_fma_f32 v[142:143], v[142:143], v[8:9], v[8:9] op_sel:[0,0,1] op_sel_hi:[1,0,1]
 v_cvt_pk_bf16_f32 v2, v136, v137
 v_cvt_pk_bf16_f32 v3, v138, v139
 v_cvt_pk_bf16_f32 v4, v140, v141
 v_cvt_pk_bf16_f32 v5, v142, v143
 v_accvgpr_write_b32 a108, v2
 v_accvgpr_write_b32 a109, v3
 v_accvgpr_write_b32 a110, v4
 v_accvgpr_write_b32 a111, v5
 v_pk_fma_f32 v[144:145], v[144:145], v[8:9], v[8:9] op_sel:[0,0,1] op_sel_hi:[1,0,1]
 v_pk_fma_f32 v[146:147], v[146:147], v[8:9], v[8:9] op_sel:[0,0,1] op_sel_hi:[1,0,1]
 v_pk_fma_f32 v[148:149], v[148:149], v[8:9], v[8:9] op_sel:[0,0,1] op_sel_hi:[1,0,1]
 v_pk_fma_f32 v[150:151], v[150:151], v[8:9], v[8:9] op_sel:[0,0,1] op_sel_hi:[1,0,1]
 v_cvt_pk_bf16_f32 v2, v144, v145
 v_cvt_pk_bf16_f32 v3, v146, v147
 v_cvt_pk_bf16_f32 v4, v148, v149
 v_cvt_pk_bf16_f32 v5, v150, v151
 v_accvgpr_write_b32 a112, v2
 v_accvgpr_write_b32 a113, v3
 v_accvgpr_write_b32 a114, v4
 v_accvgpr_write_b32 a115, v5
 v_pk_fma_f32 v[152:153], v[152:153], v[8:9], v[8:9] op_sel:[0,0,1] op_sel_hi:[1,0,1]
 v_pk_fma_f32 v[154:155], v[154:155], v[8:9], v[8:9] op_sel:[0,0,1] op_sel_hi:[1,0,1]
 v_pk_fma_f32 v[156:157], v[156:157], v[8:9], v[8:9] op_sel:[0,0,1] op_sel_hi:[1,0,1]
 v_pk_fma_f32 v[158:159], v[158:159], v[8:9], v[8:9] op_sel:[0,0,1] op_sel_hi:[1,0,1]
 v_cvt_pk_bf16_f32 v2, v152, v153
 v_cvt_pk_bf16_f32 v3, v154, v155
 v_cvt_pk_bf16_f32 v4, v156, v157
 v_cvt_pk_bf16_f32 v5, v158, v159
 v_accvgpr_write_b32 a116, v2
 v_accvgpr_write_b32 a117, v3
 v_accvgpr_write_b32 a118, v4
 v_accvgpr_write_b32 a119, v5
 v_pk_fma_f32 v[160:161], v[160:161], v[8:9], v[8:9] op_sel:[0,0,1] op_sel_hi:[1,0,1]
 v_pk_fma_f32 v[162:163], v[162:163], v[8:9], v[8:9] op_sel:[0,0,1] op_sel_hi:[1,0,1]
 v_pk_fma_f32 v[164:165], v[164:165], v[8:9], v[8:9] op_sel:[0,0,1] op_sel_hi:[1,0,1]
 v_pk_fma_f32 v[166:167], v[166:167], v[8:9], v[8:9] op_sel:[0,0,1] op_sel_hi:[1,0,1]
 v_cvt_pk_bf16_f32 v2, v160, v161
 v_cvt_pk_bf16_f32 v3, v162, v163
 v_cvt_pk_bf16_f32 v4, v164, v165
 v_cvt_pk_bf16_f32 v5, v166, v167
 v_accvgpr_write_b32 a120, v2
 v_accvgpr_write_b32 a121, v3
 v_accvgpr_write_b32 a122, v4
 v_accvgpr_write_b32 a123, v5
 v_pk_fma_f32 v[168:169], v[168:169], v[8:9], v[8:9] op_sel:[0,0,1] op_sel_hi:[1,0,1]
 v_pk_fma_f32 v[170:171], v[170:171], v[8:9], v[8:9] op_sel:[0,0,1] op_sel_hi:[1,0,1]
 v_pk_fma_f32 v[172:173], v[172:173], v[8:9], v[8:9] op_sel:[0,0,1] op_sel_hi:[1,0,1]
 v_pk_fma_f32 v[174:175], v[174:175], v[8:9], v[8:9] op_sel:[0,0,1] op_sel_hi:[1,0,1]
 v_cvt_pk_bf16_f32 v2, v168, v169
 v_cvt_pk_bf16_f32 v3, v170, v171
 v_cvt_pk_bf16_f32 v4, v172, v173
 v_cvt_pk_bf16_f32 v5, v174, v175
 v_accvgpr_write_b32 a124, v2
 v_accvgpr_write_b32 a125, v3
 v_accvgpr_write_b32 a126, v4
 v_accvgpr_write_b32 a127, v5
 v_pk_fma_f32 v[176:177], v[176:177], v[8:9], v[8:9] op_sel:[0,0,1] op_sel_hi:[1,0,1]
 v_pk_fma_f32 v[178:179], v[178:179], v[8:9], v[8:9] op_sel:[0,0,1] op_sel_hi:[1,0,1]
 v_pk_fma_f32 v[180:181], v[180:181], v[8:9], v[8:9] op_sel:[0,0,1] op_sel_hi:[1,0,1]
 v_pk_fma_f32 v[182:183], v[182:183], v[8:9], v[8:9] op_sel:[0,0,1] op_sel_hi:[1,0,1]
 v_cvt_pk_bf16_f32 v2, v176, v177
 v_cvt_pk_bf16_f32 v3, v178, v179
 v_cvt_pk_bf16_f32 v4, v180, v181
 v_cvt_pk_bf16_f32 v5, v182, v183
 v_accvgpr_write_b32 a128, v2
 v_accvgpr_write_b32 a129, v3
 v_accvgpr_write_b32 a130, v4
 v_accvgpr_write_b32 a131, v5
 v_pk_fma_f32 v[184:185], v[184:185], v[8:9], v[8:9] op_sel:[0,0,1] op_sel_hi:[1,0,1]
 v_pk_fma_f32 v[186:187], v[186:187], v[8:9], v[8:9] op_sel:[0,0,1] op_sel_hi:[1,0,1]
 v_pk_fma_f32 v[188:189], v[188:189], v[8:9], v[8:9] op_sel:[0,0,1] op_sel_hi:[1,0,1]
 v_pk_fma_f32 v[190:191], v[190:191], v[8:9], v[8:9] op_sel:[0,0,1] op_sel_hi:[1,0,1]
 v_cvt_pk_bf16_f32 v2, v184, v185
 v_cvt_pk_bf16_f32 v3, v186, v187
 v_cvt_pk_bf16_f32 v4, v188, v189
 v_cvt_pk_bf16_f32 v5, v190, v191
 v_accvgpr_write_b32 a132, v2
 v_accvgpr_write_b32 a133, v3
 v_accvgpr_write_b32 a134, v4
 v_accvgpr_write_b32 a135, v5
 v_pk_fma_f32 v[192:193], v[192:193], v[8:9], v[8:9] op_sel:[0,0,1] op_sel_hi:[1,0,1]
 v_pk_fma_f32 v[194:195], v[194:195], v[8:9], v[8:9] op_sel:[0,0,1] op_sel_hi:[1,0,1]
 v_pk_fma_f32 v[196:197], v[196:197], v[8:9], v[8:9] op_sel:[0,0,1] op_sel_hi:[1,0,1]
 v_pk_fma_f32 v[198:199], v[198:199], v[8:9], v[8:9] op_sel:[0,0,1] op_sel_hi:[1,0,1]
 v_cvt_pk_bf16_f32 v2, v192, v193
 v_cvt_pk_bf16_f32 v3, v194, v195
 v_cvt_pk_bf16_f32 v4, v196, v197
 v_cvt_pk_bf16_f32 v5, v198, v199
 v_accvgpr_write_b32 a136, v2
 v_accvgpr_write_b32 a137, v3
 v_accvgpr_write_b32 a138, v4
 v_accvgpr_write_b32 a139, v5
 v_pk_fma_f32 v[200:201], v[200:201], v[8:9], v[8:9] op_sel:[0,0,1] op_sel_hi:[1,0,1]
 v_pk_fma_f32 v[202:203], v[202:203], v[8:9], v[8:9] op_sel:[0,0,1] op_sel_hi:[1,0,1]
 v_pk_fma_f32 v[204:205], v[204:205], v[8:9], v[8:9] op_sel:[0,0,1] op_sel_hi:[1,0,1]
 v_pk_fma_f32 v[206:207], v[206:207], v[8:9], v[8:9] op_sel:[0,0,1] op_sel_hi:[1,0,1]
 v_cvt_pk_bf16_f32 v2, v200, v201
 v_cvt_pk_bf16_f32 v3, v202, v203
 v_cvt_pk_bf16_f32 v4, v204, v205
 v_cvt_pk_bf16_f32 v5, v206, v207
 v_accvgpr_write_b32 a140, v2
 v_accvgpr_write_b32 a141, v3
 v_accvgpr_write_b32 a142, v4
 v_accvgpr_write_b32 a143, v5
 v_add_u32 v12, 49152, v12
 v_add_u32 v13, 49152, v13
 s_waitcnt vmcnt(11)
 ds_read_b128 a[144:147], v12 offset:0
 ds_read_b128 v[160:163], v12 offset:0
 ds_read_b128 a[148:151], v13 offset:0
 ds_read_b128 v[164:167], v13 offset:0
 s_add_u32 m0, s24, 0x0
 s_nop 0
 buffer_load_dwordx4 v0, s[36:39], s17 offen offset:0 sc1 lds
 buffer_load_dwordx4 v0, s[36:39], s17 offen offset:1024 sc1 lds
 s_waitcnt vmcnt(11)
 ds_read_b128 a[152:155], v12 offset:8192
 ds_read_b128 v[168:171], v12 offset:8192
 ds_read_b128 a[156:159], v13 offset:8192
 ds_read_b128 v[172:175], v13 offset:8192
 buffer_load_dwordx4 v0, s[36:39], s17 offen offset:2048 sc1 lds
 s_add_u32 s17, s17, 0xc00
 s_add_u32 m0, s24, 0xc00
 s_nop 0
 buffer_load_dwordx4 v0, s[36:39], s17 offen offset:0 sc1 lds
 s_waitcnt lgkmcnt(6)
 v_dot2_f32_bf16 v112, v160, v16, 0
 v_dot2_f32_bf16 v113, v160, v64, 0
 v_dot2_f32_bf16 v114, v161, v17, 0
 v_dot2_f32_bf16 v115, v161, v65, 0
 v_dot2_f32_bf16 v116, v162, v18, 0
 v_dot2_f32_bf16 v117, v162, v66, 0
 v_dot2_f32_bf16 v118, v163, v19, 0
 v_dot2_f32_bf16 v119, v163, v67, 0
 s_nop 2
 v_pk_add_f32 v[2:3], v[112:113], v[116:117]
 v_pk_mul_f32 v[6:7], v[112:113], v[112:113]
 v_pk_add_f32 v[4:5], v[114:115], v[118:119]
 v_pk_mul_f32 v[8:9], v[114:115], v[114:115]
 v_pk_fma_f32 v[6:7], v[116:117], v[116:117], v[6:7]
 v_pk_fma_f32 v[8:9], v[118:119], v[118:119], v[8:9]
 s_waitcnt lgkmcnt(4)
 v_dot2_f32_bf16 v120, v164, v20, 0
 v_dot2_f32_bf16 v121, v164, v68, 0
 v_dot2_f32_bf16 v122, v165, v21, 0
 v_dot2_f32_bf16 v123, v165, v69, 0
 v_dot2_f32_bf16 v124, v166, v22, 0
 v_dot2_f32_bf16 v125, v166, v70, 0
 v_dot2_f32_bf16 v126, v167, v23, 0
 v_dot2_f32_bf16 v127, v167, v71, 0
 v_pk_add_f32 v[2:3], v[2:3], v[120:121]
 v_pk_fma_f32 v[6:7], v[120:121], v[120:121], v[6:7]
 v_pk_add_f32 v[4:5], v[4:5], v[122:123]
 v_pk_fma_f32 v[8:9], v[122:123], v[122:123], v[8:9]
 v_pk_add_f32 v[2:3], v[2:3], v[124:125]
 v_pk_fma_f32 v[6:7], v[124:125], v[124:125], v[6:7]
 v_pk_add_f32 v[4:5], v[4:5], v[126:127]
 v_pk_fma_f32 v[8:9], v[126:127], v[126:127], v[8:9]
 s_waitcnt vmcnt(11)
 ds_read_b128 a[160:163], v12 offset:16384
 ds_read_b128 v[176:179], v12 offset:16384
 ds_read_b128 a[164:167], v13 offset:16384
 ds_read_b128 v[180:183], v13 offset:16384
 buffer_load_dwordx4 v0, s[36:39], s17 offen offset:1024 sc1 lds
 buffer_load_dwordx4 v0, s[36:39], s17 offen offset:2048 sc1 lds
 s_add_u32 s17, s17, 0x5400
 s_waitcnt lgkmcnt(6)
 v_dot2_f32_bf16 v128, v168, v24, 0
 v_dot2_f32_bf16 v129, v168, v72, 0
 v_dot2_f32_bf16 v130, v169, v25, 0
 v_dot2_f32_bf16 v131, v169, v73, 0
 v_dot2_f32_bf16 v132, v170, v26, 0
 v_dot2_f32_bf16 v133, v170, v74, 0
 v_dot2_f32_bf16 v134, v171, v27, 0
 v_dot2_f32_bf16 v135, v171, v75, 0
 v_pk_add_f32 v[2:3], v[2:3], v[128:129]
 v_pk_fma_f32 v[6:7], v[128:129], v[128:129], v[6:7]
 v_pk_add_f32 v[4:5], v[4:5], v[130:131]
 v_pk_fma_f32 v[8:9], v[130:131], v[130:131], v[8:9]
 v_pk_add_f32 v[2:3], v[2:3], v[132:133]
 v_pk_fma_f32 v[6:7], v[132:133], v[132:133], v[6:7]
 v_pk_add_f32 v[4:5], v[4:5], v[134:135]
 v_pk_fma_f32 v[8:9], v[134:135], v[134:135], v[8:9]
 s_waitcnt lgkmcnt(4)
 v_dot2_f32_bf16 v136, v172, v28, 0
 v_dot2_f32_bf16 v137, v172, v76, 0
 v_dot2_f32_bf16 v138, v173, v29, 0
 v_dot2_f32_bf16 v139, v173, v77, 0
 v_dot2_f32_bf16 v140, v174, v30, 0
 v_dot2_f32_bf16 v141, v174, v78, 0
 v_dot2_f32_bf16 v142, v175, v31, 0
 v_dot2_f32_bf16 v143, v175, v79, 0
 v_pk_add_f32 v[2:3], v[2:3], v[136:137]
 v_pk_fma_f32 v[6:7], v[136:137], v[136:137], v[6:7]
 v_pk_add_f32 v[4:5], v[4:5], v[138:139]
 v_pk_fma_f32 v[8:9], v[138:139], v[138:139], v[8:9]
 v_pk_add_f32 v[2:3], v[2:3], v[140:141]
 v_pk_fma_f32 v[6:7], v[140:141], v[140:141], v[6:7]
 v_pk_add_f32 v[4:5], v[4:5], v[142:143]
 v_pk_fma_f32 v[8:9], v[142:143], v[142:143], v[8:9]
 s_waitcnt vmcnt(11)
 ds_read_b128 a[168:171], v12 offset:24576
 ds_read_b128 v[184:187], v12 offset:24576
 ds_read_b128 a[172:175], v13 offset:24576
 ds_read_b128 v[188:191], v13 offset:24576
 s_add_u32 m0, s24, 0x6000
 s_nop 0
 buffer_load_dwordx4 v0, s[36:39], s17 offen offset:0 sc1 lds
 buffer_load_dwordx4 v0, s[36:39], s17 offen offset:1024 sc1 lds
 s_waitcnt lgkmcnt(6)
 v_dot2_f32_bf16 v144, v176, v32, 0
 v_dot2_f32_bf16 v145, v176, v80, 0
 v_dot2_f32_bf16 v146, v177, v33, 0
 v_dot2_f32_bf16 v147, v177, v81, 0
 v_dot2_f32_bf16 v148, v178, v34, 0
 v_dot2_f32_bf16 v149, v178, v82, 0
 v_dot2_f32_bf16 v150, v179, v35, 0
 v_dot2_f32_bf16 v151, v179, v83, 0
 v_pk_add_f32 v[2:3], v[2:3], v[144:145]
 v_pk_fma_f32 v[6:7], v[144:145], v[144:145], v[6:7]
 v_pk_add_f32 v[4:5], v[4:5], v[146:147]
 v_pk_fma_f32 v[8:9], v[146:147], v[146:147], v[8:9]
 v_pk_add_f32 v[2:3], v[2:3], v[148:149]
 v_pk_fma_f32 v[6:7], v[148:149], v[148:149], v[6:7]
 v_pk_add_f32 v[4:5], v[4:5], v[150:151]
 v_pk_fma_f32 v[8:9], v[150:151], v[150:151], v[8:9]
 s_waitcnt lgkmcnt(4)
 v_dot2_f32_bf16 v152, v180, v36, 0
 v_dot2_f32_bf16 v153, v180, v84, 0
 v_dot2_f32_bf16 v154, v181, v37, 0
 v_dot2_f32_bf16 v155, v181, v85, 0
 v_dot2_f32_bf16 v156, v182, v38, 0
 v_dot2_f32_bf16 v157, v182, v86, 0
 v_dot2_f32_bf16 v158, v183, v39, 0
 v_dot2_f32_bf16 v159, v183, v87, 0
 v_pk_add_f32 v[2:3], v[2:3], v[152:153]
 v_pk_fma_f32 v[6:7], v[152:153], v[152:153], v[6:7]
 v_pk_add_f32 v[4:5], v[4:5], v[154:155]
 v_pk_fma_f32 v[8:9], v[154:155], v[154:155], v[8:9]
 v_pk_add_f32 v[2:3], v[2:3], v[156:157]
 v_pk_fma_f32 v[6:7], v[156:157], v[156:157], v[6:7]
 v_pk_add_f32 v[4:5], v[4:5], v[158:159]
 v_pk_fma_f32 v[8:9], v[158:159], v[158:159], v[8:9]
 s_waitcnt vmcnt(11)
 ds_read_b128 a[176:179], v12 offset:32768
 ds_read_b128 v[192:195], v12 offset:32768
 ds_read_b128 a[180:183], v13 offset:32768
 ds_read_b128 v[196:199], v13 offset:32768
 buffer_load_dwordx4 v0, s[36:39], s17 offen offset:2048 sc1 lds
 s_add_u32 s17, s17, 0xc00
 s_add_u32 m0, s24, 0x6c00
 s_nop 0
 buffer_load_dwordx4 v0, s[36:39], s17 offen offset:0 sc1 lds
 s_waitcnt lgkmcnt(6)
 v_dot2_f32_bf16 v160, v184, v40, 0
 v_dot2_f32_bf16 v161, v184, v88, 0
 v_dot2_f32_bf16 v162, v185, v41, 0
 v_dot2_f32_bf16 v163, v185, v89, 0
 v_dot2_f32_bf16 v164, v186, v42, 0
 v_dot2_f32_bf16 v165, v186, v90, 0
 v_dot2_f32_bf16 v166, v187, v43, 0
 v_dot2_f32_bf16 v167, v187, v91, 0
 v_pk_add_f32 v[2:3], v[2:3], v[160:161]
 v_pk_fma_f32 v[6:7], v[160:161], v[160:161], v[6:7]
 v_pk_add_f32 v[4:5], v[4:5], v[162:163]
 v_pk_fma_f32 v[8:9], v[162:163], v[162:163], v[8:9]
 v_pk_add_f32 v[2:3], v[2:3], v[164:165]
 v_pk_fma_f32 v[6:7], v[164:165], v[164:165], v[6:7]
 v_pk_add_f32 v[4:5], v[4:5], v[166:167]
 v_pk_fma_f32 v[8:9], v[166:167], v[166:167], v[8:9]
 s_waitcnt lgkmcnt(4)
 v_dot2_f32_bf16 v168, v188, v44, 0
 v_dot2_f32_bf16 v169, v188, v92, 0
 v_dot2_f32_bf16 v170, v189, v45, 0
 v_dot2_f32_bf16 v171, v189, v93, 0
 v_dot2_f32_bf16 v172, v190, v46, 0
 v_dot2_f32_bf16 v173, v190, v94, 0
 v_dot2_f32_bf16 v174, v191, v47, 0
 v_dot2_f32_bf16 v175, v191, v95, 0
 v_pk_add_f32 v[2:3], v[2:3], v[168:169]
 v_pk_fma_f32 v[6:7], v[168:169], v[168:169], v[6:7]
 v_pk_add_f32 v[4:5], v[4:5], v[170:171]
 v_pk_fma_f32 v[8:9], v[170:171], v[170:171], v[8:9]
 v_pk_add_f32 v[2:3], v[2:3], v[172:173]
 v_pk_fma_f32 v[6:7], v[172:173], v[172:173], v[6:7]
 v_pk_add_f32 v[4:5], v[4:5], v[174:175]
 v_pk_fma_f32 v[8:9], v[174:175], v[174:175], v[8:9]
 s_waitcnt vmcnt(11)
 ds_read_b128 a[184:187], v12 offset:40960
 ds_read_b128 v[200:203], v12 offset:40960
 ds_read_b128 a[188:191], v13 offset:40960
 ds_read_b128 v[204:207], v13 offset:40960
 buffer_load_dwordx4 v0, s[36:39], s17 offen offset:1024 sc1 lds
 buffer_load_dwordx4 v0, s[36:39], s17 offen offset:2048 sc1 lds
 s_add_u32 s17, s17, 0x5400
 s_waitcnt lgkmcnt(6)
 v_dot2_f32_bf16 v176, v192, v48, 0
 v_dot2_f32_bf16 v177, v192, v96, 0
 v_dot2_f32_bf16 v178, v193, v49, 0
 v_dot2_f32_bf16 v179, v193, v97, 0
 v_dot2_f32_bf16 v180, v194, v50, 0
 v_dot2_f32_bf16 v181, v194, v98, 0
 v_dot2_f32_bf16 v182, v195, v51, 0
 v_dot2_f32_bf16 v183, v195, v99, 0
 v_pk_add_f32 v[2:3], v[2:3], v[176:177]
 v_pk_fma_f32 v[6:7], v[176:177], v[176:177], v[6:7]
 v_pk_add_f32 v[4:5], v[4:5], v[178:179]
 v_pk_fma_f32 v[8:9], v[178:179], v[178:179], v[8:9]
 v_pk_add_f32 v[2:3], v[2:3], v[180:181]
 v_pk_fma_f32 v[6:7], v[180:181], v[180:181], v[6:7]
 v_pk_add_f32 v[4:5], v[4:5], v[182:183]
 v_pk_fma_f32 v[8:9], v[182:183], v[182:183], v[8:9]
 s_waitcnt lgkmcnt(4)
 v_dot2_f32_bf16 v184, v196, v52, 0
 v_dot2_f32_bf16 v185, v196, v100, 0
 v_dot2_f32_bf16 v186, v197, v53, 0
 v_dot2_f32_bf16 v187, v197, v101, 0
 v_dot2_f32_bf16 v188, v198, v54, 0
 v_dot2_f32_bf16 v189, v198, v102, 0
 v_dot2_f32_bf16 v190, v199, v55, 0
 v_dot2_f32_bf16 v191, v199, v103, 0
 v_pk_add_f32 v[2:3], v[2:3], v[184:185]
 v_pk_fma_f32 v[6:7], v[184:185], v[184:185], v[6:7]
 v_pk_add_f32 v[4:5], v[4:5], v[186:187]
 v_pk_fma_f32 v[8:9], v[186:187], v[186:187], v[8:9]
 v_pk_add_f32 v[2:3], v[2:3], v[188:189]
 v_pk_fma_f32 v[6:7], v[188:189], v[188:189], v[6:7]
 v_pk_add_f32 v[4:5], v[4:5], v[190:191]
 v_pk_fma_f32 v[8:9], v[190:191], v[190:191], v[8:9]
 s_waitcnt lgkmcnt(2)
 v_dot2_f32_bf16 v192, v200, v56, 0
 v_dot2_f32_bf16 v193, v200, v104, 0
 v_dot2_f32_bf16 v194, v201, v57, 0
 v_dot2_f32_bf16 v195, v201, v105, 0
 v_dot2_f32_bf16 v196, v202, v58, 0
 v_dot2_f32_bf16 v197, v202, v106, 0
 v_dot2_f32_bf16 v198, v203, v59, 0
 v_dot2_f32_bf16 v199, v203, v107, 0
 v_pk_add_f32 v[2:3], v[2:3], v[192:193]
 v_pk_fma_f32 v[6:7], v[192:193], v[192:193], v[6:7]
 v_pk_add_f32 v[4:5], v[4:5], v[194:195]
 v_pk_fma_f32 v[8:9], v[194:195], v[194:195], v[8:9]
 v_pk_add_f32 v[2:3], v[2:3], v[196:197]
 v_pk_fma_f32 v[6:7], v[196:197], v[196:197], v[6:7]
 v_pk_add_f32 v[4:5], v[4:5], v[198:199]
 v_pk_fma_f32 v[8:9], v[198:199], v[198:199], v[8:9]
 s_waitcnt lgkmcnt(0)
 v_dot2_f32_bf16 v200, v204, v60, 0
 v_dot2_f32_bf16 v201, v204, v108, 0
 v_dot2_f32_bf16 v202, v205, v61, 0
 v_dot2_f32_bf16 v203, v205, v109, 0
 v_dot2_f32_bf16 v204, v206, v62, 0
 v_dot2_f32_bf16 v205, v206, v110, 0
 v_dot2_f32_bf16 v206, v207, v63, 0
 v_dot2_f32_bf16 v207, v207, v111, 0
 v_pk_add_f32 v[2:3], v[2:3], v[200:201]
 v_pk_fma_f32 v[6:7], v[200:201], v[200:201], v[6:7]
 v_pk_add_f32 v[4:5], v[4:5], v[202:203]
 v_pk_fma_f32 v[8:9], v[202:203], v[202:203], v[8:9]
 v_pk_add_f32 v[2:3], v[2:3], v[204:205]
 v_pk_fma_f32 v[6:7], v[204:205], v[204:205], v[6:7]
 v_pk_add_f32 v[4:5], v[4:5], v[206:207]
 v_pk_fma_f32 v[8:9], v[206:207], v[206:207], v[8:9]
 v_pk_add_f32 v[16:17], v[2:3], v[4:5]
 v_pk_add_f32 v[20:21], v[6:7], v[8:9]
 ds_read_b128 v[8:11], v14 offset:0
 ds_read_b128 v[12:15], v15 offset:0
 v_mov_b32 v2, v0
 v_lshrrev_b32 v3, 2, v0
 v_and_b32 v3, 0xf0, v3
 s_lshl_b32 s25, s16, 2
 s_add_u32 s25, s25, 0x17f00
 v_add_u32 v3, s25, v3
 s_add_u32 s40, s24, 0xc000
 s_add_u32 s41, s24, 0x18000
 s_mov_b32 s42, 0
 s_mov_b32 s43, 0
 s_mov_b32 s19, 15
 s_waitcnt vmcnt(6)
 s_waitcnt lgkmcnt(0)
 s_barrier
 ds_read_b128 a[192:195], v2 offset:0
 ds_read_b128 a[196:199], v2 offset:1024
 ds_read_b128 a[200:203], v2 offset:2048
 ds_read_b128 a[204:207], v2 offset:3072
 s_add_u32 m0, s24, 0xc000
 s_nop 0
 buffer_load_dwordx4 v0, s[36:39], s17 offen offset:0 sc1 lds
 buffer_load_dwordx4 v0, s[36:39], s17 offen offset:1024 sc1 lds
 buffer_load_dwordx4 v0, s[36:39], s17 offen offset:2048 sc1 lds
 s_add_u32 s17, s17, 0xc00
 s_add_u32 m0, s24, 0xcc00
 s_nop 0
 buffer_load_dwordx4 v0, s[36:39], s17 offen offset:0 sc1 lds
 buffer_load_dwordx4 v0, s[36:39], s17 offen offset:1024 sc1 lds
 buffer_load_dwordx4 v0, s[36:39], s17 offen offset:2048 sc1 lds
 v_add_f32 v16, v16, v17
 v_add_f32 v20, v20, v21
 v_mov_b32 v18, v16
 v_mov_b32 v22, v20
 s_nop 1
 v_permlane16_swap_b32 v16, v18
 v_permlane16_swap_b32 v20, v22
 s_nop 1
 v_add_f32 v16, v16, v18
 v_add_f32 v20, v20, v22
 v_mov_b32 v18, v16
 v_mov_b32 v22, v20
 s_nop 1
 v_permlane32_swap_b32 v16, v18
 v_permlane32_swap_b32 v20, v22
 s_nop 1
 v_add_f32 v16, v16, v18
 v_add_f32 v20, v20, v22
 v_mul_f32 v16, 0x3b2aaaab, v16
 v_mul_f32 v20, 0x3b2aaaab, v20
 v_fma_f32 v20, -v16, v16, v20
 v_max_f32 v20, 0, v20
 v_cvt_pk_bf16_f32 v18, v16, v20
 v_lshlrev_b32 v16, 16, v18
 v_and_b32 v20, 0xffff0000, v18
 v_add_f32 v20, 0x3727c5ac, v20
 v_cvt_pk_bf16_f32 v20, v20, v20
 v_and_b32 v20, 0xffff0000, v20
 v_sqrt_f32 v20, v20
 s_nop 0
 v_cvt_pk_bf16_f32 v20, v20, v20
 v_and_b32 v20, 0xffff0000, v20
 v_rcp_f32 v20, v20
 s_nop 0
 v_mul_f32 v22, s22, v20
 v_mul_f32_e64 v23, -v16, v22
 s_nop 0
 v_pk_fma_f32 v[206:207], v[206:207], v[22:23], v[22:23] op_sel:[0,0,1] op_sel_hi:[1,0,1]
 v_pk_fma_f32 v[204:205], v[204:205], v[22:23], v[22:23] op_sel:[0,0,1] op_sel_hi:[1,0,1]
 v_pk_fma_f32 v[202:203], v[202:203], v[22:23], v[22:23] op_sel:[0,0,1] op_sel_hi:[1,0,1]
 v_pk_fma_f32 v[200:201], v[200:201], v[22:23], v[22:23] op_sel:[0,0,1] op_sel_hi:[1,0,1]
 v_cvt_pk_bf16_f32 v207, v206, v207
 v_cvt_pk_bf16_f32 v206, v204, v205
 v_cvt_pk_bf16_f32 v205, v202, v203
 v_cvt_pk_bf16_f32 v204, v200, v201
 v_pk_fma_f32 v[198:199], v[198:199], v[22:23], v[22:23] op_sel:[0,0,1] op_sel_hi:[1,0,1]
 v_pk_fma_f32 v[196:197], v[196:197], v[22:23], v[22:23] op_sel:[0,0,1] op_sel_hi:[1,0,1]
 v_pk_fma_f32 v[194:195], v[194:195], v[22:23], v[22:23] op_sel:[0,0,1] op_sel_hi:[1,0,1]
 v_pk_fma_f32 v[192:193], v[192:193], v[22:23], v[22:23] op_sel:[0,0,1] op_sel_hi:[1,0,1]
 v_cvt_pk_bf16_f32 v203, v198, v199
 v_cvt_pk_bf16_f32 v202, v196, v197
 v_cvt_pk_bf16_f32 v201, v194, v195
 v_cvt_pk_bf16_f32 v200, v192, v193
 v_pk_fma_f32 v[190:191], v[190:191], v[22:23], v[22:23] op_sel:[0,0,1] op_sel_hi:[1,0,1]
 v_pk_fma_f32 v[188:189], v[188:189], v[22:23], v[22:23] op_sel:[0,0,1] op_sel_hi:[1,0,1]
 v_pk_fma_f32 v[186:187], v[186:187], v[22:23], v[22:23] op_sel:[0,0,1] op_sel_hi:[1,0,1]
 v_pk_fma_f32 v[184:185], v[184:185], v[22:23], v[22:23] op_sel:[0,0,1] op_sel_hi:[1,0,1]
 v_cvt_pk_bf16_f32 v199, v190, v191
 v_cvt_pk_bf16_f32 v198, v188, v189
 v_cvt_pk_bf16_f32 v197, v186, v187
 v_cvt_pk_bf16_f32 v196, v184, v185
 v_pk_fma_f32 v[182:183], v[182:183], v[22:23], v[22:23] op_sel:[0,0,1] op_sel_hi:[1,0,1]
 v_pk_fma_f32 v[180:181], v[180:181], v[22:23], v[22:23] op_sel:[0,0,1] op_sel_hi:[1,0,1]
 v_pk_fma_f32 v[178:179], v[178:179], v[22:23], v[22:23] op_sel:[0,0,1] op_sel_hi:[1,0,1]
 v_pk_fma_f32 v[176:177], v[176:177], v[22:23], v[22:23] op_sel:[0,0,1] op_sel_hi:[1,0,1]
 v_cvt_pk_bf16_f32 v195, v182, v183
 v_cvt_pk_bf16_f32 v194, v180, v181
 v_cvt_pk_bf16_f32 v193, v178, v179
 v_cvt_pk_bf16_f32 v192, v176, v177
 v_pk_fma_f32 v[174:175], v[174:175], v[22:23], v[22:23] op_sel:[0,0,1] op_sel_hi:[1,0,1]
 v_pk_fma_f32 v[172:173], v[172:173], v[22:23], v[22:23] op_sel:[0,0,1] op_sel_hi:[1,0,1]
 v_pk_fma_f32 v[170:171], v[170:171], v[22:23], v[22:23] op_sel:[0,0,1] op_sel_hi:[1,0,1]
 v_pk_fma_f32 v[168:169], v[168:169], v[22:23], v[22:23] op_sel:[0,0,1] op_sel_hi:[1,0,1]
 v_cvt_pk_bf16_f32 v191, v174, v175
 v_cvt_pk_bf16_f32 v190, v172, v173
 v_cvt_pk_bf16_f32 v189, v170, v171
 v_cvt_pk_bf16_f32 v188, v168, v169
 v_pk_fma_f32 v[166:167], v[166:167], v[22:23], v[22:23] op_sel:[0,0,1] op_sel_hi:[1,0,1]
 v_pk_fma_f32 v[164:165], v[164:165], v[22:23], v[22:23] op_sel:[0,0,1] op_sel_hi:[1,0,1]
 v_pk_fma_f32 v[162:163], v[162:163], v[22:23], v[22:23] op_sel:[0,0,1] op_sel_hi:[1,0,1]
 v_pk_fma_f32 v[160:161], v[160:161], v[22:23], v[22:23] op_sel:[0,0,1] op_sel_hi:[1,0,1]
 v_cvt_pk_bf16_f32 v187, v166, v167
 v_cvt_pk_bf16_f32 v186, v164, v165
 v_cvt_pk_bf16_f32 v185, v162, v163
 v_cvt_pk_bf16_f32 v184, v160, v161
 v_pk_fma_f32 v[158:159], v[158:159], v[22:23], v[22:23] op_sel:[0,0,1] op_sel_hi:[1,0,1]
 v_pk_fma_f32 v[156:157], v[156:157], v[22:23], v[22:23] op_sel:[0,0,1] op_sel_hi:[1,0,1]
 v_pk_fma_f32 v[154:155], v[154:155], v[22:23], v[22:23] op_sel:[0,0,1] op_sel_hi:[1,0,1]
 v_pk_fma_f32 v[152:153], v[152:153], v[22:23], v[22:23] op_sel:[0,0,1] op_sel_hi:[1,0,1]
 v_cvt_pk_bf16_f32 v183, v158, v159
 v_cvt_pk_bf16_f32 v182, v156, v157
 v_cvt_pk_bf16_f32 v181, v154, v155
 v_cvt_pk_bf16_f32 v180, v152, v153
 v_pk_fma_f32 v[150:151], v[150:151], v[22:23], v[22:23] op_sel:[0,0,1] op_sel_hi:[1,0,1]
 v_pk_fma_f32 v[148:149], v[148:149], v[22:23], v[22:23] op_sel:[0,0,1] op_sel_hi:[1,0,1]
 v_pk_fma_f32 v[146:147], v[146:147], v[22:23], v[22:23] op_sel:[0,0,1] op_sel_hi:[1,0,1]
 v_pk_fma_f32 v[144:145], v[144:145], v[22:23], v[22:23] op_sel:[0,0,1] op_sel_hi:[1,0,1]
 v_cvt_pk_bf16_f32 v179, v150, v151
 v_cvt_pk_bf16_f32 v178, v148, v149
 v_cvt_pk_bf16_f32 v177, v146, v147
 v_cvt_pk_bf16_f32 v176, v144, v145
 v_pk_fma_f32 v[142:143], v[142:143], v[22:23], v[22:23] op_sel:[0,0,1] op_sel_hi:[1,0,1]
 v_pk_fma_f32 v[140:141], v[140:141], v[22:23], v[22:23] op_sel:[0,0,1] op_sel_hi:[1,0,1]
 v_pk_fma_f32 v[138:139], v[138:139], v[22:23], v[22:23] op_sel:[0,0,1] op_sel_hi:[1,0,1]
 v_pk_fma_f32 v[136:137], v[136:137], v[22:23], v[22:23] op_sel:[0,0,1] op_sel_hi:[1,0,1]
 v_cvt_pk_bf16_f32 v175, v142, v143
 v_cvt_pk_bf16_f32 v174, v140, v141
 v_cvt_pk_bf16_f32 v173, v138, v139
 v_cvt_pk_bf16_f32 v172, v136, v137
 v_pk_fma_f32 v[134:135], v[134:135], v[22:23], v[22:23] op_sel:[0,0,1] op_sel_hi:[1,0,1]
 v_pk_fma_f32 v[132:133], v[132:133], v[22:23], v[22:23] op_sel:[0,0,1] op_sel_hi:[1,0,1]
 v_pk_fma_f32 v[130:131], v[130:131], v[22:23], v[22:23] op_sel:[0,0,1] op_sel_hi:[1,0,1]
 v_pk_fma_f32 v[128:129], v[128:129], v[22:23], v[22:23] op_sel:[0,0,1] op_sel_hi:[1,0,1]
 v_cvt_pk_bf16_f32 v171, v134, v135
 v_cvt_pk_bf16_f32 v170, v132, v133
 v_cvt_pk_bf16_f32 v169, v130, v131
 v_cvt_pk_bf16_f32 v168, v128, v129
 v_pk_fma_f32 v[126:127], v[126:127], v[22:23], v[22:23] op_sel:[0,0,1] op_sel_hi:[1,0,1]
 v_pk_fma_f32 v[124:125], v[124:125], v[22:23], v[22:23] op_sel:[0,0,1] op_sel_hi:[1,0,1]
 v_pk_fma_f32 v[122:123], v[122:123], v[22:23], v[22:23] op_sel:[0,0,1] op_sel_hi:[1,0,1]
 v_pk_fma_f32 v[120:121], v[120:121], v[22:23], v[22:23] op_sel:[0,0,1] op_sel_hi:[1,0,1]
 v_cvt_pk_bf16_f32 v167, v126, v127
 v_cvt_pk_bf16_f32 v166, v124, v125
 v_cvt_pk_bf16_f32 v165, v122, v123
 v_cvt_pk_bf16_f32 v164, v120, v121
 v_pk_fma_f32 v[118:119], v[118:119], v[22:23], v[22:23] op_sel:[0,0,1] op_sel_hi:[1,0,1]
 v_pk_fma_f32 v[116:117], v[116:117], v[22:23], v[22:23] op_sel:[0,0,1] op_sel_hi:[1,0,1]
 v_pk_fma_f32 v[114:115], v[114:115], v[22:23], v[22:23] op_sel:[0,0,1] op_sel_hi:[1,0,1]
 v_pk_fma_f32 v[112:113], v[112:113], v[22:23], v[22:23] op_sel:[0,0,1] op_sel_hi:[1,0,1]
 v_cvt_pk_bf16_f32 v163, v118, v119
 v_cvt_pk_bf16_f32 v162, v116, v117
 v_cvt_pk_bf16_f32 v161, v114, v115
 v_cvt_pk_bf16_f32 v160, v112, v113
 s_waitcnt vmcnt(6)
 s_cmp_eq_u32 s16, 1
 s_cbranch_scc1 L_k1_pre1
 s_cmp_eq_u32 s16, 2
 s_cbranch_scc1 L_k1_pre2
 s_cmp_eq_u32 s16, 3
 s_cbranch_scc1 L_k1_pre3
L_k1_pre0:
 s_waitcnt lgkmcnt(0)
L_k1_loop0:
 v_mfma_f32_16x16x32_bf16 v[64:67], a[192:195], a[0:3], 0
 s_add_u32 s30, s30, 0x4000
 v_exp_f32 v16, v16
 v_mfma_f32_16x16x32_bf16 v[64:67], a[196:199], a[4:7], v[64:67]
 ds_read_b128 v[144:147], v2 offset:4096
 v_add_f32_dpp v4, v4, v4 row_ror:8 row_mask:0xf bank_mask:0x3
 v_mfma_f32_16x16x32_bf16 v[64:67], a[200:203], a[8:11], v[64:67]
 s_add_u32 s31, s31, 0x4000
 v_exp_f32 v17, v17
 v_mfma_f32_16x16x32_bf16 v[64:67], a[204:207], a[12:15], v[64:67]
 ds_read_b128 v[148:151], v2 offset:5120
 v_add_f32_dpp v5, v5, v5 row_ror:8 row_mask:0xf bank_mask:0x3
 v_mfma_f32_16x16x32_bf16 v[68:71], a[204:207], a[60:63], 0
 s_add_u32 s40, s40, 24576
 v_exp_f32 v18, v18
 v_mfma_f32_16x16x32_bf16 v[68:71], a[200:203], a[56:59], v[68:71]
 ds_read_b128 v[152:155], v2 offset:6144
 v_add_f32_dpp v4, v6, v6 row_ror:8 row_mask:0xf bank_mask:0xc
 v_mfma_f32_16x16x32_bf16 v[68:71], a[196:199], a[52:55], v[68:71]
 s_cmp_eq_u32 s40, s41
 v_exp_f32 v19, v19
 v_mfma_f32_16x16x32_bf16 v[68:71], a[192:195], a[48:51], v[68:71]
 ds_read_b128 v[156:159], v2 offset:7168
 v_add_f32_dpp v5, v7, v7 row_ror:8 row_mask:0xf bank_mask:0xc
 v_mfma_f32_16x16x32_bf16 v[72:75], a[192:195], a[96:99], 0
 s_cselect_b32 s40, s24, s40
 v_exp_f32 v20, v20
 v_mfma_f32_16x16x32_bf16 v[72:75], a[196:199], a[100:103], v[72:75]
 v_exp_f32 v21, v21
 v_mfma_f32_16x16x32_bf16 v[72:75], a[200:203], a[104:107], v[72:75]
 s_add_u32 s17, s17, 0x5400
 v_exp_f32 v22, v22
 v_mfma_f32_16x16x32_bf16 v[72:75], a[204:207], a[108:111], v[72:75]
 v_exp_f32 v23, v23
 v_mfma_f32_16x16x32_bf16 v[76:79], a[204:207], v[172:175], 0
 s_add_u32 m0, s40, 0
 v_exp_f32 v24, v24
 v_mfma_f32_16x16x32_bf16 v[76:79], a[200:203], v[168:171], v[76:79]
 v_exp_f32 v25, v25
 v_mfma_f32_16x16x32_bf16 v[76:79], a[196:199], v[164:167], v[76:79]
 v_exp_f32 v26, v26
 v_mfma_f32_16x16x32_bf16 v[76:79], a[192:195], v[160:163], v[76:79]
 s_waitcnt lgkmcnt(0)
 v_exp_f32 v27, v27
 v_mfma_f32_16x16x32_bf16 v[64:67], v[144:147], a[16:19], v[64:67]
 v_exp_f32 v28, v28
 v_mfma_f32_16x16x32_bf16 v[64:67], v[148:151], a[20:23], v[64:67]
 ds_read_b128 a[192:195], v2 offset:8192
 v_add_f32_dpp v4, v4, v4 row_shl:4 row_mask:0xf bank_mask:0x5
 v_mfma_f32_16x16x32_bf16 v[64:67], v[152:155], a[24:27], v[64:67]
 v_exp_f32 v29, v29
 v_mfma_f32_16x16x32_bf16 v[64:67], v[156:159], a[28:31], v[64:67]
 ds_read_b128 a[196:199], v2 offset:9216
 v_add_f32_dpp v4, v5, v5 row_shr:4 row_mask:0xf bank_mask:0xa
 v_mfma_f32_16x16x32_bf16 v[68:71], v[156:159], a[76:79], v[68:71]
 v_exp_f32 v30, v30
 v_mfma_f32_16x16x32_bf16 v[68:71], v[152:155], a[72:75], v[68:71]
 ds_read_b128 a[200:203], v2 offset:10240
 v_add_f32_dpp v4, v4, v4 quad_perm:[2,3,0,1] row_mask:0xf bank_mask:0xf
 v_mfma_f32_16x16x32_bf16 v[68:71], v[148:151], a[68:71], v[68:71]
 v_exp_f32 v31, v31
 v_mfma_f32_16x16x32_bf16 v[68:71], v[144:147], a[64:67], v[68:71]
 ds_read_b128 a[204:207], v2 offset:11264
 v_add_f32_dpp v4, v4, v4 quad_perm:[1,0,3,2] row_mask:0xf bank_mask:0xf
 v_mfma_f32_16x16x32_bf16 v[72:75], v[144:147], a[112:115], v[72:75]
 v_rcp_f32 v96, v96
 v_mfma_f32_16x16x32_bf16 v[72:75], v[148:151], a[116:119], v[72:75]
 v_rcp_f32 v97, v97
 v_mfma_f32_16x16x32_bf16 v[72:75], v[152:155], a[120:123], v[72:75]
 ds_write_b32 v3, v4 offset:256
 v_mfma_f32_16x16x32_bf16 v[72:75], v[156:159], a[124:127], v[72:75]
 v_rcp_f32 v98, v98
 v_mfma_f32_16x16x32_bf16 v[76:79], v[156:159], v[188:191], v[76:79]
 v_rcp_f32 v99, v99
 v_mfma_f32_16x16x32_bf16 v[76:79], v[152:155], v[184:187], v[76:79]
 v_rcp_f32 v100, v100
 v_mfma_f32_16x16x32_bf16 v[76:79], v[148:151], v[180:183], v[76:79]
 v_rcp_f32 v101, v101
 v_mfma_f32_16x16x32_bf16 v[76:79], v[144:147], v[176:179], v[76:79]
 s_waitcnt lgkmcnt(1)
 v_rcp_f32 v102, v102
 v_mfma_f32_16x16x32_bf16 v[64:67], a[192:195], a[32:35], v[64:67]
 v_rcp_f32 v103, v103
 v_mfma_f32_16x16x32_bf16 v[64:67], a[196:199], a[36:39], v[64:67]
 ds_read_b128 v[144:147], v2 offset:12288
 v_cvt_pk_bf16_f32 v114, v80, v81
 v_mfma_f32_16x16x32_bf16 v[64:67], a[200:203], a[40:43], v[64:67]
 v_rcp_f32 v104, v104
 v_mfma_f32_16x16x32_bf16 v[64:67], a[204:207], a[44:47], v[64:67]
 ds_read_b128 v[148:151], v2 offset:13312
 v_cvt_pk_bf16_f32 v115, v82, v83
 v_mfma_f32_16x16x32_bf16 v[68:71], a[204:207], a[92:95], v[68:71]
 v_rcp_f32 v105, v105
 v_mfma_f32_16x16x32_bf16 v[68:71], a[200:203], a[88:91], v[68:71]
 ds_read_b128 v[152:155], v2 offset:14336
 v_cvt_pk_bf16_f32 v118, v84, v85
 v_mfma_f32_16x16x32_bf16 v[68:71], a[196:199], a[84:87], v[68:71]
 v_rcp_f32 v106, v106
 v_mfma_f32_16x16x32_bf16 v[68:71], a[192:195], a[80:83], v[68:71]
 ds_read_b128 v[156:159], v2 offset:15360
 v_cvt_pk_bf16_f32 v119, v86, v87
 v_mfma_f32_16x16x32_bf16 v[72:75], a[192:195], a[128:131], v[72:75]
 v_rcp_f32 v107, v107
 v_mfma_f32_16x16x32_bf16 v[72:75], a[196:199], a[132:135], v[72:75]
 v_cvt_pk_bf16_f32 v130, v88, v89
 v_cvt_pk_bf16_f32 v131, v90, v91
 v_mfma_f32_16x16x32_bf16 v[72:75], a[200:203], a[136:139], v[72:75]
 v_rcp_f32 v108, v108
 v_mfma_f32_16x16x32_bf16 v[72:75], a[204:207], a[140:143], v[72:75]
 v_cvt_pk_bf16_f32 v134, v92, v93
 v_cvt_pk_bf16_f32 v135, v94, v95
 v_mfma_f32_16x16x32_bf16 v[76:79], a[204:207], v[204:207], v[76:79]
 v_rcp_f32 v109, v109
 v_mfma_f32_16x16x32_bf16 v[76:79], a[200:203], v[200:203], v[76:79]
 v_rcp_f32 v110, v110
 v_mfma_f32_16x16x32_bf16 v[76:79], a[196:199], v[196:199], v[76:79]
 s_waitcnt vmcnt(10) lgkmcnt(0)
 v_rcp_f32_e64 v111, v111
 v_mfma_f32_16x16x32_bf16 v[76:79], a[192:195], v[192:195], v[76:79]
 s_barrier
 buffer_store_dwordx4 v[112:115], v0, s[32:35], s28 offen sc1
 buffer_load_dwordx4 v0, s[36:39], s17 offen offset:0 sc1 lds
 buffer_store_dwordx4 v[116:119], v0, s[32:35], s29 offen sc1
 buffer_load_dwordx4 v0, s[36:39], s17 offen offset:1024 sc1 lds
 buffer_load_dwordx4 v0, s[36:39], s17 offen offset:2048 sc1 lds
 v_pk_mul_f32 v[96:97], v[96:97], v[32:33]
 v_pk_mul_f32 v[98:99], v[98:99], v[34:35]
 v_pk_mul_f32 v[100:101], v[100:101], v[36:37]
 v_pk_mul_f32 v[102:103], v[102:103], v[38:39]
 v_pk_mul_f32 v[104:105], v[104:105], v[40:41]
 v_pk_mul_f32 v[106:107], v[106:107], v[42:43]
 v_pk_mul_f32 v[108:109], v[108:109], v[44:45]
 v_pk_mul_f32 v[110:111], v[110:111], v[46:47]
 v_pk_mul_f32 v[4:5], v[96:97], v[96:97]
 v_pk_fma_f32 v[16:17], v[16:17], s[22:23], s[22:23]
 v_pk_mul_f32 v[6:7], v[98:99], v[98:99]
 v_pk_fma_f32 v[18:19], v[18:19], s[22:23], s[22:23]
 v_pk_fma_f32 v[4:5], v[100:101], v[100:101], v[4:5]
 v_pk_fma_f32 v[20:21], v[20:21], s[22:23], s[22:23]
 v_pk_fma_f32 v[6:7], v[102:103], v[102:103], v[6:7]
 v_pk_fma_f32 v[22:23], v[22:23], s[22:23], s[22:23]
 v_pk_fma_f32 v[4:5], v[104:105], v[104:105], v[4:5]
 v_pk_fma_f32 v[24:25], v[24:25], s[22:23], s[22:23]
 v_pk_fma_f32 v[6:7], v[106:107], v[106:107], v[6:7]
 v_pk_fma_f32 v[26:27], v[26:27], s[22:23], s[22:23]
 v_pk_fma_f32 v[4:5], v[108:109], v[108:109], v[4:5]
 v_pk_fma_f32 v[28:29], v[28:29], s[22:23], s[22:23]
 v_pk_fma_f32 v[6:7], v[110:111], v[110:111], v[6:7]
 v_pk_fma_f32 v[30:31], v[30:31], s[22:23], s[22:23]
 v_pk_fma_f32 v[32:33], v[64:65], v[64:65], s[20:21]
 v_pk_fma_f32 v[34:35], v[66:67], v[66:67], s[20:21]
 v_pk_fma_f32 v[36:37], v[68:69], v[68:69], s[20:21]
 v_pk_fma_f32 v[38:39], v[70:71], v[70:71], s[20:21]
 v_pk_fma_f32 v[40:41], v[72:73], v[72:73], s[20:21]
 v_pk_fma_f32 v[42:43], v[74:75], v[74:75], s[20:21]
 v_pk_fma_f32 v[44:45], v[76:77], v[76:77], s[20:21]
 v_pk_fma_f32 v[46:47], v[78:79], v[78:79], s[20:21]
 v_pk_mul_f32 v[32:33], v[32:33], v[64:65] neg_lo:[1,0] neg_hi:[1,0]
 v_pk_mul_f32 v[34:35], v[34:35], v[66:67] neg_lo:[1,0] neg_hi:[1,0]
 v_pk_mul_f32 v[36:37], v[36:37], v[68:69] neg_lo:[1,0] neg_hi:[1,0]
 v_pk_mul_f32 v[38:39], v[38:39], v[70:71] neg_lo:[1,0] neg_hi:[1,0]
 v_pk_mul_f32 v[40:41], v[40:41], v[72:73] neg_lo:[1,0] neg_hi:[1,0]
 v_pk_mul_f32 v[42:43], v[42:43], v[74:75] neg_lo:[1,0] neg_hi:[1,0]
 v_pk_mul_f32 v[44:45], v[44:45], v[76:77] neg_lo:[1,0] neg_hi:[1,0]
 v_pk_mul_f32 v[46:47], v[46:47], v[78:79] neg_lo:[1,0] neg_hi:[1,0]
 v_mfma_f32_16x16x32_bf16 v[80:83], v[144:147], a[0:3], 0
 s_add_u32 s28, s28, 0x4000
 v_exp_f32 v32, v32
 v_mfma_f32_16x16x32_bf16 v[80:83], v[148:151], a[4:7], v[80:83]
 ds_read_b128 a[192:195], v2 offset:16384
 v_add_f32_dpp v4, v4, v4 row_ror:8 row_mask:0xf bank_mask:0x3
 v_mfma_f32_16x16x32_bf16 v[80:83], v[152:155], a[8:11], v[80:83]
 s_add_u32 s29, s29, 0x4000
 v_exp_f32 v33, v33
 v_mfma_f32_16x16x32_bf16 v[80:83], v[156:159], a[12:15], v[80:83]
 ds_read_b128 a[196:199], v2 offset:17408
 v_add_f32_dpp v5, v5, v5 row_ror:8 row_mask:0xf bank_mask:0x3
 v_mfma_f32_16x16x32_bf16 v[84:87], v[156:159], a[60:63], 0
 s_add_u32 s42, s42, 24576
 v_exp_f32 v34, v34
 v_mfma_f32_16x16x32_bf16 v[84:87], v[152:155], a[56:59], v[84:87]
 ds_read_b128 a[200:203], v2 offset:18432
 v_add_f32_dpp v4, v6, v6 row_ror:8 row_mask:0xf bank_mask:0xc
 v_mfma_f32_16x16x32_bf16 v[84:87], v[148:151], a[52:55], v[84:87]
 s_cmp_eq_u32 s42, 98304
 v_exp_f32 v35, v35
 v_mfma_f32_16x16x32_bf16 v[84:87], v[144:147], a[48:51], v[84:87]
 ds_read_b128 a[204:207], v2 offset:19456
 v_add_f32_dpp v5, v7, v7 row_ror:8 row_mask:0xf bank_mask:0xc
 v_mfma_f32_16x16x32_bf16 v[88:91], v[144:147], a[96:99], 0
 s_cselect_b32 s42, 0, s42
 v_exp_f32 v36, v36
 v_mfma_f32_16x16x32_bf16 v[88:91], v[148:151], a[100:103], v[88:91]
 v_exp_f32 v37, v37
 v_mfma_f32_16x16x32_bf16 v[88:91], v[152:155], a[104:107], v[88:91]
 s_add_u32 s17, s17, 0xc00
 v_exp_f32 v38, v38
 v_mfma_f32_16x16x32_bf16 v[88:91], v[156:159], a[108:111], v[88:91]
 v_exp_f32 v39, v39
 v_mfma_f32_16x16x32_bf16 v[92:95], v[156:159], v[172:175], 0
 s_add_u32 m0, s40, 3072
 v_exp_f32 v40, v40
 v_mfma_f32_16x16x32_bf16 v[92:95], v[152:155], v[168:171], v[92:95]
 v_exp_f32 v41, v41
 v_mfma_f32_16x16x32_bf16 v[92:95], v[148:151], v[164:167], v[92:95]
 v_exp_f32 v42, v42
 v_mfma_f32_16x16x32_bf16 v[92:95], v[144:147], v[160:163], v[92:95]
 s_waitcnt lgkmcnt(0)
 v_exp_f32 v43, v43
 v_mfma_f32_16x16x32_bf16 v[80:83], a[192:195], a[16:19], v[80:83]
 v_exp_f32 v44, v44
 v_mfma_f32_16x16x32_bf16 v[80:83], a[196:199], a[20:23], v[80:83]
 ds_read_b128 v[144:147], v2 offset:20480
 v_add_f32_dpp v4, v4, v4 row_shl:4 row_mask:0xf bank_mask:0x5
 v_mfma_f32_16x16x32_bf16 v[80:83], a[200:203], a[24:27], v[80:83]
 v_exp_f32 v45, v45
 v_mfma_f32_16x16x32_bf16 v[80:83], a[204:207], a[28:31], v[80:83]
 ds_read_b128 v[148:151], v2 offset:21504
 v_add_f32_dpp v4, v5, v5 row_shr:4 row_mask:0xf bank_mask:0xa
 v_mfma_f32_16x16x32_bf16 v[84:87], a[204:207], a[76:79], v[84:87]
 v_exp_f32 v46, v46
 v_mfma_f32_16x16x32_bf16 v[84:87], a[200:203], a[72:75], v[84:87]
 ds_read_b128 v[152:155], v2 offset:22528
 v_add_f32_dpp v4, v4, v4 quad_perm:[2,3,0,1] row_mask:0xf bank_mask:0xf
 v_mfma_f32_16x16x32_bf16 v[84:87], a[196:199], a[68:71], v[84:87]
 v_exp_f32 v47, v47
 v_mfma_f32_16x16x32_bf16 v[84:87], a[192:195], a[64:67], v[84:87]
 ds_read_b128 v[156:159], v2 offset:23552
 v_add_f32_dpp v4, v4, v4 quad_perm:[1,0,3,2] row_mask:0xf bank_mask:0xf
 v_mfma_f32_16x16x32_bf16 v[88:91], a[192:195], a[112:115], v[88:91]
 v_rcp_f32 v16, v16
 v_mfma_f32_16x16x32_bf16 v[88:91], a[196:199], a[116:119], v[88:91]
 v_rcp_f32 v17, v17
 v_mfma_f32_16x16x32_bf16 v[88:91], a[200:203], a[120:123], v[88:91]
 ds_write_b32 v3, v4 offset:512
 v_add_u32 v2, s42, v0
 v_mfma_f32_16x16x32_bf16 v[88:91], a[204:207], a[124:127], v[88:91]
 v_rcp_f32 v18, v18
 v_mfma_f32_16x16x32_bf16 v[92:95], a[204:207], v[188:191], v[92:95]
 v_rcp_f32 v19, v19
 v_mfma_f32_16x16x32_bf16 v[92:95], a[200:203], v[184:187], v[92:95]
 v_rcp_f32 v20, v20
 v_mfma_f32_16x16x32_bf16 v[92:95], a[196:199], v[180:183], v[92:95]
 v_rcp_f32 v21, v21
 v_mfma_f32_16x16x32_bf16 v[92:95], a[192:195], v[176:179], v[92:95]
 s_waitcnt lgkmcnt(1)
 v_rcp_f32 v22, v22
 v_mfma_f32_16x16x32_bf16 v[80:83], v[144:147], a[32:35], v[80:83]
 v_rcp_f32 v23, v23
 v_mfma_f32_16x16x32_bf16 v[80:83], v[148:151], a[36:39], v[80:83]
 ds_read_b128 a[192:195], v2 offset:0
 v_cvt_pk_bf16_f32 v112, v96, v97
 v_mfma_f32_16x16x32_bf16 v[80:83], v[152:155], a[40:43], v[80:83]
 v_rcp_f32 v24, v24
 v_mfma_f32_16x16x32_bf16 v[80:83], v[156:159], a[44:47], v[80:83]
 ds_read_b128 a[196:199], v2 offset:1024
 v_cvt_pk_bf16_f32 v113, v98, v99
 v_mfma_f32_16x16x32_bf16 v[84:87], v[156:159], a[92:95], v[84:87]
 v_rcp_f32 v25, v25
 v_mfma_f32_16x16x32_bf16 v[84:87], v[152:155], a[88:91], v[84:87]
 ds_read_b128 a[200:203], v2 offset:2048
 v_cvt_pk_bf16_f32 v116, v100, v101
 v_mfma_f32_16x16x32_bf16 v[84:87], v[148:151], a[84:87], v[84:87]
 v_rcp_f32 v26, v26
 v_mfma_f32_16x16x32_bf16 v[84:87], v[144:147], a[80:83], v[84:87]
 ds_read_b128 a[204:207], v2 offset:3072
 v_cvt_pk_bf16_f32 v117, v102, v103
 v_mfma_f32_16x16x32_bf16 v[88:91], v[144:147], a[128:131], v[88:91]
 v_rcp_f32 v27, v27
 v_mfma_f32_16x16x32_bf16 v[88:91], v[148:151], a[132:135], v[88:91]
 v_cvt_pk_bf16_f32 v136, v104, v105
 v_cvt_pk_bf16_f32 v137, v106, v107
 v_mfma_f32_16x16x32_bf16 v[88:91], v[152:155], a[136:139], v[88:91]
 v_rcp_f32 v28, v28
 v_mfma_f32_16x16x32_bf16 v[88:91], v[156:159], a[140:143], v[88:91]
 v_cvt_pk_bf16_f32 v140, v108, v109
 v_cvt_pk_bf16_f32 v141, v110, v111
 v_mfma_f32_16x16x32_bf16 v[92:95], v[156:159], v[204:207], v[92:95]
 v_rcp_f32 v29, v29
 v_mfma_f32_16x16x32_bf16 v[92:95], v[152:155], v[200:203], v[92:95]
 v_rcp_f32 v30, v30
 v_mfma_f32_16x16x32_bf16 v[92:95], v[148:151], v[196:199], v[92:95]
 s_waitcnt lgkmcnt(0)
 v_rcp_f32_e64 v31, v31
 v_mfma_f32_16x16x32_bf16 v[92:95], v[144:147], v[192:195], v[92:95]
 buffer_store_dwordx4 v[128:131], v0, s[32:35], s30 offen sc1
 buffer_load_dwordx4 v0, s[36:39], s17 offen offset:0 sc1 lds
 buffer_store_dwordx4 v[132:135], v0, s[32:35], s31 offen sc1
 buffer_load_dwordx4 v0, s[36:39], s17 offen offset:1024 sc1 lds
 buffer_load_dwordx4 v0, s[36:39], s17 offen offset:2048 sc1 lds
 v_pk_mul_f32 v[16:17], v[16:17], v[48:49]
 v_pk_mul_f32 v[18:19], v[18:19], v[50:51]
 v_pk_mul_f32 v[20:21], v[20:21], v[52:53]
 v_pk_mul_f32 v[22:23], v[22:23], v[54:55]
 v_pk_mul_f32 v[24:25], v[24:25], v[56:57]
 v_pk_mul_f32 v[26:27], v[26:27], v[58:59]
 v_pk_mul_f32 v[28:29], v[28:29], v[60:61]
 v_pk_mul_f32 v[30:31], v[30:31], v[62:63]
 v_pk_mul_f32 v[4:5], v[16:17], v[16:17]
 v_pk_fma_f32 v[32:33], v[32:33], s[22:23], s[22:23]
 v_pk_mul_f32 v[6:7], v[18:19], v[18:19]
 v_pk_fma_f32 v[34:35], v[34:35], s[22:23], s[22:23]
 v_pk_fma_f32 v[4:5], v[20:21], v[20:21], v[4:5]
 v_pk_fma_f32 v[36:37], v[36:37], s[22:23], s[22:23]
 v_pk_fma_f32 v[6:7], v[22:23], v[22:23], v[6:7]
 v_pk_fma_f32 v[38:39], v[38:39], s[22:23], s[22:23]
 v_pk_fma_f32 v[4:5], v[24:25], v[24:25], v[4:5]
 v_pk_fma_f32 v[40:41], v[40:41], s[22:23], s[22:23]
 v_pk_fma_f32 v[6:7], v[26:27], v[26:27], v[6:7]
 v_pk_fma_f32 v[42:43], v[42:43], s[22:23], s[22:23]
 v_pk_fma_f32 v[4:5], v[28:29], v[28:29], v[4:5]
 v_pk_fma_f32 v[44:45], v[44:45], s[22:23], s[22:23]
 v_pk_fma_f32 v[6:7], v[30:31], v[30:31], v[6:7]
 v_pk_fma_f32 v[46:47], v[46:47], s[22:23], s[22:23]
 v_pk_fma_f32 v[48:49], v[80:81], v[80:81], s[20:21]
 v_pk_fma_f32 v[50:51], v[82:83], v[82:83], s[20:21]
 v_pk_fma_f32 v[52:53], v[84:85], v[84:85], s[20:21]
 v_pk_fma_f32 v[54:55], v[86:87], v[86:87], s[20:21]
 v_pk_fma_f32 v[56:57], v[88:89], v[88:89], s[20:21]
 v_pk_fma_f32 v[58:59], v[90:91], v[90:91], s[20:21]
 v_pk_fma_f32 v[60:61], v[92:93], v[92:93], s[20:21]
 v_pk_fma_f32 v[62:63], v[94:95], v[94:95], s[20:21]
 v_pk_mul_f32 v[48:49], v[48:49], v[80:81] neg_lo:[1,0] neg_hi:[1,0]
 v_pk_mul_f32 v[50:51], v[50:51], v[82:83] neg_lo:[1,0] neg_hi:[1,0]
 v_pk_mul_f32 v[52:53], v[52:53], v[84:85] neg_lo:[1,0] neg_hi:[1,0]
 v_pk_mul_f32 v[54:55], v[54:55], v[86:87] neg_lo:[1,0] neg_hi:[1,0]
 v_pk_mul_f32 v[56:57], v[56:57], v[88:89] neg_lo:[1,0] neg_hi:[1,0]
 v_pk_mul_f32 v[58:59], v[58:59], v[90:91] neg_lo:[1,0] neg_hi:[1,0]
 v_pk_mul_f32 v[60:61], v[60:61], v[92:93] neg_lo:[1,0] neg_hi:[1,0]
 v_pk_mul_f32 v[62:63], v[62:63], v[94:95] neg_lo:[1,0] neg_hi:[1,0]
 v_mfma_f32_16x16x32_bf16 v[96:99], a[192:195], a[0:3], 0
 s_add_u32 s30, s30, 0x4000
 v_exp_f32 v48, v48
 v_mfma_f32_16x16x32_bf16 v[96:99], a[196:199], a[4:7], v[96:99]
 ds_read_b128 v[144:147], v2 offset:4096
 v_add_f32_dpp v4, v4, v4 row_ror:8 row_mask:0xf bank_mask:0x3
 v_mfma_f32_16x16x32_bf16 v[96:99], a[200:203], a[8:11], v[96:99]
 s_add_u32 s31, s31, 0x4000
 v_exp_f32 v49, v49
 v_mfma_f32_16x16x32_bf16 v[96:99], a[204:207], a[12:15], v[96:99]
 ds_read_b128 v[148:151], v2 offset:5120
 v_add_f32_dpp v5, v5, v5 row_ror:8 row_mask:0xf bank_mask:0x3
 v_mfma_f32_16x16x32_bf16 v[100:103], a[204:207], a[60:63], 0
 s_add_u32 s40, s40, 24576
 v_exp_f32 v50, v50
 v_mfma_f32_16x16x32_bf16 v[100:103], a[200:203], a[56:59], v[100:103]
 ds_read_b128 v[152:155], v2 offset:6144
 v_add_f32_dpp v4, v6, v6 row_ror:8 row_mask:0xf bank_mask:0xc
 v_mfma_f32_16x16x32_bf16 v[100:103], a[196:199], a[52:55], v[100:103]
 s_cmp_eq_u32 s40, s41
 v_exp_f32 v51, v51
 v_mfma_f32_16x16x32_bf16 v[100:103], a[192:195], a[48:51], v[100:103]
 ds_read_b128 v[156:159], v2 offset:7168
 v_add_f32_dpp v5, v7, v7 row_ror:8 row_mask:0xf bank_mask:0xc
 v_mfma_f32_16x16x32_bf16 v[104:107], a[192:195], a[96:99], 0
 s_cselect_b32 s40, s24, s40
 v_exp_f32 v52, v52
 v_mfma_f32_16x16x32_bf16 v[104:107], a[196:199], a[100:103], v[104:107]
 v_exp_f32 v53, v53
 v_mfma_f32_16x16x32_bf16 v[104:107], a[200:203], a[104:107], v[104:107]
 s_add_u32 s17, s17, 0x5400
 v_exp_f32 v54, v54
 v_mfma_f32_16x16x32_bf16 v[104:107], a[204:207], a[108:111], v[104:107]
 v_exp_f32 v55, v55
 v_mfma_f32_16x16x32_bf16 v[108:111], a[204:207], v[172:175], 0
 s_add_u32 m0, s40, 0
 v_exp_f32 v56, v56
 v_mfma_f32_16x16x32_bf16 v[108:111], a[200:203], v[168:171], v[108:111]
 v_exp_f32 v57, v57
 v_mfma_f32_16x16x32_bf16 v[108:111], a[196:199], v[164:167], v[108:111]
 v_exp_f32 v58, v58
 v_mfma_f32_16x16x32_bf16 v[108:111], a[192:195], v[160:163], v[108:111]
 s_waitcnt lgkmcnt(0)
 v_exp_f32 v59, v59
 v_mfma_f32_16x16x32_bf16 v[96:99], v[144:147], a[16:19], v[96:99]
 v_exp_f32 v60, v60
 v_mfma_f32_16x16x32_bf16 v[96:99], v[148:151], a[20:23], v[96:99]
 ds_read_b128 a[192:195], v2 offset:8192
 v_add_f32_dpp v4, v4, v4 row_shl:4 row_mask:0xf bank_mask:0x5
 v_mfma_f32_16x16x32_bf16 v[96:99], v[152:155], a[24:27], v[96:99]
 v_exp_f32 v61, v61
 v_mfma_f32_16x16x32_bf16 v[96:99], v[156:159], a[28:31], v[96:99]
 ds_read_b128 a[196:199], v2 offset:9216
 v_add_f32_dpp v4, v5, v5 row_shr:4 row_mask:0xf bank_mask:0xa
 v_mfma_f32_16x16x32_bf16 v[100:103], v[156:159], a[76:79], v[100:103]
 v_exp_f32 v62, v62
 v_mfma_f32_16x16x32_bf16 v[100:103], v[152:155], a[72:75], v[100:103]
 ds_read_b128 a[200:203], v2 offset:10240
 v_add_f32_dpp v4, v4, v4 quad_perm:[2,3,0,1] row_mask:0xf bank_mask:0xf
 v_mfma_f32_16x16x32_bf16 v[100:103], v[148:151], a[68:71], v[100:103]
 v_exp_f32 v63, v63
 v_mfma_f32_16x16x32_bf16 v[100:103], v[144:147], a[64:67], v[100:103]
 ds_read_b128 a[204:207], v2 offset:11264
 v_add_f32_dpp v4, v4, v4 quad_perm:[1,0,3,2] row_mask:0xf bank_mask:0xf
 v_mfma_f32_16x16x32_bf16 v[104:107], v[144:147], a[112:115], v[104:107]
 v_rcp_f32 v32, v32
 v_mfma_f32_16x16x32_bf16 v[104:107], v[148:151], a[116:119], v[104:107]
 v_rcp_f32 v33, v33
 v_mfma_f32_16x16x32_bf16 v[104:107], v[152:155], a[120:123], v[104:107]
 ds_write_b32 v3, v4 offset:768
 v_mfma_f32_16x16x32_bf16 v[104:107], v[156:159], a[124:127], v[104:107]
 v_rcp_f32 v34, v34
 v_mfma_f32_16x16x32_bf16 v[108:111], v[156:159], v[188:191], v[108:111]
 v_rcp_f32 v35, v35
 v_mfma_f32_16x16x32_bf16 v[108:111], v[152:155], v[184:187], v[108:111]
 v_rcp_f32 v36, v36
 v_mfma_f32_16x16x32_bf16 v[108:111], v[148:151], v[180:183], v[108:111]
 v_rcp_f32 v37, v37
 v_mfma_f32_16x16x32_bf16 v[108:111], v[144:147], v[176:179], v[108:111]
 s_waitcnt lgkmcnt(1)
 v_rcp_f32 v38, v38
 v_mfma_f32_16x16x32_bf16 v[96:99], a[192:195], a[32:35], v[96:99]
 v_rcp_f32 v39, v39
 v_mfma_f32_16x16x32_bf16 v[96:99], a[196:199], a[36:39], v[96:99]
 ds_read_b128 v[144:147], v2 offset:12288
 v_cvt_pk_bf16_f32 v114, v16, v17
 v_mfma_f32_16x16x32_bf16 v[96:99], a[200:203], a[40:43], v[96:99]
 v_rcp_f32 v40, v40
 v_mfma_f32_16x16x32_bf16 v[96:99], a[204:207], a[44:47], v[96:99]
 ds_read_b128 v[148:151], v2 offset:13312
 v_cvt_pk_bf16_f32 v115, v18, v19
 v_mfma_f32_16x16x32_bf16 v[100:103], a[204:207], a[92:95], v[100:103]
 v_rcp_f32 v41, v41
 v_mfma_f32_16x16x32_bf16 v[100:103], a[200:203], a[88:91], v[100:103]
 ds_read_b128 v[152:155], v2 offset:14336
 v_cvt_pk_bf16_f32 v118, v20, v21
 v_mfma_f32_16x16x32_bf16 v[100:103], a[196:199], a[84:87], v[100:103]
 v_rcp_f32 v42, v42
 v_mfma_f32_16x16x32_bf16 v[100:103], a[192:195], a[80:83], v[100:103]
 ds_read_b128 v[156:159], v2 offset:15360
 v_cvt_pk_bf16_f32 v119, v22, v23
 v_mfma_f32_16x16x32_bf16 v[104:107], a[192:195], a[128:131], v[104:107]
 v_rcp_f32 v43, v43
 v_mfma_f32_16x16x32_bf16 v[104:107], a[196:199], a[132:135], v[104:107]
 v_cvt_pk_bf16_f32 v138, v24, v25
 v_cvt_pk_bf16_f32 v139, v26, v27
 v_mfma_f32_16x16x32_bf16 v[104:107], a[200:203], a[136:139], v[104:107]
 v_rcp_f32 v44, v44
 v_mfma_f32_16x16x32_bf16 v[104:107], a[204:207], a[140:143], v[104:107]
 v_cvt_pk_bf16_f32 v142, v28, v29
 v_cvt_pk_bf16_f32 v143, v30, v31
 v_mfma_f32_16x16x32_bf16 v[108:111], a[204:207], v[204:207], v[108:111]
 v_rcp_f32 v45, v45
 v_mfma_f32_16x16x32_bf16 v[108:111], a[200:203], v[200:203], v[108:111]
 v_rcp_f32 v46, v46
 v_mfma_f32_16x16x32_bf16 v[108:111], a[196:199], v[196:199], v[108:111]
 s_waitcnt vmcnt(10) lgkmcnt(0)
 v_rcp_f32_e64 v47, v47
 v_mfma_f32_16x16x32_bf16 v[108:111], a[192:195], v[192:195], v[108:111]
 s_barrier
 buffer_store_dwordx4 v[112:115], v0, s[32:35], s28 offen sc1
 buffer_load_dwordx4 v0, s[36:39], s17 offen offset:0 sc1 lds
 buffer_store_dwordx4 v[116:119], v0, s[32:35], s29 offen sc1
 buffer_load_dwordx4 v0, s[36:39], s17 offen offset:1024 sc1 lds
 buffer_load_dwordx4 v0, s[36:39], s17 offen offset:2048 sc1 lds
 v_pk_mul_f32 v[32:33], v[32:33], v[64:65]
 v_pk_mul_f32 v[34:35], v[34:35], v[66:67]
 v_pk_mul_f32 v[36:37], v[36:37], v[68:69]
 v_pk_mul_f32 v[38:39], v[38:39], v[70:71]
 v_pk_mul_f32 v[40:41], v[40:41], v[72:73]
 v_pk_mul_f32 v[42:43], v[42:43], v[74:75]
 v_pk_mul_f32 v[44:45], v[44:45], v[76:77]
 v_pk_mul_f32 v[46:47], v[46:47], v[78:79]
 v_pk_mul_f32 v[4:5], v[32:33], v[32:33]
 v_pk_fma_f32 v[48:49], v[48:49], s[22:23], s[22:23]
 v_pk_mul_f32 v[6:7], v[34:35], v[34:35]
 v_pk_fma_f32 v[50:51], v[50:51], s[22:23], s[22:23]
 v_pk_fma_f32 v[4:5], v[36:37], v[36:37], v[4:5]
 v_pk_fma_f32 v[52:53], v[52:53], s[22:23], s[22:23]
 v_pk_fma_f32 v[6:7], v[38:39], v[38:39], v[6:7]
 v_pk_fma_f32 v[54:55], v[54:55], s[22:23], s[22:23]
 v_pk_fma_f32 v[4:5], v[40:41], v[40:41], v[4:5]
 v_pk_fma_f32 v[56:57], v[56:57], s[22:23], s[22:23]
 v_pk_fma_f32 v[6:7], v[42:43], v[42:43], v[6:7]
 v_pk_fma_f32 v[58:59], v[58:59], s[22:23], s[22:23]
 v_pk_fma_f32 v[4:5], v[44:45], v[44:45], v[4:5]
 v_pk_fma_f32 v[60:61], v[60:61], s[22:23], s[22:23]
 v_pk_fma_f32 v[6:7], v[46:47], v[46:47], v[6:7]
 v_pk_fma_f32 v[62:63], v[62:63], s[22:23], s[22:23]
 v_pk_fma_f32 v[64:65], v[96:97], v[96:97], s[20:21]
 v_pk_fma_f32 v[66:67], v[98:99], v[98:99], s[20:21]
 v_pk_fma_f32 v[68:69], v[100:101], v[100:101], s[20:21]
 v_pk_fma_f32 v[70:71], v[102:103], v[102:103], s[20:21]
 v_pk_fma_f32 v[72:73], v[104:105], v[104:105], s[20:21]
 v_pk_fma_f32 v[74:75], v[106:107], v[106:107], s[20:21]
 v_pk_fma_f32 v[76:77], v[108:109], v[108:109], s[20:21]
 v_pk_fma_f32 v[78:79], v[110:111], v[110:111], s[20:21]
 v_pk_mul_f32 v[64:65], v[64:65], v[96:97] neg_lo:[1,0] neg_hi:[1,0]
 v_pk_mul_f32 v[66:67], v[66:67], v[98:99] neg_lo:[1,0] neg_hi:[1,0]
 v_pk_mul_f32 v[68:69], v[68:69], v[100:101] neg_lo:[1,0] neg_hi:[1,0]
 v_pk_mul_f32 v[70:71], v[70:71], v[102:103] neg_lo:[1,0] neg_hi:[1,0]
 v_pk_mul_f32 v[72:73], v[72:73], v[104:105] neg_lo:[1,0] neg_hi:[1,0]
 v_pk_mul_f32 v[74:75], v[74:75], v[106:107] neg_lo:[1,0] neg_hi:[1,0]
 v_pk_mul_f32 v[76:77], v[76:77], v[108:109] neg_lo:[1,0] neg_hi:[1,0]
 v_pk_mul_f32 v[78:79], v[78:79], v[110:111] neg_lo:[1,0] neg_hi:[1,0]
 v_mfma_f32_16x16x32_bf16 v[16:19], v[144:147], a[0:3], 0
 s_add_u32 s28, s28, 0x4000
 v_exp_f32 v64, v64
 v_mfma_f32_16x16x32_bf16 v[16:19], v[148:151], a[4:7], v[16:19]
 ds_read_b128 a[192:195], v2 offset:16384
 v_add_f32_dpp v4, v4, v4 row_ror:8 row_mask:0xf bank_mask:0x3
 v_mfma_f32_16x16x32_bf16 v[16:19], v[152:155], a[8:11], v[16:19]
 s_add_u32 s29, s29, 0x4000
 v_exp_f32 v65, v65
 v_mfma_f32_16x16x32_bf16 v[16:19], v[156:159], a[12:15], v[16:19]
 ds_read_b128 a[196:199], v2 offset:17408
 v_add_f32_dpp v5, v5, v5 row_ror:8 row_mask:0xf bank_mask:0x3
 v_mfma_f32_16x16x32_bf16 v[20:23], v[156:159], a[60:63], 0
 s_add_u32 s42, s42, 24576
 v_exp_f32 v66, v66
 v_mfma_f32_16x16x32_bf16 v[20:23], v[152:155], a[56:59], v[20:23]
 ds_read_b128 a[200:203], v2 offset:18432
 v_add_f32_dpp v4, v6, v6 row_ror:8 row_mask:0xf bank_mask:0xc
 v_mfma_f32_16x16x32_bf16 v[20:23], v[148:151], a[52:55], v[20:23]
 s_cmp_eq_u32 s42, 98304
 v_exp_f32 v67, v67
 v_mfma_f32_16x16x32_bf16 v[20:23], v[144:147], a[48:51], v[20:23]
 ds_read_b128 a[204:207], v2 offset:19456
 v_add_f32_dpp v5, v7, v7 row_ror:8 row_mask:0xf bank_mask:0xc
 v_mfma_f32_16x16x32_bf16 v[24:27], v[144:147], a[96:99], 0
 s_cselect_b32 s42, 0, s42
 v_exp_f32 v68, v68
 v_mfma_f32_16x16x32_bf16 v[24:27], v[148:151], a[100:103], v[24:27]
 v_exp_f32 v69, v69
 v_mfma_f32_16x16x32_bf16 v[24:27], v[152:155], a[104:107], v[24:27]
 s_add_u32 s17, s17, 0xc00
 v_exp_f32 v70, v70
 v_mfma_f32_16x16x32_bf16 v[24:27], v[156:159], a[108:111], v[24:27]
 v_exp_f32 v71, v71
 v_mfma_f32_16x16x32_bf16 v[28:31], v[156:159], v[172:175], 0
 s_add_u32 m0, s40, 3072
 v_exp_f32 v72, v72
 v_mfma_f32_16x16x32_bf16 v[28:31], v[152:155], v[168:171], v[28:31]
 v_exp_f32 v73, v73
 v_mfma_f32_16x16x32_bf16 v[28:31], v[148:151], v[164:167], v[28:31]
 v_exp_f32 v74, v74
 v_mfma_f32_16x16x32_bf16 v[28:31], v[144:147], v[160:163], v[28:31]
 s_waitcnt lgkmcnt(0)
 v_exp_f32 v75, v75
 v_mfma_f32_16x16x32_bf16 v[16:19], a[192:195], a[16:19], v[16:19]
 v_exp_f32 v76, v76
 v_mfma_f32_16x16x32_bf16 v[16:19], a[196:199], a[20:23], v[16:19]
 ds_read_b128 v[144:147], v2 offset:20480
 v_add_f32_dpp v4, v4, v4 row_shl:4 row_mask:0xf bank_mask:0x5
 v_mfma_f32_16x16x32_bf16 v[16:19], a[200:203], a[24:27], v[16:19]
 v_exp_f32 v77, v77
 v_mfma_f32_16x16x32_bf16 v[16:19], a[204:207], a[28:31], v[16:19]
 ds_read_b128 v[148:151], v2 offset:21504
 v_add_f32_dpp v4, v5, v5 row_shr:4 row_mask:0xf bank_mask:0xa
 v_mfma_f32_16x16x32_bf16 v[20:23], a[204:207], a[76:79], v[20:23]
 v_exp_f32 v78, v78
 v_mfma_f32_16x16x32_bf16 v[20:23], a[200:203], a[72:75], v[20:23]
 ds_read_b128 v[152:155], v2 offset:22528
 v_add_f32_dpp v4, v4, v4 quad_perm:[2,3,0,1] row_mask:0xf bank_mask:0xf
 v_mfma_f32_16x16x32_bf16 v[20:23], a[196:199], a[68:71], v[20:23]
 v_exp_f32 v79, v79
 v_mfma_f32_16x16x32_bf16 v[20:23], a[192:195], a[64:67], v[20:23]
 ds_read_b128 v[156:159], v2 offset:23552
 v_add_f32_dpp v4, v4, v4 quad_perm:[1,0,3,2] row_mask:0xf bank_mask:0xf
 v_mfma_f32_16x16x32_bf16 v[24:27], a[192:195], a[112:115], v[24:27]
 v_rcp_f32 v48, v48
 v_mfma_f32_16x16x32_bf16 v[24:27], a[196:199], a[116:119], v[24:27]
 v_rcp_f32 v49, v49
 v_mfma_f32_16x16x32_bf16 v[24:27], a[200:203], a[120:123], v[24:27]
 ds_write_b32 v3, v4 offset:1024
 v_add_u32 v2, s42, v0
 v_mfma_f32_16x16x32_bf16 v[24:27], a[204:207], a[124:127], v[24:27]
 v_rcp_f32 v50, v50
 v_mfma_f32_16x16x32_bf16 v[28:31], a[204:207], v[188:191], v[28:31]
 v_rcp_f32 v51, v51
 v_mfma_f32_16x16x32_bf16 v[28:31], a[200:203], v[184:187], v[28:31]
 v_rcp_f32 v52, v52
 v_mfma_f32_16x16x32_bf16 v[28:31], a[196:199], v[180:183], v[28:31]
 v_rcp_f32 v53, v53
 v_mfma_f32_16x16x32_bf16 v[28:31], a[192:195], v[176:179], v[28:31]
 s_waitcnt lgkmcnt(1)
 v_rcp_f32 v54, v54
 v_mfma_f32_16x16x32_bf16 v[16:19], v[144:147], a[32:35], v[16:19]
 v_rcp_f32 v55, v55
 v_mfma_f32_16x16x32_bf16 v[16:19], v[148:151], a[36:39], v[16:19]
 ds_read_b128 a[192:195], v2 offset:0
 v_cvt_pk_bf16_f32 v112, v32, v33
 v_mfma_f32_16x16x32_bf16 v[16:19], v[152:155], a[40:43], v[16:19]
 v_rcp_f32 v56, v56
 v_mfma_f32_16x16x32_bf16 v[16:19], v[156:159], a[44:47], v[16:19]
 ds_read_b128 a[196:199], v2 offset:1024
 v_cvt_pk_bf16_f32 v113, v34, v35
 v_mfma_f32_16x16x32_bf16 v[20:23], v[156:159], a[92:95], v[20:23]
 v_rcp_f32 v57, v57
 v_mfma_f32_16x16x32_bf16 v[20:23], v[152:155], a[88:91], v[20:23]
 ds_read_b128 a[200:203], v2 offset:2048
 v_cvt_pk_bf16_f32 v116, v36, v37
 v_mfma_f32_16x16x32_bf16 v[20:23], v[148:151], a[84:87], v[20:23]
 v_rcp_f32 v58, v58
 v_mfma_f32_16x16x32_bf16 v[20:23], v[144:147], a[80:83], v[20:23]
 ds_read_b128 a[204:207], v2 offset:3072
 v_cvt_pk_bf16_f32 v117, v38, v39
 v_mfma_f32_16x16x32_bf16 v[24:27], v[144:147], a[128:131], v[24:27]
 v_rcp_f32 v59, v59
 v_mfma_f32_16x16x32_bf16 v[24:27], v[148:151], a[132:135], v[24:27]
 v_cvt_pk_bf16_f32 v120, v40, v41
 v_cvt_pk_bf16_f32 v121, v42, v43
 v_mfma_f32_16x16x32_bf16 v[24:27], v[152:155], a[136:139], v[24:27]
 v_rcp_f32 v60, v60
 v_mfma_f32_16x16x32_bf16 v[24:27], v[156:159], a[140:143], v[24:27]
 v_cvt_pk_bf16_f32 v124, v44, v45
 v_cvt_pk_bf16_f32 v125, v46, v47
 v_mfma_f32_16x16x32_bf16 v[28:31], v[156:159], v[204:207], v[28:31]
 v_rcp_f32 v61, v61
 v_mfma_f32_16x16x32_bf16 v[28:31], v[152:155], v[200:203], v[28:31]
 v_rcp_f32 v62, v62
 v_mfma_f32_16x16x32_bf16 v[28:31], v[148:151], v[196:199], v[28:31]
 s_waitcnt lgkmcnt(0)
 v_rcp_f32_e64 v63, v63
 v_mfma_f32_16x16x32_bf16 v[28:31], v[144:147], v[192:195], v[28:31]
 buffer_store_dwordx4 v[136:139], v0, s[32:35], s30 offen sc1
 buffer_load_dwordx4 v0, s[36:39], s17 offen offset:0 sc1 lds
 buffer_store_dwordx4 v[140:143], v0, s[32:35], s31 offen sc1
 buffer_load_dwordx4 v0, s[36:39], s17 offen offset:1024 sc1 lds
 buffer_load_dwordx4 v0, s[36:39], s17 offen offset:2048 sc1 lds
 v_pk_mul_f32 v[48:49], v[48:49], v[80:81]
 v_pk_mul_f32 v[50:51], v[50:51], v[82:83]
 v_pk_mul_f32 v[52:53], v[52:53], v[84:85]
 v_pk_mul_f32 v[54:55], v[54:55], v[86:87]
 v_pk_mul_f32 v[56:57], v[56:57], v[88:89]
 v_pk_mul_f32 v[58:59], v[58:59], v[90:91]
 v_pk_mul_f32 v[60:61], v[60:61], v[92:93]
 v_pk_mul_f32 v[62:63], v[62:63], v[94:95]
 v_pk_mul_f32 v[4:5], v[48:49], v[48:49]
 v_pk_fma_f32 v[64:65], v[64:65], s[22:23], s[22:23]
 v_pk_mul_f32 v[6:7], v[50:51], v[50:51]
 v_pk_fma_f32 v[66:67], v[66:67], s[22:23], s[22:23]
 v_pk_fma_f32 v[4:5], v[52:53], v[52:53], v[4:5]
 v_pk_fma_f32 v[68:69], v[68:69], s[22:23], s[22:23]
 v_pk_fma_f32 v[6:7], v[54:55], v[54:55], v[6:7]
 v_pk_fma_f32 v[70:71], v[70:71], s[22:23], s[22:23]
 v_pk_fma_f32 v[4:5], v[56:57], v[56:57], v[4:5]
 v_pk_fma_f32 v[72:73], v[72:73], s[22:23], s[22:23]
 v_pk_fma_f32 v[6:7], v[58:59], v[58:59], v[6:7]
 v_pk_fma_f32 v[74:75], v[74:75], s[22:23], s[22:23]
 v_pk_fma_f32 v[4:5], v[60:61], v[60:61], v[4:5]
 v_pk_fma_f32 v[76:77], v[76:77], s[22:23], s[22:23]
 v_pk_fma_f32 v[6:7], v[62:63], v[62:63], v[6:7]
 v_pk_fma_f32 v[78:79], v[78:79], s[22:23], s[22:23]
 v_pk_fma_f32 v[80:81], v[16:17], v[16:17], s[20:21]
 v_pk_fma_f32 v[82:83], v[18:19], v[18:19], s[20:21]
 v_pk_fma_f32 v[84:85], v[20:21], v[20:21], s[20:21]
 v_pk_fma_f32 v[86:87], v[22:23], v[22:23], s[20:21]
 v_pk_fma_f32 v[88:89], v[24:25], v[24:25], s[20:21]
 v_pk_fma_f32 v[90:91], v[26:27], v[26:27], s[20:21]
 v_pk_fma_f32 v[92:93], v[28:29], v[28:29], s[20:21]
 v_pk_fma_f32 v[94:95], v[30:31], v[30:31], s[20:21]
 v_pk_mul_f32 v[80:81], v[80:81], v[16:17] neg_lo:[1,0] neg_hi:[1,0]
 v_pk_mul_f32 v[82:83], v[82:83], v[18:19] neg_lo:[1,0] neg_hi:[1,0]
 v_pk_mul_f32 v[84:85], v[84:85], v[20:21] neg_lo:[1,0] neg_hi:[1,0]
 v_pk_mul_f32 v[86:87], v[86:87], v[22:23] neg_lo:[1,0] neg_hi:[1,0]
 v_pk_mul_f32 v[88:89], v[88:89], v[24:25] neg_lo:[1,0] neg_hi:[1,0]
 v_pk_mul_f32 v[90:91], v[90:91], v[26:27] neg_lo:[1,0] neg_hi:[1,0]
 v_pk_mul_f32 v[92:93], v[92:93], v[28:29] neg_lo:[1,0] neg_hi:[1,0]
 v_pk_mul_f32 v[94:95], v[94:95], v[30:31] neg_lo:[1,0] neg_hi:[1,0]
 v_mfma_f32_16x16x32_bf16 v[32:35], a[192:195], a[0:3], 0
 s_mov_b32 s34, 0xc0000
 v_exp_f32 v80, v80
 v_mfma_f32_16x16x32_bf16 v[32:35], a[196:199], a[4:7], v[32:35]
 ds_read_b128 v[144:147], v2 offset:4096
 v_add_f32_dpp v4, v4, v4 row_ror:8 row_mask:0xf bank_mask:0x3
 v_mfma_f32_16x16x32_bf16 v[32:35], a[200:203], a[8:11], v[32:35]
 s_add_u32 s30, s30, 0x4000
 v_exp_f32 v81, v81
 v_mfma_f32_16x16x32_bf16 v[32:35], a[204:207], a[12:15], v[32:35]
 ds_read_b128 v[148:151], v2 offset:5120
 v_add_f32_dpp v5, v5, v5 row_ror:8 row_mask:0xf bank_mask:0x3
 v_mfma_f32_16x16x32_bf16 v[36:39], a[204:207], a[60:63], 0
 s_add_u32 s31, s31, 0x4000
 v_exp_f32 v82, v82
 v_mfma_f32_16x16x32_bf16 v[36:39], a[200:203], a[56:59], v[36:39]
 ds_read_b128 v[152:155], v2 offset:6144
 v_add_f32_dpp v4, v6, v6 row_ror:8 row_mask:0xf bank_mask:0xc
 v_mfma_f32_16x16x32_bf16 v[36:39], a[196:199], a[52:55], v[36:39]
 s_add_u32 s40, s40, 24576
 v_exp_f32 v83, v83
 v_mfma_f32_16x16x32_bf16 v[36:39], a[192:195], a[48:51], v[36:39]
 ds_read_b128 v[156:159], v2 offset:7168
 v_add_f32_dpp v5, v7, v7 row_ror:8 row_mask:0xf bank_mask:0xc
 v_mfma_f32_16x16x32_bf16 v[40:43], a[192:195], a[96:99], 0
 s_cmp_eq_u32 s40, s41
 v_exp_f32 v84, v84
 v_mfma_f32_16x16x32_bf16 v[40:43], a[196:199], a[100:103], v[40:43]
 v_exp_f32 v85, v85
 v_mfma_f32_16x16x32_bf16 v[40:43], a[200:203], a[104:107], v[40:43]
 s_cselect_b32 s40, s24, s40
 v_exp_f32 v86, v86
 v_mfma_f32_16x16x32_bf16 v[40:43], a[204:207], a[108:111], v[40:43]
 v_exp_f32 v87, v87
 v_mfma_f32_16x16x32_bf16 v[44:47], a[204:207], v[172:175], 0
 s_add_u32 s17, s17, 0x5400
 v_exp_f32 v88, v88
 v_mfma_f32_16x16x32_bf16 v[44:47], a[200:203], v[168:171], v[44:47]
 v_exp_f32 v89, v89
 v_mfma_f32_16x16x32_bf16 v[44:47], a[196:199], v[164:167], v[44:47]
 s_add_u32 m0, s40, 0
 v_exp_f32 v90, v90
 v_mfma_f32_16x16x32_bf16 v[44:47], a[192:195], v[160:163], v[44:47]
 s_waitcnt lgkmcnt(0)
 v_exp_f32 v91, v91
 v_mfma_f32_16x16x32_bf16 v[32:35], v[144:147], a[16:19], v[32:35]
 v_exp_f32 v92, v92
 v_mfma_f32_16x16x32_bf16 v[32:35], v[148:151], a[20:23], v[32:35]
 ds_read_b128 a[192:195], v2 offset:8192
 v_add_f32_dpp v4, v4, v4 row_shl:4 row_mask:0xf bank_mask:0x5
 v_mfma_f32_16x16x32_bf16 v[32:35], v[152:155], a[24:27], v[32:35]
 v_exp_f32 v93, v93
 v_mfma_f32_16x16x32_bf16 v[32:35], v[156:159], a[28:31], v[32:35]
 ds_read_b128 a[196:199], v2 offset:9216
 v_add_f32_dpp v4, v5, v5 row_shr:4 row_mask:0xf bank_mask:0xa
 v_mfma_f32_16x16x32_bf16 v[36:39], v[156:159], a[76:79], v[36:39]
 v_exp_f32 v94, v94
 v_mfma_f32_16x16x32_bf16 v[36:39], v[152:155], a[72:75], v[36:39]
 ds_read_b128 a[200:203], v2 offset:10240
 v_add_f32_dpp v4, v4, v4 quad_perm:[2,3,0,1] row_mask:0xf bank_mask:0xf
 v_mfma_f32_16x16x32_bf16 v[36:39], v[148:151], a[68:71], v[36:39]
 v_exp_f32 v95, v95
 v_mfma_f32_16x16x32_bf16 v[36:39], v[144:147], a[64:67], v[36:39]
 ds_read_b128 a[204:207], v2 offset:11264
 v_add_f32_dpp v4, v4, v4 quad_perm:[1,0,3,2] row_mask:0xf bank_mask:0xf
 v_mfma_f32_16x16x32_bf16 v[40:43], v[144:147], a[112:115], v[40:43]
 v_rcp_f32 v64, v64
 v_mfma_f32_16x16x32_bf16 v[40:43], v[148:151], a[116:119], v[40:43]
 v_rcp_f32 v65, v65
 v_mfma_f32_16x16x32_bf16 v[40:43], v[152:155], a[120:123], v[40:43]
 ds_write_b32 v3, v4 offset:1280
 v_add_u32 v3, 1536, v3
 v_mfma_f32_16x16x32_bf16 v[40:43], v[156:159], a[124:127], v[40:43]
 v_rcp_f32 v66, v66
 v_mfma_f32_16x16x32_bf16 v[44:47], v[156:159], v[188:191], v[44:47]
 v_rcp_f32 v67, v67
 v_mfma_f32_16x16x32_bf16 v[44:47], v[152:155], v[184:187], v[44:47]
 v_rcp_f32 v68, v68
 v_mfma_f32_16x16x32_bf16 v[44:47], v[148:151], v[180:183], v[44:47]
 v_rcp_f32 v69, v69
 v_mfma_f32_16x16x32_bf16 v[44:47], v[144:147], v[176:179], v[44:47]
 s_waitcnt lgkmcnt(1)
 v_rcp_f32 v70, v70
 v_mfma_f32_16x16x32_bf16 v[32:35], a[192:195], a[32:35], v[32:35]
 v_rcp_f32 v71, v71
 v_mfma_f32_16x16x32_bf16 v[32:35], a[196:199], a[36:39], v[32:35]
 ds_read_b128 v[144:147], v2 offset:12288
 v_cvt_pk_bf16_f32 v114, v48, v49
 v_mfma_f32_16x16x32_bf16 v[32:35], a[200:203], a[40:43], v[32:35]
 v_rcp_f32 v72, v72
 v_mfma_f32_16x16x32_bf16 v[32:35], a[204:207], a[44:47], v[32:35]
 ds_read_b128 v[148:151], v2 offset:13312
 v_cvt_pk_bf16_f32 v115, v50, v51
 v_mfma_f32_16x16x32_bf16 v[36:39], a[204:207], a[92:95], v[36:39]
 v_rcp_f32 v73, v73
 v_mfma_f32_16x16x32_bf16 v[36:39], a[200:203], a[88:91], v[36:39]
 ds_read_b128 v[152:155], v2 offset:14336
 v_cvt_pk_bf16_f32 v118, v52, v53
 v_mfma_f32_16x16x32_bf16 v[36:39], a[196:199], a[84:87], v[36:39]
 v_rcp_f32 v74, v74
 v_mfma_f32_16x16x32_bf16 v[36:39], a[192:195], a[80:83], v[36:39]
 ds_read_b128 v[156:159], v2 offset:15360
 v_cvt_pk_bf16_f32 v119, v54, v55
 v_mfma_f32_16x16x32_bf16 v[40:43], a[192:195], a[128:131], v[40:43]
 v_rcp_f32 v75, v75
 v_mfma_f32_16x16x32_bf16 v[40:43], a[196:199], a[132:135], v[40:43]
 v_cvt_pk_bf16_f32 v122, v56, v57
 v_cvt_pk_bf16_f32 v123, v58, v59
 v_mfma_f32_16x16x32_bf16 v[40:43], a[200:203], a[136:139], v[40:43]
 v_rcp_f32 v76, v76
 v_mfma_f32_16x16x32_bf16 v[40:43], a[204:207], a[140:143], v[40:43]
 v_cvt_pk_bf16_f32 v126, v60, v61
 v_cvt_pk_bf16_f32 v127, v62, v63
 v_mfma_f32_16x16x32_bf16 v[44:47], a[204:207], v[204:207], v[44:47]
 v_rcp_f32 v77, v77
 v_mfma_f32_16x16x32_bf16 v[44:47], a[200:203], v[200:203], v[44:47]
 v_rcp_f32 v78, v78
 v_mfma_f32_16x16x32_bf16 v[44:47], a[196:199], v[196:199], v[44:47]
 s_waitcnt vmcnt(10) lgkmcnt(0)
 v_rcp_f32_e64 v79, v79
 v_mfma_f32_16x16x32_bf16 v[44:47], a[192:195], v[192:195], v[44:47]
 s_barrier
 buffer_store_dwordx4 v[112:115], v0, s[32:35], s28 offen sc1
 buffer_load_dwordx4 v0, s[36:39], s17 offen offset:0 sc1 lds
 buffer_store_dwordx4 v[116:119], v0, s[32:35], s29 offen sc1
 buffer_load_dwordx4 v0, s[36:39], s17 offen offset:1024 sc1 lds
 buffer_load_dwordx4 v0, s[36:39], s17 offen offset:2048 sc1 lds
 v_pk_mul_f32 v[64:65], v[64:65], v[96:97]
 v_pk_mul_f32 v[66:67], v[66:67], v[98:99]
 v_pk_mul_f32 v[68:69], v[68:69], v[100:101]
 v_pk_mul_f32 v[70:71], v[70:71], v[102:103]
 v_pk_mul_f32 v[72:73], v[72:73], v[104:105]
 v_pk_mul_f32 v[74:75], v[74:75], v[106:107]
 v_pk_mul_f32 v[76:77], v[76:77], v[108:109]
 v_pk_mul_f32 v[78:79], v[78:79], v[110:111]
 v_pk_mul_f32 v[4:5], v[64:65], v[64:65]
 v_pk_fma_f32 v[80:81], v[80:81], s[22:23], s[22:23]
 v_pk_mul_f32 v[6:7], v[66:67], v[66:67]
 v_pk_fma_f32 v[82:83], v[82:83], s[22:23], s[22:23]
 v_pk_fma_f32 v[4:5], v[68:69], v[68:69], v[4:5]
 v_pk_fma_f32 v[84:85], v[84:85], s[22:23], s[22:23]
 v_pk_fma_f32 v[6:7], v[70:71], v[70:71], v[6:7]
 v_pk_fma_f32 v[86:87], v[86:87], s[22:23], s[22:23]
 v_pk_fma_f32 v[4:5], v[72:73], v[72:73], v[4:5]
 v_pk_fma_f32 v[88:89], v[88:89], s[22:23], s[22:23]
 v_pk_fma_f32 v[6:7], v[74:75], v[74:75], v[6:7]
 v_pk_fma_f32 v[90:91], v[90:91], s[22:23], s[22:23]
 v_pk_fma_f32 v[4:5], v[76:77], v[76:77], v[4:5]
 v_pk_fma_f32 v[92:93], v[92:93], s[22:23], s[22:23]
 v_pk_fma_f32 v[6:7], v[78:79], v[78:79], v[6:7]
 v_pk_fma_f32 v[94:95], v[94:95], s[22:23], s[22:23]
 v_pk_fma_f32 v[96:97], v[32:33], v[32:33], s[20:21]
 v_pk_fma_f32 v[98:99], v[34:35], v[34:35], s[20:21]
 v_pk_fma_f32 v[100:101], v[36:37], v[36:37], s[20:21]
 v_pk_fma_f32 v[102:103], v[38:39], v[38:39], s[20:21]
 v_pk_fma_f32 v[104:105], v[40:41], v[40:41], s[20:21]
 v_pk_fma_f32 v[106:107], v[42:43], v[42:43], s[20:21]
 v_pk_fma_f32 v[108:109], v[44:45], v[44:45], s[20:21]
 v_pk_fma_f32 v[110:111], v[46:47], v[46:47], s[20:21]
 v_pk_mul_f32 v[96:97], v[96:97], v[32:33] neg_lo:[1,0] neg_hi:[1,0]
 v_pk_mul_f32 v[98:99], v[98:99], v[34:35] neg_lo:[1,0] neg_hi:[1,0]
 v_pk_mul_f32 v[100:101], v[100:101], v[36:37] neg_lo:[1,0] neg_hi:[1,0]
 v_pk_mul_f32 v[102:103], v[102:103], v[38:39] neg_lo:[1,0] neg_hi:[1,0]
 v_pk_mul_f32 v[104:105], v[104:105], v[40:41] neg_lo:[1,0] neg_hi:[1,0]
 v_pk_mul_f32 v[106:107], v[106:107], v[42:43] neg_lo:[1,0] neg_hi:[1,0]
 v_pk_mul_f32 v[108:109], v[108:109], v[44:45] neg_lo:[1,0] neg_hi:[1,0]
 v_pk_mul_f32 v[110:111], v[110:111], v[46:47] neg_lo:[1,0] neg_hi:[1,0]
 v_mfma_f32_16x16x32_bf16 v[48:51], v[144:147], a[0:3], 0
 s_add_u32 s28, s28, 0x4000
 v_exp_f32 v96, v96
 v_mfma_f32_16x16x32_bf16 v[48:51], v[148:151], a[4:7], v[48:51]
 ds_read_b128 a[192:195], v2 offset:16384
 v_add_f32_dpp v4, v4, v4 row_ror:8 row_mask:0xf bank_mask:0x3
 v_mfma_f32_16x16x32_bf16 v[48:51], v[152:155], a[8:11], v[48:51]
 s_add_u32 s29, s29, 0x4000
 v_exp_f32 v97, v97
 v_mfma_f32_16x16x32_bf16 v[48:51], v[156:159], a[12:15], v[48:51]
 ds_read_b128 a[196:199], v2 offset:17408
 v_add_f32_dpp v5, v5, v5 row_ror:8 row_mask:0xf bank_mask:0x3
 v_mfma_f32_16x16x32_bf16 v[52:55], v[156:159], a[60:63], 0
 s_add_u32 s42, s42, 24576
 v_exp_f32 v98, v98
 v_mfma_f32_16x16x32_bf16 v[52:55], v[152:155], a[56:59], v[52:55]
 ds_read_b128 a[200:203], v2 offset:18432
 v_add_f32_dpp v4, v6, v6 row_ror:8 row_mask:0xf bank_mask:0xc
 v_mfma_f32_16x16x32_bf16 v[52:55], v[148:151], a[52:55], v[52:55]
 s_cmp_eq_u32 s42, 98304
 v_exp_f32 v99, v99
 v_mfma_f32_16x16x32_bf16 v[52:55], v[144:147], a[48:51], v[52:55]
 ds_read_b128 a[204:207], v2 offset:19456
 v_add_f32_dpp v5, v7, v7 row_ror:8 row_mask:0xf bank_mask:0xc
 v_mfma_f32_16x16x32_bf16 v[56:59], v[144:147], a[96:99], 0
 s_cselect_b32 s42, 0, s42
 v_exp_f32 v100, v100
 v_mfma_f32_16x16x32_bf16 v[56:59], v[148:151], a[100:103], v[56:59]
 v_exp_f32 v101, v101
 v_mfma_f32_16x16x32_bf16 v[56:59], v[152:155], a[104:107], v[56:59]
 s_add_u32 s17, s17, 0xc00
 v_exp_f32 v102, v102
 v_mfma_f32_16x16x32_bf16 v[56:59], v[156:159], a[108:111], v[56:59]
 v_exp_f32 v103, v103
 v_mfma_f32_16x16x32_bf16 v[60:63], v[156:159], v[172:175], 0
 s_add_u32 m0, s40, 3072
 v_exp_f32 v104, v104
 v_mfma_f32_16x16x32_bf16 v[60:63], v[152:155], v[168:171], v[60:63]
 v_exp_f32 v105, v105
 v_mfma_f32_16x16x32_bf16 v[60:63], v[148:151], v[164:167], v[60:63]
 s_sub_u32 s19, s19, 1
 v_exp_f32 v106, v106
 v_mfma_f32_16x16x32_bf16 v[60:63], v[144:147], v[160:163], v[60:63]
 s_waitcnt lgkmcnt(0)
 v_exp_f32 v107, v107
 v_mfma_f32_16x16x32_bf16 v[48:51], a[192:195], a[16:19], v[48:51]
 s_cmp_lg_u32 s19, 0
 v_exp_f32 v108, v108
 v_mfma_f32_16x16x32_bf16 v[48:51], a[196:199], a[20:23], v[48:51]
 ds_read_b128 v[144:147], v2 offset:20480
 v_add_f32_dpp v4, v4, v4 row_shl:4 row_mask:0xf bank_mask:0x5
 v_mfma_f32_16x16x32_bf16 v[48:51], a[200:203], a[24:27], v[48:51]
 v_exp_f32 v109, v109
 v_mfma_f32_16x16x32_bf16 v[48:51], a[204:207], a[28:31], v[48:51]
 ds_read_b128 v[148:151], v2 offset:21504
 v_add_f32_dpp v4, v5, v5 row_shr:4 row_mask:0xf bank_mask:0xa
 v_mfma_f32_16x16x32_bf16 v[52:55], a[204:207], a[76:79], v[52:55]
 v_exp_f32 v110, v110
 v_mfma_f32_16x16x32_bf16 v[52:55], a[200:203], a[72:75], v[52:55]
 ds_read_b128 v[152:155], v2 offset:22528
 v_add_f32_dpp v4, v4, v4 quad_perm:[2,3,0,1] row_mask:0xf bank_mask:0xf
 v_mfma_f32_16x16x32_bf16 v[52:55], a[196:199], a[68:71], v[52:55]
 v_exp_f32 v111, v111
 v_mfma_f32_16x16x32_bf16 v[52:55], a[192:195], a[64:67], v[52:55]
 ds_read_b128 v[156:159], v2 offset:23552
 v_add_f32_dpp v4, v4, v4 quad_perm:[1,0,3,2] row_mask:0xf bank_mask:0xf
 v_mfma_f32_16x16x32_bf16 v[56:59], a[192:195], a[112:115], v[56:59]
 v_rcp_f32 v80, v80
 v_mfma_f32_16x16x32_bf16 v[56:59], a[196:199], a[116:119], v[56:59]
 v_rcp_f32 v81, v81
 v_mfma_f32_16x16x32_bf16 v[56:59], a[200:203], a[120:123], v[56:59]
 ds_write_b32 v3, v4 offset:0
 v_add_u32 v2, s42, v0
 v_mfma_f32_16x16x32_bf16 v[56:59], a[204:207], a[124:127], v[56:59]
 v_rcp_f32 v82, v82
 v_mfma_f32_16x16x32_bf16 v[60:63], a[204:207], v[188:191], v[60:63]
 v_rcp_f32 v83, v83
 v_mfma_f32_16x16x32_bf16 v[60:63], a[200:203], v[184:187], v[60:63]
 v_rcp_f32 v84, v84
 v_mfma_f32_16x16x32_bf16 v[60:63], a[196:199], v[180:183], v[60:63]
 v_rcp_f32 v85, v85
 v_mfma_f32_16x16x32_bf16 v[60:63], a[192:195], v[176:179], v[60:63]
 s_waitcnt lgkmcnt(1)
 v_rcp_f32 v86, v86
 v_mfma_f32_16x16x32_bf16 v[48:51], v[144:147], a[32:35], v[48:51]
 v_rcp_f32 v87, v87
 v_mfma_f32_16x16x32_bf16 v[48:51], v[148:151], a[36:39], v[48:51]
 ds_read_b128 a[192:195], v2 offset:0
 v_cvt_pk_bf16_f32 v112, v64, v65
 v_mfma_f32_16x16x32_bf16 v[48:51], v[152:155], a[40:43], v[48:51]
 v_rcp_f32 v88, v88
 v_mfma_f32_16x16x32_bf16 v[48:51], v[156:159], a[44:47], v[48:51]
 ds_read_b128 a[196:199], v2 offset:1024
 v_cvt_pk_bf16_f32 v113, v66, v67
 v_mfma_f32_16x16x32_bf16 v[52:55], v[156:159], a[92:95], v[52:55]
 v_rcp_f32 v89, v89
 v_mfma_f32_16x16x32_bf16 v[52:55], v[152:155], a[88:91], v[52:55]
 ds_read_b128 a[200:203], v2 offset:2048
 v_cvt_pk_bf16_f32 v116, v68, v69
 v_mfma_f32_16x16x32_bf16 v[52:55], v[148:151], a[84:87], v[52:55]
 v_rcp_f32 v90, v90
 v_mfma_f32_16x16x32_bf16 v[52:55], v[144:147], a[80:83], v[52:55]
 ds_read_b128 a[204:207], v2 offset:3072
 v_cvt_pk_bf16_f32 v117, v70, v71
 v_mfma_f32_16x16x32_bf16 v[56:59], v[144:147], a[128:131], v[56:59]
 v_rcp_f32 v91, v91
 v_mfma_f32_16x16x32_bf16 v[56:59], v[148:151], a[132:135], v[56:59]
 v_cvt_pk_bf16_f32 v128, v72, v73
 v_cvt_pk_bf16_f32 v129, v74, v75
 v_mfma_f32_16x16x32_bf16 v[56:59], v[152:155], a[136:139], v[56:59]
 v_rcp_f32 v92, v92
 v_mfma_f32_16x16x32_bf16 v[56:59], v[156:159], a[140:143], v[56:59]
 v_cvt_pk_bf16_f32 v132, v76, v77
 v_cvt_pk_bf16_f32 v133, v78, v79
 v_mfma_f32_16x16x32_bf16 v[60:63], v[156:159], v[204:207], v[60:63]
 v_rcp_f32 v93, v93
 v_mfma_f32_16x16x32_bf16 v[60:63], v[152:155], v[200:203], v[60:63]
 v_rcp_f32 v94, v94
 v_mfma_f32_16x16x32_bf16 v[60:63], v[148:151], v[196:199], v[60:63]
 s_waitcnt lgkmcnt(0)
 v_rcp_f32_e64 v95, v95
 v_mfma_f32_16x16x32_bf16 v[60:63], v[144:147], v[192:195], v[60:63]
 buffer_store_dwordx4 v[120:123], v0, s[32:35], s30 offen sc1
 buffer_load_dwordx4 v0, s[36:39], s17 offen offset:0 sc1 lds
 buffer_store_dwordx4 v[124:127], v0, s[32:35], s31 offen sc1
 buffer_load_dwordx4 v0, s[36:39], s17 offen offset:1024 sc1 lds
 buffer_load_dwordx4 v0, s[36:39], s17 offen offset:2048 sc1 lds
 v_pk_mul_f32 v[80:81], v[80:81], v[16:17]
 v_pk_mul_f32 v[82:83], v[82:83], v[18:19]
 v_pk_mul_f32 v[84:85], v[84:85], v[20:21]
 v_pk_mul_f32 v[86:87], v[86:87], v[22:23]
 v_pk_mul_f32 v[88:89], v[88:89], v[24:25]
 v_pk_mul_f32 v[90:91], v[90:91], v[26:27]
 v_pk_mul_f32 v[92:93], v[92:93], v[28:29]
 v_pk_mul_f32 v[94:95], v[94:95], v[30:31]
 v_pk_mul_f32 v[4:5], v[80:81], v[80:81]
 v_pk_fma_f32 v[96:97], v[96:97], s[22:23], s[22:23]
 v_pk_mul_f32 v[6:7], v[82:83], v[82:83]
 v_pk_fma_f32 v[98:99], v[98:99], s[22:23], s[22:23]
 v_pk_fma_f32 v[4:5], v[84:85], v[84:85], v[4:5]
 v_pk_fma_f32 v[100:101], v[100:101], s[22:23], s[22:23]
 v_pk_fma_f32 v[6:7], v[86:87], v[86:87], v[6:7]
 v_pk_fma_f32 v[102:103], v[102:103], s[22:23], s[22:23]
 v_pk_fma_f32 v[4:5], v[88:89], v[88:89], v[4:5]
 v_pk_fma_f32 v[104:105], v[104:105], s[22:23], s[22:23]
 v_pk_fma_f32 v[6:7], v[90:91], v[90:91], v[6:7]
 v_pk_fma_f32 v[106:107], v[106:107], s[22:23], s[22:23]
 v_pk_fma_f32 v[4:5], v[92:93], v[92:93], v[4:5]
 v_pk_fma_f32 v[108:109], v[108:109], s[22:23], s[22:23]
 v_pk_fma_f32 v[6:7], v[94:95], v[94:95], v[6:7]
 v_pk_fma_f32 v[110:111], v[110:111], s[22:23], s[22:23]
 v_pk_fma_f32 v[16:17], v[48:49], v[48:49], s[20:21]
 v_pk_fma_f32 v[18:19], v[50:51], v[50:51], s[20:21]
 v_pk_fma_f32 v[20:21], v[52:53], v[52:53], s[20:21]
 v_pk_fma_f32 v[22:23], v[54:55], v[54:55], s[20:21]
 v_pk_fma_f32 v[24:25], v[56:57], v[56:57], s[20:21]
 v_pk_fma_f32 v[26:27], v[58:59], v[58:59], s[20:21]
 v_pk_fma_f32 v[28:29], v[60:61], v[60:61], s[20:21]
 v_pk_fma_f32 v[30:31], v[62:63], v[62:63], s[20:21]
 v_pk_mul_f32 v[16:17], v[16:17], v[48:49] neg_lo:[1,0] neg_hi:[1,0]
 v_pk_mul_f32 v[18:19], v[18:19], v[50:51] neg_lo:[1,0] neg_hi:[1,0]
 v_pk_mul_f32 v[20:21], v[20:21], v[52:53] neg_lo:[1,0] neg_hi:[1,0]
 v_pk_mul_f32 v[22:23], v[22:23], v[54:55] neg_lo:[1,0] neg_hi:[1,0]
 v_pk_mul_f32 v[24:25], v[24:25], v[56:57] neg_lo:[1,0] neg_hi:[1,0]
 v_pk_mul_f32 v[26:27], v[26:27], v[58:59] neg_lo:[1,0] neg_hi:[1,0]
 v_pk_mul_f32 v[28:29], v[28:29], v[60:61] neg_lo:[1,0] neg_hi:[1,0]
 v_pk_mul_f32 v[30:31], v[30:31], v[62:63] neg_lo:[1,0] neg_hi:[1,0]
 s_cbranch_scc1 L_k1_loop0
 s_cmp_lg_u32 s43, 0
 s_cbranch_scc1 L_k1_tail
 s_mov_b32 s43, 1
 s_mov_b32 s19, 1
 s_getpc_b64 s[64:65]
L_pc3:
 s_add_u32 s64, s64, L_k1_tail-L_pc3
 s_addc_u32 s65, s65, 0
 v_and_b32 v64, 0xf0, v0
 v_lshl_add_u32 v64, v64, 2, s95
 v_min_u32 v64, L_end-L_k1_tail, v64
 v_add_co_u32 v64, vcc, s64, v64
 v_mov_b32 v65, s65
 v_mov_b32 v65, s65
 v_addc_co_u32 v65, vcc, 0, v65, vcc
 global_load_dword v1, v[64:65], off
 s_branch L_k1_loop0
L_k1_pre1:
 s_waitcnt lgkmcnt(0)
 s_nop 0
L_k1_loop1:
 v_mfma_f32_16x16x32_bf16 v[64:67], a[192:195], a[0:3], 0
 s_add_u32 s30, s30, 0x4000
 v_exp_f32 v16, v16
 v_mfma_f32_16x16x32_bf16 v[64:67], a[196:199], a[4:7], v[64:67]
 ds_read_b128 v[144:147], v2 offset:4096
 v_add_f32_dpp v4, v4, v4 row_ror:8 row_mask:0xf bank_mask:0x3
 v_mfma_f32_16x16x32_bf16 v[64:67], a[200:203], a[8:11], v[64:67]
 s_add_u32 s31, s31, 0x4000
 v_exp_f32 v17, v17
 v_mfma_f32_16x16x32_bf16 v[64:67], a[204:207], a[12:15], v[64:67]
 ds_read_b128 v[148:151], v2 offset:5120
 v_add_f32_dpp v5, v5, v5 row_ror:8 row_mask:0xf bank_mask:0x3
 v_mfma_f32_16x16x32_bf16 v[68:71], a[204:207], a[60:63], 0
 s_add_u32 s40, s40, 24576
 v_exp_f32 v18, v18
 v_mfma_f32_16x16x32_bf16 v[68:71], a[200:203], a[56:59], v[68:71]
 ds_read_b128 v[152:155], v2 offset:6144
 v_add_f32_dpp v4, v6, v6 row_ror:8 row_mask:0xf bank_mask:0xc
 v_mfma_f32_16x16x32_bf16 v[68:71], a[196:199], a[52:55], v[68:71]
 s_cmp_eq_u32 s40, s41
 v_exp_f32 v19, v19
 v_mfma_f32_16x16x32_bf16 v[68:71], a[192:195], a[48:51], v[68:71]
 ds_read_b128 v[156:159], v2 offset:7168
 v_add_f32_dpp v5, v7, v7 row_ror:8 row_mask:0xf bank_mask:0xc
 v_mfma_f32_16x16x32_bf16 v[72:75], a[192:195], a[96:99], 0
 s_cselect_b32 s40, s24, s40
 v_exp_f32 v20, v20
 v_mfma_f32_16x16x32_bf16 v[72:75], a[196:199], a[100:103], v[72:75]
 v_exp_f32 v21, v21
 v_mfma_f32_16x16x32_bf16 v[72:75], a[200:203], a[104:107], v[72:75]
 s_add_u32 s17, s17, 0x5400
 v_exp_f32 v22, v22
 v_mfma_f32_16x16x32_bf16 v[72:75], a[204:207], a[108:111], v[72:75]
 v_exp_f32 v23, v23
 v_mfma_f32_16x16x32_bf16 v[76:79], a[204:207], v[172:175], 0
 s_add_u32 m0, s40, 0
 v_exp_f32 v24, v24
 v_mfma_f32_16x16x32_bf16 v[76:79], a[200:203], v[168:171], v[76:79]
 v_exp_f32 v25, v25
 v_mfma_f32_16x16x32_bf16 v[76:79], a[196:199], v[164:167], v[76:79]
 v_exp_f32 v26, v26
 v_mfma_f32_16x16x32_bf16 v[76:79], a[192:195], v[160:163], v[76:79]
 s_waitcnt lgkmcnt(0)
 v_exp_f32 v27, v27
 v_mfma_f32_16x16x32_bf16 v[64:67], v[144:147], a[16:19], v[64:67]
 v_exp_f32 v28, v28
 v_mfma_f32_16x16x32_bf16 v[64:67], v[148:151], a[20:23], v[64:67]
 ds_read_b128 a[192:195], v2 offset:8192
 v_add_f32_dpp v4, v4, v4 row_shl:4 row_mask:0xf bank_mask:0x5
 v_mfma_f32_16x16x32_bf16 v[64:67], v[152:155], a[24:27], v[64:67]
 v_exp_f32 v29, v29
 v_mfma_f32_16x16x32_bf16 v[64:67], v[156:159], a[28:31], v[64:67]
 ds_read_b128 a[196:199], v2 offset:9216
 v_add_f32_dpp v4, v5, v5 row_shr:4 row_mask:0xf bank_mask:0xa
 v_mfma_f32_16x16x32_bf16 v[68:71], v[156:159], a[76:79], v[68:71]
 v_exp_f32 v30, v30
 v_mfma_f32_16x16x32_bf16 v[68:71], v[152:155], a[72:75], v[68:71]
 ds_read_b128 a[200:203], v2 offset:10240
 v_add_f32_dpp v4, v4, v4 quad_perm:[2,3,0,1] row_mask:0xf bank_mask:0xf
 v_mfma_f32_16x16x32_bf16 v[68:71], v[148:151], a[68:71], v[68:71]
 v_exp_f32 v31, v31
 v_mfma_f32_16x16x32_bf16 v[68:71], v[144:147], a[64:67], v[68:71]
 ds_read_b128 a[204:207], v2 offset:11264
 v_add_f32_dpp v4, v4, v4 quad_perm:[1,0,3,2] row_mask:0xf bank_mask:0xf
 v_mfma_f32_16x16x32_bf16 v[72:75], v[144:147], a[112:115], v[72:75]
 v_rcp_f32 v96, v96
 v_mfma_f32_16x16x32_bf16 v[72:75], v[148:151], a[116:119], v[72:75]
 v_rcp_f32 v97, v97
 v_mfma_f32_16x16x32_bf16 v[72:75], v[152:155], a[120:123], v[72:75]
 ds_write_b32 v3, v4 offset:256
 v_mfma_f32_16x16x32_bf16 v[72:75], v[156:159], a[124:127], v[72:75]
 v_rcp_f32 v98, v98
 v_mfma_f32_16x16x32_bf16 v[76:79], v[156:159], v[188:191], v[76:79]
 v_rcp_f32 v99, v99
 v_mfma_f32_16x16x32_bf16 v[76:79], v[152:155], v[184:187], v[76:79]
 v_rcp_f32 v100, v100
 v_mfma_f32_16x16x32_bf16 v[76:79], v[148:151], v[180:183], v[76:79]
 v_rcp_f32 v101, v101
 v_mfma_f32_16x16x32_bf16 v[76:79], v[144:147], v[176:179], v[76:79]
 s_waitcnt lgkmcnt(1)
 v_rcp_f32 v102, v102
 v_mfma_f32_16x16x32_bf16 v[64:67], a[192:195], a[32:35], v[64:67]
 v_rcp_f32 v103, v103
 v_mfma_f32_16x16x32_bf16 v[64:67], a[196:199], a[36:39], v[64:67]
 ds_read_b128 v[144:147], v2 offset:12288
 v_cvt_pk_bf16_f32 v114, v80, v81
 v_mfma_f32_16x16x32_bf16 v[64:67], a[200:203], a[40:43], v[64:67]
 v_rcp_f32 v104, v104
 v_mfma_f32_16x16x32_bf16 v[64:67], a[204:207], a[44:47], v[64:67]
 ds_read_b128 v[148:151], v2 offset:13312
 v_cvt_pk_bf16_f32 v115, v82, v83
 v_mfma_f32_16x16x32_bf16 v[68:71], a[204:207], a[92:95], v[68:71]
 v_rcp_f32 v105, v105
 v_mfma_f32_16x16x32_bf16 v[68:71], a[200:203], a[88:91], v[68:71]
 ds_read_b128 v[152:155], v2 offset:14336
 v_cvt_pk_bf16_f32 v118, v84, v85
 v_mfma_f32_16x16x32_bf16 v[68:71], a[196:199], a[84:87], v[68:71]
 v_rcp_f32 v106, v106
 v_mfma_f32_16x16x32_bf16 v[68:71], a[192:195], a[80:83], v[68:71]
 ds_read_b128 v[156:159], v2 offset:15360
 v_cvt_pk_bf16_f32 v119, v86, v87
 v_mfma_f32_16x16x32_bf16 v[72:75], a[192:195], a[128:131], v[72:75]
 v_rcp_f32 v107, v107
 v_mfma_f32_16x16x32_bf16 v[72:75], a[196:199], a[132:135], v[72:75]
 v_cvt_pk_bf16_f32 v130, v88, v89
 v_cvt_pk_bf16_f32 v131, v90, v91
 v_mfma_f32_16x16x32_bf16 v[72:75], a[200:203], a[136:139], v[72:75]
 s_waitcnt vmcnt(10)
 v_rcp_f32 v108, v108
 v_mfma_f32_16x16x32_bf16 v[72:75], a[204:207], a[140:143], v[72:75]
 s_barrier
 v_cvt_pk_bf16_f32 v134, v92, v93
 v_cvt_pk_bf16_f32 v135, v94, v95
 v_mfma_f32_16x16x32_bf16 v[76:79], a[204:207], v[204:207], v[76:79]
 v_rcp_f32 v109, v109
 v_mfma_f32_16x16x32_bf16 v[76:79], a[200:203], v[200:203], v[76:79]
 v_rcp_f32 v110, v110
 v_mfma_f32_16x16x32_bf16 v[76:79], a[196:199], v[196:199], v[76:79]
 s_waitcnt lgkmcnt(0)
 v_rcp_f32 v111, v111
 v_mfma_f32_16x16x32_bf16 v[76:79], a[192:195], v[192:195], v[76:79]
 buffer_store_dwordx4 v[112:115], v0, s[32:35], s28 offen sc1
 buffer_load_dwordx4 v0, s[36:39], s17 offen offset:0 sc1 lds
 buffer_store_dwordx4 v[116:119], v0, s[32:35], s29 offen sc1
 buffer_load_dwordx4 v0, s[36:39], s17 offen offset:1024 sc1 lds
 buffer_load_dwordx4 v0, s[36:39], s17 offen offset:2048 sc1 lds
 v_pk_mul_f32 v[96:97], v[96:97], v[32:33]
 v_pk_mul_f32 v[98:99], v[98:99], v[34:35]
 v_pk_mul_f32 v[100:101], v[100:101], v[36:37]
 v_pk_mul_f32 v[102:103], v[102:103], v[38:39]
 v_pk_mul_f32 v[104:105], v[104:105], v[40:41]
 v_pk_mul_f32 v[106:107], v[106:107], v[42:43]
 v_pk_mul_f32 v[108:109], v[108:109], v[44:45]
 v_pk_mul_f32 v[110:111], v[110:111], v[46:47]
 v_pk_mul_f32 v[4:5], v[96:97], v[96:97]
 v_pk_fma_f32 v[16:17], v[16:17], s[22:23], s[22:23]
 v_pk_mul_f32 v[6:7], v[98:99], v[98:99]
 v_pk_fma_f32 v[18:19], v[18:19], s[22:23], s[22:23]
 v_pk_fma_f32 v[4:5], v[100:101], v[100:101], v[4:5]
 v_pk_fma_f32 v[20:21], v[20:21], s[22:23], s[22:23]
 v_pk_fma_f32 v[6:7], v[102:103], v[102:103], v[6:7]
 v_pk_fma_f32 v[22:23], v[22:23], s[22:23], s[22:23]
 v_pk_fma_f32 v[4:5], v[104:105], v[104:105], v[4:5]
 v_pk_fma_f32 v[24:25], v[24:25], s[22:23], s[22:23]
 v_pk_fma_f32 v[6:7], v[106:107], v[106:107], v[6:7]
 v_pk_fma_f32 v[26:27], v[26:27], s[22:23], s[22:23]
 v_pk_fma_f32 v[4:5], v[108:109], v[108:109], v[4:5]
 v_pk_fma_f32 v[28:29], v[28:29], s[22:23], s[22:23]
 v_pk_fma_f32 v[6:7], v[110:111], v[110:111], v[6:7]
 v_pk_fma_f32 v[30:31], v[30:31], s[22:23], s[22:23]
 v_pk_fma_f32 v[32:33], v[64:65], v[64:65], s[20:21]
 v_pk_fma_f32 v[34:35], v[66:67], v[66:67], s[20:21]
 v_pk_fma_f32 v[36:37], v[68:69], v[68:69], s[20:21]
 v_pk_fma_f32 v[38:39], v[70:71], v[70:71], s[20:21]
 v_pk_fma_f32 v[40:41], v[72:73], v[72:73], s[20:21]
 v_pk_fma_f32 v[42:43], v[74:75], v[74:75], s[20:21]
 v_pk_fma_f32 v[44:45], v[76:77], v[76:77], s[20:21]
 v_pk_fma_f32 v[46:47], v[78:79], v[78:79], s[20:21]
 v_pk_mul_f32 v[32:33], v[32:33], v[64:65] neg_lo:[1,0] neg_hi:[1,0]
 v_pk_mul_f32 v[34:35], v[34:35], v[66:67] neg_lo:[1,0] neg_hi:[1,0]
 v_pk_mul_f32 v[36:37], v[36:37], v[68:69] neg_lo:[1,0] neg_hi:[1,0]
 v_pk_mul_f32 v[38:39], v[38:39], v[70:71] neg_lo:[1,0] neg_hi:[1,0]
 v_pk_mul_f32 v[40:41], v[40:41], v[72:73] neg_lo:[1,0] neg_hi:[1,0]
 v_pk_mul_f32 v[42:43], v[42:43], v[74:75] neg_lo:[1,0] neg_hi:[1,0]
 v_pk_mul_f32 v[44:45], v[44:45], v[76:77] neg_lo:[1,0] neg_hi:[1,0]
 v_pk_mul_f32 v[46:47], v[46:47], v[78:79] neg_lo:[1,0] neg_hi:[1,0]
 v_mfma_f32_16x16x32_bf16 v[80:83], v[144:147], a[0:3], 0
 s_add_u32 s28, s28, 0x4000
 v_exp_f32 v32, v32
 v_mfma_f32_16x16x32_bf16 v[80:83], v[148:151], a[4:7], v[80:83]
 ds_read_b128 a[192:195], v2 offset:16384
 v_add_f32_dpp v4, v4, v4 row_ror:8 row_mask:0xf bank_mask:0x3
 v_mfma_f32_16x16x32_bf16 v[80:83], v[152:155], a[8:11], v[80:83]
 s_add_u32 s29, s29, 0x4000
 v_exp_f32 v33, v33
 v_mfma_f32_16x16x32_bf16 v[80:83], v[156:159], a[12:15], v[80:83]
 ds_read_b128 a[196:199], v2 offset:17408
 v_add_f32_dpp v5, v5, v5 row_ror:8 row_mask:0xf bank_mask:0x3
 v_mfma_f32_16x16x32_bf16 v[84:87], v[156:159], a[60:63], 0
 s_add_u32 s42, s42, 24576
 v_exp_f32 v34, v34
 v_mfma_f32_16x16x32_bf16 v[84:87], v[152:155], a[56:59], v[84:87]
 ds_read_b128 a[200:203], v2 offset:18432
 v_add_f32_dpp v4, v6, v6 row_ror:8 row_mask:0xf bank_mask:0xc
 v_mfma_f32_16x16x32_bf16 v[84:87], v[148:151], a[52:55], v[84:87]
 s_cmp_eq_u32 s42, 98304
 v_exp_f32 v35, v35
 v_mfma_f32_16x16x32_bf16 v[84:87], v[144:147], a[48:51], v[84:87]
 ds_read_b128 a[204:207], v2 offset:19456
 v_add_f32_dpp v5, v7, v7 row_ror:8 row_mask:0xf bank_mask:0xc
 v_mfma_f32_16x16x32_bf16 v[88:91], v[144:147], a[96:99], 0
 s_cselect_b32 s42, 0, s42
 v_exp_f32 v36, v36
 v_mfma_f32_16x16x32_bf16 v[88:91], v[148:151], a[100:103], v[88:91]
 v_exp_f32 v37, v37
 v_mfma_f32_16x16x32_bf16 v[88:91], v[152:155], a[104:107], v[88:91]
 s_add_u32 s17, s17, 0xc00
 v_exp_f32 v38, v38
 v_mfma_f32_16x16x32_bf16 v[88:91], v[156:159], a[108:111], v[88:91]
 v_exp_f32 v39, v39
 v_mfma_f32_16x16x32_bf16 v[92:95], v[156:159], v[172:175], 0
 s_add_u32 m0, s40, 3072
 v_exp_f32 v40, v40
 v_mfma_f32_16x16x32_bf16 v[92:95], v[152:155], v[168:171], v[92:95]
 v_exp_f32 v41, v41
 v_mfma_f32_16x16x32_bf16 v[92:95], v[148:151], v[164:167], v[92:95]
 v_exp_f32 v42, v42
 v_mfma_f32_16x16x32_bf16 v[92:95], v[144:147], v[160:163], v[92:95]
 s_waitcnt lgkmcnt(0)
 v_exp_f32 v43, v43
 v_mfma_f32_16x16x32_bf16 v[80:83], a[192:195], a[16:19], v[80:83]
 v_exp_f32 v44, v44
 v_mfma_f32_16x16x32_bf16 v[80:83], a[196:199], a[20:23], v[80:83]
 ds_read_b128 v[144:147], v2 offset:20480
 v_add_f32_dpp v4, v4, v4 row_shl:4 row_mask:0xf bank_mask:0x5
 v_mfma_f32_16x16x32_bf16 v[80:83], a[200:203], a[24:27], v[80:83]
 v_exp_f32 v45, v45
 v_mfma_f32_16x16x32_bf16 v[80:83], a[204:207], a[28:31], v[80:83]
 ds_read_b128 v[148:151], v2 offset:21504
 v_add_f32_dpp v4, v5, v5 row_shr:4 row_mask:0xf bank_mask:0xa
 v_mfma_f32_16x16x32_bf16 v[84:87], a[204:207], a[76:79], v[84:87]
 v_exp_f32 v46, v46
 v_mfma_f32_16x16x32_bf16 v[84:87], a[200:203], a[72:75], v[84:87]
 ds_read_b128 v[152:155], v2 offset:22528
 v_add_f32_dpp v4, v4, v4 quad_perm:[2,3,0,1] row_mask:0xf bank_mask:0xf
 v_mfma_f32_16x16x32_bf16 v[84:87], a[196:199], a[68:71], v[84:87]
 v_exp_f32 v47, v47
 v_mfma_f32_16x16x32_bf16 v[84:87], a[192:195], a[64:67], v[84:87]
 ds_read_b128 v[156:159], v2 offset:23552
 v_add_f32_dpp v4, v4, v4 quad_perm:[1,0,3,2] row_mask:0xf bank_mask:0xf
 v_mfma_f32_16x16x32_bf16 v[88:91], a[192:195], a[112:115], v[88:91]
 v_rcp_f32 v16, v16
 v_mfma_f32_16x16x32_bf16 v[88:91], a[196:199], a[116:119], v[88:91]
 v_rcp_f32 v17, v17
 v_mfma_f32_16x16x32_bf16 v[88:91], a[200:203], a[120:123], v[88:91]
 ds_write_b32 v3, v4 offset:512
 v_add_u32 v2, s42, v0
 v_mfma_f32_16x16x32_bf16 v[88:91], a[204:207], a[124:127], v[88:91]
 v_rcp_f32 v18, v18
 v_mfma_f32_16x16x32_bf16 v[92:95], a[204:207], v[188:191], v[92:95]
 v_rcp_f32 v19, v19
 v_mfma_f32_16x16x32_bf16 v[92:95], a[200:203], v[184:187], v[92:95]
 v_rcp_f32 v20, v20
 v_mfma_f32_16x16x32_bf16 v[92:95], a[196:199], v[180:183], v[92:95]
 v_rcp_f32 v21, v21
 v_mfma_f32_16x16x32_bf16 v[92:95], a[192:195], v[176:179], v[92:95]
 s_waitcnt lgkmcnt(1)
 v_rcp_f32 v22, v22
 v_mfma_f32_16x16x32_bf16 v[80:83], v[144:147], a[32:35], v[80:83]
 v_rcp_f32 v23, v23
 v_mfma_f32_16x16x32_bf16 v[80:83], v[148:151], a[36:39], v[80:83]
 ds_read_b128 a[192:195], v2 offset:0
 v_cvt_pk_bf16_f32 v112, v96, v97
 v_mfma_f32_16x16x32_bf16 v[80:83], v[152:155], a[40:43], v[80:83]
 v_rcp_f32 v24, v24
 v_mfma_f32_16x16x32_bf16 v[80:83], v[156:159], a[44:47], v[80:83]
 ds_read_b128 a[196:199], v2 offset:1024
 v_cvt_pk_bf16_f32 v113, v98, v99
 v_mfma_f32_16x16x32_bf16 v[84:87], v[156:159], a[92:95], v[84:87]
 v_rcp_f32 v25, v25
 v_mfma_f32_16x16x32_bf16 v[84:87], v[152:155], a[88:91], v[84:87]
 ds_read_b128 a[200:203], v2 offset:2048
 v_cvt_pk_bf16_f32 v116, v100, v101
 v_mfma_f32_16x16x32_bf16 v[84:87], v[148:151], a[84:87], v[84:87]
 v_rcp_f32 v26, v26
 v_mfma_f32_16x16x32_bf16 v[84:87], v[144:147], a[80:83], v[84:87]
 ds_read_b128 a[204:207], v2 offset:3072
 v_cvt_pk_bf16_f32 v117, v102, v103
 v_mfma_f32_16x16x32_bf16 v[88:91], v[144:147], a[128:131], v[88:91]
 v_rcp_f32 v27, v27
 v_mfma_f32_16x16x32_bf16 v[88:91], v[148:151], a[132:135], v[88:91]
 v_cvt_pk_bf16_f32 v136, v104, v105
 v_cvt_pk_bf16_f32 v137, v106, v107
 v_mfma_f32_16x16x32_bf16 v[88:91], v[152:155], a[136:139], v[88:91]
 v_rcp_f32 v28, v28
 v_mfma_f32_16x16x32_bf16 v[88:91], v[156:159], a[140:143], v[88:91]
 v_cvt_pk_bf16_f32 v140, v108, v109
 v_cvt_pk_bf16_f32 v141, v110, v111
 v_mfma_f32_16x16x32_bf16 v[92:95], v[156:159], v[204:207], v[92:95]
 v_rcp_f32 v29, v29
 v_mfma_f32_16x16x32_bf16 v[92:95], v[152:155], v[200:203], v[92:95]
 v_rcp_f32 v30, v30
 v_mfma_f32_16x16x32_bf16 v[92:95], v[148:151], v[196:199], v[92:95]
 s_waitcnt lgkmcnt(0)
 v_rcp_f32_e64 v31, v31
 v_mfma_f32_16x16x32_bf16 v[92:95], v[144:147], v[192:195], v[92:95]
 buffer_store_dwordx4 v[128:131], v0, s[32:35], s30 offen sc1
 buffer_load_dwordx4 v0, s[36:39], s17 offen offset:0 sc1 lds
 buffer_store_dwordx4 v[132:135], v0, s[32:35], s31 offen sc1
 buffer_load_dwordx4 v0, s[36:39], s17 offen offset:1024 sc1 lds
 buffer_load_dwordx4 v0, s[36:39], s17 offen offset:2048 sc1 lds
 v_pk_mul_f32 v[16:17], v[16:17], v[48:49]
 v_pk_mul_f32 v[18:19], v[18:19], v[50:51]
 v_pk_mul_f32 v[20:21], v[20:21], v[52:53]
 v_pk_mul_f32 v[22:23], v[22:23], v[54:55]
 v_pk_mul_f32 v[24:25], v[24:25], v[56:57]
 v_pk_mul_f32 v[26:27], v[26:27], v[58:59]
 v_pk_mul_f32 v[28:29], v[28:29], v[60:61]
 v_pk_mul_f32 v[30:31], v[30:31], v[62:63]
 v_pk_mul_f32 v[4:5], v[16:17], v[16:17]
 v_pk_fma_f32 v[32:33], v[32:33], s[22:23], s[22:23]
 v_pk_mul_f32 v[6:7], v[18:19], v[18:19]
 v_pk_fma_f32 v[34:35], v[34:35], s[22:23], s[22:23]
 v_pk_fma_f32 v[4:5], v[20:21], v[20:21], v[4:5]
 v_pk_fma_f32 v[36:37], v[36:37], s[22:23], s[22:23]
 v_pk_fma_f32 v[6:7], v[22:23], v[22:23], v[6:7]
 v_pk_fma_f32 v[38:39], v[38:39], s[22:23], s[22:23]
 v_pk_fma_f32 v[4:5], v[24:25], v[24:25], v[4:5]
 v_pk_fma_f32 v[40:41], v[40:41], s[22:23], s[22:23]
 v_pk_fma_f32 v[6:7], v[26:27], v[26:27], v[6:7]
 v_pk_fma_f32 v[42:43], v[42:43], s[22:23], s[22:23]
 v_pk_fma_f32 v[4:5], v[28:29], v[28:29], v[4:5]
 v_pk_fma_f32 v[44:45], v[44:45], s[22:23], s[22:23]
 v_pk_fma_f32 v[6:7], v[30:31], v[30:31], v[6:7]
 v_pk_fma_f32 v[46:47], v[46:47], s[22:23], s[22:23]
 v_pk_fma_f32 v[48:49], v[80:81], v[80:81], s[20:21]
 v_pk_fma_f32 v[50:51], v[82:83], v[82:83], s[20:21]
 v_pk_fma_f32 v[52:53], v[84:85], v[84:85], s[20:21]
 v_pk_fma_f32 v[54:55], v[86:87], v[86:87], s[20:21]
 v_pk_fma_f32 v[56:57], v[88:89], v[88:89], s[20:21]
 v_pk_fma_f32 v[58:59], v[90:91], v[90:91], s[20:21]
 v_pk_fma_f32 v[60:61], v[92:93], v[92:93], s[20:21]
 v_pk_fma_f32 v[62:63], v[94:95], v[94:95], s[20:21]
 v_pk_mul_f32 v[48:49], v[48:49], v[80:81] neg_lo:[1,0] neg_hi:[1,0]
 v_pk_mul_f32 v[50:51], v[50:51], v[82:83] neg_lo:[1,0] neg_hi:[1,0]
 v_pk_mul_f32 v[52:53], v[52:53], v[84:85] neg_lo:[1,0] neg_hi:[1,0]
 v_pk_mul_f32 v[54:55], v[54:55], v[86:87] neg_lo:[1,0] neg_hi:[1,0]
 v_pk_mul_f32 v[56:57], v[56:57], v[88:89] neg_lo:[1,0] neg_hi:[1,0]
 v_pk_mul_f32 v[58:59], v[58:59], v[90:91] neg_lo:[1,0] neg_hi:[1,0]
 v_pk_mul_f32 v[60:61], v[60:61], v[92:93] neg_lo:[1,0] neg_hi:[1,0]
 v_pk_mul_f32 v[62:63], v[62:63], v[94:95] neg_lo:[1,0] neg_hi:[1,0]
 v_mfma_f32_16x16x32_bf16 v[96:99], a[192:195], a[0:3], 0
 s_add_u32 s30, s30, 0x4000
 v_exp_f32 v48, v48
 v_mfma_f32_16x16x32_bf16 v[96:99], a[196:199], a[4:7], v[96:99]
 ds_read_b128 v[144:147], v2 offset:4096
 v_add_f32_dpp v4, v4, v4 row_ror:8 row_mask:0xf bank_mask:0x3
 v_mfma_f32_16x16x32_bf16 v[96:99], a[200:203], a[8:11], v[96:99]
 s_add_u32 s31, s31, 0x4000
 v_exp_f32 v49, v49
 v_mfma_f32_16x16x32_bf16 v[96:99], a[204:207], a[12:15], v[96:99]
 ds_read_b128 v[148:151], v2 offset:5120
 v_add_f32_dpp v5, v5, v5 row_ror:8 row_mask:0xf bank_mask:0x3
 v_mfma_f32_16x16x32_bf16 v[100:103], a[204:207], a[60:63], 0
 s_add_u32 s40, s40, 24576
 v_exp_f32 v50, v50
 v_mfma_f32_16x16x32_bf16 v[100:103], a[200:203], a[56:59], v[100:103]
 ds_read_b128 v[152:155], v2 offset:6144
 v_add_f32_dpp v4, v6, v6 row_ror:8 row_mask:0xf bank_mask:0xc
 v_mfma_f32_16x16x32_bf16 v[100:103], a[196:199], a[52:55], v[100:103]
 s_cmp_eq_u32 s40, s41
 v_exp_f32 v51, v51
 v_mfma_f32_16x16x32_bf16 v[100:103], a[192:195], a[48:51], v[100:103]
 ds_read_b128 v[156:159], v2 offset:7168
 v_add_f32_dpp v5, v7, v7 row_ror:8 row_mask:0xf bank_mask:0xc
 v_mfma_f32_16x16x32_bf16 v[104:107], a[192:195], a[96:99], 0
 s_cselect_b32 s40, s24, s40
 v_exp_f32 v52, v52
 v_mfma_f32_16x16x32_bf16 v[104:107], a[196:199], a[100:103], v[104:107]
 v_exp_f32 v53, v53
 v_mfma_f32_16x16x32_bf16 v[104:107], a[200:203], a[104:107], v[104:107]
 s_add_u32 s17, s17, 0x5400
 v_exp_f32 v54, v54
 v_mfma_f32_16x16x32_bf16 v[104:107], a[204:207], a[108:111], v[104:107]
 v_exp_f32 v55, v55
 v_mfma_f32_16x16x32_bf16 v[108:111], a[204:207], v[172:175], 0
 s_add_u32 m0, s40, 0
 v_exp_f32 v56, v56
 v_mfma_f32_16x16x32_bf16 v[108:111], a[200:203], v[168:171], v[108:111]
 v_exp_f32 v57, v57
 v_mfma_f32_16x16x32_bf16 v[108:111], a[196:199], v[164:167], v[108:111]
 v_exp_f32 v58, v58
 v_mfma_f32_16x16x32_bf16 v[108:111], a[192:195], v[160:163], v[108:111]
 s_waitcnt lgkmcnt(0)
 v_exp_f32 v59, v59
 v_mfma_f32_16x16x32_bf16 v[96:99], v[144:147], a[16:19], v[96:99]
 v_exp_f32 v60, v60
 v_mfma_f32_16x16x32_bf16 v[96:99], v[148:151], a[20:23], v[96:99]
 ds_read_b128 a[192:195], v2 offset:8192
 v_add_f32_dpp v4, v4, v4 row_shl:4 row_mask:0xf bank_mask:0x5
 v_mfma_f32_16x16x32_bf16 v[96:99], v[152:155], a[24:27], v[96:99]
 v_exp_f32 v61, v61
 v_mfma_f32_16x16x32_bf16 v[96:99], v[156:159], a[28:31], v[96:99]
 ds_read_b128 a[196:199], v2 offset:9216
 v_add_f32_dpp v4, v5, v5 row_shr:4 row_mask:0xf bank_mask:0xa
 v_mfma_f32_16x16x32_bf16 v[100:103], v[156:159], a[76:79], v[100:103]
 v_exp_f32 v62, v62
 v_mfma_f32_16x16x32_bf16 v[100:103], v[152:155], a[72:75], v[100:103]
 ds_read_b128 a[200:203], v2 offset:10240
 v_add_f32_dpp v4, v4, v4 quad_perm:[2,3,0,1] row_mask:0xf bank_mask:0xf
 v_mfma_f32_16x16x32_bf16 v[100:103], v[148:151], a[68:71], v[100:103]
 v_exp_f32 v63, v63
 v_mfma_f32_16x16x32_bf16 v[100:103], v[144:147], a[64:67], v[100:103]
 ds_read_b128 a[204:207], v2 offset:11264
 v_add_f32_dpp v4, v4, v4 quad_perm:[1,0,3,2] row_mask:0xf bank_mask:0xf
 v_mfma_f32_16x16x32_bf16 v[104:107], v[144:147], a[112:115], v[104:107]
 v_rcp_f32 v32, v32
 v_mfma_f32_16x16x32_bf16 v[104:107], v[148:151], a[116:119], v[104:107]
 v_rcp_f32 v33, v33
 v_mfma_f32_16x16x32_bf16 v[104:107], v[152:155], a[120:123], v[104:107]
 ds_write_b32 v3, v4 offset:768
 v_mfma_f32_16x16x32_bf16 v[104:107], v[156:159], a[124:127], v[104:107]
 v_rcp_f32 v34, v34
 v_mfma_f32_16x16x32_bf16 v[108:111], v[156:159], v[188:191], v[108:111]
 v_rcp_f32 v35, v35
 v_mfma_f32_16x16x32_bf16 v[108:111], v[152:155], v[184:187], v[108:111]
 v_rcp_f32 v36, v36
 v_mfma_f32_16x16x32_bf16 v[108:111], v[148:151], v[180:183], v[108:111]
 v_rcp_f32 v37, v37
 v_mfma_f32_16x16x32_bf16 v[108:111], v[144:147], v[176:179], v[108:111]
 s_waitcnt lgkmcnt(1)
 v_rcp_f32 v38, v38
 v_mfma_f32_16x16x32_bf16 v[96:99], a[192:195], a[32:35], v[96:99]
 v_rcp_f32 v39, v39
 v_mfma_f32_16x16x32_bf16 v[96:99], a[196:199], a[36:39], v[96:99]
 ds_read_b128 v[144:147], v2 offset:12288
 v_cvt_pk_bf16_f32 v114, v16, v17
 v_mfma_f32_16x16x32_bf16 v[96:99], a[200:203], a[40:43], v[96:99]
 v_rcp_f32 v40, v40
 v_mfma_f32_16x16x32_bf16 v[96:99], a[204:207], a[44:47], v[96:99]
 ds_read_b128 v[148:151], v2 offset:13312
 v_cvt_pk_bf16_f32 v115, v18, v19
 v_mfma_f32_16x16x32_bf16 v[100:103], a[204:207], a[92:95], v[100:103]
 v_rcp_f32 v41, v41
 v_mfma_f32_16x16x32_bf16 v[100:103], a[200:203], a[88:91], v[100:103]
 ds_read_b128 v[152:155], v2 offset:14336
 v_cvt_pk_bf16_f32 v118, v20, v21
 v_mfma_f32_16x16x32_bf16 v[100:103], a[196:199], a[84:87], v[100:103]
 v_rcp_f32 v42, v42
 v_mfma_f32_16x16x32_bf16 v[100:103], a[192:195], a[80:83], v[100:103]
 ds_read_b128 v[156:159], v2 offset:15360
 v_cvt_pk_bf16_f32 v119, v22, v23
 v_mfma_f32_16x16x32_bf16 v[104:107], a[192:195], a[128:131], v[104:107]
 v_rcp_f32 v43, v43
 v_mfma_f32_16x16x32_bf16 v[104:107], a[196:199], a[132:135], v[104:107]
 v_cvt_pk_bf16_f32 v138, v24, v25
 v_cvt_pk_bf16_f32 v139, v26, v27
 v_mfma_f32_16x16x32_bf16 v[104:107], a[200:203], a[136:139], v[104:107]
 s_waitcnt vmcnt(10)
 v_rcp_f32 v44, v44
 v_mfma_f32_16x16x32_bf16 v[104:107], a[204:207], a[140:143], v[104:107]
 s_barrier
 v_cvt_pk_bf16_f32 v142, v28, v29
 v_cvt_pk_bf16_f32 v143, v30, v31
 v_mfma_f32_16x16x32_bf16 v[108:111], a[204:207], v[204:207], v[108:111]
 v_rcp_f32 v45, v45
 v_mfma_f32_16x16x32_bf16 v[108:111], a[200:203], v[200:203], v[108:111]
 v_rcp_f32 v46, v46
 v_mfma_f32_16x16x32_bf16 v[108:111], a[196:199], v[196:199], v[108:111]
 s_waitcnt lgkmcnt(0)
 v_rcp_f32 v47, v47
 v_mfma_f32_16x16x32_bf16 v[108:111], a[192:195], v[192:195], v[108:111]
 buffer_store_dwordx4 v[112:115], v0, s[32:35], s28 offen sc1
 buffer_load_dwordx4 v0, s[36:39], s17 offen offset:0 sc1 lds
 buffer_store_dwordx4 v[116:119], v0, s[32:35], s29 offen sc1
 buffer_load_dwordx4 v0, s[36:39], s17 offen offset:1024 sc1 lds
 buffer_load_dwordx4 v0, s[36:39], s17 offen offset:2048 sc1 lds
 v_pk_mul_f32 v[32:33], v[32:33], v[64:65]
 v_pk_mul_f32 v[34:35], v[34:35], v[66:67]
 v_pk_mul_f32 v[36:37], v[36:37], v[68:69]
 v_pk_mul_f32 v[38:39], v[38:39], v[70:71]
 v_pk_mul_f32 v[40:41], v[40:41], v[72:73]
 v_pk_mul_f32 v[42:43], v[42:43], v[74:75]
 v_pk_mul_f32 v[44:45], v[44:45], v[76:77]
 v_pk_mul_f32 v[46:47], v[46:47], v[78:79]
 v_pk_mul_f32 v[4:5], v[32:33], v[32:33]
 v_pk_fma_f32 v[48:49], v[48:49], s[22:23], s[22:23]
 v_pk_mul_f32 v[6:7], v[34:35], v[34:35]
 v_pk_fma_f32 v[50:51], v[50:51], s[22:23], s[22:23]
 v_pk_fma_f32 v[4:5], v[36:37], v[36:37], v[4:5]
 v_pk_fma_f32 v[52:53], v[52:53], s[22:23], s[22:23]
 v_pk_fma_f32 v[6:7], v[38:39], v[38:39], v[6:7]
 v_pk_fma_f32 v[54:55], v[54:55], s[22:23], s[22:23]
 v_pk_fma_f32 v[4:5], v[40:41], v[40:41], v[4:5]
 v_pk_fma_f32 v[56:57], v[56:57], s[22:23], s[22:23]
 v_pk_fma_f32 v[6:7], v[42:43], v[42:43], v[6:7]
 v_pk_fma_f32 v[58:59], v[58:59], s[22:23], s[22:23]
 v_pk_fma_f32 v[4:5], v[44:45], v[44:45], v[4:5]
 v_pk_fma_f32 v[60:61], v[60:61], s[22:23], s[22:23]
 v_pk_fma_f32 v[6:7], v[46:47], v[46:47], v[6:7]
 v_pk_fma_f32 v[62:63], v[62:63], s[22:23], s[22:23]
 v_pk_fma_f32 v[64:65], v[96:97], v[96:97], s[20:21]
 v_pk_fma_f32 v[66:67], v[98:99], v[98:99], s[20:21]
 v_pk_fma_f32 v[68:69], v[100:101], v[100:101], s[20:21]
 v_pk_fma_f32 v[70:71], v[102:103], v[102:103], s[20:21]
 v_pk_fma_f32 v[72:73], v[104:105], v[104:105], s[20:21]
 v_pk_fma_f32 v[74:75], v[106:107], v[106:107], s[20:21]
 v_pk_fma_f32 v[76:77], v[108:109], v[108:109], s[20:21]
 v_pk_fma_f32 v[78:79], v[110:111], v[110:111], s[20:21]
 v_pk_mul_f32 v[64:65], v[64:65], v[96:97] neg_lo:[1,0] neg_hi:[1,0]
 v_pk_mul_f32 v[66:67], v[66:67], v[98:99] neg_lo:[1,0] neg_hi:[1,0]
 v_pk_mul_f32 v[68:69], v[68:69], v[100:101] neg_lo:[1,0] neg_hi:[1,0]
 v_pk_mul_f32 v[70:71], v[70:71], v[102:103] neg_lo:[1,0] neg_hi:[1,0]
 v_pk_mul_f32 v[72:73], v[72:73], v[104:105] neg_lo:[1,0] neg_hi:[1,0]
 v_pk_mul_f32 v[74:75], v[74:75], v[106:107] neg_lo:[1,0] neg_hi:[1,0]
 v_pk_mul_f32 v[76:77], v[76:77], v[108:109] neg_lo:[1,0] neg_hi:[1,0]
 v_pk_mul_f32 v[78:79], v[78:79], v[110:111] neg_lo:[1,0] neg_hi:[1,0]
 v_mfma_f32_16x16x32_bf16 v[16:19], v[144:147], a[0:3], 0
 s_add_u32 s28, s28, 0x4000
 v_exp_f32 v64, v64
 v_mfma_f32_16x16x32_bf16 v[16:19], v[148:151], a[4:7], v[16:19]
 ds_read_b128 a[192:195], v2 offset:16384
 v_add_f32_dpp v4, v4, v4 row_ror:8 row_mask:0xf bank_mask:0x3
 v_mfma_f32_16x16x32_bf16 v[16:19], v[152:155], a[8:11], v[16:19]
 s_add_u32 s29, s29, 0x4000
 v_exp_f32 v65, v65
 v_mfma_f32_16x16x32_bf16 v[16:19], v[156:159], a[12:15], v[16:19]
 ds_read_b128 a[196:199], v2 offset:17408
 v_add_f32_dpp v5, v5, v5 row_ror:8 row_mask:0xf bank_mask:0x3
 v_mfma_f32_16x16x32_bf16 v[20:23], v[156:159], a[60:63], 0
 s_add_u32 s42, s42, 24576
 v_exp_f32 v66, v66
 v_mfma_f32_16x16x32_bf16 v[20:23], v[152:155], a[56:59], v[20:23]
 ds_read_b128 a[200:203], v2 offset:18432
 v_add_f32_dpp v4, v6, v6 row_ror:8 row_mask:0xf bank_mask:0xc
 v_mfma_f32_16x16x32_bf16 v[20:23], v[148:151], a[52:55], v[20:23]
 s_cmp_eq_u32 s42, 98304
 v_exp_f32 v67, v67
 v_mfma_f32_16x16x32_bf16 v[20:23], v[144:147], a[48:51], v[20:23]
 ds_read_b128 a[204:207], v2 offset:19456
 v_add_f32_dpp v5, v7, v7 row_ror:8 row_mask:0xf bank_mask:0xc
 v_mfma_f32_16x16x32_bf16 v[24:27], v[144:147], a[96:99], 0
 s_cselect_b32 s42, 0, s42
 v_exp_f32 v68, v68
 v_mfma_f32_16x16x32_bf16 v[24:27], v[148:151], a[100:103], v[24:27]
 v_exp_f32 v69, v69
 v_mfma_f32_16x16x32_bf16 v[24:27], v[152:155], a[104:107], v[24:27]
 s_add_u32 s17, s17, 0xc00
 v_exp_f32 v70, v70
 v_mfma_f32_16x16x32_bf16 v[24:27], v[156:159], a[108:111], v[24:27]
 v_exp_f32 v71, v71
 v_mfma_f32_16x16x32_bf16 v[28:31], v[156:159], v[172:175], 0
 s_add_u32 m0, s40, 3072
 v_exp_f32 v72, v72
 v_mfma_f32_16x16x32_bf16 v[28:31], v[152:155], v[168:171], v[28:31]
 v_exp_f32 v73, v73
 v_mfma_f32_16x16x32_bf16 v[28:31], v[148:151], v[164:167], v[28:31]
 v_exp_f32 v74, v74
 v_mfma_f32_16x16x32_bf16 v[28:31], v[144:147], v[160:163], v[28:31]
 s_waitcnt lgkmcnt(0)
 v_exp_f32 v75, v75
 v_mfma_f32_16x16x32_bf16 v[16:19], a[192:195], a[16:19], v[16:19]
 v_exp_f32 v76, v76
 v_mfma_f32_16x16x32_bf16 v[16:19], a[196:199], a[20:23], v[16:19]
 ds_read_b128 v[144:147], v2 offset:20480
 v_add_f32_dpp v4, v4, v4 row_shl:4 row_mask:0xf bank_mask:0x5
 v_mfma_f32_16x16x32_bf16 v[16:19], a[200:203], a[24:27], v[16:19]
 v_exp_f32 v77, v77
 v_mfma_f32_16x16x32_bf16 v[16:19], a[204:207], a[28:31], v[16:19]
 ds_read_b128 v[148:151], v2 offset:21504
 v_add_f32_dpp v4, v5, v5 row_shr:4 row_mask:0xf bank_mask:0xa
 v_mfma_f32_16x16x32_bf16 v[20:23], a[204:207], a[76:79], v[20:23]
 v_exp_f32 v78, v78
 v_mfma_f32_16x16x32_bf16 v[20:23], a[200:203], a[72:75], v[20:23]
 ds_read_b128 v[152:155], v2 offset:22528
 v_add_f32_dpp v4, v4, v4 quad_perm:[2,3,0,1] row_mask:0xf bank_mask:0xf
 v_mfma_f32_16x16x32_bf16 v[20:23], a[196:199], a[68:71], v[20:23]
 v_exp_f32 v79, v79
 v_mfma_f32_16x16x32_bf16 v[20:23], a[192:195], a[64:67], v[20:23]
 ds_read_b128 v[156:159], v2 offset:23552
 v_add_f32_dpp v4, v4, v4 quad_perm:[1,0,3,2] row_mask:0xf bank_mask:0xf
 v_mfma_f32_16x16x32_bf16 v[24:27], a[192:195], a[112:115], v[24:27]
 v_rcp_f32 v48, v48
 v_mfma_f32_16x16x32_bf16 v[24:27], a[196:199], a[116:119], v[24:27]
 v_rcp_f32 v49, v49
 v_mfma_f32_16x16x32_bf16 v[24:27], a[200:203], a[120:123], v[24:27]
 ds_write_b32 v3, v4 offset:1024
 v_add_u32 v2, s42, v0
 v_mfma_f32_16x16x32_bf16 v[24:27], a[204:207], a[124:127], v[24:27]
 v_rcp_f32 v50, v50
 v_mfma_f32_16x16x32_bf16 v[28:31], a[204:207], v[188:191], v[28:31]
 v_rcp_f32 v51, v51
 v_mfma_f32_16x16x32_bf16 v[28:31], a[200:203], v[184:187], v[28:31]
 v_rcp_f32 v52, v52
 v_mfma_f32_16x16x32_bf16 v[28:31], a[196:199], v[180:183], v[28:31]
 v_rcp_f32 v53, v53
 v_mfma_f32_16x16x32_bf16 v[28:31], a[192:195], v[176:179], v[28:31]
 s_waitcnt lgkmcnt(1)
 v_rcp_f32 v54, v54
 v_mfma_f32_16x16x32_bf16 v[16:19], v[144:147], a[32:35], v[16:19]
 v_rcp_f32 v55, v55
 v_mfma_f32_16x16x32_bf16 v[16:19], v[148:151], a[36:39], v[16:19]
 ds_read_b128 a[192:195], v2 offset:0
 v_cvt_pk_bf16_f32 v112, v32, v33
 v_mfma_f32_16x16x32_bf16 v[16:19], v[152:155], a[40:43], v[16:19]
 v_rcp_f32 v56, v56
 v_mfma_f32_16x16x32_bf16 v[16:19], v[156:159], a[44:47], v[16:19]
 ds_read_b128 a[196:199], v2 offset:1024
 v_cvt_pk_bf16_f32 v113, v34, v35
 v_mfma_f32_16x16x32_bf16 v[20:23], v[156:159], a[92:95], v[20:23]
 v_rcp_f32 v57, v57
 v_mfma_f32_16x16x32_bf16 v[20:23], v[152:155], a[88:91], v[20:23]
 ds_read_b128 a[200:203], v2 offset:2048
 v_cvt_pk_bf16_f32 v116, v36, v37
 v_mfma_f32_16x16x32_bf16 v[20:23], v[148:151], a[84:87], v[20:23]
 v_rcp_f32 v58, v58
 v_mfma_f32_16x16x32_bf16 v[20:23], v[144:147], a[80:83], v[20:23]
 ds_read_b128 a[204:207], v2 offset:3072
 v_cvt_pk_bf16_f32 v117, v38, v39
 v_mfma_f32_16x16x32_bf16 v[24:27], v[144:147], a[128:131], v[24:27]
 v_rcp_f32 v59, v59
 v_mfma_f32_16x16x32_bf16 v[24:27], v[148:151], a[132:135], v[24:27]
 v_cvt_pk_bf16_f32 v120, v40, v41
 v_cvt_pk_bf16_f32 v121, v42, v43
 v_mfma_f32_16x16x32_bf16 v[24:27], v[152:155], a[136:139], v[24:27]
 v_rcp_f32 v60, v60
 v_mfma_f32_16x16x32_bf16 v[24:27], v[156:159], a[140:143], v[24:27]
 v_cvt_pk_bf16_f32 v124, v44, v45
 v_cvt_pk_bf16_f32 v125, v46, v47
 v_mfma_f32_16x16x32_bf16 v[28:31], v[156:159], v[204:207], v[28:31]
 v_rcp_f32 v61, v61
 v_mfma_f32_16x16x32_bf16 v[28:31], v[152:155], v[200:203], v[28:31]
 v_rcp_f32 v62, v62
 v_mfma_f32_16x16x32_bf16 v[28:31], v[148:151], v[196:199], v[28:31]
 s_waitcnt lgkmcnt(0)
 v_rcp_f32_e64 v63, v63
 v_mfma_f32_16x16x32_bf16 v[28:31], v[144:147], v[192:195], v[28:31]
 buffer_store_dwordx4 v[136:139], v0, s[32:35], s30 offen sc1
 buffer_load_dwordx4 v0, s[36:39], s17 offen offset:0 sc1 lds
 buffer_store_dwordx4 v[140:143], v0, s[32:35], s31 offen sc1
 buffer_load_dwordx4 v0, s[36:39], s17 offen offset:1024 sc1 lds
 buffer_load_dwordx4 v0, s[36:39], s17 offen offset:2048 sc1 lds
 v_pk_mul_f32 v[48:49], v[48:49], v[80:81]
 v_pk_mul_f32 v[50:51], v[50:51], v[82:83]
 v_pk_mul_f32 v[52:53], v[52:53], v[84:85]
 v_pk_mul_f32 v[54:55], v[54:55], v[86:87]
 v_pk_mul_f32 v[56:57], v[56:57], v[88:89]
 v_pk_mul_f32 v[58:59], v[58:59], v[90:91]
 v_pk_mul_f32 v[60:61], v[60:61], v[92:93]
 v_pk_mul_f32 v[62:63], v[62:63], v[94:95]
 v_pk_mul_f32 v[4:5], v[48:49], v[48:49]
 v_pk_fma_f32 v[64:65], v[64:65], s[22:23], s[22:23]
 v_pk_mul_f32 v[6:7], v[50:51], v[50:51]
 v_pk_fma_f32 v[66:67], v[66:67], s[22:23], s[22:23]
 v_pk_fma_f32 v[4:5], v[52:53], v[52:53], v[4:5]
 v_pk_fma_f32 v[68:69], v[68:69], s[22:23], s[22:23]
 v_pk_fma_f32 v[6:7], v[54:55], v[54:55], v[6:7]
 v_pk_fma_f32 v[70:71], v[70:71], s[22:23], s[22:23]
 v_pk_fma_f32 v[4:5], v[56:57], v[56:57], v[4:5]
 v_pk_fma_f32 v[72:73], v[72:73], s[22:23], s[22:23]
 v_pk_fma_f32 v[6:7], v[58:59], v[58:59], v[6:7]
 v_pk_fma_f32 v[74:75], v[74:75], s[22:23], s[22:23]
 v_pk_fma_f32 v[4:5], v[60:61], v[60:61], v[4:5]
 v_pk_fma_f32 v[76:77], v[76:77], s[22:23], s[22:23]
 v_pk_fma_f32 v[6:7], v[62:63], v[62:63], v[6:7]
 v_pk_fma_f32 v[78:79], v[78:79], s[22:23], s[22:23]
 v_pk_fma_f32 v[80:81], v[16:17], v[16:17], s[20:21]
 v_pk_fma_f32 v[82:83], v[18:19], v[18:19], s[20:21]
 v_pk_fma_f32 v[84:85], v[20:21], v[20:21], s[20:21]
 v_pk_fma_f32 v[86:87], v[22:23], v[22:23], s[20:21]
 v_pk_fma_f32 v[88:89], v[24:25], v[24:25], s[20:21]
 v_pk_fma_f32 v[90:91], v[26:27], v[26:27], s[20:21]
 v_pk_fma_f32 v[92:93], v[28:29], v[28:29], s[20:21]
 v_pk_fma_f32 v[94:95], v[30:31], v[30:31], s[20:21]
 v_pk_mul_f32 v[80:81], v[80:81], v[16:17] neg_lo:[1,0] neg_hi:[1,0]
 v_pk_mul_f32 v[82:83], v[82:83], v[18:19] neg_lo:[1,0] neg_hi:[1,0]
 v_pk_mul_f32 v[84:85], v[84:85], v[20:21] neg_lo:[1,0] neg_hi:[1,0]
 v_pk_mul_f32 v[86:87], v[86:87], v[22:23] neg_lo:[1,0] neg_hi:[1,0]
 v_pk_mul_f32 v[88:89], v[88:89], v[24:25] neg_lo:[1,0] neg_hi:[1,0]
 v_pk_mul_f32 v[90:91], v[90:91], v[26:27] neg_lo:[1,0] neg_hi:[1,0]
 v_pk_mul_f32 v[92:93], v[92:93], v[28:29] neg_lo:[1,0] neg_hi:[1,0]
 v_pk_mul_f32 v[94:95], v[94:95], v[30:31] neg_lo:[1,0] neg_hi:[1,0]
 v_mfma_f32_16x16x32_bf16 v[32:35], a[192:195], a[0:3], 0
 s_mov_b32 s34, 0xc0000
 v_exp_f32 v80, v80
 v_mfma_f32_16x16x32_bf16 v[32:35], a[196:199], a[4:7], v[32:35]
 ds_read_b128 v[144:147], v2 offset:4096
 v_add_f32_dpp v4, v4, v4 row_ror:8 row_mask:0xf bank_mask:0x3
 v_mfma_f32_16x16x32_bf16 v[32:35], a[200:203], a[8:11], v[32:35]
 s_add_u32 s30, s30, 0x4000
 v_exp_f32 v81, v81
 v_mfma_f32_16x16x32_bf16 v[32:35], a[204:207], a[12:15], v[32:35]
 ds_read_b128 v[148:151], v2 offset:5120
 v_add_f32_dpp v5, v5, v5 row_ror:8 row_mask:0xf bank_mask:0x3
 v_mfma_f32_16x16x32_bf16 v[36:39], a[204:207], a[60:63], 0
 s_add_u32 s31, s31, 0x4000
 v_exp_f32 v82, v82
 v_mfma_f32_16x16x32_bf16 v[36:39], a[200:203], a[56:59], v[36:39]
 ds_read_b128 v[152:155], v2 offset:6144
 v_add_f32_dpp v4, v6, v6 row_ror:8 row_mask:0xf bank_mask:0xc
 v_mfma_f32_16x16x32_bf16 v[36:39], a[196:199], a[52:55], v[36:39]
 s_add_u32 s40, s40, 24576
 v_exp_f32 v83, v83
 v_mfma_f32_16x16x32_bf16 v[36:39], a[192:195], a[48:51], v[36:39]
 ds_read_b128 v[156:159], v2 offset:7168
 v_add_f32_dpp v5, v7, v7 row_ror:8 row_mask:0xf bank_mask:0xc
 v_mfma_f32_16x16x32_bf16 v[40:43], a[192:195], a[96:99], 0
 s_cmp_eq_u32 s40, s41
 v_exp_f32 v84, v84
 v_mfma_f32_16x16x32_bf16 v[40:43], a[196:199], a[100:103], v[40:43]
 v_exp_f32 v85, v85
 v_mfma_f32_16x16x32_bf16 v[40:43], a[200:203], a[104:107], v[40:43]
 s_cselect_b32 s40, s24, s40
 v_exp_f32 v86, v86
 v_mfma_f32_16x16x32_bf16 v[40:43], a[204:207], a[108:111], v[40:43]
 v_exp_f32 v87, v87
 v_mfma_f32_16x16x32_bf16 v[44:47], a[204:207], v[172:175], 0
 s_add_u32 s17, s17, 0x5400
 v_exp_f32 v88, v88
 v_mfma_f32_16x16x32_bf16 v[44:47], a[200:203], v[168:171], v[44:47]
 v_exp_f32 v89, v89
 v_mfma_f32_16x16x32_bf16 v[44:47], a[196:199], v[164:167], v[44:47]
 s_add_u32 m0, s40, 0
 v_exp_f32 v90, v90
 v_mfma_f32_16x16x32_bf16 v[44:47], a[192:195], v[160:163], v[44:47]
 s_waitcnt lgkmcnt(0)
 v_exp_f32 v91, v91
 v_mfma_f32_16x16x32_bf16 v[32:35], v[144:147], a[16:19], v[32:35]
 v_exp_f32 v92, v92
 v_mfma_f32_16x16x32_bf16 v[32:35], v[148:151], a[20:23], v[32:35]
 ds_read_b128 a[192:195], v2 offset:8192
 v_add_f32_dpp v4, v4, v4 row_shl:4 row_mask:0xf bank_mask:0x5
 v_mfma_f32_16x16x32_bf16 v[32:35], v[152:155], a[24:27], v[32:35]
 v_exp_f32 v93, v93
 v_mfma_f32_16x16x32_bf16 v[32:35], v[156:159], a[28:31], v[32:35]
 ds_read_b128 a[196:199], v2 offset:9216
 v_add_f32_dpp v4, v5, v5 row_shr:4 row_mask:0xf bank_mask:0xa
 v_mfma_f32_16x16x32_bf16 v[36:39], v[156:159], a[76:79], v[36:39]
 v_exp_f32 v94, v94
 v_mfma_f32_16x16x32_bf16 v[36:39], v[152:155], a[72:75], v[36:39]
 ds_read_b128 a[200:203], v2 offset:10240
 v_add_f32_dpp v4, v4, v4 quad_perm:[2,3,0,1] row_mask:0xf bank_mask:0xf
 v_mfma_f32_16x16x32_bf16 v[36:39], v[148:151], a[68:71], v[36:39]
 v_exp_f32 v95, v95
 v_mfma_f32_16x16x32_bf16 v[36:39], v[144:147], a[64:67], v[36:39]
 ds_read_b128 a[204:207], v2 offset:11264
 v_add_f32_dpp v4, v4, v4 quad_perm:[1,0,3,2] row_mask:0xf bank_mask:0xf
 v_mfma_f32_16x16x32_bf16 v[40:43], v[144:147], a[112:115], v[40:43]
 v_rcp_f32 v64, v64
 v_mfma_f32_16x16x32_bf16 v[40:43], v[148:151], a[116:119], v[40:43]
 v_rcp_f32 v65, v65
 v_mfma_f32_16x16x32_bf16 v[40:43], v[152:155], a[120:123], v[40:43]
 ds_write_b32 v3, v4 offset:1280
 v_add_u32 v3, 1536, v3
 v_mfma_f32_16x16x32_bf16 v[40:43], v[156:159], a[124:127], v[40:43]
 v_rcp_f32 v66, v66
 v_mfma_f32_16x16x32_bf16 v[44:47], v[156:159], v[188:191], v[44:47]
 v_rcp_f32 v67, v67
 v_mfma_f32_16x16x32_bf16 v[44:47], v[152:155], v[184:187], v[44:47]
 v_rcp_f32 v68, v68
 v_mfma_f32_16x16x32_bf16 v[44:47], v[148:151], v[180:183], v[44:47]
 v_rcp_f32 v69, v69
 v_mfma_f32_16x16x32_bf16 v[44:47], v[144:147], v[176:179], v[44:47]
 s_waitcnt lgkmcnt(1)
 v_rcp_f32 v70, v70
 v_mfma_f32_16x16x32_bf16 v[32:35], a[192:195], a[32:35], v[32:35]
 v_rcp_f32 v71, v71
 v_mfma_f32_16x16x32_bf16 v[32:35], a[196:199], a[36:39], v[32:35]
 ds_read_b128 v[144:147], v2 offset:12288
 v_cvt_pk_bf16_f32 v114, v48, v49
 v_mfma_f32_16x16x32_bf16 v[32:35], a[200:203], a[40:43], v[32:35]
 v_rcp_f32 v72, v72
 v_mfma_f32_16x16x32_bf16 v[32:35], a[204:207], a[44:47], v[32:35]
 ds_read_b128 v[148:151], v2 offset:13312
 v_cvt_pk_bf16_f32 v115, v50, v51
 v_mfma_f32_16x16x32_bf16 v[36:39], a[204:207], a[92:95], v[36:39]
 v_rcp_f32 v73, v73
 v_mfma_f32_16x16x32_bf16 v[36:39], a[200:203], a[88:91], v[36:39]
 ds_read_b128 v[152:155], v2 offset:14336
 v_cvt_pk_bf16_f32 v118, v52, v53
 v_mfma_f32_16x16x32_bf16 v[36:39], a[196:199], a[84:87], v[36:39]
 v_rcp_f32 v74, v74
 v_mfma_f32_16x16x32_bf16 v[36:39], a[192:195], a[80:83], v[36:39]
 ds_read_b128 v[156:159], v2 offset:15360
 v_cvt_pk_bf16_f32 v119, v54, v55
 v_mfma_f32_16x16x32_bf16 v[40:43], a[192:195], a[128:131], v[40:43]
 v_rcp_f32 v75, v75
 v_mfma_f32_16x16x32_bf16 v[40:43], a[196:199], a[132:135], v[40:43]
 v_cvt_pk_bf16_f32 v122, v56, v57
 v_cvt_pk_bf16_f32 v123, v58, v59
 v_mfma_f32_16x16x32_bf16 v[40:43], a[200:203], a[136:139], v[40:43]
 s_waitcnt vmcnt(10)
 v_rcp_f32 v76, v76
 v_mfma_f32_16x16x32_bf16 v[40:43], a[204:207], a[140:143], v[40:43]
 s_barrier
 v_cvt_pk_bf16_f32 v126, v60, v61
 v_cvt_pk_bf16_f32 v127, v62, v63
 v_mfma_f32_16x16x32_bf16 v[44:47], a[204:207], v[204:207], v[44:47]
 v_rcp_f32 v77, v77
 v_mfma_f32_16x16x32_bf16 v[44:47], a[200:203], v[200:203], v[44:47]
 v_rcp_f32 v78, v78
 v_mfma_f32_16x16x32_bf16 v[44:47], a[196:199], v[196:199], v[44:47]
 s_waitcnt lgkmcnt(0)
 v_rcp_f32 v79, v79
 v_mfma_f32_16x16x32_bf16 v[44:47], a[192:195], v[192:195], v[44:47]
 buffer_store_dwordx4 v[112:115], v0, s[32:35], s28 offen sc1
 buffer_load_dwordx4 v0, s[36:39], s17 offen offset:0 sc1 lds
 buffer_store_dwordx4 v[116:119], v0, s[32:35], s29 offen sc1
 buffer_load_dwordx4 v0, s[36:39], s17 offen offset:1024 sc1 lds
 buffer_load_dwordx4 v0, s[36:39], s17 offen offset:2048 sc1 lds
 v_pk_mul_f32 v[64:65], v[64:65], v[96:97]
 v_pk_mul_f32 v[66:67], v[66:67], v[98:99]
 v_pk_mul_f32 v[68:69], v[68:69], v[100:101]
 v_pk_mul_f32 v[70:71], v[70:71], v[102:103]
 v_pk_mul_f32 v[72:73], v[72:73], v[104:105]
 v_pk_mul_f32 v[74:75], v[74:75], v[106:107]
 v_pk_mul_f32 v[76:77], v[76:77], v[108:109]
 v_pk_mul_f32 v[78:79], v[78:79], v[110:111]
 v_pk_mul_f32 v[4:5], v[64:65], v[64:65]
 v_pk_fma_f32 v[80:81], v[80:81], s[22:23], s[22:23]
 v_pk_mul_f32 v[6:7], v[66:67], v[66:67]
 v_pk_fma_f32 v[82:83], v[82:83], s[22:23], s[22:23]
 v_pk_fma_f32 v[4:5], v[68:69], v[68:69], v[4:5]
 v_pk_fma_f32 v[84:85], v[84:85], s[22:23], s[22:23]
 v_pk_fma_f32 v[6:7], v[70:71], v[70:71], v[6:7]
 v_pk_fma_f32 v[86:87], v[86:87], s[22:23], s[22:23]
 v_pk_fma_f32 v[4:5], v[72:73], v[72:73], v[4:5]
 v_pk_fma_f32 v[88:89], v[88:89], s[22:23], s[22:23]
 v_pk_fma_f32 v[6:7], v[74:75], v[74:75], v[6:7]
 v_pk_fma_f32 v[90:91], v[90:91], s[22:23], s[22:23]
 v_pk_fma_f32 v[4:5], v[76:77], v[76:77], v[4:5]
 v_pk_fma_f32 v[92:93], v[92:93], s[22:23], s[22:23]
 v_pk_fma_f32 v[6:7], v[78:79], v[78:79], v[6:7]
 v_pk_fma_f32 v[94:95], v[94:95], s[22:23], s[22:23]
 v_pk_fma_f32 v[96:97], v[32:33], v[32:33], s[20:21]
 v_pk_fma_f32 v[98:99], v[34:35], v[34:35], s[20:21]
 v_pk_fma_f32 v[100:101], v[36:37], v[36:37], s[20:21]
 v_pk_fma_f32 v[102:103], v[38:39], v[38:39], s[20:21]
 v_pk_fma_f32 v[104:105], v[40:41], v[40:41], s[20:21]
 v_pk_fma_f32 v[106:107], v[42:43], v[42:43], s[20:21]
 v_pk_fma_f32 v[108:109], v[44:45], v[44:45], s[20:21]
 v_pk_fma_f32 v[110:111], v[46:47], v[46:47], s[20:21]
 v_pk_mul_f32 v[96:97], v[96:97], v[32:33] neg_lo:[1,0] neg_hi:[1,0]
 v_pk_mul_f32 v[98:99], v[98:99], v[34:35] neg_lo:[1,0] neg_hi:[1,0]
 v_pk_mul_f32 v[100:101], v[100:101], v[36:37] neg_lo:[1,0] neg_hi:[1,0]
 v_pk_mul_f32 v[102:103], v[102:103], v[38:39] neg_lo:[1,0] neg_hi:[1,0]
 v_pk_mul_f32 v[104:105], v[104:105], v[40:41] neg_lo:[1,0] neg_hi:[1,0]
 v_pk_mul_f32 v[106:107], v[106:107], v[42:43] neg_lo:[1,0] neg_hi:[1,0]
 v_pk_mul_f32 v[108:109], v[108:109], v[44:45] neg_lo:[1,0] neg_hi:[1,0]
 v_pk_mul_f32 v[110:111], v[110:111], v[46:47] neg_lo:[1,0] neg_hi:[1,0]
 v_mfma_f32_16x16x32_bf16 v[48:51], v[144:147], a[0:3], 0
 s_add_u32 s28, s28, 0x4000
 v_exp_f32 v96, v96
 v_mfma_f32_16x16x32_bf16 v[48:51], v[148:151], a[4:7], v[48:51]
 ds_read_b128 a[192:195], v2 offset:16384
 v_add_f32_dpp v4, v4, v4 row_ror:8 row_mask:0xf bank_mask:0x3
 v_mfma_f32_16x16x32_bf16 v[48:51], v[152:155], a[8:11], v[48:51]
 s_add_u32 s29, s29, 0x4000
 v_exp_f32 v97, v97
 v_mfma_f32_16x16x32_bf16 v[48:51], v[156:159], a[12:15], v[48:51]
 ds_read_b128 a[196:199], v2 offset:17408
 v_add_f32_dpp v5, v5, v5 row_ror:8 row_mask:0xf bank_mask:0x3
 v_mfma_f32_16x16x32_bf16 v[52:55], v[156:159], a[60:63], 0
 s_add_u32 s42, s42, 24576
 v_exp_f32 v98, v98
 v_mfma_f32_16x16x32_bf16 v[52:55], v[152:155], a[56:59], v[52:55]
 ds_read_b128 a[200:203], v2 offset:18432
 v_add_f32_dpp v4, v6, v6 row_ror:8 row_mask:0xf bank_mask:0xc
 v_mfma_f32_16x16x32_bf16 v[52:55], v[148:151], a[52:55], v[52:55]
 s_cmp_eq_u32 s42, 98304
 v_exp_f32 v99, v99
 v_mfma_f32_16x16x32_bf16 v[52:55], v[144:147], a[48:51], v[52:55]
 ds_read_b128 a[204:207], v2 offset:19456
 v_add_f32_dpp v5, v7, v7 row_ror:8 row_mask:0xf bank_mask:0xc
 v_mfma_f32_16x16x32_bf16 v[56:59], v[144:147], a[96:99], 0
 s_cselect_b32 s42, 0, s42
 v_exp_f32 v100, v100
 v_mfma_f32_16x16x32_bf16 v[56:59], v[148:151], a[100:103], v[56:59]
 v_exp_f32 v101, v101
 v_mfma_f32_16x16x32_bf16 v[56:59], v[152:155], a[104:107], v[56:59]
 s_add_u32 s17, s17, 0xc00
 v_exp_f32 v102, v102
 v_mfma_f32_16x16x32_bf16 v[56:59], v[156:159], a[108:111], v[56:59]
 v_exp_f32 v103, v103
 v_mfma_f32_16x16x32_bf16 v[60:63], v[156:159], v[172:175], 0
 s_add_u32 m0, s40, 3072
 v_exp_f32 v104, v104
 v_mfma_f32_16x16x32_bf16 v[60:63], v[152:155], v[168:171], v[60:63]
 v_exp_f32 v105, v105
 v_mfma_f32_16x16x32_bf16 v[60:63], v[148:151], v[164:167], v[60:63]
 s_sub_u32 s19, s19, 1
 v_exp_f32 v106, v106
 v_mfma_f32_16x16x32_bf16 v[60:63], v[144:147], v[160:163], v[60:63]
 s_waitcnt lgkmcnt(0)
 v_exp_f32 v107, v107
 v_mfma_f32_16x16x32_bf16 v[48:51], a[192:195], a[16:19], v[48:51]
 s_cmp_lg_u32 s19, 0
 v_exp_f32 v108, v108
 v_mfma_f32_16x16x32_bf16 v[48:51], a[196:199], a[20:23], v[48:51]
 ds_read_b128 v[144:147], v2 offset:20480
 v_add_f32_dpp v4, v4, v4 row_shl:4 row_mask:0xf bank_mask:0x5
 v_mfma_f32_16x16x32_bf16 v[48:51], a[200:203], a[24:27], v[48:51]
 v_exp_f32 v109, v109
 v_mfma_f32_16x16x32_bf16 v[48:51], a[204:207], a[28:31], v[48:51]
 ds_read_b128 v[148:151], v2 offset:21504
 v_add_f32_dpp v4, v5, v5 row_shr:4 row_mask:0xf bank_mask:0xa
 v_mfma_f32_16x16x32_bf16 v[52:55], a[204:207], a[76:79], v[52:55]
 v_exp_f32 v110, v110
 v_mfma_f32_16x16x32_bf16 v[52:55], a[200:203], a[72:75], v[52:55]
 ds_read_b128 v[152:155], v2 offset:22528
 v_add_f32_dpp v4, v4, v4 quad_perm:[2,3,0,1] row_mask:0xf bank_mask:0xf
 v_mfma_f32_16x16x32_bf16 v[52:55], a[196:199], a[68:71], v[52:55]
 v_exp_f32 v111, v111
 v_mfma_f32_16x16x32_bf16 v[52:55], a[192:195], a[64:67], v[52:55]
 ds_read_b128 v[156:159], v2 offset:23552
 v_add_f32_dpp v4, v4, v4 quad_perm:[1,0,3,2] row_mask:0xf bank_mask:0xf
 v_mfma_f32_16x16x32_bf16 v[56:59], a[192:195], a[112:115], v[56:59]
 v_rcp_f32 v80, v80
 v_mfma_f32_16x16x32_bf16 v[56:59], a[196:199], a[116:119], v[56:59]
 v_rcp_f32 v81, v81
 v_mfma_f32_16x16x32_bf16 v[56:59], a[200:203], a[120:123], v[56:59]
 ds_write_b32 v3, v4 offset:0
 v_add_u32 v2, s42, v0
 v_mfma_f32_16x16x32_bf16 v[56:59], a[204:207], a[124:127], v[56:59]
 v_rcp_f32 v82, v82
 v_mfma_f32_16x16x32_bf16 v[60:63], a[204:207], v[188:191], v[60:63]
 v_rcp_f32 v83, v83
 v_mfma_f32_16x16x32_bf16 v[60:63], a[200:203], v[184:187], v[60:63]
 v_rcp_f32 v84, v84
 v_mfma_f32_16x16x32_bf16 v[60:63], a[196:199], v[180:183], v[60:63]
 v_rcp_f32 v85, v85
 v_mfma_f32_16x16x32_bf16 v[60:63], a[192:195], v[176:179], v[60:63]
 s_waitcnt lgkmcnt(1)
 v_rcp_f32 v86, v86
 v_mfma_f32_16x16x32_bf16 v[48:51], v[144:147], a[32:35], v[48:51]
 v_rcp_f32 v87, v87
 v_mfma_f32_16x16x32_bf16 v[48:51], v[148:151], a[36:39], v[48:51]
 ds_read_b128 a[192:195], v2 offset:0
 v_cvt_pk_bf16_f32 v112, v64, v65
 v_mfma_f32_16x16x32_bf16 v[48:51], v[152:155], a[40:43], v[48:51]
 v_rcp_f32 v88, v88
 v_mfma_f32_16x16x32_bf16 v[48:51], v[156:159], a[44:47], v[48:51]
 ds_read_b128 a[196:199], v2 offset:1024
 v_cvt_pk_bf16_f32 v113, v66, v67
 v_mfma_f32_16x16x32_bf16 v[52:55], v[156:159], a[92:95], v[52:55]
 v_rcp_f32 v89, v89
 v_mfma_f32_16x16x32_bf16 v[52:55], v[152:155], a[88:91], v[52:55]
 ds_read_b128 a[200:203], v2 offset:2048
 v_cvt_pk_bf16_f32 v116, v68, v69
 v_mfma_f32_16x16x32_bf16 v[52:55], v[148:151], a[84:87], v[52:55]
 v_rcp_f32 v90, v90
 v_mfma_f32_16x16x32_bf16 v[52:55], v[144:147], a[80:83], v[52:55]
 ds_read_b128 a[204:207], v2 offset:3072
 v_cvt_pk_bf16_f32 v117, v70, v71
 v_mfma_f32_16x16x32_bf16 v[56:59], v[144:147], a[128:131], v[56:59]
 v_rcp_f32 v91, v91
 v_mfma_f32_16x16x32_bf16 v[56:59], v[148:151], a[132:135], v[56:59]
 v_cvt_pk_bf16_f32 v128, v72, v73
 v_cvt_pk_bf16_f32 v129, v74, v75
 v_mfma_f32_16x16x32_bf16 v[56:59], v[152:155], a[136:139], v[56:59]
 v_rcp_f32 v92, v92
 v_mfma_f32_16x16x32_bf16 v[56:59], v[156:159], a[140:143], v[56:59]
 v_cvt_pk_bf16_f32 v132, v76, v77
 v_cvt_pk_bf16_f32 v133, v78, v79
 v_mfma_f32_16x16x32_bf16 v[60:63], v[156:159], v[204:207], v[60:63]
 v_rcp_f32 v93, v93
 v_mfma_f32_16x16x32_bf16 v[60:63], v[152:155], v[200:203], v[60:63]
 v_rcp_f32 v94, v94
 v_mfma_f32_16x16x32_bf16 v[60:63], v[148:151], v[196:199], v[60:63]
 s_waitcnt lgkmcnt(0)
 v_rcp_f32_e64 v95, v95
 v_mfma_f32_16x16x32_bf16 v[60:63], v[144:147], v[192:195], v[60:63]
 buffer_store_dwordx4 v[120:123], v0, s[32:35], s30 offen sc1
 buffer_load_dwordx4 v0, s[36:39], s17 offen offset:0 sc1 lds
 buffer_store_dwordx4 v[124:127], v0, s[32:35], s31 offen sc1
 buffer_load_dwordx4 v0, s[36:39], s17 offen offset:1024 sc1 lds
 buffer_load_dwordx4 v0, s[36:39], s17 offen offset:2048 sc1 lds
 v_pk_mul_f32 v[80:81], v[80:81], v[16:17]
 v_pk_mul_f32 v[82:83], v[82:83], v[18:19]
 v_pk_mul_f32 v[84:85], v[84:85], v[20:21]
 v_pk_mul_f32 v[86:87], v[86:87], v[22:23]
 v_pk_mul_f32 v[88:89], v[88:89], v[24:25]
 v_pk_mul_f32 v[90:91], v[90:91], v[26:27]
 v_pk_mul_f32 v[92:93], v[92:93], v[28:29]
 v_pk_mul_f32 v[94:95], v[94:95], v[30:31]
 v_pk_mul_f32 v[4:5], v[80:81], v[80:81]
 v_pk_fma_f32 v[96:97], v[96:97], s[22:23], s[22:23]
 v_pk_mul_f32 v[6:7], v[82:83], v[82:83]
 v_pk_fma_f32 v[98:99], v[98:99], s[22:23], s[22:23]
 v_pk_fma_f32 v[4:5], v[84:85], v[84:85], v[4:5]
 v_pk_fma_f32 v[100:101], v[100:101], s[22:23], s[22:23]
 v_pk_fma_f32 v[6:7], v[86:87], v[86:87], v[6:7]
 v_pk_fma_f32 v[102:103], v[102:103], s[22:23], s[22:23]
 v_pk_fma_f32 v[4:5], v[88:89], v[88:89], v[4:5]
 v_pk_fma_f32 v[104:105], v[104:105], s[22:23], s[22:23]
 v_pk_fma_f32 v[6:7], v[90:91], v[90:91], v[6:7]
 v_pk_fma_f32 v[106:107], v[106:107], s[22:23], s[22:23]
 v_pk_fma_f32 v[4:5], v[92:93], v[92:93], v[4:5]
 v_pk_fma_f32 v[108:109], v[108:109], s[22:23], s[22:23]
 v_pk_fma_f32 v[6:7], v[94:95], v[94:95], v[6:7]
 v_pk_fma_f32 v[110:111], v[110:111], s[22:23], s[22:23]
 v_pk_fma_f32 v[16:17], v[48:49], v[48:49], s[20:21]
 v_pk_fma_f32 v[18:19], v[50:51], v[50:51], s[20:21]
 v_pk_fma_f32 v[20:21], v[52:53], v[52:53], s[20:21]
 v_pk_fma_f32 v[22:23], v[54:55], v[54:55], s[20:21]
 v_pk_fma_f32 v[24:25], v[56:57], v[56:57], s[20:21]
 v_pk_fma_f32 v[26:27], v[58:59], v[58:59], s[20:21]
 v_pk_fma_f32 v[28:29], v[60:61], v[60:61], s[20:21]
 v_pk_fma_f32 v[30:31], v[62:63], v[62:63], s[20:21]
 v_pk_mul_f32 v[16:17], v[16:17], v[48:49] neg_lo:[1,0] neg_hi:[1,0]
 v_pk_mul_f32 v[18:19], v[18:19], v[50:51] neg_lo:[1,0] neg_hi:[1,0]
 v_pk_mul_f32 v[20:21], v[20:21], v[52:53] neg_lo:[1,0] neg_hi:[1,0]
 v_pk_mul_f32 v[22:23], v[22:23], v[54:55] neg_lo:[1,0] neg_hi:[1,0]
 v_pk_mul_f32 v[24:25], v[24:25], v[56:57] neg_lo:[1,0] neg_hi:[1,0]
 v_pk_mul_f32 v[26:27], v[26:27], v[58:59] neg_lo:[1,0] neg_hi:[1,0]
 v_pk_mul_f32 v[28:29], v[28:29], v[60:61] neg_lo:[1,0] neg_hi:[1,0]
 v_pk_mul_f32 v[30:31], v[30:31], v[62:63] neg_lo:[1,0] neg_hi:[1,0]
 s_cbranch_scc1 L_k1_loop1
 s_cmp_lg_u32 s43, 0
 s_cbranch_scc1 L_k1_tail
 s_mov_b32 s43, 1
 s_mov_b32 s19, 1
 s_getpc_b64 s[64:65]
L_pc4:
 s_add_u32 s64, s64, L_k1_tail-L_pc4
 s_addc_u32 s65, s65, 0
 v_and_b32 v64, 0xf0, v0
 v_lshl_add_u32 v64, v64, 2, s95
 v_min_u32 v64, L_end-L_k1_tail, v64
 v_add_co_u32 v64, vcc, s64, v64
 v_mov_b32 v65, s65
 v_mov_b32 v65, s65
 v_addc_co_u32 v65, vcc, 0, v65, vcc
 global_load_dword v1, v[64:65], off
 s_branch L_k1_loop1
L_k1_pre2:
 s_waitcnt lgkmcnt(0)
 s_nop 0
L_k1_loop2:
 v_mfma_f32_16x16x32_bf16 v[64:67], a[192:195], a[0:3], 0
 s_add_u32 s30, s30, 0x4000
 v_exp_f32 v16, v16
 v_mfma_f32_16x16x32_bf16 v[64:67], a[196:199], a[4:7], v[64:67]
 ds_read_b128 v[144:147], v2 offset:4096
 v_add_f32_dpp v4, v4, v4 row_ror:8 row_mask:0xf bank_mask:0x3
 v_mfma_f32_16x16x32_bf16 v[64:67], a[200:203], a[8:11], v[64:67]
 s_add_u32 s31, s31, 0x4000
 v_exp_f32 v17, v17
 v_mfma_f32_16x16x32_bf16 v[64:67], a[204:207], a[12:15], v[64:67]
 ds_read_b128 v[148:151], v2 offset:5120
 v_add_f32_dpp v5, v5, v5 row_ror:8 row_mask:0xf bank_mask:0x3
 v_mfma_f32_16x16x32_bf16 v[68:71], a[204:207], a[60:63], 0
 s_add_u32 s40, s40, 24576
 v_exp_f32 v18, v18
 v_mfma_f32_16x16x32_bf16 v[68:71], a[200:203], a[56:59], v[68:71]
 ds_read_b128 v[152:155], v2 offset:6144
 v_add_f32_dpp v4, v6, v6 row_ror:8 row_mask:0xf bank_mask:0xc
 v_mfma_f32_16x16x32_bf16 v[68:71], a[196:199], a[52:55], v[68:71]
 s_cmp_eq_u32 s40, s41
 v_exp_f32 v19, v19
 v_mfma_f32_16x16x32_bf16 v[68:71], a[192:195], a[48:51], v[68:71]
 ds_read_b128 v[156:159], v2 offset:7168
 v_add_f32_dpp v5, v7, v7 row_ror:8 row_mask:0xf bank_mask:0xc
 v_mfma_f32_16x16x32_bf16 v[72:75], a[192:195], a[96:99], 0
 s_cselect_b32 s40, s24, s40
 v_exp_f32 v20, v20
 v_mfma_f32_16x16x32_bf16 v[72:75], a[196:199], a[100:103], v[72:75]
 v_exp_f32 v21, v21
 v_mfma_f32_16x16x32_bf16 v[72:75], a[200:203], a[104:107], v[72:75]
 s_add_u32 s17, s17, 0x5400
 v_exp_f32 v22, v22
 v_mfma_f32_16x16x32_bf16 v[72:75], a[204:207], a[108:111], v[72:75]
 v_exp_f32 v23, v23
 v_mfma_f32_16x16x32_bf16 v[76:79], a[204:207], v[172:175], 0
 s_add_u32 m0, s40, 0
 v_exp_f32 v24, v24
 v_mfma_f32_16x16x32_bf16 v[76:79], a[200:203], v[168:171], v[76:79]
 v_exp_f32 v25, v25
 v_mfma_f32_16x16x32_bf16 v[76:79], a[196:199], v[164:167], v[76:79]
 v_exp_f32 v26, v26
 v_mfma_f32_16x16x32_bf16 v[76:79], a[192:195], v[160:163], v[76:79]
 s_waitcnt lgkmcnt(0)
 v_exp_f32 v27, v27
 v_mfma_f32_16x16x32_bf16 v[64:67], v[144:147], a[16:19], v[64:67]
 v_exp_f32 v28, v28
 v_mfma_f32_16x16x32_bf16 v[64:67], v[148:151], a[20:23], v[64:67]
 ds_read_b128 a[192:195], v2 offset:8192
 v_add_f32_dpp v4, v4, v4 row_shl:4 row_mask:0xf bank_mask:0x5
 v_mfma_f32_16x16x32_bf16 v[64:67], v[152:155], a[24:27], v[64:67]
 v_exp_f32 v29, v29
 v_mfma_f32_16x16x32_bf16 v[64:67], v[156:159], a[28:31], v[64:67]
 ds_read_b128 a[196:199], v2 offset:9216
 v_add_f32_dpp v4, v5, v5 row_shr:4 row_mask:0xf bank_mask:0xa
 v_mfma_f32_16x16x32_bf16 v[68:71], v[156:159], a[76:79], v[68:71]
 v_exp_f32 v30, v30
 v_mfma_f32_16x16x32_bf16 v[68:71], v[152:155], a[72:75], v[68:71]
 ds_read_b128 a[200:203], v2 offset:10240
 v_add_f32_dpp v4, v4, v4 quad_perm:[2,3,0,1] row_mask:0xf bank_mask:0xf
 v_mfma_f32_16x16x32_bf16 v[68:71], v[148:151], a[68:71], v[68:71]
 v_exp_f32 v31, v31
 v_mfma_f32_16x16x32_bf16 v[68:71], v[144:147], a[64:67], v[68:71]
 ds_read_b128 a[204:207], v2 offset:11264
 v_add_f32_dpp v4, v4, v4 quad_perm:[1,0,3,2] row_mask:0xf bank_mask:0xf
 v_mfma_f32_16x16x32_bf16 v[72:75], v[144:147], a[112:115], v[72:75]
 v_rcp_f32 v96, v96
 v_mfma_f32_16x16x32_bf16 v[72:75], v[148:151], a[116:119], v[72:75]
 v_rcp_f32 v97, v97
 v_mfma_f32_16x16x32_bf16 v[72:75], v[152:155], a[120:123], v[72:75]
 ds_write_b32 v3, v4 offset:256
 v_mfma_f32_16x16x32_bf16 v[72:75], v[156:159], a[124:127], v[72:75]
 v_rcp_f32 v98, v98
 v_mfma_f32_16x16x32_bf16 v[76:79], v[156:159], v[188:191], v[76:79]
 v_rcp_f32 v99, v99
 v_mfma_f32_16x16x32_bf16 v[76:79], v[152:155], v[184:187], v[76:79]
 v_rcp_f32 v100, v100
 v_mfma_f32_16x16x32_bf16 v[76:79], v[148:151], v[180:183], v[76:79]
 v_rcp_f32 v101, v101
 v_mfma_f32_16x16x32_bf16 v[76:79], v[144:147], v[176:179], v[76:79]
 s_waitcnt lgkmcnt(1)
 v_rcp_f32 v102, v102
 v_mfma_f32_16x16x32_bf16 v[64:67], a[192:195], a[32:35], v[64:67]
 v_rcp_f32 v103, v103
 v_mfma_f32_16x16x32_bf16 v[64:67], a[196:199], a[36:39], v[64:67]
 ds_read_b128 v[144:147], v2 offset:12288
 v_cvt_pk_bf16_f32 v114, v80, v81
 v_mfma_f32_16x16x32_bf16 v[64:67], a[200:203], a[40:43], v[64:67]
 v_rcp_f32 v104, v104
 v_mfma_f32_16x16x32_bf16 v[64:67], a[204:207], a[44:47], v[64:67]
 ds_read_b128 v[148:151], v2 offset:13312
 v_cvt_pk_bf16_f32 v115, v82, v83
 v_mfma_f32_16x16x32_bf16 v[68:71], a[204:207], a[92:95], v[68:71]
 v_rcp_f32 v105, v105
 v_mfma_f32_16x16x32_bf16 v[68:71], a[200:203], a[88:91], v[68:71]
 ds_read_b128 v[152:155], v2 offset:14336
 v_cvt_pk_bf16_f32 v118, v84, v85
 v_mfma_f32_16x16x32_bf16 v[68:71], a[196:199], a[84:87], v[68:71]
 s_waitcnt vmcnt(10)
 v_rcp_f32 v106, v106
 v_mfma_f32_16x16x32_bf16 v[68:71], a[192:195], a[80:83], v[68:71]
 s_barrier
 ds_read_b128 v[156:159], v2 offset:15360
 v_cvt_pk_bf16_f32 v119, v86, v87
 v_mfma_f32_16x16x32_bf16 v[72:75], a[192:195], a[128:131], v[72:75]
 v_rcp_f32 v107, v107
 v_mfma_f32_16x16x32_bf16 v[72:75], a[196:199], a[132:135], v[72:75]
 v_cvt_pk_bf16_f32 v130, v88, v89
 v_cvt_pk_bf16_f32 v131, v90, v91
 v_mfma_f32_16x16x32_bf16 v[72:75], a[200:203], a[136:139], v[72:75]
 v_rcp_f32 v108, v108
 v_mfma_f32_16x16x32_bf16 v[72:75], a[204:207], a[140:143], v[72:75]
 v_cvt_pk_bf16_f32 v134, v92, v93
 v_cvt_pk_bf16_f32 v135, v94, v95
 v_mfma_f32_16x16x32_bf16 v[76:79], a[204:207], v[204:207], v[76:79]
 v_rcp_f32 v109, v109
 v_mfma_f32_16x16x32_bf16 v[76:79], a[200:203], v[200:203], v[76:79]
 v_rcp_f32 v110, v110
 v_mfma_f32_16x16x32_bf16 v[76:79], a[196:199], v[196:199], v[76:79]
 s_waitcnt lgkmcnt(0)
 v_rcp_f32 v111, v111
 v_mfma_f32_16x16x32_bf16 v[76:79], a[192:195], v[192:195], v[76:79]
 buffer_store_dwordx4 v[112:115], v0, s[32:35], s28 offen sc1
 buffer_load_dwordx4 v0, s[36:39], s17 offen offset:0 sc1 lds
 buffer_store_dwordx4 v[116:119], v0, s[32:35], s29 offen sc1
 buffer_load_dwordx4 v0, s[36:39], s17 offen offset:1024 sc1 lds
 buffer_load_dwordx4 v0, s[36:39], s17 offen offset:2048 sc1 lds
 v_pk_mul_f32 v[96:97], v[96:97], v[32:33]
 v_pk_mul_f32 v[98:99], v[98:99], v[34:35]
 v_pk_mul_f32 v[100:101], v[100:101], v[36:37]
 v_pk_mul_f32 v[102:103], v[102:103], v[38:39]
 v_pk_mul_f32 v[104:105], v[104:105], v[40:41]
 v_pk_mul_f32 v[106:107], v[106:107], v[42:43]
 v_pk_mul_f32 v[108:109], v[108:109], v[44:45]
 v_pk_mul_f32 v[110:111], v[110:111], v[46:47]
 v_pk_mul_f32 v[4:5], v[96:97], v[96:97]
 v_pk_fma_f32 v[16:17], v[16:17], s[22:23], s[22:23]
 v_pk_mul_f32 v[6:7], v[98:99], v[98:99]
 v_pk_fma_f32 v[18:19], v[18:19], s[22:23], s[22:23]
 v_pk_fma_f32 v[4:5], v[100:101], v[100:101], v[4:5]
 v_pk_fma_f32 v[20:21], v[20:21], s[22:23], s[22:23]
 v_pk_fma_f32 v[6:7], v[102:103], v[102:103], v[6:7]
 v_pk_fma_f32 v[22:23], v[22:23], s[22:23], s[22:23]
 v_pk_fma_f32 v[4:5], v[104:105], v[104:105], v[4:5]
 v_pk_fma_f32 v[24:25], v[24:25], s[22:23], s[22:23]
 v_pk_fma_f32 v[6:7], v[106:107], v[106:107], v[6:7]
 v_pk_fma_f32 v[26:27], v[26:27], s[22:23], s[22:23]
 v_pk_fma_f32 v[4:5], v[108:109], v[108:109], v[4:5]
 v_pk_fma_f32 v[28:29], v[28:29], s[22:23], s[22:23]
 v_pk_fma_f32 v[6:7], v[110:111], v[110:111], v[6:7]
 v_pk_fma_f32 v[30:31], v[30:31], s[22:23], s[22:23]
 v_pk_fma_f32 v[32:33], v[64:65], v[64:65], s[20:21]
 v_pk_fma_f32 v[34:35], v[66:67], v[66:67], s[20:21]
 v_pk_fma_f32 v[36:37], v[68:69], v[68:69], s[20:21]
 v_pk_fma_f32 v[38:39], v[70:71], v[70:71], s[20:21]
 v_pk_fma_f32 v[40:41], v[72:73], v[72:73], s[20:21]
 v_pk_fma_f32 v[42:43], v[74:75], v[74:75], s[20:21]
 v_pk_fma_f32 v[44:45], v[76:77], v[76:77], s[20:21]
 v_pk_fma_f32 v[46:47], v[78:79], v[78:79], s[20:21]
 v_pk_mul_f32 v[32:33], v[32:33], v[64:65] neg_lo:[1,0] neg_hi:[1,0]
 v_pk_mul_f32 v[34:35], v[34:35], v[66:67] neg_lo:[1,0] neg_hi:[1,0]
 v_pk_mul_f32 v[36:37], v[36:37], v[68:69] neg_lo:[1,0] neg_hi:[1,0]
 v_pk_mul_f32 v[38:39], v[38:39], v[70:71] neg_lo:[1,0] neg_hi:[1,0]
 v_pk_mul_f32 v[40:41], v[40:41], v[72:73] neg_lo:[1,0] neg_hi:[1,0]
 v_pk_mul_f32 v[42:43], v[42:43], v[74:75] neg_lo:[1,0] neg_hi:[1,0]
 v_pk_mul_f32 v[44:45], v[44:45], v[76:77] neg_lo:[1,0] neg_hi:[1,0]
 v_pk_mul_f32 v[46:47], v[46:47], v[78:79] neg_lo:[1,0] neg_hi:[1,0]
 v_mfma_f32_16x16x32_bf16 v[80:83], v[144:147], a[0:3], 0
 s_add_u32 s28, s28, 0x4000
 v_exp_f32 v32, v32
 v_mfma_f32_16x16x32_bf16 v[80:83], v[148:151], a[4:7], v[80:83]
 ds_read_b128 a[192:195], v2 offset:16384
 v_add_f32_dpp v4, v4, v4 row_ror:8 row_mask:0xf bank_mask:0x3
 v_mfma_f32_16x16x32_bf16 v[80:83], v[152:155], a[8:11], v[80:83]
 s_add_u32 s29, s29, 0x4000
 v_exp_f32 v33, v33
 v_mfma_f32_16x16x32_bf16 v[80:83], v[156:159], a[12:15], v[80:83]
 ds_read_b128 a[196:199], v2 offset:17408
 v_add_f32_dpp v5, v5, v5 row_ror:8 row_mask:0xf bank_mask:0x3
 v_mfma_f32_16x16x32_bf16 v[84:87], v[156:159], a[60:63], 0
 s_add_u32 s42, s42, 24576
 v_exp_f32 v34, v34
 v_mfma_f32_16x16x32_bf16 v[84:87], v[152:155], a[56:59], v[84:87]
 ds_read_b128 a[200:203], v2 offset:18432
 v_add_f32_dpp v4, v6, v6 row_ror:8 row_mask:0xf bank_mask:0xc
 v_mfma_f32_16x16x32_bf16 v[84:87], v[148:151], a[52:55], v[84:87]
 s_cmp_eq_u32 s42, 98304
 v_exp_f32 v35, v35
 v_mfma_f32_16x16x32_bf16 v[84:87], v[144:147], a[48:51], v[84:87]
 ds_read_b128 a[204:207], v2 offset:19456
 v_add_f32_dpp v5, v7, v7 row_ror:8 row_mask:0xf bank_mask:0xc
 v_mfma_f32_16x16x32_bf16 v[88:91], v[144:147], a[96:99], 0
 s_cselect_b32 s42, 0, s42
 v_exp_f32 v36, v36
 v_mfma_f32_16x16x32_bf16 v[88:91], v[148:151], a[100:103], v[88:91]
 v_exp_f32 v37, v37
 v_mfma_f32_16x16x32_bf16 v[88:91], v[152:155], a[104:107], v[88:91]
 s_add_u32 s17, s17, 0xc00
 v_exp_f32 v38, v38
 v_mfma_f32_16x16x32_bf16 v[88:91], v[156:159], a[108:111], v[88:91]
 v_exp_f32 v39, v39
 v_mfma_f32_16x16x32_bf16 v[92:95], v[156:159], v[172:175], 0
 s_add_u32 m0, s40, 3072
 v_exp_f32 v40, v40
 v_mfma_f32_16x16x32_bf16 v[92:95], v[152:155], v[168:171], v[92:95]
 v_exp_f32 v41, v41
 v_mfma_f32_16x16x32_bf16 v[92:95], v[148:151], v[164:167], v[92:95]
 v_exp_f32 v42, v42
 v_mfma_f32_16x16x32_bf16 v[92:95], v[144:147], v[160:163], v[92:95]
 s_waitcnt lgkmcnt(0)
 v_exp_f32 v43, v43
 v_mfma_f32_16x16x32_bf16 v[80:83], a[192:195], a[16:19], v[80:83]
 v_exp_f32 v44, v44
 v_mfma_f32_16x16x32_bf16 v[80:83], a[196:199], a[20:23], v[80:83]
 ds_read_b128 v[144:147], v2 offset:20480
 v_add_f32_dpp v4, v4, v4 row_shl:4 row_mask:0xf bank_mask:0x5
 v_mfma_f32_16x16x32_bf16 v[80:83], a[200:203], a[24:27], v[80:83]
 v_exp_f32 v45, v45
 v_mfma_f32_16x16x32_bf16 v[80:83], a[204:207], a[28:31], v[80:83]
 ds_read_b128 v[148:151], v2 offset:21504
 v_add_f32_dpp v4, v5, v5 row_shr:4 row_mask:0xf bank_mask:0xa
 v_mfma_f32_16x16x32_bf16 v[84:87], a[204:207], a[76:79], v[84:87]
 v_exp_f32 v46, v46
 v_mfma_f32_16x16x32_bf16 v[84:87], a[200:203], a[72:75], v[84:87]
 ds_read_b128 v[152:155], v2 offset:22528
 v_add_f32_dpp v4, v4, v4 quad_perm:[2,3,0,1] row_mask:0xf bank_mask:0xf
 v_mfma_f32_16x16x32_bf16 v[84:87], a[196:199], a[68:71], v[84:87]
 v_exp_f32 v47, v47
 v_mfma_f32_16x16x32_bf16 v[84:87], a[192:195], a[64:67], v[84:87]
 ds_read_b128 v[156:159], v2 offset:23552
 v_add_f32_dpp v4, v4, v4 quad_perm:[1,0,3,2] row_mask:0xf bank_mask:0xf
 v_mfma_f32_16x16x32_bf16 v[88:91], a[192:195], a[112:115], v[88:91]
 v_rcp_f32 v16, v16
 v_mfma_f32_16x16x32_bf16 v[88:91], a[196:199], a[116:119], v[88:91]
 v_rcp_f32 v17, v17
 v_mfma_f32_16x16x32_bf16 v[88:91], a[200:203], a[120:123], v[88:91]
 ds_write_b32 v3, v4 offset:512
 v_add_u32 v2, s42, v0
 v_mfma_f32_16x16x32_bf16 v[88:91], a[204:207], a[124:127], v[88:91]
 v_rcp_f32 v18, v18
 v_mfma_f32_16x16x32_bf16 v[92:95], a[204:207], v[188:191], v[92:95]
 v_rcp_f32 v19, v19
 v_mfma_f32_16x16x32_bf16 v[92:95], a[200:203], v[184:187], v[92:95]
 v_rcp_f32 v20, v20
 v_mfma_f32_16x16x32_bf16 v[92:95], a[196:199], v[180:183], v[92:95]
 v_rcp_f32 v21, v21
 v_mfma_f32_16x16x32_bf16 v[92:95], a[192:195], v[176:179], v[92:95]
 s_waitcnt lgkmcnt(1)
 v_rcp_f32 v22, v22
 v_mfma_f32_16x16x32_bf16 v[80:83], v[144:147], a[32:35], v[80:83]
 v_rcp_f32 v23, v23
 v_mfma_f32_16x16x32_bf16 v[80:83], v[148:151], a[36:39], v[80:83]
 ds_read_b128 a[192:195], v2 offset:0
 v_cvt_pk_bf16_f32 v112, v96, v97
 v_mfma_f32_16x16x32_bf16 v[80:83], v[152:155], a[40:43], v[80:83]
 v_rcp_f32 v24, v24
 v_mfma_f32_16x16x32_bf16 v[80:83], v[156:159], a[44:47], v[80:83]
 ds_read_b128 a[196:199], v2 offset:1024
 v_cvt_pk_bf16_f32 v113, v98, v99
 v_mfma_f32_16x16x32_bf16 v[84:87], v[156:159], a[92:95], v[84:87]
 v_rcp_f32 v25, v25
 v_mfma_f32_16x16x32_bf16 v[84:87], v[152:155], a[88:91], v[84:87]
 ds_read_b128 a[200:203], v2 offset:2048
 v_cvt_pk_bf16_f32 v116, v100, v101
 v_mfma_f32_16x16x32_bf16 v[84:87], v[148:151], a[84:87], v[84:87]
 v_rcp_f32 v26, v26
 v_mfma_f32_16x16x32_bf16 v[84:87], v[144:147], a[80:83], v[84:87]
 ds_read_b128 a[204:207], v2 offset:3072
 v_cvt_pk_bf16_f32 v117, v102, v103
 v_mfma_f32_16x16x32_bf16 v[88:91], v[144:147], a[128:131], v[88:91]
 v_rcp_f32 v27, v27
 v_mfma_f32_16x16x32_bf16 v[88:91], v[148:151], a[132:135], v[88:91]
 v_cvt_pk_bf16_f32 v136, v104, v105
 v_cvt_pk_bf16_f32 v137, v106, v107
 v_mfma_f32_16x16x32_bf16 v[88:91], v[152:155], a[136:139], v[88:91]
 v_rcp_f32 v28, v28
 v_mfma_f32_16x16x32_bf16 v[88:91], v[156:159], a[140:143], v[88:91]
 v_cvt_pk_bf16_f32 v140, v108, v109
 v_cvt_pk_bf16_f32 v141, v110, v111
 v_mfma_f32_16x16x32_bf16 v[92:95], v[156:159], v[204:207], v[92:95]
 v_rcp_f32 v29, v29
 v_mfma_f32_16x16x32_bf16 v[92:95], v[152:155], v[200:203], v[92:95]
 v_rcp_f32 v30, v30
 v_mfma_f32_16x16x32_bf16 v[92:95], v[148:151], v[196:199], v[92:95]
 s_waitcnt lgkmcnt(0)
 v_rcp_f32_e64 v31, v31
 v_mfma_f32_16x16x32_bf16 v[92:95], v[144:147], v[192:195], v[92:95]
 buffer_store_dwordx4 v[128:131], v0, s[32:35], s30 offen sc1
 buffer_load_dwordx4 v0, s[36:39], s17 offen offset:0 sc1 lds
 buffer_store_dwordx4 v[132:135], v0, s[32:35], s31 offen sc1
 buffer_load_dwordx4 v0, s[36:39], s17 offen offset:1024 sc1 lds
 buffer_load_dwordx4 v0, s[36:39], s17 offen offset:2048 sc1 lds
 v_pk_mul_f32 v[16:17], v[16:17], v[48:49]
 v_pk_mul_f32 v[18:19], v[18:19], v[50:51]
 v_pk_mul_f32 v[20:21], v[20:21], v[52:53]
 v_pk_mul_f32 v[22:23], v[22:23], v[54:55]
 v_pk_mul_f32 v[24:25], v[24:25], v[56:57]
 v_pk_mul_f32 v[26:27], v[26:27], v[58:59]
 v_pk_mul_f32 v[28:29], v[28:29], v[60:61]
 v_pk_mul_f32 v[30:31], v[30:31], v[62:63]
 v_pk_mul_f32 v[4:5], v[16:17], v[16:17]
 v_pk_fma_f32 v[32:33], v[32:33], s[22:23], s[22:23]
 v_pk_mul_f32 v[6:7], v[18:19], v[18:19]
 v_pk_fma_f32 v[34:35], v[34:35], s[22:23], s[22:23]
 v_pk_fma_f32 v[4:5], v[20:21], v[20:21], v[4:5]
 v_pk_fma_f32 v[36:37], v[36:37], s[22:23], s[22:23]
 v_pk_fma_f32 v[6:7], v[22:23], v[22:23], v[6:7]
 v_pk_fma_f32 v[38:39], v[38:39], s[22:23], s[22:23]
 v_pk_fma_f32 v[4:5], v[24:25], v[24:25], v[4:5]
 v_pk_fma_f32 v[40:41], v[40:41], s[22:23], s[22:23]
 v_pk_fma_f32 v[6:7], v[26:27], v[26:27], v[6:7]
 v_pk_fma_f32 v[42:43], v[42:43], s[22:23], s[22:23]
 v_pk_fma_f32 v[4:5], v[28:29], v[28:29], v[4:5]
 v_pk_fma_f32 v[44:45], v[44:45], s[22:23], s[22:23]
 v_pk_fma_f32 v[6:7], v[30:31], v[30:31], v[6:7]
 v_pk_fma_f32 v[46:47], v[46:47], s[22:23], s[22:23]
 v_pk_fma_f32 v[48:49], v[80:81], v[80:81], s[20:21]
 v_pk_fma_f32 v[50:51], v[82:83], v[82:83], s[20:21]
 v_pk_fma_f32 v[52:53], v[84:85], v[84:85], s[20:21]
 v_pk_fma_f32 v[54:55], v[86:87], v[86:87], s[20:21]
 v_pk_fma_f32 v[56:57], v[88:89], v[88:89], s[20:21]
 v_pk_fma_f32 v[58:59], v[90:91], v[90:91], s[20:21]
 v_pk_fma_f32 v[60:61], v[92:93], v[92:93], s[20:21]
 v_pk_fma_f32 v[62:63], v[94:95], v[94:95], s[20:21]
 v_pk_mul_f32 v[48:49], v[48:49], v[80:81] neg_lo:[1,0] neg_hi:[1,0]
 v_pk_mul_f32 v[50:51], v[50:51], v[82:83] neg_lo:[1,0] neg_hi:[1,0]
 v_pk_mul_f32 v[52:53], v[52:53], v[84:85] neg_lo:[1,0] neg_hi:[1,0]
 v_pk_mul_f32 v[54:55], v[54:55], v[86:87] neg_lo:[1,0] neg_hi:[1,0]
 v_pk_mul_f32 v[56:57], v[56:57], v[88:89] neg_lo:[1,0] neg_hi:[1,0]
 v_pk_mul_f32 v[58:59], v[58:59], v[90:91] neg_lo:[1,0] neg_hi:[1,0]
 v_pk_mul_f32 v[60:61], v[60:61], v[92:93] neg_lo:[1,0] neg_hi:[1,0]
 v_pk_mul_f32 v[62:63], v[62:63], v[94:95] neg_lo:[1,0] neg_hi:[1,0]
 v_mfma_f32_16x16x32_bf16 v[96:99], a[192:195], a[0:3], 0
 s_add_u32 s30, s30, 0x4000
 v_exp_f32 v48, v48
 v_mfma_f32_16x16x32_bf16 v[96:99], a[196:199], a[4:7], v[96:99]
 ds_read_b128 v[144:147], v2 offset:4096
 v_add_f32_dpp v4, v4, v4 row_ror:8 row_mask:0xf bank_mask:0x3
 v_mfma_f32_16x16x32_bf16 v[96:99], a[200:203], a[8:11], v[96:99]
 s_add_u32 s31, s31, 0x4000
 v_exp_f32 v49, v49
 v_mfma_f32_16x16x32_bf16 v[96:99], a[204:207], a[12:15], v[96:99]
 ds_read_b128 v[148:151], v2 offset:5120
 v_add_f32_dpp v5, v5, v5 row_ror:8 row_mask:0xf bank_mask:0x3
 v_mfma_f32_16x16x32_bf16 v[100:103], a[204:207], a[60:63], 0
 s_add_u32 s40, s40, 24576
 v_exp_f32 v50, v50
 v_mfma_f32_16x16x32_bf16 v[100:103], a[200:203], a[56:59], v[100:103]
 ds_read_b128 v[152:155], v2 offset:6144
 v_add_f32_dpp v4, v6, v6 row_ror:8 row_mask:0xf bank_mask:0xc
 v_mfma_f32_16x16x32_bf16 v[100:103], a[196:199], a[52:55], v[100:103]
 s_cmp_eq_u32 s40, s41
 v_exp_f32 v51, v51
 v_mfma_f32_16x16x32_bf16 v[100:103], a[192:195], a[48:51], v[100:103]
 ds_read_b128 v[156:159], v2 offset:7168
 v_add_f32_dpp v5, v7, v7 row_ror:8 row_mask:0xf bank_mask:0xc
 v_mfma_f32_16x16x32_bf16 v[104:107], a[192:195], a[96:99], 0
 s_cselect_b32 s40, s24, s40
 v_exp_f32 v52, v52
 v_mfma_f32_16x16x32_bf16 v[104:107], a[196:199], a[100:103], v[104:107]
 v_exp_f32 v53, v53
 v_mfma_f32_16x16x32_bf16 v[104:107], a[200:203], a[104:107], v[104:107]
 s_add_u32 s17, s17, 0x5400
 v_exp_f32 v54, v54
 v_mfma_f32_16x16x32_bf16 v[104:107], a[204:207], a[108:111], v[104:107]
 v_exp_f32 v55, v55
 v_mfma_f32_16x16x32_bf16 v[108:111], a[204:207], v[172:175], 0
 s_add_u32 m0, s40, 0
 v_exp_f32 v56, v56
 v_mfma_f32_16x16x32_bf16 v[108:111], a[200:203], v[168:171], v[108:111]
 v_exp_f32 v57, v57
 v_mfma_f32_16x16x32_bf16 v[108:111], a[196:199], v[164:167], v[108:111]
 v_exp_f32 v58, v58
 v_mfma_f32_16x16x32_bf16 v[108:111], a[192:195], v[160:163], v[108:111]
 s_waitcnt lgkmcnt(0)
 v_exp_f32 v59, v59
 v_mfma_f32_16x16x32_bf16 v[96:99], v[144:147], a[16:19], v[96:99]
 v_exp_f32 v60, v60
 v_mfma_f32_16x16x32_bf16 v[96:99], v[148:151], a[20:23], v[96:99]
 ds_read_b128 a[192:195], v2 offset:8192
 v_add_f32_dpp v4, v4, v4 row_shl:4 row_mask:0xf bank_mask:0x5
 v_mfma_f32_16x16x32_bf16 v[96:99], v[152:155], a[24:27], v[96:99]
 v_exp_f32 v61, v61
 v_mfma_f32_16x16x32_bf16 v[96:99], v[156:159], a[28:31], v[96:99]
 ds_read_b128 a[196:199], v2 offset:9216
 v_add_f32_dpp v4, v5, v5 row_shr:4 row_mask:0xf bank_mask:0xa
 v_mfma_f32_16x16x32_bf16 v[100:103], v[156:159], a[76:79], v[100:103]
 v_exp_f32 v62, v62
 v_mfma_f32_16x16x32_bf16 v[100:103], v[152:155], a[72:75], v[100:103]
 ds_read_b128 a[200:203], v2 offset:10240
 v_add_f32_dpp v4, v4, v4 quad_perm:[2,3,0,1] row_mask:0xf bank_mask:0xf
 v_mfma_f32_16x16x32_bf16 v[100:103], v[148:151], a[68:71], v[100:103]
 v_exp_f32 v63, v63
 v_mfma_f32_16x16x32_bf16 v[100:103], v[144:147], a[64:67], v[100:103]
 ds_read_b128 a[204:207], v2 offset:11264
 v_add_f32_dpp v4, v4, v4 quad_perm:[1,0,3,2] row_mask:0xf bank_mask:0xf
 v_mfma_f32_16x16x32_bf16 v[104:107], v[144:147], a[112:115], v[104:107]
 v_rcp_f32 v32, v32
 v_mfma_f32_16x16x32_bf16 v[104:107], v[148:151], a[116:119], v[104:107]
 v_rcp_f32 v33, v33
 v_mfma_f32_16x16x32_bf16 v[104:107], v[152:155], a[120:123], v[104:107]
 ds_write_b32 v3, v4 offset:768
 v_mfma_f32_16x16x32_bf16 v[104:107], v[156:159], a[124:127], v[104:107]
 v_rcp_f32 v34, v34
 v_mfma_f32_16x16x32_bf16 v[108:111], v[156:159], v[188:191], v[108:111]
 v_rcp_f32 v35, v35
 v_mfma_f32_16x16x32_bf16 v[108:111], v[152:155], v[184:187], v[108:111]
 v_rcp_f32 v36, v36
 v_mfma_f32_16x16x32_bf16 v[108:111], v[148:151], v[180:183], v[108:111]
 v_rcp_f32 v37, v37
 v_mfma_f32_16x16x32_bf16 v[108:111], v[144:147], v[176:179], v[108:111]
 s_waitcnt lgkmcnt(1)
 v_rcp_f32 v38, v38
 v_mfma_f32_16x16x32_bf16 v[96:99], a[192:195], a[32:35], v[96:99]
 v_rcp_f32 v39, v39
 v_mfma_f32_16x16x32_bf16 v[96:99], a[196:199], a[36:39], v[96:99]
 ds_read_b128 v[144:147], v2 offset:12288
 v_cvt_pk_bf16_f32 v114, v16, v17
 v_mfma_f32_16x16x32_bf16 v[96:99], a[200:203], a[40:43], v[96:99]
 v_rcp_f32 v40, v40
 v_mfma_f32_16x16x32_bf16 v[96:99], a[204:207], a[44:47], v[96:99]
 ds_read_b128 v[148:151], v2 offset:13312
 v_cvt_pk_bf16_f32 v115, v18, v19
 v_mfma_f32_16x16x32_bf16 v[100:103], a[204:207], a[92:95], v[100:103]
 v_rcp_f32 v41, v41
 v_mfma_f32_16x16x32_bf16 v[100:103], a[200:203], a[88:91], v[100:103]
 ds_read_b128 v[152:155], v2 offset:14336
 v_cvt_pk_bf16_f32 v118, v20, v21
 v_mfma_f32_16x16x32_bf16 v[100:103], a[196:199], a[84:87], v[100:103]
 s_waitcnt vmcnt(10)
 v_rcp_f32 v42, v42
 v_mfma_f32_16x16x32_bf16 v[100:103], a[192:195], a[80:83], v[100:103]
 s_barrier
 ds_read_b128 v[156:159], v2 offset:15360
 v_cvt_pk_bf16_f32 v119, v22, v23
 v_mfma_f32_16x16x32_bf16 v[104:107], a[192:195], a[128:131], v[104:107]
 v_rcp_f32 v43, v43
 v_mfma_f32_16x16x32_bf16 v[104:107], a[196:199], a[132:135], v[104:107]
 v_cvt_pk_bf16_f32 v138, v24, v25
 v_cvt_pk_bf16_f32 v139, v26, v27
 v_mfma_f32_16x16x32_bf16 v[104:107], a[200:203], a[136:139], v[104:107]
 v_rcp_f32 v44, v44
 v_mfma_f32_16x16x32_bf16 v[104:107], a[204:207], a[140:143], v[104:107]
 v_cvt_pk_bf16_f32 v142, v28, v29
 v_cvt_pk_bf16_f32 v143, v30, v31
 v_mfma_f32_16x16x32_bf16 v[108:111], a[204:207], v[204:207], v[108:111]
 v_rcp_f32 v45, v45
 v_mfma_f32_16x16x32_bf16 v[108:111], a[200:203], v[200:203], v[108:111]
 v_rcp_f32 v46, v46
 v_mfma_f32_16x16x32_bf16 v[108:111], a[196:199], v[196:199], v[108:111]
 s_waitcnt lgkmcnt(0)
 v_rcp_f32 v47, v47
 v_mfma_f32_16x16x32_bf16 v[108:111], a[192:195], v[192:195], v[108:111]
 buffer_store_dwordx4 v[112:115], v0, s[32:35], s28 offen sc1
 buffer_load_dwordx4 v0, s[36:39], s17 offen offset:0 sc1 lds
 buffer_store_dwordx4 v[116:119], v0, s[32:35], s29 offen sc1
 buffer_load_dwordx4 v0, s[36:39], s17 offen offset:1024 sc1 lds
 buffer_load_dwordx4 v0, s[36:39], s17 offen offset:2048 sc1 lds
 v_pk_mul_f32 v[32:33], v[32:33], v[64:65]
 v_pk_mul_f32 v[34:35], v[34:35], v[66:67]
 v_pk_mul_f32 v[36:37], v[36:37], v[68:69]
 v_pk_mul_f32 v[38:39], v[38:39], v[70:71]
 v_pk_mul_f32 v[40:41], v[40:41], v[72:73]
 v_pk_mul_f32 v[42:43], v[42:43], v[74:75]
 v_pk_mul_f32 v[44:45], v[44:45], v[76:77]
 v_pk_mul_f32 v[46:47], v[46:47], v[78:79]
 v_pk_mul_f32 v[4:5], v[32:33], v[32:33]
 v_pk_fma_f32 v[48:49], v[48:49], s[22:23], s[22:23]
 v_pk_mul_f32 v[6:7], v[34:35], v[34:35]
 v_pk_fma_f32 v[50:51], v[50:51], s[22:23], s[22:23]
 v_pk_fma_f32 v[4:5], v[36:37], v[36:37], v[4:5]
 v_pk_fma_f32 v[52:53], v[52:53], s[22:23], s[22:23]
 v_pk_fma_f32 v[6:7], v[38:39], v[38:39], v[6:7]
 v_pk_fma_f32 v[54:55], v[54:55], s[22:23], s[22:23]
 v_pk_fma_f32 v[4:5], v[40:41], v[40:41], v[4:5]
 v_pk_fma_f32 v[56:57], v[56:57], s[22:23], s[22:23]
 v_pk_fma_f32 v[6:7], v[42:43], v[42:43], v[6:7]
 v_pk_fma_f32 v[58:59], v[58:59], s[22:23], s[22:23]
 v_pk_fma_f32 v[4:5], v[44:45], v[44:45], v[4:5]
 v_pk_fma_f32 v[60:61], v[60:61], s[22:23], s[22:23]
 v_pk_fma_f32 v[6:7], v[46:47], v[46:47], v[6:7]
 v_pk_fma_f32 v[62:63], v[62:63], s[22:23], s[22:23]
 v_pk_fma_f32 v[64:65], v[96:97], v[96:97], s[20:21]
 v_pk_fma_f32 v[66:67], v[98:99], v[98:99], s[20:21]
 v_pk_fma_f32 v[68:69], v[100:101], v[100:101], s[20:21]
 v_pk_fma_f32 v[70:71], v[102:103], v[102:103], s[20:21]
 v_pk_fma_f32 v[72:73], v[104:105], v[104:105], s[20:21]
 v_pk_fma_f32 v[74:75], v[106:107], v[106:107], s[20:21]
 v_pk_fma_f32 v[76:77], v[108:109], v[108:109], s[20:21]
 v_pk_fma_f32 v[78:79], v[110:111], v[110:111], s[20:21]
 v_pk_mul_f32 v[64:65], v[64:65], v[96:97] neg_lo:[1,0] neg_hi:[1,0]
 v_pk_mul_f32 v[66:67], v[66:67], v[98:99] neg_lo:[1,0] neg_hi:[1,0]
 v_pk_mul_f32 v[68:69], v[68:69], v[100:101] neg_lo:[1,0] neg_hi:[1,0]
 v_pk_mul_f32 v[70:71], v[70:71], v[102:103] neg_lo:[1,0] neg_hi:[1,0]
 v_pk_mul_f32 v[72:73], v[72:73], v[104:105] neg_lo:[1,0] neg_hi:[1,0]
 v_pk_mul_f32 v[74:75], v[74:75], v[106:107] neg_lo:[1,0] neg_hi:[1,0]
 v_pk_mul_f32 v[76:77], v[76:77], v[108:109] neg_lo:[1,0] neg_hi:[1,0]
 v_pk_mul_f32 v[78:79], v[78:79], v[110:111] neg_lo:[1,0] neg_hi:[1,0]
 v_mfma_f32_16x16x32_bf16 v[16:19], v[144:147], a[0:3], 0
 s_add_u32 s28, s28, 0x4000
 v_exp_f32 v64, v64
 v_mfma_f32_16x16x32_bf16 v[16:19], v[148:151], a[4:7], v[16:19]
 ds_read_b128 a[192:195], v2 offset:16384
 v_add_f32_dpp v4, v4, v4 row_ror:8 row_mask:0xf bank_mask:0x3
 v_mfma_f32_16x16x32_bf16 v[16:19], v[152:155], a[8:11], v[16:19]
 s_add_u32 s29, s29, 0x4000
 v_exp_f32 v65, v65
 v_mfma_f32_16x16x32_bf16 v[16:19], v[156:159], a[12:15], v[16:19]
 ds_read_b128 a[196:199], v2 offset:17408
 v_add_f32_dpp v5, v5, v5 row_ror:8 row_mask:0xf bank_mask:0x3
 v_mfma_f32_16x16x32_bf16 v[20:23], v[156:159], a[60:63], 0
 s_add_u32 s42, s42, 24576
 v_exp_f32 v66, v66
 v_mfma_f32_16x16x32_bf16 v[20:23], v[152:155], a[56:59], v[20:23]
 ds_read_b128 a[200:203], v2 offset:18432
 v_add_f32_dpp v4, v6, v6 row_ror:8 row_mask:0xf bank_mask:0xc
 v_mfma_f32_16x16x32_bf16 v[20:23], v[148:151], a[52:55], v[20:23]
 s_cmp_eq_u32 s42, 98304
 v_exp_f32 v67, v67
 v_mfma_f32_16x16x32_bf16 v[20:23], v[144:147], a[48:51], v[20:23]
 ds_read_b128 a[204:207], v2 offset:19456
 v_add_f32_dpp v5, v7, v7 row_ror:8 row_mask:0xf bank_mask:0xc
 v_mfma_f32_16x16x32_bf16 v[24:27], v[144:147], a[96:99], 0
 s_cselect_b32 s42, 0, s42
 v_exp_f32 v68, v68
 v_mfma_f32_16x16x32_bf16 v[24:27], v[148:151], a[100:103], v[24:27]
 v_exp_f32 v69, v69
 v_mfma_f32_16x16x32_bf16 v[24:27], v[152:155], a[104:107], v[24:27]
 s_add_u32 s17, s17, 0xc00
 v_exp_f32 v70, v70
 v_mfma_f32_16x16x32_bf16 v[24:27], v[156:159], a[108:111], v[24:27]
 v_exp_f32 v71, v71
 v_mfma_f32_16x16x32_bf16 v[28:31], v[156:159], v[172:175], 0
 s_add_u32 m0, s40, 3072
 v_exp_f32 v72, v72
 v_mfma_f32_16x16x32_bf16 v[28:31], v[152:155], v[168:171], v[28:31]
 v_exp_f32 v73, v73
 v_mfma_f32_16x16x32_bf16 v[28:31], v[148:151], v[164:167], v[28:31]
 v_exp_f32 v74, v74
 v_mfma_f32_16x16x32_bf16 v[28:31], v[144:147], v[160:163], v[28:31]
 s_waitcnt lgkmcnt(0)
 v_exp_f32 v75, v75
 v_mfma_f32_16x16x32_bf16 v[16:19], a[192:195], a[16:19], v[16:19]
 v_exp_f32 v76, v76
 v_mfma_f32_16x16x32_bf16 v[16:19], a[196:199], a[20:23], v[16:19]
 ds_read_b128 v[144:147], v2 offset:20480
 v_add_f32_dpp v4, v4, v4 row_shl:4 row_mask:0xf bank_mask:0x5
 v_mfma_f32_16x16x32_bf16 v[16:19], a[200:203], a[24:27], v[16:19]
 v_exp_f32 v77, v77
 v_mfma_f32_16x16x32_bf16 v[16:19], a[204:207], a[28:31], v[16:19]
 ds_read_b128 v[148:151], v2 offset:21504
 v_add_f32_dpp v4, v5, v5 row_shr:4 row_mask:0xf bank_mask:0xa
 v_mfma_f32_16x16x32_bf16 v[20:23], a[204:207], a[76:79], v[20:23]
 v_exp_f32 v78, v78
 v_mfma_f32_16x16x32_bf16 v[20:23], a[200:203], a[72:75], v[20:23]
 ds_read_b128 v[152:155], v2 offset:22528
 v_add_f32_dpp v4, v4, v4 quad_perm:[2,3,0,1] row_mask:0xf bank_mask:0xf
 v_mfma_f32_16x16x32_bf16 v[20:23], a[196:199], a[68:71], v[20:23]
 v_exp_f32 v79, v79
 v_mfma_f32_16x16x32_bf16 v[20:23], a[192:195], a[64:67], v[20:23]
 ds_read_b128 v[156:159], v2 offset:23552
 v_add_f32_dpp v4, v4, v4 quad_perm:[1,0,3,2] row_mask:0xf bank_mask:0xf
 v_mfma_f32_16x16x32_bf16 v[24:27], a[192:195], a[112:115], v[24:27]
 v_rcp_f32 v48, v48
 v_mfma_f32_16x16x32_bf16 v[24:27], a[196:199], a[116:119], v[24:27]
 v_rcp_f32 v49, v49
 v_mfma_f32_16x16x32_bf16 v[24:27], a[200:203], a[120:123], v[24:27]
 ds_write_b32 v3, v4 offset:1024
 v_add_u32 v2, s42, v0
 v_mfma_f32_16x16x32_bf16 v[24:27], a[204:207], a[124:127], v[24:27]
 v_rcp_f32 v50, v50
 v_mfma_f32_16x16x32_bf16 v[28:31], a[204:207], v[188:191], v[28:31]
 v_rcp_f32 v51, v51
 v_mfma_f32_16x16x32_bf16 v[28:31], a[200:203], v[184:187], v[28:31]
 v_rcp_f32 v52, v52
 v_mfma_f32_16x16x32_bf16 v[28:31], a[196:199], v[180:183], v[28:31]
 v_rcp_f32 v53, v53
 v_mfma_f32_16x16x32_bf16 v[28:31], a[192:195], v[176:179], v[28:31]
 s_waitcnt lgkmcnt(1)
 v_rcp_f32 v54, v54
 v_mfma_f32_16x16x32_bf16 v[16:19], v[144:147], a[32:35], v[16:19]
 v_rcp_f32 v55, v55
 v_mfma_f32_16x16x32_bf16 v[16:19], v[148:151], a[36:39], v[16:19]
 ds_read_b128 a[192:195], v2 offset:0
 v_cvt_pk_bf16_f32 v112, v32, v33
 v_mfma_f32_16x16x32_bf16 v[16:19], v[152:155], a[40:43], v[16:19]
 v_rcp_f32 v56, v56
 v_mfma_f32_16x16x32_bf16 v[16:19], v[156:159], a[44:47], v[16:19]
 ds_read_b128 a[196:199], v2 offset:1024
 v_cvt_pk_bf16_f32 v113, v34, v35
 v_mfma_f32_16x16x32_bf16 v[20:23], v[156:159], a[92:95], v[20:23]
 v_rcp_f32 v57, v57
 v_mfma_f32_16x16x32_bf16 v[20:23], v[152:155], a[88:91], v[20:23]
 ds_read_b128 a[200:203], v2 offset:2048
 v_cvt_pk_bf16_f32 v116, v36, v37
 v_mfma_f32_16x16x32_bf16 v[20:23], v[148:151], a[84:87], v[20:23]
 v_rcp_f32 v58, v58
 v_mfma_f32_16x16x32_bf16 v[20:23], v[144:147], a[80:83], v[20:23]
 ds_read_b128 a[204:207], v2 offset:3072
 v_cvt_pk_bf16_f32 v117, v38, v39
 v_mfma_f32_16x16x32_bf16 v[24:27], v[144:147], a[128:131], v[24:27]
 v_rcp_f32 v59, v59
 v_mfma_f32_16x16x32_bf16 v[24:27], v[148:151], a[132:135], v[24:27]
 v_cvt_pk_bf16_f32 v120, v40, v41
 v_cvt_pk_bf16_f32 v121, v42, v43
 v_mfma_f32_16x16x32_bf16 v[24:27], v[152:155], a[136:139], v[24:27]
 v_rcp_f32 v60, v60
 v_mfma_f32_16x16x32_bf16 v[24:27], v[156:159], a[140:143], v[24:27]
 v_cvt_pk_bf16_f32 v124, v44, v45
 v_cvt_pk_bf16_f32 v125, v46, v47
 v_mfma_f32_16x16x32_bf16 v[28:31], v[156:159], v[204:207], v[28:31]
 v_rcp_f32 v61, v61
 v_mfma_f32_16x16x32_bf16 v[28:31], v[152:155], v[200:203], v[28:31]
 v_rcp_f32 v62, v62
 v_mfma_f32_16x16x32_bf16 v[28:31], v[148:151], v[196:199], v[28:31]
 s_waitcnt lgkmcnt(0)
 v_rcp_f32_e64 v63, v63
 v_mfma_f32_16x16x32_bf16 v[28:31], v[144:147], v[192:195], v[28:31]
 buffer_store_dwordx4 v[136:139], v0, s[32:35], s30 offen sc1
 buffer_load_dwordx4 v0, s[36:39], s17 offen offset:0 sc1 lds
 buffer_store_dwordx4 v[140:143], v0, s[32:35], s31 offen sc1
 buffer_load_dwordx4 v0, s[36:39], s17 offen offset:1024 sc1 lds
 buffer_load_dwordx4 v0, s[36:39], s17 offen offset:2048 sc1 lds
 v_pk_mul_f32 v[48:49], v[48:49], v[80:81]
 v_pk_mul_f32 v[50:51], v[50:51], v[82:83]
 v_pk_mul_f32 v[52:53], v[52:53], v[84:85]
 v_pk_mul_f32 v[54:55], v[54:55], v[86:87]
 v_pk_mul_f32 v[56:57], v[56:57], v[88:89]
 v_pk_mul_f32 v[58:59], v[58:59], v[90:91]
 v_pk_mul_f32 v[60:61], v[60:61], v[92:93]
 v_pk_mul_f32 v[62:63], v[62:63], v[94:95]
 v_pk_mul_f32 v[4:5], v[48:49], v[48:49]
 v_pk_fma_f32 v[64:65], v[64:65], s[22:23], s[22:23]
 v_pk_mul_f32 v[6:7], v[50:51], v[50:51]
 v_pk_fma_f32 v[66:67], v[66:67], s[22:23], s[22:23]
 v_pk_fma_f32 v[4:5], v[52:53], v[52:53], v[4:5]
 v_pk_fma_f32 v[68:69], v[68:69], s[22:23], s[22:23]
 v_pk_fma_f32 v[6:7], v[54:55], v[54:55], v[6:7]
 v_pk_fma_f32 v[70:71], v[70:71], s[22:23], s[22:23]
 v_pk_fma_f32 v[4:5], v[56:57], v[56:57], v[4:5]
 v_pk_fma_f32 v[72:73], v[72:73], s[22:23], s[22:23]
 v_pk_fma_f32 v[6:7], v[58:59], v[58:59], v[6:7]
 v_pk_fma_f32 v[74:75], v[74:75], s[22:23], s[22:23]
 v_pk_fma_f32 v[4:5], v[60:61], v[60:61], v[4:5]
 v_pk_fma_f32 v[76:77], v[76:77], s[22:23], s[22:23]
 v_pk_fma_f32 v[6:7], v[62:63], v[62:63], v[6:7]
 v_pk_fma_f32 v[78:79], v[78:79], s[22:23], s[22:23]
 v_pk_fma_f32 v[80:81], v[16:17], v[16:17], s[20:21]
 v_pk_fma_f32 v[82:83], v[18:19], v[18:19], s[20:21]
 v_pk_fma_f32 v[84:85], v[20:21], v[20:21], s[20:21]
 v_pk_fma_f32 v[86:87], v[22:23], v[22:23], s[20:21]
 v_pk_fma_f32 v[88:89], v[24:25], v[24:25], s[20:21]
 v_pk_fma_f32 v[90:91], v[26:27], v[26:27], s[20:21]
 v_pk_fma_f32 v[92:93], v[28:29], v[28:29], s[20:21]
 v_pk_fma_f32 v[94:95], v[30:31], v[30:31], s[20:21]
 v_pk_mul_f32 v[80:81], v[80:81], v[16:17] neg_lo:[1,0] neg_hi:[1,0]
 v_pk_mul_f32 v[82:83], v[82:83], v[18:19] neg_lo:[1,0] neg_hi:[1,0]
 v_pk_mul_f32 v[84:85], v[84:85], v[20:21] neg_lo:[1,0] neg_hi:[1,0]
 v_pk_mul_f32 v[86:87], v[86:87], v[22:23] neg_lo:[1,0] neg_hi:[1,0]
 v_pk_mul_f32 v[88:89], v[88:89], v[24:25] neg_lo:[1,0] neg_hi:[1,0]
 v_pk_mul_f32 v[90:91], v[90:91], v[26:27] neg_lo:[1,0] neg_hi:[1,0]
 v_pk_mul_f32 v[92:93], v[92:93], v[28:29] neg_lo:[1,0] neg_hi:[1,0]
 v_pk_mul_f32 v[94:95], v[94:95], v[30:31] neg_lo:[1,0] neg_hi:[1,0]
 v_mfma_f32_16x16x32_bf16 v[32:35], a[192:195], a[0:3], 0
 s_mov_b32 s34, 0xc0000
 v_exp_f32 v80, v80
 v_mfma_f32_16x16x32_bf16 v[32:35], a[196:199], a[4:7], v[32:35]
 ds_read_b128 v[144:147], v2 offset:4096
 v_add_f32_dpp v4, v4, v4 row_ror:8 row_mask:0xf bank_mask:0x3
 v_mfma_f32_16x16x32_bf16 v[32:35], a[200:203], a[8:11], v[32:35]
 s_add_u32 s30, s30, 0x4000
 v_exp_f32 v81, v81
 v_mfma_f32_16x16x32_bf16 v[32:35], a[204:207], a[12:15], v[32:35]
 ds_read_b128 v[148:151], v2 offset:5120
 v_add_f32_dpp v5, v5, v5 row_ror:8 row_mask:0xf bank_mask:0x3
 v_mfma_f32_16x16x32_bf16 v[36:39], a[204:207], a[60:63], 0
 s_add_u32 s31, s31, 0x4000
 v_exp_f32 v82, v82
 v_mfma_f32_16x16x32_bf16 v[36:39], a[200:203], a[56:59], v[36:39]
 ds_read_b128 v[152:155], v2 offset:6144
 v_add_f32_dpp v4, v6, v6 row_ror:8 row_mask:0xf bank_mask:0xc
 v_mfma_f32_16x16x32_bf16 v[36:39], a[196:199], a[52:55], v[36:39]
 s_add_u32 s40, s40, 24576
 v_exp_f32 v83, v83
 v_mfma_f32_16x16x32_bf16 v[36:39], a[192:195], a[48:51], v[36:39]
 ds_read_b128 v[156:159], v2 offset:7168
 v_add_f32_dpp v5, v7, v7 row_ror:8 row_mask:0xf bank_mask:0xc
 v_mfma_f32_16x16x32_bf16 v[40:43], a[192:195], a[96:99], 0
 s_cmp_eq_u32 s40, s41
 v_exp_f32 v84, v84
 v_mfma_f32_16x16x32_bf16 v[40:43], a[196:199], a[100:103], v[40:43]
 v_exp_f32 v85, v85
 v_mfma_f32_16x16x32_bf16 v[40:43], a[200:203], a[104:107], v[40:43]
 s_cselect_b32 s40, s24, s40
 v_exp_f32 v86, v86
 v_mfma_f32_16x16x32_bf16 v[40:43], a[204:207], a[108:111], v[40:43]
 v_exp_f32 v87, v87
 v_mfma_f32_16x16x32_bf16 v[44:47], a[204:207], v[172:175], 0
 s_add_u32 s17, s17, 0x5400
 v_exp_f32 v88, v88
 v_mfma_f32_16x16x32_bf16 v[44:47], a[200:203], v[168:171], v[44:47]
 v_exp_f32 v89, v89
 v_mfma_f32_16x16x32_bf16 v[44:47], a[196:199], v[164:167], v[44:47]
 s_add_u32 m0, s40, 0
 v_exp_f32 v90, v90
 v_mfma_f32_16x16x32_bf16 v[44:47], a[192:195], v[160:163], v[44:47]
 s_waitcnt lgkmcnt(0)
 v_exp_f32 v91, v91
 v_mfma_f32_16x16x32_bf16 v[32:35], v[144:147], a[16:19], v[32:35]
 v_exp_f32 v92, v92
 v_mfma_f32_16x16x32_bf16 v[32:35], v[148:151], a[20:23], v[32:35]
 ds_read_b128 a[192:195], v2 offset:8192
 v_add_f32_dpp v4, v4, v4 row_shl:4 row_mask:0xf bank_mask:0x5
 v_mfma_f32_16x16x32_bf16 v[32:35], v[152:155], a[24:27], v[32:35]
 v_exp_f32 v93, v93
 v_mfma_f32_16x16x32_bf16 v[32:35], v[156:159], a[28:31], v[32:35]
 ds_read_b128 a[196:199], v2 offset:9216
 v_add_f32_dpp v4, v5, v5 row_shr:4 row_mask:0xf bank_mask:0xa
 v_mfma_f32_16x16x32_bf16 v[36:39], v[156:159], a[76:79], v[36:39]
 v_exp_f32 v94, v94
 v_mfma_f32_16x16x32_bf16 v[36:39], v[152:155], a[72:75], v[36:39]
 ds_read_b128 a[200:203], v2 offset:10240
 v_add_f32_dpp v4, v4, v4 quad_perm:[2,3,0,1] row_mask:0xf bank_mask:0xf
 v_mfma_f32_16x16x32_bf16 v[36:39], v[148:151], a[68:71], v[36:39]
 v_exp_f32 v95, v95
 v_mfma_f32_16x16x32_bf16 v[36:39], v[144:147], a[64:67], v[36:39]
 ds_read_b128 a[204:207], v2 offset:11264
 v_add_f32_dpp v4, v4, v4 quad_perm:[1,0,3,2] row_mask:0xf bank_mask:0xf
 v_mfma_f32_16x16x32_bf16 v[40:43], v[144:147], a[112:115], v[40:43]
 v_rcp_f32 v64, v64
 v_mfma_f32_16x16x32_bf16 v[40:43], v[148:151], a[116:119], v[40:43]
 v_rcp_f32 v65, v65
 v_mfma_f32_16x16x32_bf16 v[40:43], v[152:155], a[120:123], v[40:43]
 ds_write_b32 v3, v4 offset:1280
 v_add_u32 v3, 1536, v3
 v_mfma_f32_16x16x32_bf16 v[40:43], v[156:159], a[124:127], v[40:43]
 v_rcp_f32 v66, v66
 v_mfma_f32_16x16x32_bf16 v[44:47], v[156:159], v[188:191], v[44:47]
 v_rcp_f32 v67, v67
 v_mfma_f32_16x16x32_bf16 v[44:47], v[152:155], v[184:187], v[44:47]
 v_rcp_f32 v68, v68
 v_mfma_f32_16x16x32_bf16 v[44:47], v[148:151], v[180:183], v[44:47]
 v_rcp_f32 v69, v69
 v_mfma_f32_16x16x32_bf16 v[44:47], v[144:147], v[176:179], v[44:47]
 s_waitcnt lgkmcnt(1)
 v_rcp_f32 v70, v70
 v_mfma_f32_16x16x32_bf16 v[32:35], a[192:195], a[32:35], v[32:35]
 v_rcp_f32 v71, v71
 v_mfma_f32_16x16x32_bf16 v[32:35], a[196:199], a[36:39], v[32:35]
 ds_read_b128 v[144:147], v2 offset:12288
 v_cvt_pk_bf16_f32 v114, v48, v49
 v_mfma_f32_16x16x32_bf16 v[32:35], a[200:203], a[40:43], v[32:35]
 v_rcp_f32 v72, v72
 v_mfma_f32_16x16x32_bf16 v[32:35], a[204:207], a[44:47], v[32:35]
 ds_read_b128 v[148:151], v2 offset:13312
 v_cvt_pk_bf16_f32 v115, v50, v51
 v_mfma_f32_16x16x32_bf16 v[36:39], a[204:207], a[92:95], v[36:39]
 v_rcp_f32 v73, v73
 v_mfma_f32_16x16x32_bf16 v[36:39], a[200:203], a[88:91], v[36:39]
 ds_read_b128 v[152:155], v2 offset:14336
 v_cvt_pk_bf16_f32 v118, v52, v53
 v_mfma_f32_16x16x32_bf16 v[36:39], a[196:199], a[84:87], v[36:39]
 s_waitcnt vmcnt(10)
 v_rcp_f32 v74, v74
 v_mfma_f32_16x16x32_bf16 v[36:39], a[192:195], a[80:83], v[36:39]
 s_barrier
 ds_read_b128 v[156:159], v2 offset:15360
 v_cvt_pk_bf16_f32 v119, v54, v55
 v_mfma_f32_16x16x32_bf16 v[40:43], a[192:195], a[128:131], v[40:43]
 v_rcp_f32 v75, v75
 v_mfma_f32_16x16x32_bf16 v[40:43], a[196:199], a[132:135], v[40:43]
 v_cvt_pk_bf16_f32 v122, v56, v57
 v_cvt_pk_bf16_f32 v123, v58, v59
 v_mfma_f32_16x16x32_bf16 v[40:43], a[200:203], a[136:139], v[40:43]
 v_rcp_f32 v76, v76
 v_mfma_f32_16x16x32_bf16 v[40:43], a[204:207], a[140:143], v[40:43]
 v_cvt_pk_bf16_f32 v126, v60, v61
 v_cvt_pk_bf16_f32 v127, v62, v63
 v_mfma_f32_16x16x32_bf16 v[44:47], a[204:207], v[204:207], v[44:47]
 v_rcp_f32 v77, v77
 v_mfma_f32_16x16x32_bf16 v[44:47], a[200:203], v[200:203], v[44:47]
 v_rcp_f32 v78, v78
 v_mfma_f32_16x16x32_bf16 v[44:47], a[196:199], v[196:199], v[44:47]
 s_waitcnt lgkmcnt(0)
 v_rcp_f32 v79, v79
 v_mfma_f32_16x16x32_bf16 v[44:47], a[192:195], v[192:195], v[44:47]
 buffer_store_dwordx4 v[112:115], v0, s[32:35], s28 offen sc1
 buffer_load_dwordx4 v0, s[36:39], s17 offen offset:0 sc1 lds
 buffer_store_dwordx4 v[116:119], v0, s[32:35], s29 offen sc1
 buffer_load_dwordx4 v0, s[36:39], s17 offen offset:1024 sc1 lds
 buffer_load_dwordx4 v0, s[36:39], s17 offen offset:2048 sc1 lds
 v_pk_mul_f32 v[64:65], v[64:65], v[96:97]
 v_pk_mul_f32 v[66:67], v[66:67], v[98:99]
 v_pk_mul_f32 v[68:69], v[68:69], v[100:101]
 v_pk_mul_f32 v[70:71], v[70:71], v[102:103]
 v_pk_mul_f32 v[72:73], v[72:73], v[104:105]
 v_pk_mul_f32 v[74:75], v[74:75], v[106:107]
 v_pk_mul_f32 v[76:77], v[76:77], v[108:109]
 v_pk_mul_f32 v[78:79], v[78:79], v[110:111]
 v_pk_mul_f32 v[4:5], v[64:65], v[64:65]
 v_pk_fma_f32 v[80:81], v[80:81], s[22:23], s[22:23]
 v_pk_mul_f32 v[6:7], v[66:67], v[66:67]
 v_pk_fma_f32 v[82:83], v[82:83], s[22:23], s[22:23]
 v_pk_fma_f32 v[4:5], v[68:69], v[68:69], v[4:5]
 v_pk_fma_f32 v[84:85], v[84:85], s[22:23], s[22:23]
 v_pk_fma_f32 v[6:7], v[70:71], v[70:71], v[6:7]
 v_pk_fma_f32 v[86:87], v[86:87], s[22:23], s[22:23]
 v_pk_fma_f32 v[4:5], v[72:73], v[72:73], v[4:5]
 v_pk_fma_f32 v[88:89], v[88:89], s[22:23], s[22:23]
 v_pk_fma_f32 v[6:7], v[74:75], v[74:75], v[6:7]
 v_pk_fma_f32 v[90:91], v[90:91], s[22:23], s[22:23]
 v_pk_fma_f32 v[4:5], v[76:77], v[76:77], v[4:5]
 v_pk_fma_f32 v[92:93], v[92:93], s[22:23], s[22:23]
 v_pk_fma_f32 v[6:7], v[78:79], v[78:79], v[6:7]
 v_pk_fma_f32 v[94:95], v[94:95], s[22:23], s[22:23]
 v_pk_fma_f32 v[96:97], v[32:33], v[32:33], s[20:21]
 v_pk_fma_f32 v[98:99], v[34:35], v[34:35], s[20:21]
 v_pk_fma_f32 v[100:101], v[36:37], v[36:37], s[20:21]
 v_pk_fma_f32 v[102:103], v[38:39], v[38:39], s[20:21]
 v_pk_fma_f32 v[104:105], v[40:41], v[40:41], s[20:21]
 v_pk_fma_f32 v[106:107], v[42:43], v[42:43], s[20:21]
 v_pk_fma_f32 v[108:109], v[44:45], v[44:45], s[20:21]
 v_pk_fma_f32 v[110:111], v[46:47], v[46:47], s[20:21]
 v_pk_mul_f32 v[96:97], v[96:97], v[32:33] neg_lo:[1,0] neg_hi:[1,0]
 v_pk_mul_f32 v[98:99], v[98:99], v[34:35] neg_lo:[1,0] neg_hi:[1,0]
 v_pk_mul_f32 v[100:101], v[100:101], v[36:37] neg_lo:[1,0] neg_hi:[1,0]
 v_pk_mul_f32 v[102:103], v[102:103], v[38:39] neg_lo:[1,0] neg_hi:[1,0]
 v_pk_mul_f32 v[104:105], v[104:105], v[40:41] neg_lo:[1,0] neg_hi:[1,0]
 v_pk_mul_f32 v[106:107], v[106:107], v[42:43] neg_lo:[1,0] neg_hi:[1,0]
 v_pk_mul_f32 v[108:109], v[108:109], v[44:45] neg_lo:[1,0] neg_hi:[1,0]
 v_pk_mul_f32 v[110:111], v[110:111], v[46:47] neg_lo:[1,0] neg_hi:[1,0]
 v_mfma_f32_16x16x32_bf16 v[48:51], v[144:147], a[0:3], 0
 s_add_u32 s28, s28, 0x4000
 v_exp_f32 v96, v96
 v_mfma_f32_16x16x32_bf16 v[48:51], v[148:151], a[4:7], v[48:51]
 ds_read_b128 a[192:195], v2 offset:16384
 v_add_f32_dpp v4, v4, v4 row_ror:8 row_mask:0xf bank_mask:0x3
 v_mfma_f32_16x16x32_bf16 v[48:51], v[152:155], a[8:11], v[48:51]
 s_add_u32 s29, s29, 0x4000
 v_exp_f32 v97, v97
 v_mfma_f32_16x16x32_bf16 v[48:51], v[156:159], a[12:15], v[48:51]
 ds_read_b128 a[196:199], v2 offset:17408
 v_add_f32_dpp v5, v5, v5 row_ror:8 row_mask:0xf bank_mask:0x3
 v_mfma_f32_16x16x32_bf16 v[52:55], v[156:159], a[60:63], 0
 s_add_u32 s42, s42, 24576
 v_exp_f32 v98, v98
 v_mfma_f32_16x16x32_bf16 v[52:55], v[152:155], a[56:59], v[52:55]
 ds_read_b128 a[200:203], v2 offset:18432
 v_add_f32_dpp v4, v6, v6 row_ror:8 row_mask:0xf bank_mask:0xc
 v_mfma_f32_16x16x32_bf16 v[52:55], v[148:151], a[52:55], v[52:55]
 s_cmp_eq_u32 s42, 98304
 v_exp_f32 v99, v99
 v_mfma_f32_16x16x32_bf16 v[52:55], v[144:147], a[48:51], v[52:55]
 ds_read_b128 a[204:207], v2 offset:19456
 v_add_f32_dpp v5, v7, v7 row_ror:8 row_mask:0xf bank_mask:0xc
 v_mfma_f32_16x16x32_bf16 v[56:59], v[144:147], a[96:99], 0
 s_cselect_b32 s42, 0, s42
 v_exp_f32 v100, v100
 v_mfma_f32_16x16x32_bf16 v[56:59], v[148:151], a[100:103], v[56:59]
 v_exp_f32 v101, v101
 v_mfma_f32_16x16x32_bf16 v[56:59], v[152:155], a[104:107], v[56:59]
 s_add_u32 s17, s17, 0xc00
 v_exp_f32 v102, v102
 v_mfma_f32_16x16x32_bf16 v[56:59], v[156:159], a[108:111], v[56:59]
 v_exp_f32 v103, v103
 v_mfma_f32_16x16x32_bf16 v[60:63], v[156:159], v[172:175], 0
 s_add_u32 m0, s40, 3072
 v_exp_f32 v104, v104
 v_mfma_f32_16x16x32_bf16 v[60:63], v[152:155], v[168:171], v[60:63]
 v_exp_f32 v105, v105
 v_mfma_f32_16x16x32_bf16 v[60:63], v[148:151], v[164:167], v[60:63]
 s_sub_u32 s19, s19, 1
 v_exp_f32 v106, v106
 v_mfma_f32_16x16x32_bf16 v[60:63], v[144:147], v[160:163], v[60:63]
 s_waitcnt lgkmcnt(0)
 v_exp_f32 v107, v107
 v_mfma_f32_16x16x32_bf16 v[48:51], a[192:195], a[16:19], v[48:51]
 s_cmp_lg_u32 s19, 0
 v_exp_f32 v108, v108
 v_mfma_f32_16x16x32_bf16 v[48:51], a[196:199], a[20:23], v[48:51]
 ds_read_b128 v[144:147], v2 offset:20480
 v_add_f32_dpp v4, v4, v4 row_shl:4 row_mask:0xf bank_mask:0x5
 v_mfma_f32_16x16x32_bf16 v[48:51], a[200:203], a[24:27], v[48:51]
 v_exp_f32 v109, v109
 v_mfma_f32_16x16x32_bf16 v[48:51], a[204:207], a[28:31], v[48:51]
 ds_read_b128 v[148:151], v2 offset:21504
 v_add_f32_dpp v4, v5, v5 row_shr:4 row_mask:0xf bank_mask:0xa
 v_mfma_f32_16x16x32_bf16 v[52:55], a[204:207], a[76:79], v[52:55]
 v_exp_f32 v110, v110
 v_mfma_f32_16x16x32_bf16 v[52:55], a[200:203], a[72:75], v[52:55]
 ds_read_b128 v[152:155], v2 offset:22528
 v_add_f32_dpp v4, v4, v4 quad_perm:[2,3,0,1] row_mask:0xf bank_mask:0xf
 v_mfma_f32_16x16x32_bf16 v[52:55], a[196:199], a[68:71], v[52:55]
 v_exp_f32 v111, v111
 v_mfma_f32_16x16x32_bf16 v[52:55], a[192:195], a[64:67], v[52:55]
 ds_read_b128 v[156:159], v2 offset:23552
 v_add_f32_dpp v4, v4, v4 quad_perm:[1,0,3,2] row_mask:0xf bank_mask:0xf
 v_mfma_f32_16x16x32_bf16 v[56:59], a[192:195], a[112:115], v[56:59]
 v_rcp_f32 v80, v80
 v_mfma_f32_16x16x32_bf16 v[56:59], a[196:199], a[116:119], v[56:59]
 v_rcp_f32 v81, v81
 v_mfma_f32_16x16x32_bf16 v[56:59], a[200:203], a[120:123], v[56:59]
 ds_write_b32 v3, v4 offset:0
 v_add_u32 v2, s42, v0
 v_mfma_f32_16x16x32_bf16 v[56:59], a[204:207], a[124:127], v[56:59]
 v_rcp_f32 v82, v82
 v_mfma_f32_16x16x32_bf16 v[60:63], a[204:207], v[188:191], v[60:63]
 v_rcp_f32 v83, v83
 v_mfma_f32_16x16x32_bf16 v[60:63], a[200:203], v[184:187], v[60:63]
 v_rcp_f32 v84, v84
 v_mfma_f32_16x16x32_bf16 v[60:63], a[196:199], v[180:183], v[60:63]
 v_rcp_f32 v85, v85
 v_mfma_f32_16x16x32_bf16 v[60:63], a[192:195], v[176:179], v[60:63]
 s_waitcnt lgkmcnt(1)
 v_rcp_f32 v86, v86
 v_mfma_f32_16x16x32_bf16 v[48:51], v[144:147], a[32:35], v[48:51]
 v_rcp_f32 v87, v87
 v_mfma_f32_16x16x32_bf16 v[48:51], v[148:151], a[36:39], v[48:51]
 ds_read_b128 a[192:195], v2 offset:0
 v_cvt_pk_bf16_f32 v112, v64, v65
 v_mfma_f32_16x16x32_bf16 v[48:51], v[152:155], a[40:43], v[48:51]
 v_rcp_f32 v88, v88
 v_mfma_f32_16x16x32_bf16 v[48:51], v[156:159], a[44:47], v[48:51]
 ds_read_b128 a[196:199], v2 offset:1024
 v_cvt_pk_bf16_f32 v113, v66, v67
 v_mfma_f32_16x16x32_bf16 v[52:55], v[156:159], a[92:95], v[52:55]
 v_rcp_f32 v89, v89
 v_mfma_f32_16x16x32_bf16 v[52:55], v[152:155], a[88:91], v[52:55]
 ds_read_b128 a[200:203], v2 offset:2048
 v_cvt_pk_bf16_f32 v116, v68, v69
 v_mfma_f32_16x16x32_bf16 v[52:55], v[148:151], a[84:87], v[52:55]
 v_rcp_f32 v90, v90
 v_mfma_f32_16x16x32_bf16 v[52:55], v[144:147], a[80:83], v[52:55]
 ds_read_b128 a[204:207], v2 offset:3072
 v_cvt_pk_bf16_f32 v117, v70, v71
 v_mfma_f32_16x16x32_bf16 v[56:59], v[144:147], a[128:131], v[56:59]
 v_rcp_f32 v91, v91
 v_mfma_f32_16x16x32_bf16 v[56:59], v[148:151], a[132:135], v[56:59]
 v_cvt_pk_bf16_f32 v128, v72, v73
 v_cvt_pk_bf16_f32 v129, v74, v75
 v_mfma_f32_16x16x32_bf16 v[56:59], v[152:155], a[136:139], v[56:59]
 v_rcp_f32 v92, v92
 v_mfma_f32_16x16x32_bf16 v[56:59], v[156:159], a[140:143], v[56:59]
 v_cvt_pk_bf16_f32 v132, v76, v77
 v_cvt_pk_bf16_f32 v133, v78, v79
 v_mfma_f32_16x16x32_bf16 v[60:63], v[156:159], v[204:207], v[60:63]
 v_rcp_f32 v93, v93
 v_mfma_f32_16x16x32_bf16 v[60:63], v[152:155], v[200:203], v[60:63]
 v_rcp_f32 v94, v94
 v_mfma_f32_16x16x32_bf16 v[60:63], v[148:151], v[196:199], v[60:63]
 s_waitcnt lgkmcnt(0)
 v_rcp_f32_e64 v95, v95
 v_mfma_f32_16x16x32_bf16 v[60:63], v[144:147], v[192:195], v[60:63]
 buffer_store_dwordx4 v[120:123], v0, s[32:35], s30 offen sc1
 buffer_load_dwordx4 v0, s[36:39], s17 offen offset:0 sc1 lds
 buffer_store_dwordx4 v[124:127], v0, s[32:35], s31 offen sc1
 buffer_load_dwordx4 v0, s[36:39], s17 offen offset:1024 sc1 lds
 buffer_load_dwordx4 v0, s[36:39], s17 offen offset:2048 sc1 lds
 v_pk_mul_f32 v[80:81], v[80:81], v[16:17]
 v_pk_mul_f32 v[82:83], v[82:83], v[18:19]
 v_pk_mul_f32 v[84:85], v[84:85], v[20:21]
 v_pk_mul_f32 v[86:87], v[86:87], v[22:23]
 v_pk_mul_f32 v[88:89], v[88:89], v[24:25]
 v_pk_mul_f32 v[90:91], v[90:91], v[26:27]
 v_pk_mul_f32 v[92:93], v[92:93], v[28:29]
 v_pk_mul_f32 v[94:95], v[94:95], v[30:31]
 v_pk_mul_f32 v[4:5], v[80:81], v[80:81]
 v_pk_fma_f32 v[96:97], v[96:97], s[22:23], s[22:23]
 v_pk_mul_f32 v[6:7], v[82:83], v[82:83]
 v_pk_fma_f32 v[98:99], v[98:99], s[22:23], s[22:23]
 v_pk_fma_f32 v[4:5], v[84:85], v[84:85], v[4:5]
 v_pk_fma_f32 v[100:101], v[100:101], s[22:23], s[22:23]
 v_pk_fma_f32 v[6:7], v[86:87], v[86:87], v[6:7]
 v_pk_fma_f32 v[102:103], v[102:103], s[22:23], s[22:23]
 v_pk_fma_f32 v[4:5], v[88:89], v[88:89], v[4:5]
 v_pk_fma_f32 v[104:105], v[104:105], s[22:23], s[22:23]
 v_pk_fma_f32 v[6:7], v[90:91], v[90:91], v[6:7]
 v_pk_fma_f32 v[106:107], v[106:107], s[22:23], s[22:23]
 v_pk_fma_f32 v[4:5], v[92:93], v[92:93], v[4:5]
 v_pk_fma_f32 v[108:109], v[108:109], s[22:23], s[22:23]
 v_pk_fma_f32 v[6:7], v[94:95], v[94:95], v[6:7]
 v_pk_fma_f32 v[110:111], v[110:111], s[22:23], s[22:23]
 v_pk_fma_f32 v[16:17], v[48:49], v[48:49], s[20:21]
 v_pk_fma_f32 v[18:19], v[50:51], v[50:51], s[20:21]
 v_pk_fma_f32 v[20:21], v[52:53], v[52:53], s[20:21]
 v_pk_fma_f32 v[22:23], v[54:55], v[54:55], s[20:21]
 v_pk_fma_f32 v[24:25], v[56:57], v[56:57], s[20:21]
 v_pk_fma_f32 v[26:27], v[58:59], v[58:59], s[20:21]
 v_pk_fma_f32 v[28:29], v[60:61], v[60:61], s[20:21]
 v_pk_fma_f32 v[30:31], v[62:63], v[62:63], s[20:21]
 v_pk_mul_f32 v[16:17], v[16:17], v[48:49] neg_lo:[1,0] neg_hi:[1,0]
 v_pk_mul_f32 v[18:19], v[18:19], v[50:51] neg_lo:[1,0] neg_hi:[1,0]
 v_pk_mul_f32 v[20:21], v[20:21], v[52:53] neg_lo:[1,0] neg_hi:[1,0]
 v_pk_mul_f32 v[22:23], v[22:23], v[54:55] neg_lo:[1,0] neg_hi:[1,0]
 v_pk_mul_f32 v[24:25], v[24:25], v[56:57] neg_lo:[1,0] neg_hi:[1,0]
 v_pk_mul_f32 v[26:27], v[26:27], v[58:59] neg_lo:[1,0] neg_hi:[1,0]
 v_pk_mul_f32 v[28:29], v[28:29], v[60:61] neg_lo:[1,0] neg_hi:[1,0]
 v_pk_mul_f32 v[30:31], v[30:31], v[62:63] neg_lo:[1,0] neg_hi:[1,0]
 s_cbranch_scc1 L_k1_loop2
 s_cmp_lg_u32 s43, 0
 s_cbranch_scc1 L_k1_tail
 s_mov_b32 s43, 1
 s_mov_b32 s19, 1
 s_getpc_b64 s[64:65]
L_pc5:
 s_add_u32 s64, s64, L_k1_tail-L_pc5
 s_addc_u32 s65, s65, 0
 v_and_b32 v64, 0xf0, v0
 v_lshl_add_u32 v64, v64, 2, s95
 v_min_u32 v64, L_end-L_k1_tail, v64
 v_add_co_u32 v64, vcc, s64, v64
 v_mov_b32 v65, s65
 v_mov_b32 v65, s65
 v_addc_co_u32 v65, vcc, 0, v65, vcc
 global_load_dword v1, v[64:65], off
 s_branch L_k1_loop2
L_k1_pre3:
 s_waitcnt lgkmcnt(0)
 s_nop 0
L_k1_loop3:
 v_mfma_f32_16x16x32_bf16 v[64:67], a[192:195], a[0:3], 0
 s_add_u32 s30, s30, 0x4000
 v_exp_f32 v16, v16
 v_mfma_f32_16x16x32_bf16 v[64:67], a[196:199], a[4:7], v[64:67]
 ds_read_b128 v[144:147], v2 offset:4096
 v_add_f32_dpp v4, v4, v4 row_ror:8 row_mask:0xf bank_mask:0x3
 v_mfma_f32_16x16x32_bf16 v[64:67], a[200:203], a[8:11], v[64:67]
 s_add_u32 s31, s31, 0x4000
 v_exp_f32 v17, v17
 v_mfma_f32_16x16x32_bf16 v[64:67], a[204:207], a[12:15], v[64:67]
 ds_read_b128 v[148:151], v2 offset:5120
 v_add_f32_dpp v5, v5, v5 row_ror:8 row_mask:0xf bank_mask:0x3
 v_mfma_f32_16x16x32_bf16 v[68:71], a[204:207], a[60:63], 0
 s_add_u32 s40, s40, 24576
 v_exp_f32 v18, v18
 v_mfma_f32_16x16x32_bf16 v[68:71], a[200:203], a[56:59], v[68:71]
 ds_read_b128 v[152:155], v2 offset:6144
 v_add_f32_dpp v4, v6, v6 row_ror:8 row_mask:0xf bank_mask:0xc
 v_mfma_f32_16x16x32_bf16 v[68:71], a[196:199], a[52:55], v[68:71]
 s_cmp_eq_u32 s40, s41
 v_exp_f32 v19, v19
 v_mfma_f32_16x16x32_bf16 v[68:71], a[192:195], a[48:51], v[68:71]
 ds_read_b128 v[156:159], v2 offset:7168
 v_add_f32_dpp v5, v7, v7 row_ror:8 row_mask:0xf bank_mask:0xc
 v_mfma_f32_16x16x32_bf16 v[72:75], a[192:195], a[96:99], 0
 s_cselect_b32 s40, s24, s40
 v_exp_f32 v20, v20
 v_mfma_f32_16x16x32_bf16 v[72:75], a[196:199], a[100:103], v[72:75]
 v_exp_f32 v21, v21
 v_mfma_f32_16x16x32_bf16 v[72:75], a[200:203], a[104:107], v[72:75]
 s_add_u32 s17, s17, 0x5400
 v_exp_f32 v22, v22
 v_mfma_f32_16x16x32_bf16 v[72:75], a[204:207], a[108:111], v[72:75]
 v_exp_f32 v23, v23
 v_mfma_f32_16x16x32_bf16 v[76:79], a[204:207], v[172:175], 0
 s_add_u32 m0, s40, 0
 v_exp_f32 v24, v24
 v_mfma_f32_16x16x32_bf16 v[76:79], a[200:203], v[168:171], v[76:79]
 v_exp_f32 v25, v25
 v_mfma_f32_16x16x32_bf16 v[76:79], a[196:199], v[164:167], v[76:79]
 v_exp_f32 v26, v26
 v_mfma_f32_16x16x32_bf16 v[76:79], a[192:195], v[160:163], v[76:79]
 s_waitcnt lgkmcnt(0)
 v_exp_f32 v27, v27
 v_mfma_f32_16x16x32_bf16 v[64:67], v[144:147], a[16:19], v[64:67]
 v_exp_f32 v28, v28
 v_mfma_f32_16x16x32_bf16 v[64:67], v[148:151], a[20:23], v[64:67]
 ds_read_b128 a[192:195], v2 offset:8192
 v_add_f32_dpp v4, v4, v4 row_shl:4 row_mask:0xf bank_mask:0x5
 v_mfma_f32_16x16x32_bf16 v[64:67], v[152:155], a[24:27], v[64:67]
 v_exp_f32 v29, v29
 v_mfma_f32_16x16x32_bf16 v[64:67], v[156:159], a[28:31], v[64:67]
 ds_read_b128 a[196:199], v2 offset:9216
 v_add_f32_dpp v4, v5, v5 row_shr:4 row_mask:0xf bank_mask:0xa
 v_mfma_f32_16x16x32_bf16 v[68:71], v[156:159], a[76:79], v[68:71]
 v_exp_f32 v30, v30
 v_mfma_f32_16x16x32_bf16 v[68:71], v[152:155], a[72:75], v[68:71]
 ds_read_b128 a[200:203], v2 offset:10240
 v_add_f32_dpp v4, v4, v4 quad_perm:[2,3,0,1] row_mask:0xf bank_mask:0xf
 v_mfma_f32_16x16x32_bf16 v[68:71], v[148:151], a[68:71], v[68:71]
 v_exp_f32 v31, v31
 v_mfma_f32_16x16x32_bf16 v[68:71], v[144:147], a[64:67], v[68:71]
 ds_read_b128 a[204:207], v2 offset:11264
 v_add_f32_dpp v4, v4, v4 quad_perm:[1,0,3,2] row_mask:0xf bank_mask:0xf
 v_mfma_f32_16x16x32_bf16 v[72:75], v[144:147], a[112:115], v[72:75]
 v_rcp_f32 v96, v96
 v_mfma_f32_16x16x32_bf16 v[72:75], v[148:151], a[116:119], v[72:75]
 v_rcp_f32 v97, v97
 v_mfma_f32_16x16x32_bf16 v[72:75], v[152:155], a[120:123], v[72:75]
 ds_write_b32 v3, v4 offset:256
 v_mfma_f32_16x16x32_bf16 v[72:75], v[156:159], a[124:127], v[72:75]
 v_rcp_f32 v98, v98
 v_mfma_f32_16x16x32_bf16 v[76:79], v[156:159], v[188:191], v[76:79]
 v_rcp_f32 v99, v99
 v_mfma_f32_16x16x32_bf16 v[76:79], v[152:155], v[184:187], v[76:79]
 v_rcp_f32 v100, v100
 v_mfma_f32_16x16x32_bf16 v[76:79], v[148:151], v[180:183], v[76:79]
 v_rcp_f32 v101, v101
 v_mfma_f32_16x16x32_bf16 v[76:79], v[144:147], v[176:179], v[76:79]
 s_waitcnt lgkmcnt(1)
 v_rcp_f32 v102, v102
 v_mfma_f32_16x16x32_bf16 v[64:67], a[192:195], a[32:35], v[64:67]
 v_rcp_f32 v103, v103
 v_mfma_f32_16x16x32_bf16 v[64:67], a[196:199], a[36:39], v[64:67]
 ds_read_b128 v[144:147], v2 offset:12288
 v_cvt_pk_bf16_f32 v114, v80, v81
 v_mfma_f32_16x16x32_bf16 v[64:67], a[200:203], a[40:43], v[64:67]
 s_waitcnt vmcnt(10)
 v_rcp_f32 v104, v104
 v_mfma_f32_16x16x32_bf16 v[64:67], a[204:207], a[44:47], v[64:67]
 s_barrier
 ds_read_b128 v[148:151], v2 offset:13312
 v_cvt_pk_bf16_f32 v115, v82, v83
 v_mfma_f32_16x16x32_bf16 v[68:71], a[204:207], a[92:95], v[68:71]
 v_rcp_f32 v105, v105
 v_mfma_f32_16x16x32_bf16 v[68:71], a[200:203], a[88:91], v[68:71]
 ds_read_b128 v[152:155], v2 offset:14336
 v_cvt_pk_bf16_f32 v118, v84, v85
 v_mfma_f32_16x16x32_bf16 v[68:71], a[196:199], a[84:87], v[68:71]
 v_rcp_f32 v106, v106
 v_mfma_f32_16x16x32_bf16 v[68:71], a[192:195], a[80:83], v[68:71]
 ds_read_b128 v[156:159], v2 offset:15360
 v_cvt_pk_bf16_f32 v119, v86, v87
 v_mfma_f32_16x16x32_bf16 v[72:75], a[192:195], a[128:131], v[72:75]
 v_rcp_f32 v107, v107
 v_mfma_f32_16x16x32_bf16 v[72:75], a[196:199], a[132:135], v[72:75]
 v_cvt_pk_bf16_f32 v130, v88, v89
 v_cvt_pk_bf16_f32 v131, v90, v91
 v_mfma_f32_16x16x32_bf16 v[72:75], a[200:203], a[136:139], v[72:75]
 v_rcp_f32 v108, v108
 v_mfma_f32_16x16x32_bf16 v[72:75], a[204:207], a[140:143], v[72:75]
 v_cvt_pk_bf16_f32 v134, v92, v93
 v_cvt_pk_bf16_f32 v135, v94, v95
 v_mfma_f32_16x16x32_bf16 v[76:79], a[204:207], v[204:207], v[76:79]
 v_rcp_f32 v109, v109
 v_mfma_f32_16x16x32_bf16 v[76:79], a[200:203], v[200:203], v[76:79]
 v_rcp_f32 v110, v110
 v_mfma_f32_16x16x32_bf16 v[76:79], a[196:199], v[196:199], v[76:79]
 s_waitcnt lgkmcnt(0)
 v_rcp_f32 v111, v111
 v_mfma_f32_16x16x32_bf16 v[76:79], a[192:195], v[192:195], v[76:79]
 buffer_store_dwordx4 v[112:115], v0, s[32:35], s28 offen sc1
 buffer_load_dwordx4 v0, s[36:39], s17 offen offset:0 sc1 lds
 buffer_store_dwordx4 v[116:119], v0, s[32:35], s29 offen sc1
 buffer_load_dwordx4 v0, s[36:39], s17 offen offset:1024 sc1 lds
 buffer_load_dwordx4 v0, s[36:39], s17 offen offset:2048 sc1 lds
 v_pk_mul_f32 v[96:97], v[96:97], v[32:33]
 v_pk_mul_f32 v[98:99], v[98:99], v[34:35]
 v_pk_mul_f32 v[100:101], v[100:101], v[36:37]
 v_pk_mul_f32 v[102:103], v[102:103], v[38:39]
 v_pk_mul_f32 v[104:105], v[104:105], v[40:41]
 v_pk_mul_f32 v[106:107], v[106:107], v[42:43]
 v_pk_mul_f32 v[108:109], v[108:109], v[44:45]
 v_pk_mul_f32 v[110:111], v[110:111], v[46:47]
 v_pk_mul_f32 v[4:5], v[96:97], v[96:97]
 v_pk_fma_f32 v[16:17], v[16:17], s[22:23], s[22:23]
 v_pk_mul_f32 v[6:7], v[98:99], v[98:99]
 v_pk_fma_f32 v[18:19], v[18:19], s[22:23], s[22:23]
 v_pk_fma_f32 v[4:5], v[100:101], v[100:101], v[4:5]
 v_pk_fma_f32 v[20:21], v[20:21], s[22:23], s[22:23]
 v_pk_fma_f32 v[6:7], v[102:103], v[102:103], v[6:7]
 v_pk_fma_f32 v[22:23], v[22:23], s[22:23], s[22:23]
 v_pk_fma_f32 v[4:5], v[104:105], v[104:105], v[4:5]
 v_pk_fma_f32 v[24:25], v[24:25], s[22:23], s[22:23]
 v_pk_fma_f32 v[6:7], v[106:107], v[106:107], v[6:7]
 v_pk_fma_f32 v[26:27], v[26:27], s[22:23], s[22:23]
 v_pk_fma_f32 v[4:5], v[108:109], v[108:109], v[4:5]
 v_pk_fma_f32 v[28:29], v[28:29], s[22:23], s[22:23]
 v_pk_fma_f32 v[6:7], v[110:111], v[110:111], v[6:7]
 v_pk_fma_f32 v[30:31], v[30:31], s[22:23], s[22:23]
 v_pk_fma_f32 v[32:33], v[64:65], v[64:65], s[20:21]
 v_pk_fma_f32 v[34:35], v[66:67], v[66:67], s[20:21]
 v_pk_fma_f32 v[36:37], v[68:69], v[68:69], s[20:21]
 v_pk_fma_f32 v[38:39], v[70:71], v[70:71], s[20:21]
 v_pk_fma_f32 v[40:41], v[72:73], v[72:73], s[20:21]
 v_pk_fma_f32 v[42:43], v[74:75], v[74:75], s[20:21]
 v_pk_fma_f32 v[44:45], v[76:77], v[76:77], s[20:21]
 v_pk_fma_f32 v[46:47], v[78:79], v[78:79], s[20:21]
 v_pk_mul_f32 v[32:33], v[32:33], v[64:65] neg_lo:[1,0] neg_hi:[1,0]
 v_pk_mul_f32 v[34:35], v[34:35], v[66:67] neg_lo:[1,0] neg_hi:[1,0]
 v_pk_mul_f32 v[36:37], v[36:37], v[68:69] neg_lo:[1,0] neg_hi:[1,0]
 v_pk_mul_f32 v[38:39], v[38:39], v[70:71] neg_lo:[1,0] neg_hi:[1,0]
 v_pk_mul_f32 v[40:41], v[40:41], v[72:73] neg_lo:[1,0] neg_hi:[1,0]
 v_pk_mul_f32 v[42:43], v[42:43], v[74:75] neg_lo:[1,0] neg_hi:[1,0]
 v_pk_mul_f32 v[44:45], v[44:45], v[76:77] neg_lo:[1,0] neg_hi:[1,0]
 v_pk_mul_f32 v[46:47], v[46:47], v[78:79] neg_lo:[1,0] neg_hi:[1,0]
 v_mfma_f32_16x16x32_bf16 v[80:83], v[144:147], a[0:3], 0
 s_add_u32 s28, s28, 0x4000
 v_exp_f32 v32, v32
 v_mfma_f32_16x16x32_bf16 v[80:83], v[148:151], a[4:7], v[80:83]
 ds_read_b128 a[192:195], v2 offset:16384
 v_add_f32_dpp v4, v4, v4 row_ror:8 row_mask:0xf bank_mask:0x3
 v_mfma_f32_16x16x32_bf16 v[80:83], v[152:155], a[8:11], v[80:83]
 s_add_u32 s29, s29, 0x4000
 v_exp_f32 v33, v33
 v_mfma_f32_16x16x32_bf16 v[80:83], v[156:159], a[12:15], v[80:83]
 ds_read_b128 a[196:199], v2 offset:17408
 v_add_f32_dpp v5, v5, v5 row_ror:8 row_mask:0xf bank_mask:0x3
 v_mfma_f32_16x16x32_bf16 v[84:87], v[156:159], a[60:63], 0
 s_add_u32 s42, s42, 24576
 v_exp_f32 v34, v34
 v_mfma_f32_16x16x32_bf16 v[84:87], v[152:155], a[56:59], v[84:87]
 ds_read_b128 a[200:203], v2 offset:18432
 v_add_f32_dpp v4, v6, v6 row_ror:8 row_mask:0xf bank_mask:0xc
 v_mfma_f32_16x16x32_bf16 v[84:87], v[148:151], a[52:55], v[84:87]
 s_cmp_eq_u32 s42, 98304
 v_exp_f32 v35, v35
 v_mfma_f32_16x16x32_bf16 v[84:87], v[144:147], a[48:51], v[84:87]
 ds_read_b128 a[204:207], v2 offset:19456
 v_add_f32_dpp v5, v7, v7 row_ror:8 row_mask:0xf bank_mask:0xc
 v_mfma_f32_16x16x32_bf16 v[88:91], v[144:147], a[96:99], 0
 s_cselect_b32 s42, 0, s42
 v_exp_f32 v36, v36
 v_mfma_f32_16x16x32_bf16 v[88:91], v[148:151], a[100:103], v[88:91]
 v_exp_f32 v37, v37
 v_mfma_f32_16x16x32_bf16 v[88:91], v[152:155], a[104:107], v[88:91]
 s_add_u32 s17, s17, 0xc00
 v_exp_f32 v38, v38
 v_mfma_f32_16x16x32_bf16 v[88:91], v[156:159], a[108:111], v[88:91]
 v_exp_f32 v39, v39
 v_mfma_f32_16x16x32_bf16 v[92:95], v[156:159], v[172:175], 0
 s_add_u32 m0, s40, 3072
 v_exp_f32 v40, v40
 v_mfma_f32_16x16x32_bf16 v[92:95], v[152:155], v[168:171], v[92:95]
 v_exp_f32 v41, v41
 v_mfma_f32_16x16x32_bf16 v[92:95], v[148:151], v[164:167], v[92:95]
 v_exp_f32 v42, v42
 v_mfma_f32_16x16x32_bf16 v[92:95], v[144:147], v[160:163], v[92:95]
 s_waitcnt lgkmcnt(0)
 v_exp_f32 v43, v43
 v_mfma_f32_16x16x32_bf16 v[80:83], a[192:195], a[16:19], v[80:83]
 v_exp_f32 v44, v44
 v_mfma_f32_16x16x32_bf16 v[80:83], a[196:199], a[20:23], v[80:83]
 ds_read_b128 v[144:147], v2 offset:20480
 v_add_f32_dpp v4, v4, v4 row_shl:4 row_mask:0xf bank_mask:0x5
 v_mfma_f32_16x16x32_bf16 v[80:83], a[200:203], a[24:27], v[80:83]
 v_exp_f32 v45, v45
 v_mfma_f32_16x16x32_bf16 v[80:83], a[204:207], a[28:31], v[80:83]
 ds_read_b128 v[148:151], v2 offset:21504
 v_add_f32_dpp v4, v5, v5 row_shr:4 row_mask:0xf bank_mask:0xa
 v_mfma_f32_16x16x32_bf16 v[84:87], a[204:207], a[76:79], v[84:87]
 v_exp_f32 v46, v46
 v_mfma_f32_16x16x32_bf16 v[84:87], a[200:203], a[72:75], v[84:87]
 ds_read_b128 v[152:155], v2 offset:22528
 v_add_f32_dpp v4, v4, v4 quad_perm:[2,3,0,1] row_mask:0xf bank_mask:0xf
 v_mfma_f32_16x16x32_bf16 v[84:87], a[196:199], a[68:71], v[84:87]
 v_exp_f32 v47, v47
 v_mfma_f32_16x16x32_bf16 v[84:87], a[192:195], a[64:67], v[84:87]
 ds_read_b128 v[156:159], v2 offset:23552
 v_add_f32_dpp v4, v4, v4 quad_perm:[1,0,3,2] row_mask:0xf bank_mask:0xf
 v_mfma_f32_16x16x32_bf16 v[88:91], a[192:195], a[112:115], v[88:91]
 v_rcp_f32 v16, v16
 v_mfma_f32_16x16x32_bf16 v[88:91], a[196:199], a[116:119], v[88:91]
 v_rcp_f32 v17, v17
 v_mfma_f32_16x16x32_bf16 v[88:91], a[200:203], a[120:123], v[88:91]
 ds_write_b32 v3, v4 offset:512
 v_add_u32 v2, s42, v0
 v_mfma_f32_16x16x32_bf16 v[88:91], a[204:207], a[124:127], v[88:91]
 v_rcp_f32 v18, v18
 v_mfma_f32_16x16x32_bf16 v[92:95], a[204:207], v[188:191], v[92:95]
 v_rcp_f32 v19, v19
 v_mfma_f32_16x16x32_bf16 v[92:95], a[200:203], v[184:187], v[92:95]
 v_rcp_f32 v20, v20
 v_mfma_f32_16x16x32_bf16 v[92:95], a[196:199], v[180:183], v[92:95]
 v_rcp_f32 v21, v21
 v_mfma_f32_16x16x32_bf16 v[92:95], a[192:195], v[176:179], v[92:95]
 s_waitcnt lgkmcnt(1)
 v_rcp_f32 v22, v22
 v_mfma_f32_16x16x32_bf16 v[80:83], v[144:147], a[32:35], v[80:83]
 v_rcp_f32 v23, v23
 v_mfma_f32_16x16x32_bf16 v[80:83], v[148:151], a[36:39], v[80:83]
 ds_read_b128 a[192:195], v2 offset:0
 v_cvt_pk_bf16_f32 v112, v96, v97
 v_mfma_f32_16x16x32_bf16 v[80:83], v[152:155], a[40:43], v[80:83]
 v_rcp_f32 v24, v24
 v_mfma_f32_16x16x32_bf16 v[80:83], v[156:159], a[44:47], v[80:83]
 ds_read_b128 a[196:199], v2 offset:1024
 v_cvt_pk_bf16_f32 v113, v98, v99
 v_mfma_f32_16x16x32_bf16 v[84:87], v[156:159], a[92:95], v[84:87]
 v_rcp_f32 v25, v25
 v_mfma_f32_16x16x32_bf16 v[84:87], v[152:155], a[88:91], v[84:87]
 ds_read_b128 a[200:203], v2 offset:2048
 v_cvt_pk_bf16_f32 v116, v100, v101
 v_mfma_f32_16x16x32_bf16 v[84:87], v[148:151], a[84:87], v[84:87]
 v_rcp_f32 v26, v26
 v_mfma_f32_16x16x32_bf16 v[84:87], v[144:147], a[80:83], v[84:87]
 ds_read_b128 a[204:207], v2 offset:3072
 v_cvt_pk_bf16_f32 v117, v102, v103
 v_mfma_f32_16x16x32_bf16 v[88:91], v[144:147], a[128:131], v[88:91]
 v_rcp_f32 v27, v27
 v_mfma_f32_16x16x32_bf16 v[88:91], v[148:151], a[132:135], v[88:91]
 v_cvt_pk_bf16_f32 v136, v104, v105
 v_cvt_pk_bf16_f32 v137, v106, v107
 v_mfma_f32_16x16x32_bf16 v[88:91], v[152:155], a[136:139], v[88:91]
 v_rcp_f32 v28, v28
 v_mfma_f32_16x16x32_bf16 v[88:91], v[156:159], a[140:143], v[88:91]
 v_cvt_pk_bf16_f32 v140, v108, v109
 v_cvt_pk_bf16_f32 v141, v110, v111
 v_mfma_f32_16x16x32_bf16 v[92:95], v[156:159], v[204:207], v[92:95]
 v_rcp_f32 v29, v29
 v_mfma_f32_16x16x32_bf16 v[92:95], v[152:155], v[200:203], v[92:95]
 v_rcp_f32 v30, v30
 v_mfma_f32_16x16x32_bf16 v[92:95], v[148:151], v[196:199], v[92:95]
 s_waitcnt lgkmcnt(0)
 v_rcp_f32_e64 v31, v31
 v_mfma_f32_16x16x32_bf16 v[92:95], v[144:147], v[192:195], v[92:95]
 buffer_store_dwordx4 v[128:131], v0, s[32:35], s30 offen sc1
 buffer_load_dwordx4 v0, s[36:39], s17 offen offset:0 sc1 lds
 buffer_store_dwordx4 v[132:135], v0, s[32:35], s31 offen sc1
 buffer_load_dwordx4 v0, s[36:39], s17 offen offset:1024 sc1 lds
 buffer_load_dwordx4 v0, s[36:39], s17 offen offset:2048 sc1 lds
 v_pk_mul_f32 v[16:17], v[16:17], v[48:49]
 v_pk_mul_f32 v[18:19], v[18:19], v[50:51]
 v_pk_mul_f32 v[20:21], v[20:21], v[52:53]
 v_pk_mul_f32 v[22:23], v[22:23], v[54:55]
 v_pk_mul_f32 v[24:25], v[24:25], v[56:57]
 v_pk_mul_f32 v[26:27], v[26:27], v[58:59]
 v_pk_mul_f32 v[28:29], v[28:29], v[60:61]
 v_pk_mul_f32 v[30:31], v[30:31], v[62:63]
 v_pk_mul_f32 v[4:5], v[16:17], v[16:17]
 v_pk_fma_f32 v[32:33], v[32:33], s[22:23], s[22:23]
 v_pk_mul_f32 v[6:7], v[18:19], v[18:19]
 v_pk_fma_f32 v[34:35], v[34:35], s[22:23], s[22:23]
 v_pk_fma_f32 v[4:5], v[20:21], v[20:21], v[4:5]
 v_pk_fma_f32 v[36:37], v[36:37], s[22:23], s[22:23]
 v_pk_fma_f32 v[6:7], v[22:23], v[22:23], v[6:7]
 v_pk_fma_f32 v[38:39], v[38:39], s[22:23], s[22:23]
 v_pk_fma_f32 v[4:5], v[24:25], v[24:25], v[4:5]
 v_pk_fma_f32 v[40:41], v[40:41], s[22:23], s[22:23]
 v_pk_fma_f32 v[6:7], v[26:27], v[26:27], v[6:7]
 v_pk_fma_f32 v[42:43], v[42:43], s[22:23], s[22:23]
 v_pk_fma_f32 v[4:5], v[28:29], v[28:29], v[4:5]
 v_pk_fma_f32 v[44:45], v[44:45], s[22:23], s[22:23]
 v_pk_fma_f32 v[6:7], v[30:31], v[30:31], v[6:7]
 v_pk_fma_f32 v[46:47], v[46:47], s[22:23], s[22:23]
 v_pk_fma_f32 v[48:49], v[80:81], v[80:81], s[20:21]
 v_pk_fma_f32 v[50:51], v[82:83], v[82:83], s[20:21]
 v_pk_fma_f32 v[52:53], v[84:85], v[84:85], s[20:21]
 v_pk_fma_f32 v[54:55], v[86:87], v[86:87], s[20:21]
 v_pk_fma_f32 v[56:57], v[88:89], v[88:89], s[20:21]
 v_pk_fma_f32 v[58:59], v[90:91], v[90:91], s[20:21]
 v_pk_fma_f32 v[60:61], v[92:93], v[92:93], s[20:21]
 v_pk_fma_f32 v[62:63], v[94:95], v[94:95], s[20:21]
 v_pk_mul_f32 v[48:49], v[48:49], v[80:81] neg_lo:[1,0] neg_hi:[1,0]
 v_pk_mul_f32 v[50:51], v[50:51], v[82:83] neg_lo:[1,0] neg_hi:[1,0]
 v_pk_mul_f32 v[52:53], v[52:53], v[84:85] neg_lo:[1,0] neg_hi:[1,0]
 v_pk_mul_f32 v[54:55], v[54:55], v[86:87] neg_lo:[1,0] neg_hi:[1,0]
 v_pk_mul_f32 v[56:57], v[56:57], v[88:89] neg_lo:[1,0] neg_hi:[1,0]
 v_pk_mul_f32 v[58:59], v[58:59], v[90:91] neg_lo:[1,0] neg_hi:[1,0]
 v_pk_mul_f32 v[60:61], v[60:61], v[92:93] neg_lo:[1,0] neg_hi:[1,0]
 v_pk_mul_f32 v[62:63], v[62:63], v[94:95] neg_lo:[1,0] neg_hi:[1,0]
 v_mfma_f32_16x16x32_bf16 v[96:99], a[192:195], a[0:3], 0
 s_add_u32 s30, s30, 0x4000
 v_exp_f32 v48, v48
 v_mfma_f32_16x16x32_bf16 v[96:99], a[196:199], a[4:7], v[96:99]
 ds_read_b128 v[144:147], v2 offset:4096
 v_add_f32_dpp v4, v4, v4 row_ror:8 row_mask:0xf bank_mask:0x3
 v_mfma_f32_16x16x32_bf16 v[96:99], a[200:203], a[8:11], v[96:99]
 s_add_u32 s31, s31, 0x4000
 v_exp_f32 v49, v49
 v_mfma_f32_16x16x32_bf16 v[96:99], a[204:207], a[12:15], v[96:99]
 ds_read_b128 v[148:151], v2 offset:5120
 v_add_f32_dpp v5, v5, v5 row_ror:8 row_mask:0xf bank_mask:0x3
 v_mfma_f32_16x16x32_bf16 v[100:103], a[204:207], a[60:63], 0
 s_add_u32 s40, s40, 24576
 v_exp_f32 v50, v50
 v_mfma_f32_16x16x32_bf16 v[100:103], a[200:203], a[56:59], v[100:103]
 ds_read_b128 v[152:155], v2 offset:6144
 v_add_f32_dpp v4, v6, v6 row_ror:8 row_mask:0xf bank_mask:0xc
 v_mfma_f32_16x16x32_bf16 v[100:103], a[196:199], a[52:55], v[100:103]
 s_cmp_eq_u32 s40, s41
 v_exp_f32 v51, v51
 v_mfma_f32_16x16x32_bf16 v[100:103], a[192:195], a[48:51], v[100:103]
 ds_read_b128 v[156:159], v2 offset:7168
 v_add_f32_dpp v5, v7, v7 row_ror:8 row_mask:0xf bank_mask:0xc
 v_mfma_f32_16x16x32_bf16 v[104:107], a[192:195], a[96:99], 0
 s_cselect_b32 s40, s24, s40
 v_exp_f32 v52, v52
 v_mfma_f32_16x16x32_bf16 v[104:107], a[196:199], a[100:103], v[104:107]
 v_exp_f32 v53, v53
 v_mfma_f32_16x16x32_bf16 v[104:107], a[200:203], a[104:107], v[104:107]
 s_add_u32 s17, s17, 0x5400
 v_exp_f32 v54, v54
 v_mfma_f32_16x16x32_bf16 v[104:107], a[204:207], a[108:111], v[104:107]
 v_exp_f32 v55, v55
 v_mfma_f32_16x16x32_bf16 v[108:111], a[204:207], v[172:175], 0
 s_add_u32 m0, s40, 0
 v_exp_f32 v56, v56
 v_mfma_f32_16x16x32_bf16 v[108:111], a[200:203], v[168:171], v[108:111]
 v_exp_f32 v57, v57
 v_mfma_f32_16x16x32_bf16 v[108:111], a[196:199], v[164:167], v[108:111]
 v_exp_f32 v58, v58
 v_mfma_f32_16x16x32_bf16 v[108:111], a[192:195], v[160:163], v[108:111]
 s_waitcnt lgkmcnt(0)
 v_exp_f32 v59, v59
 v_mfma_f32_16x16x32_bf16 v[96:99], v[144:147], a[16:19], v[96:99]
 v_exp_f32 v60, v60
 v_mfma_f32_16x16x32_bf16 v[96:99], v[148:151], a[20:23], v[96:99]
 ds_read_b128 a[192:195], v2 offset:8192
 v_add_f32_dpp v4, v4, v4 row_shl:4 row_mask:0xf bank_mask:0x5
 v_mfma_f32_16x16x32_bf16 v[96:99], v[152:155], a[24:27], v[96:99]
 v_exp_f32 v61, v61
 v_mfma_f32_16x16x32_bf16 v[96:99], v[156:159], a[28:31], v[96:99]
 ds_read_b128 a[196:199], v2 offset:9216
 v_add_f32_dpp v4, v5, v5 row_shr:4 row_mask:0xf bank_mask:0xa
 v_mfma_f32_16x16x32_bf16 v[100:103], v[156:159], a[76:79], v[100:103]
 v_exp_f32 v62, v62
 v_mfma_f32_16x16x32_bf16 v[100:103], v[152:155], a[72:75], v[100:103]
 ds_read_b128 a[200:203], v2 offset:10240
 v_add_f32_dpp v4, v4, v4 quad_perm:[2,3,0,1] row_mask:0xf bank_mask:0xf
 v_mfma_f32_16x16x32_bf16 v[100:103], v[148:151], a[68:71], v[100:103]
 v_exp_f32 v63, v63
 v_mfma_f32_16x16x32_bf16 v[100:103], v[144:147], a[64:67], v[100:103]
 ds_read_b128 a[204:207], v2 offset:11264
 v_add_f32_dpp v4, v4, v4 quad_perm:[1,0,3,2] row_mask:0xf bank_mask:0xf
 v_mfma_f32_16x16x32_bf16 v[104:107], v[144:147], a[112:115], v[104:107]
 v_rcp_f32 v32, v32
 v_mfma_f32_16x16x32_bf16 v[104:107], v[148:151], a[116:119], v[104:107]
 v_rcp_f32 v33, v33
 v_mfma_f32_16x16x32_bf16 v[104:107], v[152:155], a[120:123], v[104:107]
 ds_write_b32 v3, v4 offset:768
 v_mfma_f32_16x16x32_bf16 v[104:107], v[156:159], a[124:127], v[104:107]
 v_rcp_f32 v34, v34
 v_mfma_f32_16x16x32_bf16 v[108:111], v[156:159], v[188:191], v[108:111]
 v_rcp_f32 v35, v35
 v_mfma_f32_16x16x32_bf16 v[108:111], v[152:155], v[184:187], v[108:111]
 v_rcp_f32 v36, v36
 v_mfma_f32_16x16x32_bf16 v[108:111], v[148:151], v[180:183], v[108:111]
 v_rcp_f32 v37, v37
 v_mfma_f32_16x16x32_bf16 v[108:111], v[144:147], v[176:179], v[108:111]
 s_waitcnt lgkmcnt(1)
 v_rcp_f32 v38, v38
 v_mfma_f32_16x16x32_bf16 v[96:99], a[192:195], a[32:35], v[96:99]
 v_rcp_f32 v39, v39
 v_mfma_f32_16x16x32_bf16 v[96:99], a[196:199], a[36:39], v[96:99]
 ds_read_b128 v[144:147], v2 offset:12288
 v_cvt_pk_bf16_f32 v114, v16, v17
 v_mfma_f32_16x16x32_bf16 v[96:99], a[200:203], a[40:43], v[96:99]
 s_waitcnt vmcnt(10)
 v_rcp_f32 v40, v40
 v_mfma_f32_16x16x32_bf16 v[96:99], a[204:207], a[44:47], v[96:99]
 s_barrier
 ds_read_b128 v[148:151], v2 offset:13312
 v_cvt_pk_bf16_f32 v115, v18, v19
 v_mfma_f32_16x16x32_bf16 v[100:103], a[204:207], a[92:95], v[100:103]
 v_rcp_f32 v41, v41
 v_mfma_f32_16x16x32_bf16 v[100:103], a[200:203], a[88:91], v[100:103]
 ds_read_b128 v[152:155], v2 offset:14336
 v_cvt_pk_bf16_f32 v118, v20, v21
 v_mfma_f32_16x16x32_bf16 v[100:103], a[196:199], a[84:87], v[100:103]
 v_rcp_f32 v42, v42
 v_mfma_f32_16x16x32_bf16 v[100:103], a[192:195], a[80:83], v[100:103]
 ds_read_b128 v[156:159], v2 offset:15360
 v_cvt_pk_bf16_f32 v119, v22, v23
 v_mfma_f32_16x16x32_bf16 v[104:107], a[192:195], a[128:131], v[104:107]
 v_rcp_f32 v43, v43
 v_mfma_f32_16x16x32_bf16 v[104:107], a[196:199], a[132:135], v[104:107]
 v_cvt_pk_bf16_f32 v138, v24, v25
 v_cvt_pk_bf16_f32 v139, v26, v27
 v_mfma_f32_16x16x32_bf16 v[104:107], a[200:203], a[136:139], v[104:107]
 v_rcp_f32 v44, v44
 v_mfma_f32_16x16x32_bf16 v[104:107], a[204:207], a[140:143], v[104:107]
 v_cvt_pk_bf16_f32 v142, v28, v29
 v_cvt_pk_bf16_f32 v143, v30, v31
 v_mfma_f32_16x16x32_bf16 v[108:111], a[204:207], v[204:207], v[108:111]
 v_rcp_f32 v45, v45
 v_mfma_f32_16x16x32_bf16 v[108:111], a[200:203], v[200:203], v[108:111]
 v_rcp_f32 v46, v46
 v_mfma_f32_16x16x32_bf16 v[108:111], a[196:199], v[196:199], v[108:111]
 s_waitcnt lgkmcnt(0)
 v_rcp_f32 v47, v47
 v_mfma_f32_16x16x32_bf16 v[108:111], a[192:195], v[192:195], v[108:111]
 buffer_store_dwordx4 v[112:115], v0, s[32:35], s28 offen sc1
 buffer_load_dwordx4 v0, s[36:39], s17 offen offset:0 sc1 lds
 buffer_store_dwordx4 v[116:119], v0, s[32:35], s29 offen sc1
 buffer_load_dwordx4 v0, s[36:39], s17 offen offset:1024 sc1 lds
 buffer_load_dwordx4 v0, s[36:39], s17 offen offset:2048 sc1 lds
 v_pk_mul_f32 v[32:33], v[32:33], v[64:65]
 v_pk_mul_f32 v[34:35], v[34:35], v[66:67]
 v_pk_mul_f32 v[36:37], v[36:37], v[68:69]
 v_pk_mul_f32 v[38:39], v[38:39], v[70:71]
 v_pk_mul_f32 v[40:41], v[40:41], v[72:73]
 v_pk_mul_f32 v[42:43], v[42:43], v[74:75]
 v_pk_mul_f32 v[44:45], v[44:45], v[76:77]
 v_pk_mul_f32 v[46:47], v[46:47], v[78:79]
 v_pk_mul_f32 v[4:5], v[32:33], v[32:33]
 v_pk_fma_f32 v[48:49], v[48:49], s[22:23], s[22:23]
 v_pk_mul_f32 v[6:7], v[34:35], v[34:35]
 v_pk_fma_f32 v[50:51], v[50:51], s[22:23], s[22:23]
 v_pk_fma_f32 v[4:5], v[36:37], v[36:37], v[4:5]
 v_pk_fma_f32 v[52:53], v[52:53], s[22:23], s[22:23]
 v_pk_fma_f32 v[6:7], v[38:39], v[38:39], v[6:7]
 v_pk_fma_f32 v[54:55], v[54:55], s[22:23], s[22:23]
 v_pk_fma_f32 v[4:5], v[40:41], v[40:41], v[4:5]
 v_pk_fma_f32 v[56:57], v[56:57], s[22:23], s[22:23]
 v_pk_fma_f32 v[6:7], v[42:43], v[42:43], v[6:7]
 v_pk_fma_f32 v[58:59], v[58:59], s[22:23], s[22:23]
 v_pk_fma_f32 v[4:5], v[44:45], v[44:45], v[4:5]
 v_pk_fma_f32 v[60:61], v[60:61], s[22:23], s[22:23]
 v_pk_fma_f32 v[6:7], v[46:47], v[46:47], v[6:7]
 v_pk_fma_f32 v[62:63], v[62:63], s[22:23], s[22:23]
 v_pk_fma_f32 v[64:65], v[96:97], v[96:97], s[20:21]
 v_pk_fma_f32 v[66:67], v[98:99], v[98:99], s[20:21]
 v_pk_fma_f32 v[68:69], v[100:101], v[100:101], s[20:21]
 v_pk_fma_f32 v[70:71], v[102:103], v[102:103], s[20:21]
 v_pk_fma_f32 v[72:73], v[104:105], v[104:105], s[20:21]
 v_pk_fma_f32 v[74:75], v[106:107], v[106:107], s[20:21]
 v_pk_fma_f32 v[76:77], v[108:109], v[108:109], s[20:21]
 v_pk_fma_f32 v[78:79], v[110:111], v[110:111], s[20:21]
 v_pk_mul_f32 v[64:65], v[64:65], v[96:97] neg_lo:[1,0] neg_hi:[1,0]
 v_pk_mul_f32 v[66:67], v[66:67], v[98:99] neg_lo:[1,0] neg_hi:[1,0]
 v_pk_mul_f32 v[68:69], v[68:69], v[100:101] neg_lo:[1,0] neg_hi:[1,0]
 v_pk_mul_f32 v[70:71], v[70:71], v[102:103] neg_lo:[1,0] neg_hi:[1,0]
 v_pk_mul_f32 v[72:73], v[72:73], v[104:105] neg_lo:[1,0] neg_hi:[1,0]
 v_pk_mul_f32 v[74:75], v[74:75], v[106:107] neg_lo:[1,0] neg_hi:[1,0]
 v_pk_mul_f32 v[76:77], v[76:77], v[108:109] neg_lo:[1,0] neg_hi:[1,0]
 v_pk_mul_f32 v[78:79], v[78:79], v[110:111] neg_lo:[1,0] neg_hi:[1,0]
 v_mfma_f32_16x16x32_bf16 v[16:19], v[144:147], a[0:3], 0
 s_add_u32 s28, s28, 0x4000
 v_exp_f32 v64, v64
 v_mfma_f32_16x16x32_bf16 v[16:19], v[148:151], a[4:7], v[16:19]
 ds_read_b128 a[192:195], v2 offset:16384
 v_add_f32_dpp v4, v4, v4 row_ror:8 row_mask:0xf bank_mask:0x3
 v_mfma_f32_16x16x32_bf16 v[16:19], v[152:155], a[8:11], v[16:19]
 s_add_u32 s29, s29, 0x4000
 v_exp_f32 v65, v65
 v_mfma_f32_16x16x32_bf16 v[16:19], v[156:159], a[12:15], v[16:19]
 ds_read_b128 a[196:199], v2 offset:17408
 v_add_f32_dpp v5, v5, v5 row_ror:8 row_mask:0xf bank_mask:0x3
 v_mfma_f32_16x16x32_bf16 v[20:23], v[156:159], a[60:63], 0
 s_add_u32 s42, s42, 24576
 v_exp_f32 v66, v66
 v_mfma_f32_16x16x32_bf16 v[20:23], v[152:155], a[56:59], v[20:23]
 ds_read_b128 a[200:203], v2 offset:18432
 v_add_f32_dpp v4, v6, v6 row_ror:8 row_mask:0xf bank_mask:0xc
 v_mfma_f32_16x16x32_bf16 v[20:23], v[148:151], a[52:55], v[20:23]
 s_cmp_eq_u32 s42, 98304
 v_exp_f32 v67, v67
 v_mfma_f32_16x16x32_bf16 v[20:23], v[144:147], a[48:51], v[20:23]
 ds_read_b128 a[204:207], v2 offset:19456
 v_add_f32_dpp v5, v7, v7 row_ror:8 row_mask:0xf bank_mask:0xc
 v_mfma_f32_16x16x32_bf16 v[24:27], v[144:147], a[96:99], 0
 s_cselect_b32 s42, 0, s42
 v_exp_f32 v68, v68
 v_mfma_f32_16x16x32_bf16 v[24:27], v[148:151], a[100:103], v[24:27]
 v_exp_f32 v69, v69
 v_mfma_f32_16x16x32_bf16 v[24:27], v[152:155], a[104:107], v[24:27]
 s_add_u32 s17, s17, 0xc00
 v_exp_f32 v70, v70
 v_mfma_f32_16x16x32_bf16 v[24:27], v[156:159], a[108:111], v[24:27]
 v_exp_f32 v71, v71
 v_mfma_f32_16x16x32_bf16 v[28:31], v[156:159], v[172:175], 0
 s_add_u32 m0, s40, 3072
 v_exp_f32 v72, v72
 v_mfma_f32_16x16x32_bf16 v[28:31], v[152:155], v[168:171], v[28:31]
 v_exp_f32 v73, v73
 v_mfma_f32_16x16x32_bf16 v[28:31], v[148:151], v[164:167], v[28:31]
 v_exp_f32 v74, v74
 v_mfma_f32_16x16x32_bf16 v[28:31], v[144:147], v[160:163], v[28:31]
 s_waitcnt lgkmcnt(0)
 v_exp_f32 v75, v75
 v_mfma_f32_16x16x32_bf16 v[16:19], a[192:195], a[16:19], v[16:19]
 v_exp_f32 v76, v76
 v_mfma_f32_16x16x32_bf16 v[16:19], a[196:199], a[20:23], v[16:19]
 ds_read_b128 v[144:147], v2 offset:20480
 v_add_f32_dpp v4, v4, v4 row_shl:4 row_mask:0xf bank_mask:0x5
 v_mfma_f32_16x16x32_bf16 v[16:19], a[200:203], a[24:27], v[16:19]
 v_exp_f32 v77, v77
 v_mfma_f32_16x16x32_bf16 v[16:19], a[204:207], a[28:31], v[16:19]
 ds_read_b128 v[148:151], v2 offset:21504
 v_add_f32_dpp v4, v5, v5 row_shr:4 row_mask:0xf bank_mask:0xa
 v_mfma_f32_16x16x32_bf16 v[20:23], a[204:207], a[76:79], v[20:23]
 v_exp_f32 v78, v78
 v_mfma_f32_16x16x32_bf16 v[20:23], a[200:203], a[72:75], v[20:23]
 ds_read_b128 v[152:155], v2 offset:22528
 v_add_f32_dpp v4, v4, v4 quad_perm:[2,3,0,1] row_mask:0xf bank_mask:0xf
 v_mfma_f32_16x16x32_bf16 v[20:23], a[196:199], a[68:71], v[20:23]
 v_exp_f32 v79, v79
 v_mfma_f32_16x16x32_bf16 v[20:23], a[192:195], a[64:67], v[20:23]
 ds_read_b128 v[156:159], v2 offset:23552
 v_add_f32_dpp v4, v4, v4 quad_perm:[1,0,3,2] row_mask:0xf bank_mask:0xf
 v_mfma_f32_16x16x32_bf16 v[24:27], a[192:195], a[112:115], v[24:27]
 v_rcp_f32 v48, v48
 v_mfma_f32_16x16x32_bf16 v[24:27], a[196:199], a[116:119], v[24:27]
 v_rcp_f32 v49, v49
 v_mfma_f32_16x16x32_bf16 v[24:27], a[200:203], a[120:123], v[24:27]
 ds_write_b32 v3, v4 offset:1024
 v_add_u32 v2, s42, v0
 v_mfma_f32_16x16x32_bf16 v[24:27], a[204:207], a[124:127], v[24:27]
 v_rcp_f32 v50, v50
 v_mfma_f32_16x16x32_bf16 v[28:31], a[204:207], v[188:191], v[28:31]
 v_rcp_f32 v51, v51
 v_mfma_f32_16x16x32_bf16 v[28:31], a[200:203], v[184:187], v[28:31]
 v_rcp_f32 v52, v52
 v_mfma_f32_16x16x32_bf16 v[28:31], a[196:199], v[180:183], v[28:31]
 v_rcp_f32 v53, v53
 v_mfma_f32_16x16x32_bf16 v[28:31], a[192:195], v[176:179], v[28:31]
 s_waitcnt lgkmcnt(1)
 v_rcp_f32 v54, v54
 v_mfma_f32_16x16x32_bf16 v[16:19], v[144:147], a[32:35], v[16:19]
 v_rcp_f32 v55, v55
 v_mfma_f32_16x16x32_bf16 v[16:19], v[148:151], a[36:39], v[16:19]
 ds_read_b128 a[192:195], v2 offset:0
 v_cvt_pk_bf16_f32 v112, v32, v33
 v_mfma_f32_16x16x32_bf16 v[16:19], v[152:155], a[40:43], v[16:19]
 v_rcp_f32 v56, v56
 v_mfma_f32_16x16x32_bf16 v[16:19], v[156:159], a[44:47], v[16:19]
 ds_read_b128 a[196:199], v2 offset:1024
 v_cvt_pk_bf16_f32 v113, v34, v35
 v_mfma_f32_16x16x32_bf16 v[20:23], v[156:159], a[92:95], v[20:23]
 v_rcp_f32 v57, v57
 v_mfma_f32_16x16x32_bf16 v[20:23], v[152:155], a[88:91], v[20:23]
 ds_read_b128 a[200:203], v2 offset:2048
 v_cvt_pk_bf16_f32 v116, v36, v37
 v_mfma_f32_16x16x32_bf16 v[20:23], v[148:151], a[84:87], v[20:23]
 v_rcp_f32 v58, v58
 v_mfma_f32_16x16x32_bf16 v[20:23], v[144:147], a[80:83], v[20:23]
 ds_read_b128 a[204:207], v2 offset:3072
 v_cvt_pk_bf16_f32 v117, v38, v39
 v_mfma_f32_16x16x32_bf16 v[24:27], v[144:147], a[128:131], v[24:27]
 v_rcp_f32 v59, v59
 v_mfma_f32_16x16x32_bf16 v[24:27], v[148:151], a[132:135], v[24:27]
 v_cvt_pk_bf16_f32 v120, v40, v41
 v_cvt_pk_bf16_f32 v121, v42, v43
 v_mfma_f32_16x16x32_bf16 v[24:27], v[152:155], a[136:139], v[24:27]
 v_rcp_f32 v60, v60
 v_mfma_f32_16x16x32_bf16 v[24:27], v[156:159], a[140:143], v[24:27]
 v_cvt_pk_bf16_f32 v124, v44, v45
 v_cvt_pk_bf16_f32 v125, v46, v47
 v_mfma_f32_16x16x32_bf16 v[28:31], v[156:159], v[204:207], v[28:31]
 v_rcp_f32 v61, v61
 v_mfma_f32_16x16x32_bf16 v[28:31], v[152:155], v[200:203], v[28:31]
 v_rcp_f32 v62, v62
 v_mfma_f32_16x16x32_bf16 v[28:31], v[148:151], v[196:199], v[28:31]
 s_waitcnt lgkmcnt(0)
 v_rcp_f32_e64 v63, v63
 v_mfma_f32_16x16x32_bf16 v[28:31], v[144:147], v[192:195], v[28:31]
 buffer_store_dwordx4 v[136:139], v0, s[32:35], s30 offen sc1
 buffer_load_dwordx4 v0, s[36:39], s17 offen offset:0 sc1 lds
 buffer_store_dwordx4 v[140:143], v0, s[32:35], s31 offen sc1
 buffer_load_dwordx4 v0, s[36:39], s17 offen offset:1024 sc1 lds
 buffer_load_dwordx4 v0, s[36:39], s17 offen offset:2048 sc1 lds
 v_pk_mul_f32 v[48:49], v[48:49], v[80:81]
 v_pk_mul_f32 v[50:51], v[50:51], v[82:83]
 v_pk_mul_f32 v[52:53], v[52:53], v[84:85]
 v_pk_mul_f32 v[54:55], v[54:55], v[86:87]
 v_pk_mul_f32 v[56:57], v[56:57], v[88:89]
 v_pk_mul_f32 v[58:59], v[58:59], v[90:91]
 v_pk_mul_f32 v[60:61], v[60:61], v[92:93]
 v_pk_mul_f32 v[62:63], v[62:63], v[94:95]
 v_pk_mul_f32 v[4:5], v[48:49], v[48:49]
 v_pk_fma_f32 v[64:65], v[64:65], s[22:23], s[22:23]
 v_pk_mul_f32 v[6:7], v[50:51], v[50:51]
 v_pk_fma_f32 v[66:67], v[66:67], s[22:23], s[22:23]
 v_pk_fma_f32 v[4:5], v[52:53], v[52:53], v[4:5]
 v_pk_fma_f32 v[68:69], v[68:69], s[22:23], s[22:23]
 v_pk_fma_f32 v[6:7], v[54:55], v[54:55], v[6:7]
 v_pk_fma_f32 v[70:71], v[70:71], s[22:23], s[22:23]
 v_pk_fma_f32 v[4:5], v[56:57], v[56:57], v[4:5]
 v_pk_fma_f32 v[72:73], v[72:73], s[22:23], s[22:23]
 v_pk_fma_f32 v[6:7], v[58:59], v[58:59], v[6:7]
 v_pk_fma_f32 v[74:75], v[74:75], s[22:23], s[22:23]
 v_pk_fma_f32 v[4:5], v[60:61], v[60:61], v[4:5]
 v_pk_fma_f32 v[76:77], v[76:77], s[22:23], s[22:23]
 v_pk_fma_f32 v[6:7], v[62:63], v[62:63], v[6:7]
 v_pk_fma_f32 v[78:79], v[78:79], s[22:23], s[22:23]
 v_pk_fma_f32 v[80:81], v[16:17], v[16:17], s[20:21]
 v_pk_fma_f32 v[82:83], v[18:19], v[18:19], s[20:21]
 v_pk_fma_f32 v[84:85], v[20:21], v[20:21], s[20:21]
 v_pk_fma_f32 v[86:87], v[22:23], v[22:23], s[20:21]
 v_pk_fma_f32 v[88:89], v[24:25], v[24:25], s[20:21]
 v_pk_fma_f32 v[90:91], v[26:27], v[26:27], s[20:21]
 v_pk_fma_f32 v[92:93], v[28:29], v[28:29], s[20:21]
 v_pk_fma_f32 v[94:95], v[30:31], v[30:31], s[20:21]
 v_pk_mul_f32 v[80:81], v[80:81], v[16:17] neg_lo:[1,0] neg_hi:[1,0]
 v_pk_mul_f32 v[82:83], v[82:83], v[18:19] neg_lo:[1,0] neg_hi:[1,0]
 v_pk_mul_f32 v[84:85], v[84:85], v[20:21] neg_lo:[1,0] neg_hi:[1,0]
 v_pk_mul_f32 v[86:87], v[86:87], v[22:23] neg_lo:[1,0] neg_hi:[1,0]
 v_pk_mul_f32 v[88:89], v[88:89], v[24:25] neg_lo:[1,0] neg_hi:[1,0]
 v_pk_mul_f32 v[90:91], v[90:91], v[26:27] neg_lo:[1,0] neg_hi:[1,0]
 v_pk_mul_f32 v[92:93], v[92:93], v[28:29] neg_lo:[1,0] neg_hi:[1,0]
 v_pk_mul_f32 v[94:95], v[94:95], v[30:31] neg_lo:[1,0] neg_hi:[1,0]
 v_mfma_f32_16x16x32_bf16 v[32:35], a[192:195], a[0:3], 0
 s_mov_b32 s34, 0xc0000
 v_exp_f32 v80, v80
 v_mfma_f32_16x16x32_bf16 v[32:35], a[196:199], a[4:7], v[32:35]
 ds_read_b128 v[144:147], v2 offset:4096
 v_add_f32_dpp v4, v4, v4 row_ror:8 row_mask:0xf bank_mask:0x3
 v_mfma_f32_16x16x32_bf16 v[32:35], a[200:203], a[8:11], v[32:35]
 s_add_u32 s30, s30, 0x4000
 v_exp_f32 v81, v81
 v_mfma_f32_16x16x32_bf16 v[32:35], a[204:207], a[12:15], v[32:35]
 ds_read_b128 v[148:151], v2 offset:5120
 v_add_f32_dpp v5, v5, v5 row_ror:8 row_mask:0xf bank_mask:0x3
 v_mfma_f32_16x16x32_bf16 v[36:39], a[204:207], a[60:63], 0
 s_add_u32 s31, s31, 0x4000
 v_exp_f32 v82, v82
 v_mfma_f32_16x16x32_bf16 v[36:39], a[200:203], a[56:59], v[36:39]
 ds_read_b128 v[152:155], v2 offset:6144
 v_add_f32_dpp v4, v6, v6 row_ror:8 row_mask:0xf bank_mask:0xc
 v_mfma_f32_16x16x32_bf16 v[36:39], a[196:199], a[52:55], v[36:39]
 s_add_u32 s40, s40, 24576
 v_exp_f32 v83, v83
 v_mfma_f32_16x16x32_bf16 v[36:39], a[192:195], a[48:51], v[36:39]
 ds_read_b128 v[156:159], v2 offset:7168
 v_add_f32_dpp v5, v7, v7 row_ror:8 row_mask:0xf bank_mask:0xc
 v_mfma_f32_16x16x32_bf16 v[40:43], a[192:195], a[96:99], 0
 s_cmp_eq_u32 s40, s41
 v_exp_f32 v84, v84
 v_mfma_f32_16x16x32_bf16 v[40:43], a[196:199], a[100:103], v[40:43]
 v_exp_f32 v85, v85
 v_mfma_f32_16x16x32_bf16 v[40:43], a[200:203], a[104:107], v[40:43]
 s_cselect_b32 s40, s24, s40
 v_exp_f32 v86, v86
 v_mfma_f32_16x16x32_bf16 v[40:43], a[204:207], a[108:111], v[40:43]
 v_exp_f32 v87, v87
 v_mfma_f32_16x16x32_bf16 v[44:47], a[204:207], v[172:175], 0
 s_add_u32 s17, s17, 0x5400
 v_exp_f32 v88, v88
 v_mfma_f32_16x16x32_bf16 v[44:47], a[200:203], v[168:171], v[44:47]
 v_exp_f32 v89, v89
 v_mfma_f32_16x16x32_bf16 v[44:47], a[196:199], v[164:167], v[44:47]
 s_add_u32 m0, s40, 0
 v_exp_f32 v90, v90
 v_mfma_f32_16x16x32_bf16 v[44:47], a[192:195], v[160:163], v[44:47]
 s_waitcnt lgkmcnt(0)
 v_exp_f32 v91, v91
 v_mfma_f32_16x16x32_bf16 v[32:35], v[144:147], a[16:19], v[32:35]
 v_exp_f32 v92, v92
 v_mfma_f32_16x16x32_bf16 v[32:35], v[148:151], a[20:23], v[32:35]
 ds_read_b128 a[192:195], v2 offset:8192
 v_add_f32_dpp v4, v4, v4 row_shl:4 row_mask:0xf bank_mask:0x5
 v_mfma_f32_16x16x32_bf16 v[32:35], v[152:155], a[24:27], v[32:35]
 v_exp_f32 v93, v93
 v_mfma_f32_16x16x32_bf16 v[32:35], v[156:159], a[28:31], v[32:35]
 ds_read_b128 a[196:199], v2 offset:9216
 v_add_f32_dpp v4, v5, v5 row_shr:4 row_mask:0xf bank_mask:0xa
 v_mfma_f32_16x16x32_bf16 v[36:39], v[156:159], a[76:79], v[36:39]
 v_exp_f32 v94, v94
 v_mfma_f32_16x16x32_bf16 v[36:39], v[152:155], a[72:75], v[36:39]
 ds_read_b128 a[200:203], v2 offset:10240
 v_add_f32_dpp v4, v4, v4 quad_perm:[2,3,0,1] row_mask:0xf bank_mask:0xf
 v_mfma_f32_16x16x32_bf16 v[36:39], v[148:151], a[68:71], v[36:39]
 v_exp_f32 v95, v95
 v_mfma_f32_16x16x32_bf16 v[36:39], v[144:147], a[64:67], v[36:39]
 ds_read_b128 a[204:207], v2 offset:11264
 v_add_f32_dpp v4, v4, v4 quad_perm:[1,0,3,2] row_mask:0xf bank_mask:0xf
 v_mfma_f32_16x16x32_bf16 v[40:43], v[144:147], a[112:115], v[40:43]
 v_rcp_f32 v64, v64
 v_mfma_f32_16x16x32_bf16 v[40:43], v[148:151], a[116:119], v[40:43]
 v_rcp_f32 v65, v65
 v_mfma_f32_16x16x32_bf16 v[40:43], v[152:155], a[120:123], v[40:43]
 ds_write_b32 v3, v4 offset:1280
 v_add_u32 v3, 1536, v3
 v_mfma_f32_16x16x32_bf16 v[40:43], v[156:159], a[124:127], v[40:43]
 v_rcp_f32 v66, v66
 v_mfma_f32_16x16x32_bf16 v[44:47], v[156:159], v[188:191], v[44:47]
 v_rcp_f32 v67, v67
 v_mfma_f32_16x16x32_bf16 v[44:47], v[152:155], v[184:187], v[44:47]
 v_rcp_f32 v68, v68
 v_mfma_f32_16x16x32_bf16 v[44:47], v[148:151], v[180:183], v[44:47]
 v_rcp_f32 v69, v69
 v_mfma_f32_16x16x32_bf16 v[44:47], v[144:147], v[176:179], v[44:47]
 s_waitcnt lgkmcnt(1)
 v_rcp_f32 v70, v70
 v_mfma_f32_16x16x32_bf16 v[32:35], a[192:195], a[32:35], v[32:35]
 v_rcp_f32 v71, v71
 v_mfma_f32_16x16x32_bf16 v[32:35], a[196:199], a[36:39], v[32:35]
 ds_read_b128 v[144:147], v2 offset:12288
 v_cvt_pk_bf16_f32 v114, v48, v49
 v_mfma_f32_16x16x32_bf16 v[32:35], a[200:203], a[40:43], v[32:35]
 s_waitcnt vmcnt(10)
 v_rcp_f32 v72, v72
 v_mfma_f32_16x16x32_bf16 v[32:35], a[204:207], a[44:47], v[32:35]
 s_barrier
 ds_read_b128 v[148:151], v2 offset:13312
 v_cvt_pk_bf16_f32 v115, v50, v51
 v_mfma_f32_16x16x32_bf16 v[36:39], a[204:207], a[92:95], v[36:39]
 v_rcp_f32 v73, v73
 v_mfma_f32_16x16x32_bf16 v[36:39], a[200:203], a[88:91], v[36:39]
 ds_read_b128 v[152:155], v2 offset:14336
 v_cvt_pk_bf16_f32 v118, v52, v53
 v_mfma_f32_16x16x32_bf16 v[36:39], a[196:199], a[84:87], v[36:39]
 v_rcp_f32 v74, v74
 v_mfma_f32_16x16x32_bf16 v[36:39], a[192:195], a[80:83], v[36:39]
 ds_read_b128 v[156:159], v2 offset:15360
 v_cvt_pk_bf16_f32 v119, v54, v55
 v_mfma_f32_16x16x32_bf16 v[40:43], a[192:195], a[128:131], v[40:43]
 v_rcp_f32 v75, v75
 v_mfma_f32_16x16x32_bf16 v[40:43], a[196:199], a[132:135], v[40:43]
 v_cvt_pk_bf16_f32 v122, v56, v57
 v_cvt_pk_bf16_f32 v123, v58, v59
 v_mfma_f32_16x16x32_bf16 v[40:43], a[200:203], a[136:139], v[40:43]
 v_rcp_f32 v76, v76
 v_mfma_f32_16x16x32_bf16 v[40:43], a[204:207], a[140:143], v[40:43]
 v_cvt_pk_bf16_f32 v126, v60, v61
 v_cvt_pk_bf16_f32 v127, v62, v63
 v_mfma_f32_16x16x32_bf16 v[44:47], a[204:207], v[204:207], v[44:47]
 v_rcp_f32 v77, v77
 v_mfma_f32_16x16x32_bf16 v[44:47], a[200:203], v[200:203], v[44:47]
 v_rcp_f32 v78, v78
 v_mfma_f32_16x16x32_bf16 v[44:47], a[196:199], v[196:199], v[44:47]
 s_waitcnt lgkmcnt(0)
 v_rcp_f32 v79, v79
 v_mfma_f32_16x16x32_bf16 v[44:47], a[192:195], v[192:195], v[44:47]
 buffer_store_dwordx4 v[112:115], v0, s[32:35], s28 offen sc1
 buffer_load_dwordx4 v0, s[36:39], s17 offen offset:0 sc1 lds
 buffer_store_dwordx4 v[116:119], v0, s[32:35], s29 offen sc1
 buffer_load_dwordx4 v0, s[36:39], s17 offen offset:1024 sc1 lds
 buffer_load_dwordx4 v0, s[36:39], s17 offen offset:2048 sc1 lds
 v_pk_mul_f32 v[64:65], v[64:65], v[96:97]
 v_pk_mul_f32 v[66:67], v[66:67], v[98:99]
 v_pk_mul_f32 v[68:69], v[68:69], v[100:101]
 v_pk_mul_f32 v[70:71], v[70:71], v[102:103]
 v_pk_mul_f32 v[72:73], v[72:73], v[104:105]
 v_pk_mul_f32 v[74:75], v[74:75], v[106:107]
 v_pk_mul_f32 v[76:77], v[76:77], v[108:109]
 v_pk_mul_f32 v[78:79], v[78:79], v[110:111]
 v_pk_mul_f32 v[4:5], v[64:65], v[64:65]
 v_pk_fma_f32 v[80:81], v[80:81], s[22:23], s[22:23]
 v_pk_mul_f32 v[6:7], v[66:67], v[66:67]
 v_pk_fma_f32 v[82:83], v[82:83], s[22:23], s[22:23]
 v_pk_fma_f32 v[4:5], v[68:69], v[68:69], v[4:5]
 v_pk_fma_f32 v[84:85], v[84:85], s[22:23], s[22:23]
 v_pk_fma_f32 v[6:7], v[70:71], v[70:71], v[6:7]
 v_pk_fma_f32 v[86:87], v[86:87], s[22:23], s[22:23]
 v_pk_fma_f32 v[4:5], v[72:73], v[72:73], v[4:5]
 v_pk_fma_f32 v[88:89], v[88:89], s[22:23], s[22:23]
 v_pk_fma_f32 v[6:7], v[74:75], v[74:75], v[6:7]
 v_pk_fma_f32 v[90:91], v[90:91], s[22:23], s[22:23]
 v_pk_fma_f32 v[4:5], v[76:77], v[76:77], v[4:5]
 v_pk_fma_f32 v[92:93], v[92:93], s[22:23], s[22:23]
 v_pk_fma_f32 v[6:7], v[78:79], v[78:79], v[6:7]
 v_pk_fma_f32 v[94:95], v[94:95], s[22:23], s[22:23]
 v_pk_fma_f32 v[96:97], v[32:33], v[32:33], s[20:21]
 v_pk_fma_f32 v[98:99], v[34:35], v[34:35], s[20:21]
 v_pk_fma_f32 v[100:101], v[36:37], v[36:37], s[20:21]
 v_pk_fma_f32 v[102:103], v[38:39], v[38:39], s[20:21]
 v_pk_fma_f32 v[104:105], v[40:41], v[40:41], s[20:21]
 v_pk_fma_f32 v[106:107], v[42:43], v[42:43], s[20:21]
 v_pk_fma_f32 v[108:109], v[44:45], v[44:45], s[20:21]
 v_pk_fma_f32 v[110:111], v[46:47], v[46:47], s[20:21]
 v_pk_mul_f32 v[96:97], v[96:97], v[32:33] neg_lo:[1,0] neg_hi:[1,0]
 v_pk_mul_f32 v[98:99], v[98:99], v[34:35] neg_lo:[1,0] neg_hi:[1,0]
 v_pk_mul_f32 v[100:101], v[100:101], v[36:37] neg_lo:[1,0] neg_hi:[1,0]
 v_pk_mul_f32 v[102:103], v[102:103], v[38:39] neg_lo:[1,0] neg_hi:[1,0]
 v_pk_mul_f32 v[104:105], v[104:105], v[40:41] neg_lo:[1,0] neg_hi:[1,0]
 v_pk_mul_f32 v[106:107], v[106:107], v[42:43] neg_lo:[1,0] neg_hi:[1,0]
 v_pk_mul_f32 v[108:109], v[108:109], v[44:45] neg_lo:[1,0] neg_hi:[1,0]
 v_pk_mul_f32 v[110:111], v[110:111], v[46:47] neg_lo:[1,0] neg_hi:[1,0]
 v_mfma_f32_16x16x32_bf16 v[48:51], v[144:147], a[0:3], 0
 s_add_u32 s28, s28, 0x4000
 v_exp_f32 v96, v96
 v_mfma_f32_16x16x32_bf16 v[48:51], v[148:151], a[4:7], v[48:51]
 ds_read_b128 a[192:195], v2 offset:16384
 v_add_f32_dpp v4, v4, v4 row_ror:8 row_mask:0xf bank_mask:0x3
 v_mfma_f32_16x16x32_bf16 v[48:51], v[152:155], a[8:11], v[48:51]
 s_add_u32 s29, s29, 0x4000
 v_exp_f32 v97, v97
 v_mfma_f32_16x16x32_bf16 v[48:51], v[156:159], a[12:15], v[48:51]
 ds_read_b128 a[196:199], v2 offset:17408
 v_add_f32_dpp v5, v5, v5 row_ror:8 row_mask:0xf bank_mask:0x3
 v_mfma_f32_16x16x32_bf16 v[52:55], v[156:159], a[60:63], 0
 s_add_u32 s42, s42, 24576
 v_exp_f32 v98, v98
 v_mfma_f32_16x16x32_bf16 v[52:55], v[152:155], a[56:59], v[52:55]
 ds_read_b128 a[200:203], v2 offset:18432
 v_add_f32_dpp v4, v6, v6 row_ror:8 row_mask:0xf bank_mask:0xc
 v_mfma_f32_16x16x32_bf16 v[52:55], v[148:151], a[52:55], v[52:55]
 s_cmp_eq_u32 s42, 98304
 v_exp_f32 v99, v99
 v_mfma_f32_16x16x32_bf16 v[52:55], v[144:147], a[48:51], v[52:55]
 ds_read_b128 a[204:207], v2 offset:19456
 v_add_f32_dpp v5, v7, v7 row_ror:8 row_mask:0xf bank_mask:0xc
 v_mfma_f32_16x16x32_bf16 v[56:59], v[144:147], a[96:99], 0
 s_cselect_b32 s42, 0, s42
 v_exp_f32 v100, v100
 v_mfma_f32_16x16x32_bf16 v[56:59], v[148:151], a[100:103], v[56:59]
 v_exp_f32 v101, v101
 v_mfma_f32_16x16x32_bf16 v[56:59], v[152:155], a[104:107], v[56:59]
 s_add_u32 s17, s17, 0xc00
 v_exp_f32 v102, v102
 v_mfma_f32_16x16x32_bf16 v[56:59], v[156:159], a[108:111], v[56:59]
 v_exp_f32 v103, v103
 v_mfma_f32_16x16x32_bf16 v[60:63], v[156:159], v[172:175], 0
 s_add_u32 m0, s40, 3072
 v_exp_f32 v104, v104
 v_mfma_f32_16x16x32_bf16 v[60:63], v[152:155], v[168:171], v[60:63]
 v_exp_f32 v105, v105
 v_mfma_f32_16x16x32_bf16 v[60:63], v[148:151], v[164:167], v[60:63]
 s_sub_u32 s19, s19, 1
 v_exp_f32 v106, v106
 v_mfma_f32_16x16x32_bf16 v[60:63], v[144:147], v[160:163], v[60:63]
 s_waitcnt lgkmcnt(0)
 v_exp_f32 v107, v107
 v_mfma_f32_16x16x32_bf16 v[48:51], a[192:195], a[16:19], v[48:51]
 s_cmp_lg_u32 s19, 0
 v_exp_f32 v108, v108
 v_mfma_f32_16x16x32_bf16 v[48:51], a[196:199], a[20:23], v[48:51]
 ds_read_b128 v[144:147], v2 offset:20480
 v_add_f32_dpp v4, v4, v4 row_shl:4 row_mask:0xf bank_mask:0x5
 v_mfma_f32_16x16x32_bf16 v[48:51], a[200:203], a[24:27], v[48:51]
 v_exp_f32 v109, v109
 v_mfma_f32_16x16x32_bf16 v[48:51], a[204:207], a[28:31], v[48:51]
 ds_read_b128 v[148:151], v2 offset:21504
 v_add_f32_dpp v4, v5, v5 row_shr:4 row_mask:0xf bank_mask:0xa
 v_mfma_f32_16x16x32_bf16 v[52:55], a[204:207], a[76:79], v[52:55]
 v_exp_f32 v110, v110
 v_mfma_f32_16x16x32_bf16 v[52:55], a[200:203], a[72:75], v[52:55]
 ds_read_b128 v[152:155], v2 offset:22528
 v_add_f32_dpp v4, v4, v4 quad_perm:[2,3,0,1] row_mask:0xf bank_mask:0xf
 v_mfma_f32_16x16x32_bf16 v[52:55], a[196:199], a[68:71], v[52:55]
 v_exp_f32 v111, v111
 v_mfma_f32_16x16x32_bf16 v[52:55], a[192:195], a[64:67], v[52:55]
 ds_read_b128 v[156:159], v2 offset:23552
 v_add_f32_dpp v4, v4, v4 quad_perm:[1,0,3,2] row_mask:0xf bank_mask:0xf
 v_mfma_f32_16x16x32_bf16 v[56:59], a[192:195], a[112:115], v[56:59]
 v_rcp_f32 v80, v80
 v_mfma_f32_16x16x32_bf16 v[56:59], a[196:199], a[116:119], v[56:59]
 v_rcp_f32 v81, v81
 v_mfma_f32_16x16x32_bf16 v[56:59], a[200:203], a[120:123], v[56:59]
 ds_write_b32 v3, v4 offset:0
 v_add_u32 v2, s42, v0
 v_mfma_f32_16x16x32_bf16 v[56:59], a[204:207], a[124:127], v[56:59]
 v_rcp_f32 v82, v82
 v_mfma_f32_16x16x32_bf16 v[60:63], a[204:207], v[188:191], v[60:63]
 v_rcp_f32 v83, v83
 v_mfma_f32_16x16x32_bf16 v[60:63], a[200:203], v[184:187], v[60:63]
 v_rcp_f32 v84, v84
 v_mfma_f32_16x16x32_bf16 v[60:63], a[196:199], v[180:183], v[60:63]
 v_rcp_f32 v85, v85
 v_mfma_f32_16x16x32_bf16 v[60:63], a[192:195], v[176:179], v[60:63]
 s_waitcnt lgkmcnt(1)
 v_rcp_f32 v86, v86
 v_mfma_f32_16x16x32_bf16 v[48:51], v[144:147], a[32:35], v[48:51]
 v_rcp_f32 v87, v87
 v_mfma_f32_16x16x32_bf16 v[48:51], v[148:151], a[36:39], v[48:51]
 ds_read_b128 a[192:195], v2 offset:0
 v_cvt_pk_bf16_f32 v112, v64, v65
 v_mfma_f32_16x16x32_bf16 v[48:51], v[152:155], a[40:43], v[48:51]
 v_rcp_f32 v88, v88
 v_mfma_f32_16x16x32_bf16 v[48:51], v[156:159], a[44:47], v[48:51]
 ds_read_b128 a[196:199], v2 offset:1024
 v_cvt_pk_bf16_f32 v113, v66, v67
 v_mfma_f32_16x16x32_bf16 v[52:55], v[156:159], a[92:95], v[52:55]
 v_rcp_f32 v89, v89
 v_mfma_f32_16x16x32_bf16 v[52:55], v[152:155], a[88:91], v[52:55]
 ds_read_b128 a[200:203], v2 offset:2048
 v_cvt_pk_bf16_f32 v116, v68, v69
 v_mfma_f32_16x16x32_bf16 v[52:55], v[148:151], a[84:87], v[52:55]
 v_rcp_f32 v90, v90
 v_mfma_f32_16x16x32_bf16 v[52:55], v[144:147], a[80:83], v[52:55]
 ds_read_b128 a[204:207], v2 offset:3072
 v_cvt_pk_bf16_f32 v117, v70, v71
 v_mfma_f32_16x16x32_bf16 v[56:59], v[144:147], a[128:131], v[56:59]
 v_rcp_f32 v91, v91
 v_mfma_f32_16x16x32_bf16 v[56:59], v[148:151], a[132:135], v[56:59]
 v_cvt_pk_bf16_f32 v128, v72, v73
 v_cvt_pk_bf16_f32 v129, v74, v75
 v_mfma_f32_16x16x32_bf16 v[56:59], v[152:155], a[136:139], v[56:59]
 v_rcp_f32 v92, v92
 v_mfma_f32_16x16x32_bf16 v[56:59], v[156:159], a[140:143], v[56:59]
 v_cvt_pk_bf16_f32 v132, v76, v77
 v_cvt_pk_bf16_f32 v133, v78, v79
 v_mfma_f32_16x16x32_bf16 v[60:63], v[156:159], v[204:207], v[60:63]
 v_rcp_f32 v93, v93
 v_mfma_f32_16x16x32_bf16 v[60:63], v[152:155], v[200:203], v[60:63]
 v_rcp_f32 v94, v94
 v_mfma_f32_16x16x32_bf16 v[60:63], v[148:151], v[196:199], v[60:63]
 s_waitcnt lgkmcnt(0)
 v_rcp_f32_e64 v95, v95
 v_mfma_f32_16x16x32_bf16 v[60:63], v[144:147], v[192:195], v[60:63]
 buffer_store_dwordx4 v[120:123], v0, s[32:35], s30 offen sc1
 buffer_load_dwordx4 v0, s[36:39], s17 offen offset:0 sc1 lds
 buffer_store_dwordx4 v[124:127], v0, s[32:35], s31 offen sc1
 buffer_load_dwordx4 v0, s[36:39], s17 offen offset:1024 sc1 lds
 buffer_load_dwordx4 v0, s[36:39], s17 offen offset:2048 sc1 lds
 v_pk_mul_f32 v[80:81], v[80:81], v[16:17]
 v_pk_mul_f32 v[82:83], v[82:83], v[18:19]
 v_pk_mul_f32 v[84:85], v[84:85], v[20:21]
 v_pk_mul_f32 v[86:87], v[86:87], v[22:23]
 v_pk_mul_f32 v[88:89], v[88:89], v[24:25]
 v_pk_mul_f32 v[90:91], v[90:91], v[26:27]
 v_pk_mul_f32 v[92:93], v[92:93], v[28:29]
 v_pk_mul_f32 v[94:95], v[94:95], v[30:31]
 v_pk_mul_f32 v[4:5], v[80:81], v[80:81]
 v_pk_fma_f32 v[96:97], v[96:97], s[22:23], s[22:23]
 v_pk_mul_f32 v[6:7], v[82:83], v[82:83]
 v_pk_fma_f32 v[98:99], v[98:99], s[22:23], s[22:23]
 v_pk_fma_f32 v[4:5], v[84:85], v[84:85], v[4:5]
 v_pk_fma_f32 v[100:101], v[100:101], s[22:23], s[22:23]
 v_pk_fma_f32 v[6:7], v[86:87], v[86:87], v[6:7]
 v_pk_fma_f32 v[102:103], v[102:103], s[22:23], s[22:23]
 v_pk_fma_f32 v[4:5], v[88:89], v[88:89], v[4:5]
 v_pk_fma_f32 v[104:105], v[104:105], s[22:23], s[22:23]
 v_pk_fma_f32 v[6:7], v[90:91], v[90:91], v[6:7]
 v_pk_fma_f32 v[106:107], v[106:107], s[22:23], s[22:23]
 v_pk_fma_f32 v[4:5], v[92:93], v[92:93], v[4:5]
 v_pk_fma_f32 v[108:109], v[108:109], s[22:23], s[22:23]
 v_pk_fma_f32 v[6:7], v[94:95], v[94:95], v[6:7]
 v_pk_fma_f32 v[110:111], v[110:111], s[22:23], s[22:23]
 v_pk_fma_f32 v[16:17], v[48:49], v[48:49], s[20:21]
 v_pk_fma_f32 v[18:19], v[50:51], v[50:51], s[20:21]
 v_pk_fma_f32 v[20:21], v[52:53], v[52:53], s[20:21]
 v_pk_fma_f32 v[22:23], v[54:55], v[54:55], s[20:21]
 v_pk_fma_f32 v[24:25], v[56:57], v[56:57], s[20:21]
 v_pk_fma_f32 v[26:27], v[58:59], v[58:59], s[20:21]
 v_pk_fma_f32 v[28:29], v[60:61], v[60:61], s[20:21]
 v_pk_fma_f32 v[30:31], v[62:63], v[62:63], s[20:21]
 v_pk_mul_f32 v[16:17], v[16:17], v[48:49] neg_lo:[1,0] neg_hi:[1,0]
 v_pk_mul_f32 v[18:19], v[18:19], v[50:51] neg_lo:[1,0] neg_hi:[1,0]
 v_pk_mul_f32 v[20:21], v[20:21], v[52:53] neg_lo:[1,0] neg_hi:[1,0]
 v_pk_mul_f32 v[22:23], v[22:23], v[54:55] neg_lo:[1,0] neg_hi:[1,0]
 v_pk_mul_f32 v[24:25], v[24:25], v[56:57] neg_lo:[1,0] neg_hi:[1,0]
 v_pk_mul_f32 v[26:27], v[26:27], v[58:59] neg_lo:[1,0] neg_hi:[1,0]
 v_pk_mul_f32 v[28:29], v[28:29], v[60:61] neg_lo:[1,0] neg_hi:[1,0]
 v_pk_mul_f32 v[30:31], v[30:31], v[62:63] neg_lo:[1,0] neg_hi:[1,0]
 s_cbranch_scc1 L_k1_loop3
 s_cmp_lg_u32 s43, 0
 s_cbranch_scc1 L_k1_tail
 s_mov_b32 s43, 1
 s_mov_b32 s19, 1
 s_getpc_b64 s[64:65]
L_pc6:
 s_add_u32 s64, s64, L_k1_tail-L_pc6
 s_addc_u32 s65, s65, 0
 v_and_b32 v64, 0xf0, v0
 v_lshl_add_u32 v64, v64, 2, s95
 v_min_u32 v64, L_end-L_k1_tail, v64
 v_add_co_u32 v64, vcc, s64, v64
 v_mov_b32 v65, s65
 v_mov_b32 v65, s65
 v_addc_co_u32 v65, vcc, 0, v65, vcc
 global_load_dword v1, v[64:65], off
 s_branch L_k1_loop3
L_k1_tail:
 v_subrev_u32 v3, 24576, v3
 v_exp_f32 v16, v16
 v_exp_f32 v17, v17
 v_add_f32_dpp v4, v4, v4 row_ror:8 row_mask:0xf bank_mask:0x3
 v_exp_f32 v18, v18
 v_exp_f32 v19, v19
 v_add_f32_dpp v5, v5, v5 row_ror:8 row_mask:0xf bank_mask:0x3
 v_exp_f32 v20, v20
 v_exp_f32 v21, v21
 v_add_f32_dpp v4, v6, v6 row_ror:8 row_mask:0xf bank_mask:0xc
 v_exp_f32 v22, v22
 v_exp_f32 v23, v23
 v_add_f32_dpp v5, v7, v7 row_ror:8 row_mask:0xf bank_mask:0xc
 v_exp_f32 v24, v24
 v_exp_f32 v25, v25
 v_add_f32_dpp v4, v4, v4 row_shl:4 row_mask:0xf bank_mask:0x5
 v_exp_f32 v26, v26
 v_exp_f32 v27, v27
 v_add_f32_dpp v4, v5, v5 row_shr:4 row_mask:0xf bank_mask:0xa
 v_exp_f32 v28, v28
 v_exp_f32 v29, v29
 v_add_f32_dpp v4, v4, v4 quad_perm:[2,3,0,1] row_mask:0xf bank_mask:0xf
 v_exp_f32 v30, v30
 v_exp_f32 v31, v31
 v_add_f32_dpp v4, v4, v4 quad_perm:[1,0,3,2] row_mask:0xf bank_mask:0xf
 ds_write_b32 v3, v4 offset:256
 v_rcp_f32 v96, v96
 v_rcp_f32 v97, v97
 v_rcp_f32 v98, v98
 v_rcp_f32 v99, v99
 v_rcp_f32 v100, v100
 v_rcp_f32 v101, v101
 v_rcp_f32 v102, v102
 v_rcp_f32 v103, v103
 v_rcp_f32 v104, v104
 v_rcp_f32 v105, v105
 v_rcp_f32 v106, v106
 v_rcp_f32 v107, v107
 v_rcp_f32 v108, v108
 v_rcp_f32 v109, v109
 v_rcp_f32 v110, v110
 v_rcp_f32 v111, v111
 v_pk_fma_f32 v[16:17], v[16:17], s[22:23], s[22:23]
 v_pk_fma_f32 v[18:19], v[18:19], s[22:23], s[22:23]
 v_pk_fma_f32 v[20:21], v[20:21], s[22:23], s[22:23]
 v_pk_fma_f32 v[22:23], v[22:23], s[22:23], s[22:23]
 v_pk_fma_f32 v[24:25], v[24:25], s[22:23], s[22:23]
 v_pk_fma_f32 v[26:27], v[26:27], s[22:23], s[22:23]
 v_pk_fma_f32 v[28:29], v[28:29], s[22:23], s[22:23]
 v_pk_fma_f32 v[30:31], v[30:31], s[22:23], s[22:23]
 v_pk_mul_f32 v[96:97], v[96:97], v[32:33]
 v_pk_mul_f32 v[98:99], v[98:99], v[34:35]
 v_pk_mul_f32 v[100:101], v[100:101], v[36:37]
 v_pk_mul_f32 v[102:103], v[102:103], v[38:39]
 v_pk_mul_f32 v[104:105], v[104:105], v[40:41]
 v_pk_mul_f32 v[106:107], v[106:107], v[42:43]
 v_pk_mul_f32 v[108:109], v[108:109], v[44:45]
 v_pk_mul_f32 v[110:111], v[110:111], v[46:47]
 v_pk_mul_f32 v[4:5], v[96:97], v[96:97]
 v_pk_mul_f32 v[6:7], v[98:99], v[98:99]
 v_pk_fma_f32 v[4:5], v[100:101], v[100:101], v[4:5]
 v_pk_fma_f32 v[6:7], v[102:103], v[102:103], v[6:7]
 v_pk_fma_f32 v[4:5], v[104:105], v[104:105], v[4:5]
 v_pk_fma_f32 v[6:7], v[106:107], v[106:107], v[6:7]
 v_pk_fma_f32 v[4:5], v[108:109], v[108:109], v[4:5]
 v_pk_fma_f32 v[6:7], v[110:111], v[110:111], v[6:7]
 v_rcp_f32 v16, v16
 v_rcp_f32 v17, v17
 v_add_f32_dpp v4, v4, v4 row_ror:8 row_mask:0xf bank_mask:0x3
 v_rcp_f32 v18, v18
 v_rcp_f32 v19, v19
 v_add_f32_dpp v5, v5, v5 row_ror:8 row_mask:0xf bank_mask:0x3
 v_rcp_f32 v20, v20
 v_rcp_f32 v21, v21
 v_add_f32_dpp v4, v6, v6 row_ror:8 row_mask:0xf bank_mask:0xc
 v_rcp_f32 v22, v22
 v_rcp_f32 v23, v23
 v_add_f32_dpp v5, v7, v7 row_ror:8 row_mask:0xf bank_mask:0xc
 v_rcp_f32 v24, v24
 v_rcp_f32 v25, v25
 v_add_f32_dpp v4, v4, v4 row_shl:4 row_mask:0xf bank_mask:0x5
 v_rcp_f32 v26, v26
 v_rcp_f32 v27, v27
 v_add_f32_dpp v4, v5, v5 row_shr:4 row_mask:0xf bank_mask:0xa
 v_rcp_f32 v28, v28
 v_rcp_f32 v29, v29
 v_add_f32_dpp v4, v4, v4 quad_perm:[2,3,0,1] row_mask:0xf bank_mask:0xf
 v_rcp_f32 v30, v30
 v_rcp_f32 v31, v31
 v_add_f32_dpp v4, v4, v4 quad_perm:[1,0,3,2] row_mask:0xf bank_mask:0xf
 ds_write_b32 v3, v4 offset:512
 v_pk_mul_f32 v[16:17], v[16:17], v[48:49]
 v_pk_mul_f32 v[18:19], v[18:19], v[50:51]
 v_pk_mul_f32 v[20:21], v[20:21], v[52:53]
 v_pk_mul_f32 v[22:23], v[22:23], v[54:55]
 v_pk_mul_f32 v[24:25], v[24:25], v[56:57]
 v_pk_mul_f32 v[26:27], v[26:27], v[58:59]
 v_pk_mul_f32 v[28:29], v[28:29], v[60:61]
 v_pk_mul_f32 v[30:31], v[30:31], v[62:63]
 v_pk_mul_f32 v[4:5], v[16:17], v[16:17]
 v_pk_mul_f32 v[6:7], v[18:19], v[18:19]
 v_pk_fma_f32 v[4:5], v[20:21], v[20:21], v[4:5]
 v_pk_fma_f32 v[6:7], v[22:23], v[22:23], v[6:7]
 v_pk_fma_f32 v[4:5], v[24:25], v[24:25], v[4:5]
 v_pk_fma_f32 v[6:7], v[26:27], v[26:27], v[6:7]
 v_pk_fma_f32 v[4:5], v[28:29], v[28:29], v[4:5]
 v_pk_fma_f32 v[6:7], v[30:31], v[30:31], v[6:7]
 v_cvt_pk_bf16_f32 v34, v80, v81
 v_cvt_pk_bf16_f32 v35, v82, v83
 v_add_f32_dpp v4, v4, v4 row_ror:8 row_mask:0xf bank_mask:0x3
 v_cvt_pk_bf16_f32 v38, v84, v85
 v_cvt_pk_bf16_f32 v39, v86, v87
 v_add_f32_dpp v5, v5, v5 row_ror:8 row_mask:0xf bank_mask:0x3
 v_cvt_pk_bf16_f32 v42, v88, v89
 v_cvt_pk_bf16_f32 v43, v90, v91
 v_add_f32_dpp v4, v6, v6 row_ror:8 row_mask:0xf bank_mask:0xc
 v_cvt_pk_bf16_f32 v46, v92, v93
 v_cvt_pk_bf16_f32 v47, v94, v95
 v_add_f32_dpp v5, v7, v7 row_ror:8 row_mask:0xf bank_mask:0xc
 v_cvt_pk_bf16_f32 v48, v96, v97
 v_cvt_pk_bf16_f32 v49, v98, v99
 v_add_f32_dpp v4, v4, v4 row_shl:4 row_mask:0xf bank_mask:0x5
 v_cvt_pk_bf16_f32 v52, v100, v101
 v_cvt_pk_bf16_f32 v53, v102, v103
 v_add_f32_dpp v4, v5, v5 row_shr:4 row_mask:0xf bank_mask:0xa
 v_cvt_pk_bf16_f32 v56, v104, v105
 v_cvt_pk_bf16_f32 v57, v106, v107
 v_add_f32_dpp v4, v4, v4 quad_perm:[2,3,0,1] row_mask:0xf bank_mask:0xf
 v_cvt_pk_bf16_f32 v60, v108, v109
 v_cvt_pk_bf16_f32 v61, v110, v111
 v_add_f32_dpp v4, v4, v4 quad_perm:[1,0,3,2] row_mask:0xf bank_mask:0xf
 ds_write_b32 v3, v4 offset:768
 s_lshl_b32 s25, s16, 10
 s_add_u32 s25, s25, 0x18300
 v_add_u32 v5, s25, v0
 v_cmp_lt_u32 vcc, 0x18fff, v5
 v_subrev_u32 v7, 24576, v5
 s_waitcnt lgkmcnt(0)
 v_cndmask_b32 v7, v5, v7, vcc
 s_barrier
 ds_read_b128 v[64:67], v5 offset:0
 ds_read_b128 v[68:71], v5 offset:4096
 ds_read_b128 v[72:75], v5 offset:8192
 ds_read_b128 v[76:79], v5 offset:12288
 ds_read_b128 v[80:83], v5 offset:16384
 ds_read_b128 v[84:87], v7 offset:20480
 v_lshrrev_b32 v4, 2, v0
 s_lshl_b32 s25, s16, 8
 v_add_u32 v4, s25, v4
 v_and_b32 v6, 0x38c, v4
 v_bfe_u32 v7, v4, 4, 2
 v_lshl_add_u32 v6, v7, 5, v6
 v_bfe_u32 v7, v4, 6, 1
 v_lshl_add_u32 v6, v7, 4, v6
 s_lshr_b32 s25, s2, 3
 s_and_b32 s25, s25, 1
 s_mul_i32 s25, s25, 6144
 s_add_u32 s26, s25, 3072
 s_waitcnt lgkmcnt(5)
 v_add_f32 v64, v64, v65
 v_add_f32 v66, v66, v67
 v_add_f32 v64, v64, v66
 buffer_atomic_add_f32 v64, v6, s[12:15], s25 offen offset:0 sc1
 s_waitcnt lgkmcnt(4)
 v_add_f32 v68, v68, v69
 v_add_f32 v70, v70, v71
 v_add_f32 v68, v68, v70
 buffer_atomic_add_f32 v68, v6, s[12:15], s25 offen offset:1024 sc1
 s_waitcnt lgkmcnt(3)
 v_add_f32 v72, v72, v73
 v_add_f32 v74, v74, v75
 v_add_f32 v72, v72, v74
 buffer_atomic_add_f32 v72, v6, s[12:15], s25 offen offset:2048 sc1
 s_waitcnt lgkmcnt(2)
 v_add_f32 v76, v76, v77
 v_add_f32 v78, v78, v79
 v_add_f32 v76, v76, v78
 buffer_atomic_add_f32 v76, v6, s[12:15], s26 offen offset:0 sc1
 s_waitcnt lgkmcnt(1)
 v_add_f32 v80, v80, v81
 v_add_f32 v82, v82, v83
 v_add_f32 v80, v80, v82
 buffer_atomic_add_f32 v80, v6, s[12:15], s26 offen offset:1024 sc1
 s_waitcnt lgkmcnt(0)
 v_add_f32 v84, v84, v85
 v_add_f32 v86, v86, v87
 v_add_f32 v84, v84, v86
 buffer_atomic_add_f32 v84, v6, s[12:15], s26 offen offset:2048 sc1
 buffer_load_dword v104, v4, s[52:55], 0 offen offset:0
 buffer_load_dword v105, v4, s[52:55], 0 offen offset:1024
 buffer_load_dword v106, v4, s[52:55], 0 offen offset:2048
 s_add_u32 s26, s18, 128
 s_lshl_b32 s30, s26, 10
 s_add_u32 s30, s30, 0x120000
 buffer_load_dwordx4 v[108:111], v0, s[36:39], s30 offen sc1
 s_add_u32 s30, s30, 0x120000
 s_mul_hi_u32 s25, s26, 0x5555556
 s_and_b32 s26, s26, 1
 s_lshl_b32 s25, s25, 1
 s_add_u32 s25, s25, s26
 s_sub_u32 s25, s25, 2
 s_lshl_b32 s31, s25, 7
 v_cvt_pk_bf16_f32 v50, v16, v17
 v_cvt_pk_bf16_f32 v51, v18, v19
 v_cvt_pk_bf16_f32 v54, v20, v21
 v_cvt_pk_bf16_f32 v55, v22, v23
 v_cvt_pk_bf16_f32 v58, v24, v25
 v_cvt_pk_bf16_f32 v59, v26, v27
 v_cvt_pk_bf16_f32 v62, v28, v29
 v_cvt_pk_bf16_f32 v63, v30, v31
 v_mov_b32 v32, v112
 v_mov_b32 v33, v113
 v_mov_b32 v36, v116
 v_mov_b32 v37, v117
 v_mov_b32 v40, v128
 v_mov_b32 v41, v129
 v_mov_b32 v44, v132
 v_mov_b32 v45, v133
 v_lshrrev_b32 v5, 8, v0
 v_bfe_u32 v7, v0, 4, 3
 v_xor_b32 v7, v7, v5
 v_and_b32 v2, 0xf0, v0
 v_lshlrev_b32 v2, 3, v2
 v_lshl_add_u32 v2, v7, 4, v2
 s_lshl_b32 s25, s16, 11
 s_add_u32 s25, s25, 0x1c000
 v_add_u32 v2, s25, v2
 v_xor_b32 v3, 64, v2
 ds_read_b128 v[64:67], v2 offset:8192
 ds_read_b128 v[68:71], v3 offset:8192
 ds_read_b128 v[72:75], v2 offset:16384
 ds_read_b128 v[76:79], v3 offset:16384
 ds_read_b128 v[80:83], v2 offset:24576
 ds_read_b128 v[84:87], v3 offset:24576
 ds_read_b128 v[88:91], v2 offset:32768
 ds_read_b128 v[92:95], v3 offset:32768
 ds_read_b128 v[96:99], v2 offset:40960
 ds_read_b128 v[100:103], v3 offset:40960
 v_lshrrev_b32 v5, 8, v0
 v_bfe_u32 v7, v0, 6, 2
 v_cmp_eq_u32 vcc, v5, v7
 v_and_b32 v5, 16, v0
 v_mov_b32 v7, 0x3f80
 v_lshlrev_b32 v7, v5, v7
 v_cndmask_b32 v7, 0, v7, vcc
 v_and_b32 v5, 32, v0
 v_cmp_eq_u32 vcc, 0, v5
 v_mov_b32 v24, 0
 v_mov_b32 v25, 0
 v_mov_b32 v28, 0
 v_mov_b32 v29, 0
 v_cndmask_b32 v26, 0, v7, vcc
 v_sub_u32 v27, v7, v26
 s_nop 1
 v_mfma_f32_16x16x32_bf16 a[0:3], v[26:29], a[144:147], 0
 v_mfma_f32_16x16x32_bf16 a[4:7], v[24:27], a[144:147], 0
 v_mfma_f32_16x16x32_bf16 a[8:11], v[26:29], a[148:151], 0
 v_mfma_f32_16x16x32_bf16 a[12:15], v[24:27], a[148:151], 0
 v_mfma_f32_16x16x32_bf16 a[16:19], v[26:29], a[152:155], 0
 v_mfma_f32_16x16x32_bf16 a[20:23], v[24:27], a[152:155], 0
 v_mfma_f32_16x16x32_bf16 a[24:27], v[26:29], a[156:159], 0
 v_mfma_f32_16x16x32_bf16 a[28:31], v[24:27], a[156:159], 0
 v_mfma_f32_16x16x32_bf16 a[32:35], v[26:29], a[160:163], 0
 v_mfma_f32_16x16x32_bf16 a[36:39], v[24:27], a[160:163], 0
 v_mfma_f32_16x16x32_bf16 a[40:43], v[26:29], a[164:167], 0
 v_mfma_f32_16x16x32_bf16 a[44:47], v[24:27], a[164:167], 0
 v_mfma_f32_16x16x32_bf16 a[48:51], v[26:29], a[168:171], 0
 v_mfma_f32_16x16x32_bf16 a[52:55], v[24:27], a[168:171], 0
 v_mfma_f32_16x16x32_bf16 a[56:59], v[26:29], a[172:175], 0
 v_mfma_f32_16x16x32_bf16 a[60:63], v[24:27], a[172:175], 0
 v_mfma_f32_16x16x32_bf16 a[64:67], v[26:29], a[176:179], 0
 v_mfma_f32_16x16x32_bf16 a[68:71], v[24:27], a[176:179], 0
 v_mfma_f32_16x16x32_bf16 a[72:75], v[26:29], a[180:183], 0
 v_mfma_f32_16x16x32_bf16 a[76:79], v[24:27], a[180:183], 0
 v_mfma_f32_16x16x32_bf16 a[80:83], v[26:29], a[184:187], 0
 v_mfma_f32_16x16x32_bf16 a[84:87], v[24:27], a[184:187], 0
 v_mfma_f32_16x16x32_bf16 a[88:91], v[26:29], a[188:191], 0
 v_mfma_f32_16x16x32_bf16 a[92:95], v[24:27], a[188:191], 0
 v_mfma_f32_16x16x32_bf16 a[96:99], v[26:29], a[208:211], 0
 v_mfma_f32_16x16x32_bf16 a[100:103], v[24:27], a[208:211], 0
 v_mfma_f32_16x16x32_bf16 a[104:107], v[26:29], a[212:215], 0
 v_mfma_f32_16x16x32_bf16 a[108:111], v[24:27], a[212:215], 0
 v_mfma_f32_16x16x32_bf16 a[112:115], v[26:29], a[216:219], 0
 v_mfma_f32_16x16x32_bf16 a[116:119], v[24:27], a[216:219], 0
 v_mfma_f32_16x16x32_bf16 a[120:123], v[26:29], a[220:223], 0
 v_mfma_f32_16x16x32_bf16 a[124:127], v[24:27], a[220:223], 0
 v_mfma_f32_16x16x32_bf16 a[128:131], v[26:29], a[224:227], 0
 v_mfma_f32_16x16x32_bf16 a[132:135], v[24:27], a[224:227], 0
 v_mfma_f32_16x16x32_bf16 a[136:139], v[26:29], a[228:231], 0
 v_mfma_f32_16x16x32_bf16 a[140:143], v[24:27], a[228:231], 0
 v_mfma_f32_16x16x32_bf16 a[144:147], v[26:29], a[232:235], 0
 v_mfma_f32_16x16x32_bf16 a[148:151], v[24:27], a[232:235], 0
 v_mfma_f32_16x16x32_bf16 a[152:155], v[26:29], a[236:239], 0
 v_mfma_f32_16x16x32_bf16 a[156:159], v[24:27], a[236:239], 0
 v_mfma_f32_16x16x32_bf16 a[160:163], v[26:29], a[240:243], 0
 v_mfma_f32_16x16x32_bf16 a[164:167], v[24:27], a[240:243], 0
 v_mfma_f32_16x16x32_bf16 a[168:171], v[26:29], a[244:247], 0
 v_mfma_f32_16x16x32_bf16 a[172:175], v[24:27], a[244:247], 0
 v_mfma_f32_16x16x32_bf16 a[176:179], v[26:29], a[248:251], 0
 v_mfma_f32_16x16x32_bf16 a[180:183], v[24:27], a[248:251], 0
 v_mfma_f32_16x16x32_bf16 a[184:187], v[26:29], a[252:255], 0
 v_mfma_f32_16x16x32_bf16 a[188:191], v[24:27], a[252:255], 0
 s_waitcnt vmcnt(4)
 s_barrier
 s_cmp_eq_u32 s16, 1
 s_cselect_b32 s25, 0, 0x100000
 s_mov_b32 s26, 0x3880
 v_mov_b32 v6, 1
 v_mov_b32 v7, s25
 s_mov_b64 exec, 1
 buffer_atomic_add v6, v7, s[48:51], 0 offen offset:4 sc0 sc1
 s_mov_b64 exec, -1
 s_mov_b32 s3, s24
 s_mul_i32 s24, s16, 12288
 s_lshl_b32 s28, s16, 10
 v_and_b32 v1, 0xf0, v0
 v_mul_u32_u24 v1, 48, v1
 v_lshrrev_b32 v5, 8, v0
 v_lshl_add_u32 v1, v5, 4, v1
 v_mfma_f32_16x16x32_bf16 v[128:131], v[26:29], v[208:211], 0
 v_mfma_f32_16x16x32_bf16 v[132:135], v[24:27], v[208:211], 0
 v_mfma_f32_16x16x32_bf16 v[136:139], v[26:29], v[212:215], 0
 v_mfma_f32_16x16x32_bf16 v[140:143], v[24:27], v[212:215], 0
 v_mfma_f32_16x16x32_bf16 v[144:147], v[26:29], v[216:219], 0
 v_mfma_f32_16x16x32_bf16 v[148:151], v[24:27], v[216:219], 0
 v_mfma_f32_16x16x32_bf16 v[152:155], v[26:29], v[220:223], 0
 v_mfma_f32_16x16x32_bf16 v[156:159], v[24:27], v[220:223], 0
 v_mfma_f32_16x16x32_bf16 a[192:195], v[26:29], v[224:227], 0
 v_mfma_f32_16x16x32_bf16 a[196:199], v[24:27], v[224:227], 0
 v_mfma_f32_16x16x32_bf16 a[200:203], v[26:29], v[228:231], 0
 v_mfma_f32_16x16x32_bf16 a[204:207], v[24:27], v[228:231], 0
 v_mfma_f32_16x16x32_bf16 a[208:211], v[26:29], v[232:235], 0
 v_mfma_f32_16x16x32_bf16 a[212:215], v[24:27], v[232:235], 0
 v_mfma_f32_16x16x32_bf16 a[216:219], v[26:29], v[236:239], 0
 v_mfma_f32_16x16x32_bf16 a[220:223], v[24:27], v[236:239], 0
 v_mfma_f32_16x16x32_bf16 a[224:227], v[26:29], v[240:243], 0
 v_mfma_f32_16x16x32_bf16 a[228:231], v[24:27], v[240:243], 0
 v_mfma_f32_16x16x32_bf16 a[232:235], v[26:29], v[244:247], 0
 v_mfma_f32_16x16x32_bf16 a[236:239], v[24:27], v[244:247], 0
 v_mfma_f32_16x16x32_bf16 a[240:243], v[26:29], v[248:251], 0
 v_mfma_f32_16x16x32_bf16 a[244:247], v[24:27], v[248:251], 0
 v_mfma_f32_16x16x32_bf16 a[248:251], v[26:29], v[252:255], 0
 v_mfma_f32_16x16x32_bf16 a[252:255], v[24:27], v[252:255], 0
 s_waitcnt lgkmcnt(0)
 v_mfma_f32_16x16x32_bf16 v[160:163], v[26:29], v[8:11], 0
 v_mfma_f32_16x16x32_bf16 v[164:167], v[24:27], v[8:11], 0
 v_mfma_f32_16x16x32_bf16 v[168:171], v[26:29], v[12:15], 0
 v_mfma_f32_16x16x32_bf16 v[172:175], v[24:27], v[12:15], 0
 v_mfma_f32_16x16x32_bf16 v[176:179], v[26:29], v[64:67], 0
 v_mfma_f32_16x16x32_bf16 v[180:183], v[24:27], v[64:67], 0
 v_mfma_f32_16x16x32_bf16 v[184:187], v[26:29], v[68:71], 0
 v_mfma_f32_16x16x32_bf16 v[188:191], v[24:27], v[68:71], 0
 v_mfma_f32_16x16x32_bf16 v[192:195], v[26:29], v[72:75], 0
 v_mfma_f32_16x16x32_bf16 v[196:199], v[24:27], v[72:75], 0
 v_mfma_f32_16x16x32_bf16 v[200:203], v[26:29], v[76:79], 0
 v_mfma_f32_16x16x32_bf16 v[204:207], v[24:27], v[76:79], 0
 v_mfma_f32_16x16x32_bf16 v[208:211], v[26:29], v[80:83], 0
 v_mfma_f32_16x16x32_bf16 v[212:215], v[24:27], v[80:83], 0
 v_mfma_f32_16x16x32_bf16 v[216:219], v[26:29], v[84:87], 0
 v_mfma_f32_16x16x32_bf16 v[220:223], v[24:27], v[84:87], 0
 v_mfma_f32_16x16x32_bf16 v[224:227], v[26:29], v[88:91], 0
 v_mfma_f32_16x16x32_bf16 v[228:231], v[24:27], v[88:91], 0
 v_mfma_f32_16x16x32_bf16 v[232:235], v[26:29], v[92:95], 0
 v_mfma_f32_16x16x32_bf16 v[236:239], v[24:27], v[92:95], 0
 v_mfma_f32_16x16x32_bf16 v[240:243], v[26:29], v[96:99], 0
 v_mfma_f32_16x16x32_bf16 v[244:247], v[24:27], v[96:99], 0
 v_mfma_f32_16x16x32_bf16 v[248:251], v[26:29], v[100:103], 0
 v_mfma_f32_16x16x32_bf16 v[252:255], v[24:27], v[100:103], 0
 s_cmp_lg_u32 s16, 1
 s_cbranch_scc1 L_arrB_done
 s_waitcnt vmcnt(0)
 v_readfirstlane_b32 s25, v6
 s_nop 3
 s_cmp_lg_u32 s25, 255
 s_cbranch_scc1 L_arrB_done
 s_mov_b64 exec, 1
 buffer_store_dword v6, v7, s[48:51], 0 offen offset:132 sc1
 s_mov_b64 exec, -1
L_arrB_done:
 v_add_u32 v2, 0x10000, v0
 v_add_u32 v3, 0x20000, v0
 v_lshrrev_b32 v124, 8, v0
 v_lshlrev_b32 v124, 5, v124
 v_add_u32 v124, 0x24000, v124
 v_add_u32 v13, s31, v124
 v_cmp_eq_u32 vcc, 256, v4
 s_lshr_b32 s25, s2, 3
 s_and_b32 s25, s25, 15
 s_lshl_b32 s25, s25, 8
 s_add_u32 s25, s25, 0x3800
 v_mov_b32 v125, 0x100000
 v_mov_b32 v126, s25
 v_cndmask_b32 v125, v125, v126, vcc
 v_mov_b32 v126, 1
 v_lshlrev_b32 v5, 1, v4
 s_lshl_b32 s25, s16, 8
 s_add_u32 m0, s25, 0x25800
 s_lshl_b32 s25, s16, 2
 s_add_u32 s25, s25, 0x27000
 v_mov_b32 v14, s25
 v_mov_b32 v15, 0x27000
 s_waitcnt vmcnt(1)
 v_lshlrev_b32 v96, 16, v104
 v_and_b32 v97, 0xffff0000, v104
 v_lshlrev_b32 v98, 16, v105
 v_and_b32 v99, 0xffff0000, v105
 v_lshlrev_b32 v100, 16, v106
 v_and_b32 v101, 0xffff0000, v106
 v_lshlrev_b32 v112, 16, v108
 v_and_b32 v113, 0xffff0000, v108
 v_lshlrev_b32 v114, 16, v109
 v_and_b32 v115, 0xffff0000, v109
 v_lshlrev_b32 v116, 16, v110
 v_and_b32 v117, 0xffff0000, v110
 v_lshlrev_b32 v118, 16, v111
 v_and_b32 v119, 0xffff0000, v111
 s_cmp_lg_u32 s16, 0
 s_cbranch_scc1 L_pollB_ok
 v_mov_b32 v8, 0
 buffer_load_dword v9, v8, s[48:51], 0 offen offset:132 sc1
 s_mov_b32 s25, 65536
 s_waitcnt vmcnt(0)
 v_cmp_eq_u32 vcc, 0, v9
 s_nop 4
 s_cbranch_vccz L_pollB_ok
L_pollB_spin:
 s_sleep 1
 buffer_load_dword v9, v8, s[48:51], 0 offen offset:132 sc1
 s_sub_u32 s25, s25, 1
 s_waitcnt vmcnt(0)
 s_cbranch_scc1 L_pollB_ok
 v_cmp_eq_u32 vcc, 0, v9
 s_nop 4
 s_cbranch_vccnz L_pollB_spin
L_pollB_ok:
 s_barrier
 s_mov_b32 s25, 0x0
 s_mov_b32 s26, 0x1000
 buffer_load_dwordx2 v[64:65], v5, s[12:15], s25 offen offset:0 sc1
 buffer_load_dwordx2 v[66:67], v5, s[12:15], s25 offen offset:2048 sc1
 buffer_load_dwordx2 v[68:69], v5, s[12:15], s26 offen offset:0 sc1
 s_mov_b32 s25, 0x1800
 s_mov_b32 s26, 0x2800
 buffer_load_dwordx2 v[70:71], v5, s[12:15], s25 offen offset:0 sc1
 buffer_load_dwordx2 v[72:73], v5, s[12:15], s25 offen offset:2048 sc1
 buffer_load_dwordx2 v[74:75], v5, s[12:15], s26 offen offset:0 sc1
 s_mov_b32 s25, 0x3000
 buffer_load_dword v4, s[12:15], s25 offen offset:0 sc1 lds
 buffer_load_dword v4, s[12:15], s25 offen offset:1024 sc1 lds
 buffer_load_dwordx4 v[16:19], v0, s[32:35], s28 offen
 s_add_u32 s28, s28, 4096
 buffer_load_dwordx4 v[20:23], v0, s[32:35], s28 offen
 s_add_u32 s28, s28, 4096
 buffer_load_dwordx4 v[24:27], v0, s[32:35], s28 offen
 s_add_u32 s28, s28, 4096
 buffer_load_dwordx4 v[28:31], v0, s[32:35], s28 offen
 s_add_u32 s28, s28, 4096
 buffer_load_dwordx4 v[80:83], v0, s[32:35], s28 offen
 s_add_u32 s28, s28, 4096
 buffer_load_dwordx4 v[84:87], v0, s[32:35], s28 offen
 s_add_u32 s28, s28, 4096
 buffer_load_dwordx4 v[88:91], v0, s[32:35], s28 offen
 s_add_u32 s28, s28, 4096
 buffer_load_dwordx4 v[92:95], v0, s[32:35], s28 offen
 s_add_u32 s28, s28, 4096
 v_add_u32 v5, 0x24000, v5
 s_waitcnt vmcnt(10)
 v_add_f32 v64, v64, v70
 v_add_f32 v65, v65, v71
 v_add_f32 v66, v66, v72
 v_add_f32 v67, v67, v73
 v_add_f32 v68, v68, v74
 v_add_f32 v69, v69, v75
 v_add_f32 v64, 0x358637bd, v64
 v_add_f32 v65, 0x358637bd, v65
 v_add_f32 v66, 0x358637bd, v66
 v_add_f32 v67, 0x358637bd, v67
 v_add_f32 v68, 0x358637bd, v68
 v_add_f32 v69, 0x358637bd, v69
 v_sqrt_f32 v64, v64
 v_sqrt_f32 v65, v65
 v_sqrt_f32 v66, v66
 v_sqrt_f32 v67, v67
 v_sqrt_f32 v68, v68
 v_sqrt_f32 v69, v69
 s_nop 0
 v_add_f32 v6, v64, v65
 v_add_f32 v6, v6, v66
 v_add_f32 v6, v6, v67
 v_add_f32 v6, v6, v68
 v_add_f32 v6, v6, v69
 v_mul_f32 v64, v64, v96
 v_mul_f32 v65, v65, v97
 v_add_f32_dpp v6, v6, v6 row_ror:8 row_mask:0xf bank_mask:0xf
 v_mul_f32 v66, v66, v98
 v_mul_f32 v67, v67, v99
 v_add_f32_dpp v6, v6, v6 row_ror:4 row_mask:0xf bank_mask:0xf
 v_mul_f32 v68, v68, v100
 v_mul_f32 v69, v69, v101
 v_add_f32_dpp v6, v6, v6 row_ror:2 row_mask:0xf bank_mask:0xf
 s_nop 1
 v_add_f32_dpp v6, v6, v6 row_ror:1 row_mask:0xf bank_mask:0xf
 ds_write_b64 v5, v[64:65] offset:0
 ds_write_b64 v5, v[66:67] offset:2048
 ds_write_b64 v5, v[68:69] offset:4096
 v_mov_b32 v7, v6
 s_nop 1
 v_permlane16_swap_b32 v6, v7
 s_nop 1
 v_add_f32 v6, v6, v7
 v_mov_b32 v7, v6
 s_nop 1
 v_permlane32_swap_b32 v6, v7
 s_nop 1
 v_add_f32 v6, v6, v7
 ds_write_b32 v14, v6
 v_mov_b32 v6, 0x358637bd
 s_waitcnt vmcnt(8)
 s_waitcnt lgkmcnt(0)
 s_barrier
 ds_read_b128 v[8:11], v15
 ds_read_b128 v[104:107], v13 offset:0
 ds_read_b128 v[108:111], v13 offset:16
 ds_read_b128 v[64:67], v124 offset:5888
 ds_read_b128 v[68:71], v124 offset:5904
 ds_read_b128 v[72:75], v124 offset:6016
 ds_read_b128 v[76:79], v124 offset:6032
 s_waitcnt lgkmcnt(6)
 v_add_f32 v8, v8, v9
 v_add_f32 v10, v10, v11
 v_add_f32 v8, v8, v10
 v_fmac_f32 v6, 0x3a2aaaab, v8
 v_rcp_f32 v6, v6
 s_waitcnt lgkmcnt(4)
 v_fma_f32 v104, v104, v6, 1.0
 v_fma_f32 v105, v105, v6, 1.0
 v_fma_f32 v106, v106, v6, 1.0
 v_fma_f32 v107, v107, v6, 1.0
 v_fma_f32 v108, v108, v6, 1.0
 v_fma_f32 v109, v109, v6, 1.0
 v_fma_f32 v110, v110, v6, 1.0
 v_fma_f32 v111, v111, v6, 1.0
 v_readfirstlane_b32 s29, v6
 v_pk_mul_f32 v[112:113], v[112:113], v[104:105]
 v_pk_mul_f32 v[114:115], v[114:115], v[106:107]
 v_pk_mul_f32 v[116:117], v[116:117], v[108:109]
 v_pk_mul_f32 v[118:119], v[118:119], v[110:111]
 v_cvt_pk_bf16_f32 v120, v112, v113
 v_cvt_pk_bf16_f32 v121, v114, v115
 v_cvt_pk_bf16_f32 v122, v116, v117
 v_cvt_pk_bf16_f32 v123, v118, v119
 buffer_store_dwordx4 v[120:123], v0, s[36:39], s30 offen sc1
 ds_read_b128 v[96:99], v0 offset:0
 ds_read_b128 v[100:103], v0 offset:1024
 ds_read_b128 v[104:107], v0 offset:2048
 ds_read_b128 v[108:111], v0 offset:3072
 s_waitcnt lgkmcnt(4)
 v_fma_f32 v64, v64, v6, 1.0
 v_fma_f32 v65, v65, v6, 1.0
 v_fma_f32 v66, v66, v6, 1.0
 v_fma_f32 v67, v67, v6, 1.0
 v_fma_f32 v68, v68, v6, 1.0
 v_fma_f32 v69, v69, v6, 1.0
 v_fma_f32 v70, v70, v6, 1.0
 v_fma_f32 v71, v71, v6, 1.0
 v_fma_f32 v72, v72, v6, 1.0
 v_fma_f32 v73, v73, v6, 1.0
 v_fma_f32 v74, v74, v6, 1.0
 v_fma_f32 v75, v75, v6, 1.0
 v_fma_f32 v76, v76, v6, 1.0
 v_fma_f32 v77, v77, v6, 1.0
 v_fma_f32 v78, v78, v6, 1.0
 v_fma_f32 v79, v79, v6, 1.0
 s_mov_b32 s27, 0xffff0000
 v_lshlrev_b32 v8, 16, v32
 v_and_b32 v9, s27, v32
 v_lshlrev_b32 v10, 16, v33
 v_and_b32 v11, s27, v33
 v_lshlrev_b32 v12, 16, v34
 v_and_b32 v13, s27, v34
 v_lshlrev_b32 v14, 16, v35
 v_and_b32 v15, s27, v35
 v_pk_mul_f32 v[8:9], v[8:9], v[64:65]
 v_pk_mul_f32 v[10:11], v[10:11], v[66:67]
 v_pk_mul_f32 v[12:13], v[12:13], v[68:69]
 v_pk_mul_f32 v[14:15], v[14:15], v[70:71]
 v_cvt_pk_bf16_f32 v32, v8, v9
 v_cvt_pk_bf16_f32 v33, v10, v11
 v_cvt_pk_bf16_f32 v34, v12, v13
 v_cvt_pk_bf16_f32 v35, v14, v15
 v_lshlrev_b32 v8, 16, v36
 v_and_b32 v9, s27, v36
 v_lshlrev_b32 v10, 16, v37
 v_and_b32 v11, s27, v37
 v_lshlrev_b32 v12, 16, v38
 v_and_b32 v13, s27, v38
 v_lshlrev_b32 v14, 16, v39
 v_and_b32 v15, s27, v39
 v_pk_mul_f32 v[8:9], v[8:9], v[64:65]
 v_pk_mul_f32 v[10:11], v[10:11], v[66:67]
 v_pk_mul_f32 v[12:13], v[12:13], v[68:69]
 v_pk_mul_f32 v[14:15], v[14:15], v[70:71]
 v_cvt_pk_bf16_f32 v36, v8, v9
 v_cvt_pk_bf16_f32 v37, v10, v11
 v_cvt_pk_bf16_f32 v38, v12, v13
 v_cvt_pk_bf16_f32 v39, v14, v15
 v_lshlrev_b32 v8, 16, v40
 v_and_b32 v9, s27, v40
 v_lshlrev_b32 v10, 16, v41
 v_and_b32 v11, s27, v41
 v_lshlrev_b32 v12, 16, v42
 v_and_b32 v13, s27, v42
 v_lshlrev_b32 v14, 16, v43
 v_and_b32 v15, s27, v43
 v_pk_mul_f32 v[8:9], v[8:9], v[64:65]
 v_pk_mul_f32 v[10:11], v[10:11], v[66:67]
 v_pk_mul_f32 v[12:13], v[12:13], v[68:69]
 v_pk_mul_f32 v[14:15], v[14:15], v[70:71]
 v_cvt_pk_bf16_f32 v40, v8, v9
 v_cvt_pk_bf16_f32 v41, v10, v11
 v_cvt_pk_bf16_f32 v42, v12, v13
 v_cvt_pk_bf16_f32 v43, v14, v15
 v_lshlrev_b32 v8, 16, v44
 v_and_b32 v9, s27, v44
 v_lshlrev_b32 v10, 16, v45
 v_and_b32 v11, s27, v45
 v_lshlrev_b32 v12, 16, v46
 v_and_b32 v13, s27, v46
 v_lshlrev_b32 v14, 16, v47
 v_and_b32 v15, s27, v47
 v_pk_mul_f32 v[8:9], v[8:9], v[64:65]
 v_pk_mul_f32 v[10:11], v[10:11], v[66:67]
 v_pk_mul_f32 v[12:13], v[12:13], v[68:69]
 v_pk_mul_f32 v[14:15], v[14:15], v[70:71]
 v_cvt_pk_bf16_f32 v44, v8, v9
 v_cvt_pk_bf16_f32 v45, v10, v11
 v_cvt_pk_bf16_f32 v46, v12, v13
 v_cvt_pk_bf16_f32 v47, v14, v15
 v_lshlrev_b32 v8, 16, v48
 v_and_b32 v9, s27, v48
 v_lshlrev_b32 v10, 16, v49
 v_and_b32 v11, s27, v49
 v_lshlrev_b32 v12, 16, v50
 v_and_b32 v13, s27, v50
 v_lshlrev_b32 v14, 16, v51
 v_and_b32 v15, s27, v51
 v_pk_mul_f32 v[8:9], v[8:9], v[72:73]
 v_pk_mul_f32 v[10:11], v[10:11], v[74:75]
 v_pk_mul_f32 v[12:13], v[12:13], v[76:77]
 v_pk_mul_f32 v[14:15], v[14:15], v[78:79]
 v_cvt_pk_bf16_f32 v48, v8, v9
 v_cvt_pk_bf16_f32 v49, v10, v11
 v_cvt_pk_bf16_f32 v50, v12, v13
 v_cvt_pk_bf16_f32 v51, v14, v15
 v_lshlrev_b32 v8, 16, v52
 v_and_b32 v9, s27, v52
 v_lshlrev_b32 v10, 16, v53
 v_and_b32 v11, s27, v53
 v_lshlrev_b32 v12, 16, v54
 v_and_b32 v13, s27, v54
 v_lshlrev_b32 v14, 16, v55
 v_and_b32 v15, s27, v55
 v_pk_mul_f32 v[8:9], v[8:9], v[72:73]
 v_pk_mul_f32 v[10:11], v[10:11], v[74:75]
 v_pk_mul_f32 v[12:13], v[12:13], v[76:77]
 v_pk_mul_f32 v[14:15], v[14:15], v[78:79]
 v_cvt_pk_bf16_f32 v52, v8, v9
 v_cvt_pk_bf16_f32 v53, v10, v11
 v_cvt_pk_bf16_f32 v54, v12, v13
 v_cvt_pk_bf16_f32 v55, v14, v15
 v_lshlrev_b32 v8, 16, v56
 v_and_b32 v9, s27, v56
 v_lshlrev_b32 v10, 16, v57
 v_and_b32 v11, s27, v57
 v_lshlrev_b32 v12, 16, v58
 v_and_b32 v13, s27, v58
 v_lshlrev_b32 v14, 16, v59
 v_and_b32 v15, s27, v59
 v_pk_mul_f32 v[8:9], v[8:9], v[72:73]
 v_pk_mul_f32 v[10:11], v[10:11], v[74:75]
 v_pk_mul_f32 v[12:13], v[12:13], v[76:77]
 v_pk_mul_f32 v[14:15], v[14:15], v[78:79]
 v_cvt_pk_bf16_f32 v56, v8, v9
 v_cvt_pk_bf16_f32 v57, v10, v11
 v_cvt_pk_bf16_f32 v58, v12, v13
 v_cvt_pk_bf16_f32 v59, v14, v15
 v_lshlrev_b32 v8, 16, v60
 v_and_b32 v9, s27, v60
 v_lshlrev_b32 v10, 16, v61
 v_and_b32 v11, s27, v61
 v_lshlrev_b32 v12, 16, v62
 v_and_b32 v13, s27, v62
 v_lshlrev_b32 v14, 16, v63
 v_and_b32 v15, s27, v63
 v_pk_mul_f32 v[8:9], v[8:9], v[72:73]
 v_pk_mul_f32 v[10:11], v[10:11], v[74:75]
 v_pk_mul_f32 v[12:13], v[12:13], v[76:77]
 v_pk_mul_f32 v[14:15], v[14:15], v[78:79]
 v_cvt_pk_bf16_f32 v60, v8, v9
 v_cvt_pk_bf16_f32 v61, v10, v11
 v_cvt_pk_bf16_f32 v62, v12, v13
 v_cvt_pk_bf16_f32 v63, v14, v15
 s_getpc_b64 s[20:21]
L_pcl:
 s_add_u32 s20, s20, L_k3_last-L_pcl
 s_addc_u32 s21, s21, 0
 s_lshl_b32 s22, s16, 12
 s_mov_b32 s19, 6
 s_sub_u32 s40, s20, L_k3_last-L_k3_loop
 s_subb_u32 s41, s21, 0
 s_mul_i32 s23, s16, 3072
 s_lshl_b32 s26, s16, 10
 s_waitcnt lgkmcnt(2)
 v_mfma_f32_16x16x32_bf16 v[160:163], v[96:99], v[32:35], v[160:163]
 s_add_u32 s17, s3, 0x132000
 ds_read_b128 v[112:115], v0 offset:4096
 ds_read_b128 v[8:11], v124 offset:0
 v_mfma_f32_16x16x32_bf16 v[160:163], v[100:103], v[48:51], v[160:163]
 s_add_u32 m0, s3, 0x12000
 ds_read_b128 v[116:119], v0 offset:5120
 ds_read_b128 v[12:15], v124 offset:16
 v_mfma_f32_16x16x32_bf16 a[96:99], v[100:103], v[52:55], a[96:99]
 ds_read_b128 v[120:123], v124 offset:6656
 ds_read_b128 v[4:7], v124 offset:6672
 v_mfma_f32_16x16x32_bf16 a[96:99], v[96:99], v[36:39], a[96:99]
 v_mfma_f32_16x16x32_bf16 v[128:131], v[96:99], v[40:43], v[128:131]
 buffer_load_dwordx4 v0, s[36:39], s17 offen offset:0 sc1 lds
 v_mfma_f32_16x16x32_bf16 v[128:131], v[100:103], v[56:59], v[128:131]
 v_mfma_f32_16x16x32_bf16 a[0:3], v[100:103], v[60:63], a[0:3]
 v_mfma_f32_16x16x32_bf16 a[0:3], v[96:99], v[44:47], a[0:3]
 s_waitcnt lgkmcnt(6)
 v_mfma_f32_16x16x32_bf16 v[164:167], v[104:107], v[32:35], v[164:167]
 s_waitcnt lgkmcnt(1)
 ds_read_b128 v[96:99], v0 offset:6144
 v_add_f32 v192, v192, v120
 v_mfma_f32_16x16x32_bf16 v[164:167], v[108:111], v[48:51], v[164:167]
 ds_read_b128 v[100:103], v0 offset:7168
 v_add_f32 v193, v193, v121
 v_mfma_f32_16x16x32_bf16 a[100:103], v[108:111], v[52:55], a[100:103]
 v_add_f32 v194, v194, v122
 v_add_f32 v195, v195, v123
 v_mfma_f32_16x16x32_bf16 a[100:103], v[104:107], v[36:39], a[100:103]
 ds_read_b128 v[120:123], v124 offset:6784
 v_mfma_f32_16x16x32_bf16 v[132:135], v[104:107], v[40:43], v[132:135]
 s_waitcnt lgkmcnt(3)
 buffer_load_dwordx4 v0, s[36:39], s17 offen offset:1024 sc1 lds
 v_mfma_f32_16x16x32_bf16 v[132:135], v[108:111], v[56:59], v[132:135]
 v_add_f32 v196, v196, v4
 v_add_f32 v197, v197, v5
 v_mfma_f32_16x16x32_bf16 a[4:7], v[108:111], v[60:63], a[4:7]
 v_add_f32 v198, v198, v6
 v_add_f32 v199, v199, v7
 v_mfma_f32_16x16x32_bf16 a[4:7], v[104:107], v[44:47], a[4:7]
 ds_read_b128 v[4:7], v124 offset:6800
 v_mfma_f32_16x16x32_bf16 v[168:171], v[112:115], v[32:35], v[168:171]
 s_waitcnt lgkmcnt(1)
 ds_read_b128 v[104:107], v0 offset:8192
 v_add_f32 v200, v200, v120
 v_mfma_f32_16x16x32_bf16 v[168:171], v[116:119], v[48:51], v[168:171]
 ds_read_b128 v[108:111], v0 offset:9216
 v_add_f32 v201, v201, v121
 v_mfma_f32_16x16x32_bf16 a[104:107], v[116:119], v[52:55], a[104:107]
 v_add_f32 v202, v202, v122
 v_add_f32 v203, v203, v123
 v_mfma_f32_16x16x32_bf16 a[104:107], v[112:115], v[36:39], a[104:107]
 ds_read_b128 v[120:123], v124 offset:6912
 v_mfma_f32_16x16x32_bf16 v[136:139], v[112:115], v[40:43], v[136:139]
 s_waitcnt lgkmcnt(3)
 buffer_load_dwordx4 v0, s[36:39], s17 offen offset:2048 sc1 lds
 v_mfma_f32_16x16x32_bf16 v[136:139], v[116:119], v[56:59], v[136:139]
 v_add_f32 v204, v204, v4
 v_add_f32 v205, v205, v5
 v_mfma_f32_16x16x32_bf16 a[8:11], v[116:119], v[60:63], a[8:11]
 v_add_f32 v206, v206, v6
 v_add_f32 v207, v207, v7
 v_mfma_f32_16x16x32_bf16 a[8:11], v[112:115], v[44:47], a[8:11]
 ds_read_b128 v[4:7], v124 offset:6928
 v_mfma_f32_16x16x32_bf16 v[172:175], v[96:99], v[32:35], v[172:175]
 s_add_u32 s17, s3, 0x132c00
 ds_read_b128 v[112:115], v0 offset:10240
 v_mfma_f32_16x16x32_bf16 v[172:175], v[100:103], v[48:51], v[172:175]
 s_add_u32 m0, s3, 0x12c00
 ds_read_b128 v[116:119], v0 offset:11264
 v_mfma_f32_16x16x32_bf16 a[108:111], v[100:103], v[52:55], a[108:111]
 s_waitcnt lgkmcnt(3)
 v_add_f32 v208, v208, v120
 v_add_f32 v209, v209, v121
 v_mfma_f32_16x16x32_bf16 a[108:111], v[96:99], v[36:39], a[108:111]
 v_add_f32 v210, v210, v122
 v_add_f32 v211, v211, v123
 v_mfma_f32_16x16x32_bf16 v[140:143], v[96:99], v[40:43], v[140:143]
 buffer_load_dwordx4 v0, s[36:39], s17 offen offset:0 sc1 lds
 v_mfma_f32_16x16x32_bf16 v[140:143], v[100:103], v[56:59], v[140:143]
 ds_read_b128 v[120:123], v124 offset:7040
 v_mfma_f32_16x16x32_bf16 a[12:15], v[100:103], v[60:63], a[12:15]
 s_waitcnt lgkmcnt(3)
 v_add_f32 v212, v212, v4
 v_add_f32 v213, v213, v5
 v_mfma_f32_16x16x32_bf16 a[12:15], v[96:99], v[44:47], a[12:15]
 v_add_f32 v214, v214, v6
 v_add_f32 v215, v215, v7
 v_mfma_f32_16x16x32_bf16 v[176:179], v[104:107], v[32:35], v[176:179]
 ds_read_b128 v[96:99], v0 offset:12288
 ds_read_b128 v[4:7], v124 offset:7056
 v_mfma_f32_16x16x32_bf16 v[176:179], v[108:111], v[48:51], v[176:179]
 s_waitcnt lgkmcnt(2)
 ds_read_b128 v[100:103], v0 offset:13312
 v_add_f32 v216, v216, v120
 v_mfma_f32_16x16x32_bf16 a[112:115], v[108:111], v[52:55], a[112:115]
 v_add_f32 v217, v217, v121
 v_add_f32 v218, v218, v122
 v_mfma_f32_16x16x32_bf16 a[112:115], v[104:107], v[36:39], a[112:115]
 v_add_f32 v219, v219, v123
 v_mfma_f32_16x16x32_bf16 v[144:147], v[104:107], v[40:43], v[144:147]
 buffer_load_dwordx4 v0, s[36:39], s17 offen offset:1024 sc1 lds
 v_mfma_f32_16x16x32_bf16 v[144:147], v[108:111], v[56:59], v[144:147]
 ds_read_b128 v[120:123], v124 offset:7168
 v_mfma_f32_16x16x32_bf16 a[16:19], v[108:111], v[60:63], a[16:19]
 s_waitcnt lgkmcnt(2)
 v_add_f32 v220, v220, v4
 v_add_f32 v221, v221, v5
 v_mfma_f32_16x16x32_bf16 a[16:19], v[104:107], v[44:47], a[16:19]
 v_add_f32 v222, v222, v6
 v_add_f32 v223, v223, v7
 v_mfma_f32_16x16x32_bf16 v[180:183], v[112:115], v[32:35], v[180:183]
 ds_read_b128 v[104:107], v0 offset:14336
 ds_read_b128 v[4:7], v124 offset:7184
 v_mfma_f32_16x16x32_bf16 v[180:183], v[116:119], v[48:51], v[180:183]
 s_waitcnt lgkmcnt(2)
 ds_read_b128 v[108:111], v0 offset:15360
 v_add_f32 v224, v224, v120
 v_mfma_f32_16x16x32_bf16 a[116:119], v[116:119], v[52:55], a[116:119]
 v_add_f32 v225, v225, v121
 v_add_f32 v226, v226, v122
 v_mfma_f32_16x16x32_bf16 a[116:119], v[112:115], v[36:39], a[116:119]
 v_add_f32 v227, v227, v123
 v_mfma_f32_16x16x32_bf16 v[148:151], v[112:115], v[40:43], v[148:151]
 buffer_load_dwordx4 v0, s[36:39], s17 offen offset:2048 sc1 lds
 v_mfma_f32_16x16x32_bf16 v[148:151], v[116:119], v[56:59], v[148:151]
 ds_read_b128 v[120:123], v124 offset:7296
 v_mfma_f32_16x16x32_bf16 a[20:23], v[116:119], v[60:63], a[20:23]
 s_waitcnt lgkmcnt(2)
 v_add_f32 v228, v228, v4
 v_add_f32 v229, v229, v5
 v_mfma_f32_16x16x32_bf16 a[20:23], v[112:115], v[44:47], a[20:23]
 v_add_f32 v230, v230, v6
 v_add_f32 v231, v231, v7
 v_mfma_f32_16x16x32_bf16 v[184:187], v[96:99], v[32:35], v[184:187]
 s_add_u32 s17, s24, 0x138000
 ds_read_b128 v[112:115], v0 offset:16384
 ds_read_b128 v[4:7], v124 offset:7312
 v_mfma_f32_16x16x32_bf16 v[184:187], v[100:103], v[48:51], v[184:187]
 s_add_u32 m0, s24, 0x18000
 ds_read_b128 v[116:119], v0 offset:17408
 v_mfma_f32_16x16x32_bf16 a[120:123], v[100:103], v[52:55], a[120:123]
 s_waitcnt lgkmcnt(3)
 v_add_f32 v232, v232, v120
 v_add_f32 v233, v233, v121
 v_mfma_f32_16x16x32_bf16 a[120:123], v[96:99], v[36:39], a[120:123]
 v_add_f32 v234, v234, v122
 v_add_f32 v235, v235, v123
 v_mfma_f32_16x16x32_bf16 v[152:155], v[96:99], v[40:43], v[152:155]
 buffer_load_dwordx4 v0, s[36:39], s17 offen offset:0 sc1 lds
 v_mfma_f32_16x16x32_bf16 v[152:155], v[100:103], v[56:59], v[152:155]
 ds_read_b128 v[120:123], v124 offset:7424
 v_mfma_f32_16x16x32_bf16 a[24:27], v[100:103], v[60:63], a[24:27]
 s_waitcnt lgkmcnt(2)
 v_add_f32 v236, v236, v4
 v_add_f32 v237, v237, v5
 v_mfma_f32_16x16x32_bf16 a[24:27], v[96:99], v[44:47], a[24:27]
 v_add_f32 v238, v238, v6
 v_add_f32 v239, v239, v7
 v_mfma_f32_16x16x32_bf16 v[188:191], v[104:107], v[32:35], v[188:191]
 ds_read_b128 v[96:99], v0 offset:18432
 ds_read_b128 v[4:7], v124 offset:7440
 v_mfma_f32_16x16x32_bf16 v[188:191], v[108:111], v[48:51], v[188:191]
 s_waitcnt lgkmcnt(2)
 ds_read_b128 v[100:103], v0 offset:19456
 v_add_f32 v240, v240, v120
 v_mfma_f32_16x16x32_bf16 a[124:127], v[108:111], v[52:55], a[124:127]
 v_add_f32 v241, v241, v121
 v_add_f32 v242, v242, v122
 v_mfma_f32_16x16x32_bf16 a[124:127], v[104:107], v[36:39], a[124:127]
 v_add_f32 v243, v243, v123
 v_mfma_f32_16x16x32_bf16 v[156:159], v[104:107], v[40:43], v[156:159]
 buffer_load_dwordx4 v0, s[36:39], s17 offen offset:1024 sc1 lds
 v_mfma_f32_16x16x32_bf16 v[156:159], v[108:111], v[56:59], v[156:159]
 ds_read_b128 v[120:123], v124 offset:7552
 v_mfma_f32_16x16x32_bf16 a[28:31], v[108:111], v[60:63], a[28:31]
 s_waitcnt lgkmcnt(2)
 v_add_f32 v244, v244, v4
 v_add_f32 v245, v245, v5
 v_mfma_f32_16x16x32_bf16 a[28:31], v[104:107], v[44:47], a[28:31]
 v_add_f32 v246, v246, v6
 v_add_f32 v247, v247, v7
 v_mfma_f32_16x16x32_bf16 v[192:195], v[112:115], v[32:35], v[192:195]
 ds_read_b128 v[104:107], v0 offset:20480
 ds_read_b128 v[4:7], v124 offset:7568
 v_mfma_f32_16x16x32_bf16 v[192:195], v[116:119], v[48:51], v[192:195]
 s_waitcnt lgkmcnt(2)
 ds_read_b128 v[108:111], v0 offset:21504
 v_add_f32 v248, v248, v120
 v_mfma_f32_16x16x32_bf16 a[128:131], v[116:119], v[52:55], a[128:131]
 v_add_f32 v249, v249, v121
 v_add_f32 v250, v250, v122
 v_mfma_f32_16x16x32_bf16 a[128:131], v[112:115], v[36:39], a[128:131]
 v_add_f32 v251, v251, v123
 v_mfma_f32_16x16x32_bf16 a[192:195], v[112:115], v[40:43], a[192:195]
 s_waitcnt lgkmcnt(1)
 buffer_load_dwordx4 v0, s[36:39], s17 offen offset:2048 sc1 lds
 v_mfma_f32_16x16x32_bf16 a[192:195], v[116:119], v[56:59], a[192:195]
 v_add_f32 v252, v252, v4
 v_add_f32 v253, v253, v5
 v_mfma_f32_16x16x32_bf16 a[32:35], v[116:119], v[60:63], a[32:35]
 v_add_f32 v254, v254, v6
 v_add_f32 v255, v255, v7
 v_mfma_f32_16x16x32_bf16 a[32:35], v[112:115], v[44:47], a[32:35]
 s_waitcnt vmcnt(14)
 v_fma_f32 v8, v8, s29, 1.0
 v_fma_f32 v9, v9, s29, 1.0
 v_mfma_f32_16x16x32_bf16 v[196:199], v[96:99], v[32:35], v[196:199]
 ds_read_b128 v[112:115], v0 offset:22528
 v_fma_f32 v10, v10, s29, 1.0
 v_mfma_f32_16x16x32_bf16 v[196:199], v[100:103], v[48:51], v[196:199]
 ds_read_b128 v[116:119], v0 offset:23552
 v_fma_f32 v11, v11, s29, 1.0
 v_mfma_f32_16x16x32_bf16 a[132:135], v[100:103], v[52:55], a[132:135]
 v_lshlrev_b32 v4, 16, v16
 v_and_b32 v5, s27, v16
 v_mfma_f32_16x16x32_bf16 a[132:135], v[96:99], v[36:39], a[132:135]
 v_lshlrev_b32 v6, 16, v17
 v_and_b32 v7, s27, v17
 v_mfma_f32_16x16x32_bf16 a[196:199], v[96:99], v[40:43], a[196:199]
 buffer_load_dwordx4 v0, s[36:39], s17 offen offset:3072 sc1 lds
 v_mfma_f32_16x16x32_bf16 a[196:199], v[100:103], v[56:59], a[196:199]
 v_mul_f32 v4, v4, v8
 v_mul_f32 v5, v5, v9
 v_mfma_f32_16x16x32_bf16 a[36:39], v[100:103], v[60:63], a[36:39]
 v_mul_f32 v6, v6, v10
 v_mul_f32 v7, v7, v11
 v_mfma_f32_16x16x32_bf16 a[36:39], v[96:99], v[44:47], a[36:39]
 s_waitcnt lgkmcnt(2)
 v_cvt_pk_bf16_f32 v64, v4, v5
 v_cvt_pk_bf16_f32 v65, v6, v7
 v_mfma_f32_16x16x32_bf16 v[200:203], v[104:107], v[32:35], v[200:203]
 ds_read_b128 v[96:99], v0 offset:24576
 v_lshlrev_b32 v4, 16, v20
 v_mfma_f32_16x16x32_bf16 v[200:203], v[108:111], v[48:51], v[200:203]
 ds_read_b128 v[100:103], v0 offset:25600
 v_and_b32 v5, s27, v20
 v_mfma_f32_16x16x32_bf16 a[136:139], v[108:111], v[52:55], a[136:139]
 v_lshlrev_b32 v6, 16, v21
 v_and_b32 v7, s27, v21
 v_mfma_f32_16x16x32_bf16 a[136:139], v[104:107], v[36:39], a[136:139]
 v_mul_f32 v4, v4, v8
 v_mul_f32 v5, v5, v9
 v_mfma_f32_16x16x32_bf16 a[200:203], v[104:107], v[40:43], a[200:203]
 v_mul_f32 v6, v6, v10
 v_mul_f32 v7, v7, v11
 v_mfma_f32_16x16x32_bf16 a[200:203], v[108:111], v[56:59], a[200:203]
 s_waitcnt vmcnt(10)
 v_cvt_pk_bf16_f32 v68, v4, v5
 v_cvt_pk_bf16_f32 v69, v6, v7
 v_mfma_f32_16x16x32_bf16 a[40:43], v[108:111], v[60:63], a[40:43]
 s_barrier
 v_mfma_f32_16x16x32_bf16 a[40:43], v[104:107], v[44:47], a[40:43]
 s_waitcnt lgkmcnt(2)
 v_lshlrev_b32 v4, 16, v24
 v_and_b32 v5, s27, v24
 v_mfma_f32_16x16x32_bf16 v[204:207], v[112:115], v[32:35], v[204:207]
 ds_read_b128 v[104:107], v0 offset:26624
 v_lshlrev_b32 v6, 16, v25
 v_mfma_f32_16x16x32_bf16 v[204:207], v[116:119], v[48:51], v[204:207]
 ds_read_b128 v[108:111], v0 offset:27648
 v_and_b32 v7, s27, v25
 v_mfma_f32_16x16x32_bf16 a[140:143], v[116:119], v[52:55], a[140:143]
 v_mul_f32 v4, v4, v8
 v_mul_f32 v5, v5, v9
 v_mfma_f32_16x16x32_bf16 a[140:143], v[112:115], v[36:39], a[140:143]
 v_mul_f32 v6, v6, v10
 v_mul_f32 v7, v7, v11
 v_mfma_f32_16x16x32_bf16 a[204:207], v[112:115], v[40:43], a[204:207]
 buffer_atomic_add v126, v125, s[12:15], 0 offen sc1
 v_mfma_f32_16x16x32_bf16 a[204:207], v[116:119], v[56:59], a[204:207]
 v_cvt_pk_bf16_f32 v72, v4, v5
 v_cvt_pk_bf16_f32 v73, v6, v7
 v_mfma_f32_16x16x32_bf16 a[44:47], v[116:119], v[60:63], a[44:47]
 v_lshlrev_b32 v4, 16, v28
 v_and_b32 v5, s27, v28
 v_mfma_f32_16x16x32_bf16 a[44:47], v[112:115], v[44:47], a[44:47]
 s_waitcnt lgkmcnt(2)
 v_lshlrev_b32 v6, 16, v29
 v_and_b32 v7, s27, v29
 v_mfma_f32_16x16x32_bf16 v[208:211], v[96:99], v[32:35], v[208:211]
 ds_read_b128 v[112:115], v0 offset:28672
 v_mul_f32 v4, v4, v8
 v_mfma_f32_16x16x32_bf16 v[208:211], v[100:103], v[48:51], v[208:211]
 ds_read_b128 v[116:119], v0 offset:29696
 v_mul_f32 v5, v5, v9
 v_mfma_f32_16x16x32_bf16 a[144:147], v[100:103], v[52:55], a[144:147]
 v_mul_f32 v6, v6, v10
 v_mul_f32 v7, v7, v11
 v_mfma_f32_16x16x32_bf16 a[144:147], v[96:99], v[36:39], a[144:147]
 v_cvt_pk_bf16_f32 v76, v4, v5
 v_cvt_pk_bf16_f32 v77, v6, v7
 v_mfma_f32_16x16x32_bf16 a[208:211], v[96:99], v[40:43], a[208:211]
 ds_read_b128 v[8:11], v124 offset:128
 v_mfma_f32_16x16x32_bf16 a[208:211], v[100:103], v[56:59], a[208:211]
 v_fma_f32 v12, v12, s29, 1.0
 v_fma_f32 v13, v13, s29, 1.0
 v_mfma_f32_16x16x32_bf16 a[48:51], v[100:103], v[60:63], a[48:51]
 v_fma_f32 v14, v14, s29, 1.0
 v_fma_f32 v15, v15, s29, 1.0
 v_mfma_f32_16x16x32_bf16 a[48:51], v[96:99], v[44:47], a[48:51]
 s_waitcnt lgkmcnt(3)
 v_lshlrev_b32 v4, 16, v18
 v_and_b32 v5, s27, v18
 v_mfma_f32_16x16x32_bf16 v[212:215], v[104:107], v[32:35], v[212:215]
 ds_read_b128 v[96:99], v0 offset:30720
 v_lshlrev_b32 v6, 16, v19
 v_mfma_f32_16x16x32_bf16 v[212:215], v[108:111], v[48:51], v[212:215]
 ds_read_b128 v[100:103], v0 offset:31744
 v_and_b32 v7, s27, v19
 v_mfma_f32_16x16x32_bf16 a[148:151], v[108:111], v[52:55], a[148:151]
 v_mul_f32 v4, v4, v12
 v_mul_f32 v5, v5, v13
 v_mfma_f32_16x16x32_bf16 a[148:151], v[104:107], v[36:39], a[148:151]
 v_mul_f32 v6, v6, v14
 v_mul_f32 v7, v7, v15
 v_mfma_f32_16x16x32_bf16 a[212:215], v[104:107], v[40:43], a[212:215]
 v_cvt_pk_bf16_f32 v66, v4, v5
 v_cvt_pk_bf16_f32 v67, v6, v7
 v_mfma_f32_16x16x32_bf16 a[212:215], v[108:111], v[56:59], a[212:215]
 v_lshlrev_b32 v4, 16, v22
 v_and_b32 v5, s27, v22
 v_mfma_f32_16x16x32_bf16 a[52:55], v[108:111], v[60:63], a[52:55]
 v_lshlrev_b32 v6, 16, v23
 v_and_b32 v7, s27, v23
 v_mfma_f32_16x16x32_bf16 a[52:55], v[104:107], v[44:47], a[52:55]
 s_waitcnt lgkmcnt(3)
 v_mul_f32 v4, v4, v12
 v_mul_f32 v5, v5, v13
 v_mfma_f32_16x16x32_bf16 v[216:219], v[112:115], v[32:35], v[216:219]
 ds_read_b128 v[104:107], v0 offset:32768
 v_mul_f32 v6, v6, v14
 v_mfma_f32_16x16x32_bf16 v[216:219], v[116:119], v[48:51], v[216:219]
 ds_read_b128 v[108:111], v0 offset:33792
 v_mul_f32 v7, v7, v15
 v_mfma_f32_16x16x32_bf16 a[152:155], v[116:119], v[52:55], a[152:155]
 v_cvt_pk_bf16_f32 v70, v4, v5
 v_cvt_pk_bf16_f32 v71, v6, v7
 v_mfma_f32_16x16x32_bf16 a[152:155], v[112:115], v[36:39], a[152:155]
 v_lshlrev_b32 v4, 16, v26
 v_and_b32 v5, s27, v26
 v_mfma_f32_16x16x32_bf16 a[216:219], v[112:115], v[40:43], a[216:219]
 v_lshlrev_b32 v6, 16, v27
 v_and_b32 v7, s27, v27
 v_mfma_f32_16x16x32_bf16 a[216:219], v[116:119], v[56:59], a[216:219]
 v_mul_f32 v4, v4, v12
 v_mul_f32 v5, v5, v13
 v_mfma_f32_16x16x32_bf16 a[56:59], v[116:119], v[60:63], a[56:59]
 v_mul_f32 v6, v6, v14
 v_mul_f32 v7, v7, v15
 v_mfma_f32_16x16x32_bf16 a[56:59], v[112:115], v[44:47], a[56:59]
 s_waitcnt lgkmcnt(2)
 v_cvt_pk_bf16_f32 v74, v4, v5
 v_cvt_pk_bf16_f32 v75, v6, v7
 v_mfma_f32_16x16x32_bf16 v[220:223], v[96:99], v[32:35], v[220:223]
 ds_read_b128 v[112:115], v0 offset:34816
 v_lshlrev_b32 v4, 16, v30
 v_mfma_f32_16x16x32_bf16 v[220:223], v[100:103], v[48:51], v[220:223]
 ds_read_b128 v[116:119], v0 offset:35840
 v_and_b32 v5, s27, v30
 v_mfma_f32_16x16x32_bf16 a[156:159], v[100:103], v[52:55], a[156:159]
 v_lshlrev_b32 v6, 16, v31
 v_and_b32 v7, s27, v31
 v_mfma_f32_16x16x32_bf16 a[156:159], v[96:99], v[36:39], a[156:159]
 v_mul_f32 v4, v4, v12
 v_mul_f32 v5, v5, v13
 v_mfma_f32_16x16x32_bf16 a[220:223], v[96:99], v[40:43], a[220:223]
 v_mul_f32 v6, v6, v14
 v_mul_f32 v7, v7, v15
 v_mfma_f32_16x16x32_bf16 a[220:223], v[100:103], v[56:59], a[220:223]
 v_cvt_pk_bf16_f32 v78, v4, v5
 v_cvt_pk_bf16_f32 v79, v6, v7
 v_mfma_f32_16x16x32_bf16 a[60:63], v[100:103], v[60:63], a[60:63]
 ds_read_b128 v[12:15], v124 offset:144
 v_mfma_f32_16x16x32_bf16 a[60:63], v[96:99], v[44:47], a[60:63]
 s_waitcnt lgkmcnt(3)
 v_fma_f32 v8, v8, s29, 1.0
 v_fma_f32 v9, v9, s29, 1.0
 v_mfma_f32_16x16x32_bf16 v[224:227], v[104:107], v[32:35], v[224:227]
 ds_read_b128 v[96:99], v0 offset:36864
 v_fma_f32 v10, v10, s29, 1.0
 v_mfma_f32_16x16x32_bf16 v[224:227], v[108:111], v[48:51], v[224:227]
 ds_read_b128 v[100:103], v0 offset:37888
 v_fma_f32 v11, v11, s29, 1.0
 v_mfma_f32_16x16x32_bf16 a[160:163], v[108:111], v[52:55], a[160:163]
 v_lshlrev_b32 v4, 16, v80
 v_and_b32 v5, s27, v80
 v_mfma_f32_16x16x32_bf16 a[160:163], v[104:107], v[36:39], a[160:163]
 v_lshlrev_b32 v6, 16, v81
 v_and_b32 v7, s27, v81
 v_mfma_f32_16x16x32_bf16 a[224:227], v[104:107], v[40:43], a[224:227]
 v_pk_mul_f32 v[4:5], v[4:5], v[8:9]
 v_pk_mul_f32 v[6:7], v[6:7], v[10:11]
 v_mfma_f32_16x16x32_bf16 a[224:227], v[108:111], v[56:59], a[224:227]
 v_cvt_pk_bf16_f32 v80, v4, v5
 v_cvt_pk_bf16_f32 v81, v6, v7
 v_mfma_f32_16x16x32_bf16 a[64:67], v[108:111], v[60:63], a[64:67]
 v_lshlrev_b32 v4, 16, v84
 v_and_b32 v5, s27, v84
 v_mfma_f32_16x16x32_bf16 a[64:67], v[104:107], v[44:47], a[64:67]
 s_waitcnt lgkmcnt(3)
 v_lshlrev_b32 v6, 16, v85
 v_and_b32 v7, s27, v85
 v_mfma_f32_16x16x32_bf16 v[228:231], v[112:115], v[32:35], v[228:231]
 ds_read_b128 v[104:107], v0 offset:38912
 v_pk_mul_f32 v[4:5], v[4:5], v[8:9]
 v_mfma_f32_16x16x32_bf16 v[228:231], v[116:119], v[48:51], v[228:231]
 ds_read_b128 v[108:111], v0 offset:39936
 v_pk_mul_f32 v[6:7], v[6:7], v[10:11]
 v_mfma_f32_16x16x32_bf16 a[164:167], v[116:119], v[52:55], a[164:167]
 v_cvt_pk_bf16_f32 v84, v4, v5
 v_cvt_pk_bf16_f32 v85, v6, v7
 v_mfma_f32_16x16x32_bf16 a[164:167], v[112:115], v[36:39], a[164:167]
 v_lshlrev_b32 v4, 16, v88
 v_and_b32 v5, s27, v88
 v_mfma_f32_16x16x32_bf16 a[228:231], v[112:115], v[40:43], a[228:231]
 buffer_load_dwordx4 v[16:19], v0, s[32:35], s28 offen
 v_mfma_f32_16x16x32_bf16 a[228:231], v[116:119], v[56:59], a[228:231]
 s_add_u32 s28, s28, 4096
 v_lshlrev_b32 v6, 16, v89
 v_and_b32 v7, s27, v89
 v_mfma_f32_16x16x32_bf16 a[68:71], v[116:119], v[60:63], a[68:71]
 buffer_load_dwordx4 v[20:23], v0, s[32:35], s28 offen
 v_mfma_f32_16x16x32_bf16 a[68:71], v[112:115], v[44:47], a[68:71]
 s_waitcnt lgkmcnt(2)
 v_pk_mul_f32 v[4:5], v[4:5], v[8:9]
 v_pk_mul_f32 v[6:7], v[6:7], v[10:11]
 v_mfma_f32_16x16x32_bf16 v[232:235], v[96:99], v[32:35], v[232:235]
 s_add_u32 s28, s28, 4096
 ds_read_b128 v[112:115], v0 offset:40960
 v_cvt_pk_bf16_f32 v88, v4, v5
 v_mfma_f32_16x16x32_bf16 v[232:235], v[100:103], v[48:51], v[232:235]
 ds_read_b128 v[116:119], v0 offset:41984
 v_cvt_pk_bf16_f32 v89, v6, v7
 v_mfma_f32_16x16x32_bf16 a[168:171], v[100:103], v[52:55], a[168:171]
 v_lshlrev_b32 v4, 16, v92
 v_and_b32 v5, s27, v92
 v_mfma_f32_16x16x32_bf16 a[168:171], v[96:99], v[36:39], a[168:171]
 v_lshlrev_b32 v6, 16, v93
 v_and_b32 v7, s27, v93
 v_mfma_f32_16x16x32_bf16 a[232:235], v[96:99], v[40:43], a[232:235]
 buffer_load_dwordx4 v[24:27], v0, s[32:35], s28 offen
 v_mfma_f32_16x16x32_bf16 a[232:235], v[100:103], v[56:59], a[232:235]
 s_add_u32 s28, s28, 4096
 v_pk_mul_f32 v[4:5], v[4:5], v[8:9]
 v_pk_mul_f32 v[6:7], v[6:7], v[10:11]
 v_mfma_f32_16x16x32_bf16 a[72:75], v[100:103], v[60:63], a[72:75]
 buffer_load_dwordx4 v[28:31], v0, s[32:35], s28 offen
 v_mfma_f32_16x16x32_bf16 a[72:75], v[96:99], v[44:47], a[72:75]
 s_waitcnt lgkmcnt(2)
 v_cvt_pk_bf16_f32 v92, v4, v5
 v_cvt_pk_bf16_f32 v93, v6, v7
 v_mfma_f32_16x16x32_bf16 v[236:239], v[104:107], v[32:35], v[236:239]
 s_add_u32 s28, s28, 4096
 ds_read_b128 v[96:99], v0 offset:43008
 v_mfma_f32_16x16x32_bf16 v[236:239], v[108:111], v[48:51], v[236:239]
 ds_read_b128 v[100:103], v0 offset:44032
 v_fma_f32 v12, v12, s29, 1.0
 v_mfma_f32_16x16x32_bf16 a[172:175], v[108:111], v[52:55], a[172:175]
 v_fma_f32 v13, v13, s29, 1.0
 v_fma_f32 v14, v14, s29, 1.0
 v_mfma_f32_16x16x32_bf16 a[172:175], v[104:107], v[36:39], a[172:175]
 v_fma_f32 v15, v15, s29, 1.0
 v_lshlrev_b32 v4, 16, v82
 v_mfma_f32_16x16x32_bf16 a[236:239], v[104:107], v[40:43], a[236:239]
 v_and_b32 v5, s27, v82
 v_lshlrev_b32 v6, 16, v83
 v_mfma_f32_16x16x32_bf16 a[236:239], v[108:111], v[56:59], a[236:239]
 v_and_b32 v7, s27, v83
 v_pk_mul_f32 v[4:5], v[4:5], v[12:13]
 v_mfma_f32_16x16x32_bf16 a[76:79], v[108:111], v[60:63], a[76:79]
 v_pk_mul_f32 v[6:7], v[6:7], v[14:15]
 v_cvt_pk_bf16_f32 v82, v4, v5
 v_mfma_f32_16x16x32_bf16 a[76:79], v[104:107], v[44:47], a[76:79]
 s_waitcnt lgkmcnt(2)
 v_cvt_pk_bf16_f32 v83, v6, v7
 v_lshlrev_b32 v4, 16, v86
 v_mfma_f32_16x16x32_bf16 v[240:243], v[112:115], v[32:35], v[240:243]
 ds_read_b128 v[104:107], v0 offset:45056
 v_and_b32 v5, s27, v86
 v_mfma_f32_16x16x32_bf16 v[240:243], v[116:119], v[48:51], v[240:243]
 ds_read_b128 v[108:111], v0 offset:46080
 v_lshlrev_b32 v6, 16, v87
 v_mfma_f32_16x16x32_bf16 a[176:179], v[116:119], v[52:55], a[176:179]
 v_and_b32 v7, s27, v87
 v_pk_mul_f32 v[4:5], v[4:5], v[12:13]
 v_mfma_f32_16x16x32_bf16 a[176:179], v[112:115], v[36:39], a[176:179]
 v_pk_mul_f32 v[6:7], v[6:7], v[14:15]
 v_cvt_pk_bf16_f32 v86, v4, v5
 v_mfma_f32_16x16x32_bf16 a[240:243], v[112:115], v[40:43], a[240:243]
 v_cvt_pk_bf16_f32 v87, v6, v7
 v_lshlrev_b32 v4, 16, v90
 v_mfma_f32_16x16x32_bf16 a[240:243], v[116:119], v[56:59], a[240:243]
 v_and_b32 v5, s27, v90
 v_lshlrev_b32 v6, 16, v91
 v_mfma_f32_16x16x32_bf16 a[80:83], v[116:119], v[60:63], a[80:83]
 v_and_b32 v7, s27, v91
 v_pk_mul_f32 v[4:5], v[4:5], v[12:13]
 v_mfma_f32_16x16x32_bf16 a[80:83], v[112:115], v[44:47], a[80:83]
 s_waitcnt lgkmcnt(2)
 v_pk_mul_f32 v[6:7], v[6:7], v[14:15]
 v_cvt_pk_bf16_f32 v90, v4, v5
 v_mfma_f32_16x16x32_bf16 v[244:247], v[96:99], v[32:35], v[244:247]
 ds_read_b128 v[112:115], v0 offset:47104
 v_cvt_pk_bf16_f32 v91, v6, v7
 v_mfma_f32_16x16x32_bf16 v[244:247], v[100:103], v[48:51], v[244:247]
 ds_read_b128 v[116:119], v0 offset:48128
 v_lshlrev_b32 v4, 16, v94
 v_mfma_f32_16x16x32_bf16 a[180:183], v[100:103], v[52:55], a[180:183]
 v_and_b32 v5, s27, v94
 v_lshlrev_b32 v6, 16, v95
 v_mfma_f32_16x16x32_bf16 a[180:183], v[96:99], v[36:39], a[180:183]
 v_and_b32 v7, s27, v95
 v_pk_mul_f32 v[4:5], v[4:5], v[12:13]
 v_mfma_f32_16x16x32_bf16 a[244:247], v[96:99], v[40:43], a[244:247]
 v_pk_mul_f32 v[6:7], v[6:7], v[14:15]
 v_cvt_pk_bf16_f32 v94, v4, v5
 v_mfma_f32_16x16x32_bf16 a[244:247], v[100:103], v[56:59], a[244:247]
 s_waitcnt vmcnt(9)
 v_cvt_pk_bf16_f32 v95, v6, v7
 v_mfma_f32_16x16x32_bf16 a[84:87], v[100:103], v[60:63], a[84:87]
 s_barrier
 v_mfma_f32_16x16x32_bf16 a[84:87], v[96:99], v[44:47], a[84:87]
 s_waitcnt lgkmcnt(2)
 v_mfma_f32_16x16x32_bf16 v[248:251], v[104:107], v[32:35], v[248:251]
 ds_read_b128 v[96:99], v0 offset:49152
 v_mfma_f32_16x16x32_bf16 v[248:251], v[108:111], v[48:51], v[248:251]
 ds_read_b128 v[100:103], v0 offset:50176
 v_mfma_f32_16x16x32_bf16 a[184:187], v[108:111], v[52:55], a[184:187]
 v_mfma_f32_16x16x32_bf16 a[184:187], v[104:107], v[36:39], a[184:187]
 v_mfma_f32_16x16x32_bf16 a[248:251], v[104:107], v[40:43], a[248:251]
 v_mfma_f32_16x16x32_bf16 a[248:251], v[108:111], v[56:59], a[248:251]
 v_mfma_f32_16x16x32_bf16 a[88:91], v[108:111], v[60:63], a[88:91]
 v_mfma_f32_16x16x32_bf16 a[88:91], v[104:107], v[44:47], a[88:91]
 s_waitcnt lgkmcnt(2)
 v_mfma_f32_16x16x32_bf16 v[252:255], v[112:115], v[32:35], v[252:255]
 ds_read_b128 v[104:107], v0 offset:51200
 v_mfma_f32_16x16x32_bf16 v[252:255], v[116:119], v[48:51], v[252:255]
 ds_read_b128 v[108:111], v0 offset:52224
 v_mfma_f32_16x16x32_bf16 a[188:191], v[116:119], v[52:55], a[188:191]
 v_mfma_f32_16x16x32_bf16 a[188:191], v[112:115], v[36:39], a[188:191]
 v_mfma_f32_16x16x32_bf16 a[252:255], v[112:115], v[40:43], a[252:255]
 v_mfma_f32_16x16x32_bf16 a[252:255], v[116:119], v[56:59], a[252:255]
 v_mfma_f32_16x16x32_bf16 a[92:95], v[116:119], v[60:63], a[92:95]
 v_mfma_f32_16x16x32_bf16 a[92:95], v[112:115], v[44:47], a[92:95]
 s_waitcnt lgkmcnt(2)
 v_mfma_f32_16x16x32_bf16 v[160:163], v[96:99], v[64:67], v[160:163]
 ds_read_b128 v[112:115], v0 offset:53248
 ds_read_b128 v[8:11], v124 offset:256
 v_mfma_f32_16x16x32_bf16 v[160:163], v[100:103], v[80:83], v[160:163]
 ds_read_b128 v[116:119], v0 offset:54272
 ds_read_b128 v[12:15], v124 offset:272
 v_mfma_f32_16x16x32_bf16 a[96:99], v[100:103], v[84:87], a[96:99]
 v_and_b32 v125, 0xf0, v0
 v_lshlrev_b32 v125, 4, v125
 v_mfma_f32_16x16x32_bf16 a[96:99], v[96:99], v[68:71], a[96:99]
 v_add_u32 v125, 0x3800, v125
 v_mfma_f32_16x16x32_bf16 v[128:131], v[96:99], v[72:75], v[128:131]
 buffer_load_dwordx4 v[48:51], v0, s[32:35], s28 offen
 v_mfma_f32_16x16x32_bf16 v[128:131], v[100:103], v[88:91], v[128:131]
 s_add_u32 s28, s28, 4096
 ds_read_b128 v[120:123], v124 offset:6416
 ds_read_b128 v[4:7], v124 offset:6528
 v_mfma_f32_16x16x32_bf16 a[0:3], v[100:103], v[92:95], a[0:3]
 buffer_load_dwordx4 v[52:55], v0, s[32:35], s28 offen
 v_mfma_f32_16x16x32_bf16 a[0:3], v[96:99], v[76:79], a[0:3]
 s_waitcnt lgkmcnt(6)
 v_mfma_f32_16x16x32_bf16 v[164:167], v[104:107], v[64:67], v[164:167]
 s_add_u32 s28, s28, 4096
 ds_read_b128 v[96:99], v0 offset:55296
 v_mfma_f32_16x16x32_bf16 v[164:167], v[108:111], v[80:83], v[164:167]
 s_waitcnt lgkmcnt(2)
 ds_read_b128 v[100:103], v0 offset:56320
 v_pk_add_f32 v[180:181], v[180:181], v[120:121]
 v_mfma_f32_16x16x32_bf16 a[100:103], v[108:111], v[84:87], a[100:103]
 v_pk_add_f32 v[182:183], v[182:183], v[122:123]
 v_pk_add_f32 v[148:149], v[148:149], v[120:121]
 v_mfma_f32_16x16x32_bf16 a[100:103], v[104:107], v[68:71], a[100:103]
 v_pk_add_f32 v[150:151], v[150:151], v[122:123]
 v_mfma_f32_16x16x32_bf16 v[132:135], v[104:107], v[72:75], v[132:135]
 buffer_load_dwordx4 v[56:59], v0, s[32:35], s28 offen
 v_mfma_f32_16x16x32_bf16 v[132:135], v[108:111], v[88:91], v[132:135]
 s_add_u32 s28, s28, 4096
 ds_read_b128 v[120:123], v124 offset:6544
 v_mfma_f32_16x16x32_bf16 a[4:7], v[108:111], v[92:95], a[4:7]
 s_waitcnt lgkmcnt(3)
 buffer_load_dwordx4 v[60:63], v0, s[32:35], s28 offen
 v_mfma_f32_16x16x32_bf16 a[4:7], v[104:107], v[76:79], a[4:7]
 s_add_u32 s28, s28, 4096
 v_pk_add_f32 v[184:185], v[184:185], v[4:5]
 v_pk_add_f32 v[186:187], v[186:187], v[6:7]
 v_mfma_f32_16x16x32_bf16 v[168:171], v[112:115], v[64:67], v[168:171]
 s_add_u32 s17, s17, 4096
 ds_read_b128 v[104:107], v0 offset:57344
 v_pk_add_f32 v[152:153], v[152:153], v[4:5]
 v_mfma_f32_16x16x32_bf16 v[168:171], v[116:119], v[80:83], v[168:171]
 s_add_u32 m0, s24, 0x19000
 ds_read_b128 v[108:111], v0 offset:58368
 v_pk_add_f32 v[154:155], v[154:155], v[6:7]
 v_mfma_f32_16x16x32_bf16 a[104:107], v[116:119], v[84:87], a[104:107]
 ds_read_b128 v[4:7], v124 offset:6144
 v_mfma_f32_16x16x32_bf16 a[104:107], v[112:115], v[68:71], a[104:107]
 s_waitcnt lgkmcnt(3)
 v_pk_add_f32 v[188:189], v[188:189], v[120:121]
 v_pk_add_f32 v[190:191], v[190:191], v[122:123]
 v_mfma_f32_16x16x32_bf16 v[136:139], v[112:115], v[72:75], v[136:139]
 buffer_load_dwordx4 v0, s[36:39], s17 offen offset:0 sc1 lds
 v_mfma_f32_16x16x32_bf16 v[136:139], v[116:119], v[88:91], v[136:139]
 v_pk_add_f32 v[156:157], v[156:157], v[120:121]
 v_pk_add_f32 v[158:159], v[158:159], v[122:123]
 v_mfma_f32_16x16x32_bf16 a[8:11], v[116:119], v[92:95], a[8:11]
 ds_read_b128 v[120:123], v124 offset:6160
 v_mfma_f32_16x16x32_bf16 a[8:11], v[112:115], v[76:79], a[8:11]
 s_waitcnt lgkmcnt(1)
 v_pk_add_f32 v[160:161], v[160:161], v[4:5]
 v_pk_add_f32 v[162:163], v[162:163], v[6:7]
 v_mfma_f32_16x16x32_bf16 v[172:175], v[96:99], v[64:67], v[172:175]
 ds_read_b128 v[112:115], v0 offset:59392
 v_pk_add_f32 v[128:129], v[128:129], v[4:5]
 v_mfma_f32_16x16x32_bf16 v[172:175], v[100:103], v[80:83], v[172:175]
 ds_read_b128 v[116:119], v0 offset:60416
 v_pk_add_f32 v[130:131], v[130:131], v[6:7]
 v_mfma_f32_16x16x32_bf16 a[108:111], v[100:103], v[84:87], a[108:111]
 ds_read_b128 v[4:7], v124 offset:6272
 v_mfma_f32_16x16x32_bf16 a[108:111], v[96:99], v[68:71], a[108:111]
 s_waitcnt lgkmcnt(3)
 v_pk_add_f32 v[164:165], v[164:165], v[120:121]
 v_pk_add_f32 v[166:167], v[166:167], v[122:123]
 v_mfma_f32_16x16x32_bf16 v[140:143], v[96:99], v[72:75], v[140:143]
 buffer_load_dwordx4 v0, s[36:39], s17 offen offset:1024 sc1 lds
 v_mfma_f32_16x16x32_bf16 v[140:143], v[100:103], v[88:91], v[140:143]
 v_pk_add_f32 v[132:133], v[132:133], v[120:121]
 v_pk_add_f32 v[134:135], v[134:135], v[122:123]
 v_mfma_f32_16x16x32_bf16 a[12:15], v[100:103], v[92:95], a[12:15]
 ds_read_b128 v[120:123], v124 offset:6288
 v_mfma_f32_16x16x32_bf16 a[12:15], v[96:99], v[76:79], a[12:15]
 v_mfma_f32_16x16x32_bf16 v[176:179], v[104:107], v[64:67], v[176:179]
 s_waitcnt lgkmcnt(1)
 ds_read_b128 v[96:99], v0 offset:61440
 v_pk_add_f32 v[168:169], v[168:169], v[4:5]
 v_mfma_f32_16x16x32_bf16 v[176:179], v[108:111], v[80:83], v[176:179]
 ds_read_b128 v[100:103], v0 offset:62464
 v_pk_add_f32 v[170:171], v[170:171], v[6:7]
 v_mfma_f32_16x16x32_bf16 a[112:115], v[108:111], v[84:87], a[112:115]
 v_pk_add_f32 v[136:137], v[136:137], v[4:5]
 v_pk_add_f32 v[138:139], v[138:139], v[6:7]
 v_mfma_f32_16x16x32_bf16 a[112:115], v[104:107], v[68:71], a[112:115]
 ds_read_b128 v[4:7], v124 offset:6400
 v_mfma_f32_16x16x32_bf16 v[144:147], v[104:107], v[72:75], v[144:147]
 buffer_load_dwordx4 v0, s[36:39], s17 offen offset:2048 sc1 lds
 v_mfma_f32_16x16x32_bf16 v[144:147], v[108:111], v[88:91], v[144:147]
 v_mfma_f32_16x16x32_bf16 a[16:19], v[108:111], v[92:95], a[16:19]
 v_mfma_f32_16x16x32_bf16 a[16:19], v[104:107], v[76:79], a[16:19]
 v_mfma_f32_16x16x32_bf16 v[180:183], v[112:115], v[64:67], v[180:183]
 s_waitcnt lgkmcnt(3)
 ds_read_b128 v[104:107], v0 offset:63488
 v_pk_add_f32 v[172:173], v[172:173], v[120:121]
 v_mfma_f32_16x16x32_bf16 v[180:183], v[116:119], v[80:83], v[180:183]
 ds_read_b128 v[108:111], v0 offset:64512
 v_pk_add_f32 v[174:175], v[174:175], v[122:123]
 v_mfma_f32_16x16x32_bf16 a[116:119], v[116:119], v[84:87], a[116:119]
 v_pk_add_f32 v[140:141], v[140:141], v[120:121]
 v_pk_add_f32 v[142:143], v[142:143], v[122:123]
 v_mfma_f32_16x16x32_bf16 a[116:119], v[112:115], v[68:71], a[116:119]
 v_mfma_f32_16x16x32_bf16 v[148:151], v[112:115], v[72:75], v[148:151]
 buffer_load_dwordx4 v0, s[36:39], s17 offen offset:3072 sc1 lds
 v_mfma_f32_16x16x32_bf16 v[148:151], v[116:119], v[88:91], v[148:151]
 v_mfma_f32_16x16x32_bf16 a[20:23], v[116:119], v[92:95], a[20:23]
 v_mfma_f32_16x16x32_bf16 a[20:23], v[112:115], v[76:79], a[20:23]
 s_waitcnt lgkmcnt(3)
 v_mfma_f32_16x16x32_bf16 v[184:187], v[96:99], v[64:67], v[184:187]
 s_add_u32 s17, s17, 4096
 ds_read_b128 v[112:115], v2 offset:0
 v_mfma_f32_16x16x32_bf16 v[184:187], v[100:103], v[80:83], v[184:187]
 s_add_u32 m0, s24, 0x1a000
 ds_read_b128 v[116:119], v2 offset:1024
 v_mfma_f32_16x16x32_bf16 a[120:123], v[100:103], v[84:87], a[120:123]
 s_waitcnt lgkmcnt(4)
 v_pk_add_f32 v[176:177], v[176:177], v[4:5]
 v_pk_add_f32 v[178:179], v[178:179], v[6:7]
 v_mfma_f32_16x16x32_bf16 a[120:123], v[96:99], v[68:71], a[120:123]
 v_pk_add_f32 v[144:145], v[144:145], v[4:5]
 v_pk_add_f32 v[146:147], v[146:147], v[6:7]
 v_mfma_f32_16x16x32_bf16 v[152:155], v[96:99], v[72:75], v[152:155]
 buffer_load_dwordx4 v0, s[36:39], s17 offen offset:0 sc1 lds
 v_mfma_f32_16x16x32_bf16 v[152:155], v[100:103], v[88:91], v[152:155]
 v_mfma_f32_16x16x32_bf16 a[24:27], v[100:103], v[92:95], a[24:27]
 v_mfma_f32_16x16x32_bf16 a[24:27], v[96:99], v[76:79], a[24:27]
 s_waitcnt lgkmcnt(2)
 v_mfma_f32_16x16x32_bf16 v[188:191], v[104:107], v[64:67], v[188:191]
 ds_read_b128 v[96:99], v2 offset:2048
 v_mfma_f32_16x16x32_bf16 v[188:191], v[108:111], v[80:83], v[188:191]
 ds_read_b128 v[100:103], v2 offset:3072
 v_mfma_f32_16x16x32_bf16 a[124:127], v[108:111], v[84:87], a[124:127]
 v_mfma_f32_16x16x32_bf16 a[124:127], v[104:107], v[68:71], a[124:127]
 v_mfma_f32_16x16x32_bf16 v[156:159], v[104:107], v[72:75], v[156:159]
 buffer_load_dwordx4 v0, s[36:39], s17 offen offset:1024 sc1 lds
 v_mfma_f32_16x16x32_bf16 v[156:159], v[108:111], v[88:91], v[156:159]
 v_mfma_f32_16x16x32_bf16 a[28:31], v[108:111], v[92:95], a[28:31]
 v_mfma_f32_16x16x32_bf16 a[28:31], v[104:107], v[76:79], a[28:31]
 s_waitcnt lgkmcnt(2)
 v_mfma_f32_16x16x32_bf16 v[192:195], v[112:115], v[64:67], v[192:195]
 s_waitcnt vmcnt(10)
 ds_read_b128 v[104:107], v2 offset:4096
 v_fma_f32 v8, v8, s29, 1.0
 v_mfma_f32_16x16x32_bf16 v[192:195], v[116:119], v[80:83], v[192:195]
 ds_read_b128 v[108:111], v2 offset:5120
 v_fma_f32 v9, v9, s29, 1.0
 v_mfma_f32_16x16x32_bf16 a[128:131], v[116:119], v[84:87], a[128:131]
 v_fma_f32 v10, v10, s29, 1.0
 v_fma_f32 v11, v11, s29, 1.0
 v_mfma_f32_16x16x32_bf16 a[128:131], v[112:115], v[68:71], a[128:131]
 v_lshlrev_b32 v4, 16, v16
 v_and_b32 v5, s27, v16
 v_mfma_f32_16x16x32_bf16 a[192:195], v[112:115], v[72:75], a[192:195]
 buffer_load_dwordx4 v0, s[36:39], s17 offen offset:2048 sc1 lds
 v_mfma_f32_16x16x32_bf16 a[192:195], v[116:119], v[88:91], a[192:195]
 v_lshlrev_b32 v6, 16, v17
 v_and_b32 v7, s27, v17
 v_mfma_f32_16x16x32_bf16 a[32:35], v[116:119], v[92:95], a[32:35]
 v_pk_mul_f32 v[4:5], v[4:5], v[8:9]
 v_pk_mul_f32 v[6:7], v[6:7], v[10:11]
 v_mfma_f32_16x16x32_bf16 a[32:35], v[112:115], v[76:79], a[32:35]
 s_waitcnt lgkmcnt(2)
 v_cvt_pk_bf16_f32 v32, v4, v5
 v_cvt_pk_bf16_f32 v33, v6, v7
 v_mfma_f32_16x16x32_bf16 v[196:199], v[96:99], v[64:67], v[196:199]
 ds_read_b128 v[112:115], v2 offset:6144
 v_lshlrev_b32 v4, 16, v20
 v_mfma_f32_16x16x32_bf16 v[196:199], v[100:103], v[80:83], v[196:199]
 ds_read_b128 v[116:119], v2 offset:7168
 v_and_b32 v5, s27, v20
 v_mfma_f32_16x16x32_bf16 a[132:135], v[100:103], v[84:87], a[132:135]
 v_lshlrev_b32 v6, 16, v21
 v_and_b32 v7, s27, v21
 v_mfma_f32_16x16x32_bf16 a[132:135], v[96:99], v[68:71], a[132:135]
 v_pk_mul_f32 v[4:5], v[4:5], v[8:9]
 v_pk_mul_f32 v[6:7], v[6:7], v[10:11]
 v_mfma_f32_16x16x32_bf16 a[196:199], v[96:99], v[72:75], a[196:199]
 buffer_load_dwordx4 v0, s[36:39], s17 offen offset:3072 sc1 lds
 v_mfma_f32_16x16x32_bf16 a[196:199], v[100:103], v[88:91], a[196:199]
 v_cvt_pk_bf16_f32 v36, v4, v5
 v_cvt_pk_bf16_f32 v37, v6, v7
 v_mfma_f32_16x16x32_bf16 a[36:39], v[100:103], v[92:95], a[36:39]
 v_lshlrev_b32 v4, 16, v24
 v_and_b32 v5, s27, v24
 v_mfma_f32_16x16x32_bf16 a[36:39], v[96:99], v[76:79], a[36:39]
 s_waitcnt lgkmcnt(2)
 v_lshlrev_b32 v6, 16, v25
 v_and_b32 v7, s27, v25
 v_mfma_f32_16x16x32_bf16 v[200:203], v[104:107], v[64:67], v[200:203]
 ds_read_b128 v[96:99], v2 offset:8192
 v_pk_mul_f32 v[4:5], v[4:5], v[8:9]
 v_mfma_f32_16x16x32_bf16 v[200:203], v[108:111], v[80:83], v[200:203]
 ds_read_b128 v[100:103], v2 offset:9216
 v_pk_mul_f32 v[6:7], v[6:7], v[10:11]
 v_mfma_f32_16x16x32_bf16 a[136:139], v[108:111], v[84:87], a[136:139]
 v_cvt_pk_bf16_f32 v40, v4, v5
 v_cvt_pk_bf16_f32 v41, v6, v7
 v_mfma_f32_16x16x32_bf16 a[136:139], v[104:107], v[68:71], a[136:139]
 v_lshlrev_b32 v4, 16, v28
 v_and_b32 v5, s27, v28
 v_mfma_f32_16x16x32_bf16 a[200:203], v[104:107], v[72:75], a[200:203]
 v_lshlrev_b32 v6, 16, v29
 v_and_b32 v7, s27, v29
 v_mfma_f32_16x16x32_bf16 a[200:203], v[108:111], v[88:91], a[200:203]
 v_pk_mul_f32 v[4:5], v[4:5], v[8:9]
 v_pk_mul_f32 v[6:7], v[6:7], v[10:11]
 v_mfma_f32_16x16x32_bf16 a[40:43], v[108:111], v[92:95], a[40:43]
 v_cvt_pk_bf16_f32 v44, v4, v5
 v_cvt_pk_bf16_f32 v45, v6, v7
 v_mfma_f32_16x16x32_bf16 a[40:43], v[104:107], v[76:79], a[40:43]
 s_waitcnt lgkmcnt(2)
 ds_read_b128 v[8:11], v124 offset:384
 v_mfma_f32_16x16x32_bf16 v[204:207], v[112:115], v[64:67], v[204:207]
 ds_read_b128 v[104:107], v2 offset:10240
 v_fma_f32 v12, v12, s29, 1.0
 v_mfma_f32_16x16x32_bf16 v[204:207], v[116:119], v[80:83], v[204:207]
 ds_read_b128 v[108:111], v2 offset:11264
 v_fma_f32 v13, v13, s29, 1.0
 v_mfma_f32_16x16x32_bf16 a[140:143], v[116:119], v[84:87], a[140:143]
 v_fma_f32 v14, v14, s29, 1.0
 v_fma_f32 v15, v15, s29, 1.0
 v_mfma_f32_16x16x32_bf16 a[140:143], v[112:115], v[68:71], a[140:143]
 v_lshlrev_b32 v4, 16, v18
 v_and_b32 v5, s27, v18
 v_mfma_f32_16x16x32_bf16 a[204:207], v[112:115], v[72:75], a[204:207]
 buffer_load_dword v127, v125, s[12:15], 0 offen sc1
 v_mfma_f32_16x16x32_bf16 a[204:207], v[116:119], v[88:91], a[204:207]
 v_lshlrev_b32 v6, 16, v19
 v_and_b32 v7, s27, v19
 v_mfma_f32_16x16x32_bf16 a[44:47], v[116:119], v[92:95], a[44:47]
 v_pk_mul_f32 v[4:5], v[4:5], v[12:13]
 v_pk_mul_f32 v[6:7], v[6:7], v[14:15]
 v_mfma_f32_16x16x32_bf16 a[44:47], v[112:115], v[76:79], a[44:47]
 s_waitcnt lgkmcnt(3)
 v_cvt_pk_bf16_f32 v34, v4, v5
 v_cvt_pk_bf16_f32 v35, v6, v7
 v_mfma_f32_16x16x32_bf16 v[208:211], v[96:99], v[64:67], v[208:211]
 ds_read_b128 v[112:115], v2 offset:12288
 v_lshlrev_b32 v4, 16, v22
 v_mfma_f32_16x16x32_bf16 v[208:211], v[100:103], v[80:83], v[208:211]
 ds_read_b128 v[116:119], v2 offset:13312
 v_and_b32 v5, s27, v22
 v_mfma_f32_16x16x32_bf16 a[144:147], v[100:103], v[84:87], a[144:147]
 v_lshlrev_b32 v6, 16, v23
 v_and_b32 v7, s27, v23
 v_mfma_f32_16x16x32_bf16 a[144:147], v[96:99], v[68:71], a[144:147]
 v_pk_mul_f32 v[4:5], v[4:5], v[12:13]
 v_pk_mul_f32 v[6:7], v[6:7], v[14:15]
 v_mfma_f32_16x16x32_bf16 a[208:211], v[96:99], v[72:75], a[208:211]
 v_cvt_pk_bf16_f32 v38, v4, v5
 v_cvt_pk_bf16_f32 v39, v6, v7
 v_mfma_f32_16x16x32_bf16 a[208:211], v[100:103], v[88:91], a[208:211]
 v_lshlrev_b32 v4, 16, v26
 v_and_b32 v5, s27, v26
 v_mfma_f32_16x16x32_bf16 a[48:51], v[100:103], v[92:95], a[48:51]
 v_lshlrev_b32 v6, 16, v27
 v_and_b32 v7, s27, v27
 v_mfma_f32_16x16x32_bf16 a[48:51], v[96:99], v[76:79], a[48:51]
 s_waitcnt lgkmcnt(2)
 v_pk_mul_f32 v[4:5], v[4:5], v[12:13]
 v_pk_mul_f32 v[6:7], v[6:7], v[14:15]
 v_mfma_f32_16x16x32_bf16 v[212:215], v[104:107], v[64:67], v[212:215]
 ds_read_b128 v[96:99], v2 offset:14336
 v_cvt_pk_bf16_f32 v42, v4, v5
 v_mfma_f32_16x16x32_bf16 v[212:215], v[108:111], v[80:83], v[212:215]
 ds_read_b128 v[100:103], v2 offset:15360
 v_cvt_pk_bf16_f32 v43, v6, v7
 v_mfma_f32_16x16x32_bf16 a[148:151], v[108:111], v[84:87], a[148:151]
 v_lshlrev_b32 v4, 16, v30
 v_and_b32 v5, s27, v30
 v_mfma_f32_16x16x32_bf16 a[148:151], v[104:107], v[68:71], a[148:151]
 v_lshlrev_b32 v6, 16, v31
 v_and_b32 v7, s27, v31
 v_mfma_f32_16x16x32_bf16 a[212:215], v[104:107], v[72:75], a[212:215]
 v_pk_mul_f32 v[4:5], v[4:5], v[12:13]
 v_pk_mul_f32 v[6:7], v[6:7], v[14:15]
 v_mfma_f32_16x16x32_bf16 a[212:215], v[108:111], v[88:91], a[212:215]
 v_cvt_pk_bf16_f32 v46, v4, v5
 v_cvt_pk_bf16_f32 v47, v6, v7
 v_mfma_f32_16x16x32_bf16 a[52:55], v[108:111], v[92:95], a[52:55]
 ds_read_b128 v[12:15], v124 offset:400
 v_mfma_f32_16x16x32_bf16 a[52:55], v[104:107], v[76:79], a[52:55]
 s_waitcnt lgkmcnt(3)
 v_mfma_f32_16x16x32_bf16 v[216:219], v[112:115], v[64:67], v[216:219]
 s_waitcnt vmcnt(9)
 ds_read_b128 v[104:107], v2 offset:16384
 v_fma_f32 v8, v8, s29, 1.0
 v_mfma_f32_16x16x32_bf16 v[216:219], v[116:119], v[80:83], v[216:219]
 ds_read_b128 v[108:111], v2 offset:17408
 v_fma_f32 v9, v9, s29, 1.0
 v_mfma_f32_16x16x32_bf16 a[152:155], v[116:119], v[84:87], a[152:155]
 v_fma_f32 v10, v10, s29, 1.0
 v_fma_f32 v11, v11, s29, 1.0
 v_mfma_f32_16x16x32_bf16 a[152:155], v[112:115], v[68:71], a[152:155]
 v_lshlrev_b32 v4, 16, v48
 v_and_b32 v5, s27, v48
 v_mfma_f32_16x16x32_bf16 a[216:219], v[112:115], v[72:75], a[216:219]
 v_lshlrev_b32 v6, 16, v49
 v_and_b32 v7, s27, v49
 v_mfma_f32_16x16x32_bf16 a[216:219], v[116:119], v[88:91], a[216:219]
 v_mul_f32 v4, v4, v8
 v_mul_f32 v5, v5, v9
 v_mfma_f32_16x16x32_bf16 a[56:59], v[116:119], v[92:95], a[56:59]
 v_mul_f32 v6, v6, v10
 v_mul_f32 v7, v7, v11
 v_mfma_f32_16x16x32_bf16 a[56:59], v[112:115], v[76:79], a[56:59]
 s_waitcnt lgkmcnt(3)
 v_cvt_pk_bf16_f32 v48, v4, v5
 v_cvt_pk_bf16_f32 v49, v6, v7
 v_mfma_f32_16x16x32_bf16 v[220:223], v[96:99], v[64:67], v[220:223]
 ds_read_b128 v[112:115], v2 offset:18432
 v_lshlrev_b32 v4, 16, v52
 v_mfma_f32_16x16x32_bf16 v[220:223], v[100:103], v[80:83], v[220:223]
 ds_read_b128 v[116:119], v2 offset:19456
 v_and_b32 v5, s27, v52
 v_mfma_f32_16x16x32_bf16 a[156:159], v[100:103], v[84:87], a[156:159]
 v_lshlrev_b32 v6, 16, v53
 v_and_b32 v7, s27, v53
 v_mfma_f32_16x16x32_bf16 a[156:159], v[96:99], v[68:71], a[156:159]
 v_mul_f32 v4, v4, v8
 v_mul_f32 v5, v5, v9
 v_mfma_f32_16x16x32_bf16 a[220:223], v[96:99], v[72:75], a[220:223]
 v_mul_f32 v6, v6, v10
 v_mul_f32 v7, v7, v11
 v_mfma_f32_16x16x32_bf16 a[220:223], v[100:103], v[88:91], a[220:223]
 v_cvt_pk_bf16_f32 v52, v4, v5
 v_cvt_pk_bf16_f32 v53, v6, v7
 v_mfma_f32_16x16x32_bf16 a[60:63], v[100:103], v[92:95], a[60:63]
 v_lshlrev_b32 v4, 16, v56
 v_and_b32 v5, s27, v56
 v_mfma_f32_16x16x32_bf16 a[60:63], v[96:99], v[76:79], a[60:63]
 s_waitcnt lgkmcnt(2)
 v_lshlrev_b32 v6, 16, v57
 v_and_b32 v7, s27, v57
 v_mfma_f32_16x16x32_bf16 v[224:227], v[104:107], v[64:67], v[224:227]
 ds_read_b128 v[96:99], v2 offset:20480
 v_mul_f32 v4, v4, v8
 v_mfma_f32_16x16x32_bf16 v[224:227], v[108:111], v[80:83], v[224:227]
 ds_read_b128 v[100:103], v2 offset:21504
 v_mul_f32 v5, v5, v9
 v_mfma_f32_16x16x32_bf16 a[160:163], v[108:111], v[84:87], a[160:163]
 v_mul_f32 v6, v6, v10
 v_mul_f32 v7, v7, v11
 v_mfma_f32_16x16x32_bf16 a[160:163], v[104:107], v[68:71], a[160:163]
 v_cvt_pk_bf16_f32 v56, v4, v5
 v_cvt_pk_bf16_f32 v57, v6, v7
 v_mfma_f32_16x16x32_bf16 a[224:227], v[104:107], v[72:75], a[224:227]
 buffer_load_dwordx4 v[16:19], v0, s[32:35], s28 offen
 v_mfma_f32_16x16x32_bf16 a[224:227], v[108:111], v[88:91], a[224:227]
 s_add_u32 s28, s28, 4096
 v_lshlrev_b32 v4, 16, v60
 v_and_b32 v5, s27, v60
 v_mfma_f32_16x16x32_bf16 a[64:67], v[108:111], v[92:95], a[64:67]
 buffer_load_dwordx4 v[20:23], v0, s[32:35], s28 offen
 v_mfma_f32_16x16x32_bf16 a[64:67], v[104:107], v[76:79], a[64:67]
 s_waitcnt lgkmcnt(2)
 v_lshlrev_b32 v6, 16, v61
 v_and_b32 v7, s27, v61
 v_mfma_f32_16x16x32_bf16 v[228:231], v[112:115], v[64:67], v[228:231]
 s_add_u32 s28, s28, 4096
 ds_read_b128 v[104:107], v2 offset:22528
 v_mul_f32 v4, v4, v8
 v_mfma_f32_16x16x32_bf16 v[228:231], v[116:119], v[80:83], v[228:231]
 ds_read_b128 v[108:111], v2 offset:23552
 v_mul_f32 v5, v5, v9
 v_mfma_f32_16x16x32_bf16 a[164:167], v[116:119], v[84:87], a[164:167]
 v_mul_f32 v6, v6, v10
 v_mul_f32 v7, v7, v11
 v_mfma_f32_16x16x32_bf16 a[164:167], v[112:115], v[68:71], a[164:167]
 v_cvt_pk_bf16_f32 v60, v4, v5
 v_cvt_pk_bf16_f32 v61, v6, v7
 v_mfma_f32_16x16x32_bf16 a[228:231], v[112:115], v[72:75], a[228:231]
 buffer_load_dwordx4 v[24:27], v0, s[32:35], s28 offen
 v_mfma_f32_16x16x32_bf16 a[228:231], v[116:119], v[88:91], a[228:231]
 s_add_u32 s28, s28, 4096
 v_fma_f32 v12, v12, s29, 1.0
 v_fma_f32 v13, v13, s29, 1.0
 v_mfma_f32_16x16x32_bf16 a[68:71], v[116:119], v[92:95], a[68:71]
 buffer_load_dwordx4 v[28:31], v0, s[32:35], s28 offen
 v_mfma_f32_16x16x32_bf16 a[68:71], v[112:115], v[76:79], a[68:71]
 s_waitcnt lgkmcnt(2)
 v_fma_f32 v14, v14, s29, 1.0
 v_fma_f32 v15, v15, s29, 1.0
 v_mfma_f32_16x16x32_bf16 v[232:235], v[96:99], v[64:67], v[232:235]
 s_add_u32 s28, s28, 4096
 ds_read_b128 v[112:115], v2 offset:24576
 v_lshlrev_b32 v4, 16, v50
 v_mfma_f32_16x16x32_bf16 v[232:235], v[100:103], v[80:83], v[232:235]
 s_mov_b32 s25, 65536
 s_waitcnt vmcnt(4)
 v_cmp_gt_u32 vcc, 16, v127
 s_nop 4
 s_cbranch_vccz L_pollC_ok
L_pollC_spin:
 s_sleep 16
 buffer_load_dword v127, v125, s[12:15], 0 offen sc1
 s_sub_u32 s25, s25, 1
 s_waitcnt vmcnt(0)
 s_cbranch_scc1 L_pollC_ok
 v_cmp_gt_u32 vcc, 16, v127
 s_nop 4
 s_cbranch_vccnz L_pollC_spin
L_pollC_ok:
 ds_read_b128 v[116:119], v2 offset:25600
 v_mfma_f32_16x16x32_bf16 a[168:171], v[100:103], v[84:87], a[168:171]
 v_and_b32 v5, s27, v50
 v_lshlrev_b32 v6, 16, v51
 v_mfma_f32_16x16x32_bf16 a[168:171], v[96:99], v[68:71], a[168:171]
 s_barrier
 v_mfma_f32_16x16x32_bf16 a[232:235], v[96:99], v[72:75], a[232:235]
 v_and_b32 v7, s27, v51
 v_mul_f32 v4, v4, v12
 v_mfma_f32_16x16x32_bf16 a[232:235], v[100:103], v[88:91], a[232:235]
 v_mul_f32 v5, v5, v13
 v_mul_f32 v6, v6, v14
 v_mfma_f32_16x16x32_bf16 a[72:75], v[100:103], v[92:95], a[72:75]
 v_mul_f32 v7, v7, v15
 v_cvt_pk_bf16_f32 v50, v4, v5
 v_mfma_f32_16x16x32_bf16 a[72:75], v[96:99], v[76:79], a[72:75]
 s_waitcnt lgkmcnt(2)
 v_cvt_pk_bf16_f32 v51, v6, v7
 v_lshlrev_b32 v4, 16, v54
 v_mfma_f32_16x16x32_bf16 v[236:239], v[104:107], v[64:67], v[236:239]
 s_add_u32 s17, s17, 0x12a000
 ds_read_b128 v[96:99], v2 offset:26624
 v_and_b32 v5, s27, v54
 v_mfma_f32_16x16x32_bf16 v[236:239], v[108:111], v[80:83], v[236:239]
 s_add_u32 m0, s24, 0x0
 ds_read_b128 v[100:103], v2 offset:27648
 v_lshlrev_b32 v6, 16, v55
 v_mfma_f32_16x16x32_bf16 a[172:175], v[108:111], v[84:87], a[172:175]
 v_and_b32 v7, s27, v55
 v_mul_f32 v4, v4, v12
 v_mfma_f32_16x16x32_bf16 a[172:175], v[104:107], v[68:71], a[172:175]
 v_mul_f32 v5, v5, v13
 v_mul_f32 v6, v6, v14
 v_mfma_f32_16x16x32_bf16 a[236:239], v[104:107], v[72:75], a[236:239]
 buffer_load_dwordx4 v0, s[36:39], s17 offen offset:0 sc1 lds
 v_mfma_f32_16x16x32_bf16 a[236:239], v[108:111], v[88:91], a[236:239]
 v_mul_f32 v7, v7, v15
 v_cvt_pk_bf16_f32 v54, v4, v5
 v_mfma_f32_16x16x32_bf16 a[76:79], v[108:111], v[92:95], a[76:79]
 buffer_load_dwordx4 v0, s[36:39], s17 offen offset:1024 sc1 lds
 v_mfma_f32_16x16x32_bf16 a[76:79], v[104:107], v[76:79], a[76:79]
 s_waitcnt lgkmcnt(2)
 v_cvt_pk_bf16_f32 v55, v6, v7
 v_lshlrev_b32 v4, 16, v58
 v_mfma_f32_16x16x32_bf16 v[240:243], v[112:115], v[64:67], v[240:243]
 ds_read_b128 v[104:107], v2 offset:28672
 v_and_b32 v5, s27, v58
 v_mfma_f32_16x16x32_bf16 v[240:243], v[116:119], v[80:83], v[240:243]
 ds_read_b128 v[108:111], v2 offset:29696
 v_lshlrev_b32 v6, 16, v59
 v_mfma_f32_16x16x32_bf16 a[176:179], v[116:119], v[84:87], a[176:179]
 v_and_b32 v7, s27, v59
 v_mul_f32 v4, v4, v12
 v_mfma_f32_16x16x32_bf16 a[176:179], v[112:115], v[68:71], a[176:179]
 v_mul_f32 v5, v5, v13
 v_mul_f32 v6, v6, v14
 v_mfma_f32_16x16x32_bf16 a[240:243], v[112:115], v[72:75], a[240:243]
 buffer_load_dwordx4 v0, s[36:39], s17 offen offset:2048 sc1 lds
 v_mfma_f32_16x16x32_bf16 a[240:243], v[116:119], v[88:91], a[240:243]
 v_mul_f32 v7, v7, v15
 v_cvt_pk_bf16_f32 v58, v4, v5
 v_mfma_f32_16x16x32_bf16 a[80:83], v[116:119], v[92:95], a[80:83]
 buffer_load_dwordx4 v0, s[36:39], s17 offen offset:3072 sc1 lds
 v_mfma_f32_16x16x32_bf16 a[80:83], v[112:115], v[76:79], a[80:83]
 s_waitcnt lgkmcnt(2)
 v_cvt_pk_bf16_f32 v59, v6, v7
 v_lshlrev_b32 v4, 16, v62
 v_mfma_f32_16x16x32_bf16 v[244:247], v[96:99], v[64:67], v[244:247]
 s_add_u32 s17, s17, 4096
 ds_read_b128 v[112:115], v2 offset:30720
 v_and_b32 v5, s27, v62
 v_mfma_f32_16x16x32_bf16 v[244:247], v[100:103], v[80:83], v[244:247]
 s_add_u32 m0, s24, 0x1000
 ds_read_b128 v[116:119], v2 offset:31744
 v_lshlrev_b32 v6, 16, v63
 v_mfma_f32_16x16x32_bf16 a[180:183], v[100:103], v[84:87], a[180:183]
 v_and_b32 v7, s27, v63
 v_mul_f32 v4, v4, v12
 v_mfma_f32_16x16x32_bf16 a[180:183], v[96:99], v[68:71], a[180:183]
 v_mul_f32 v5, v5, v13
 v_mul_f32 v6, v6, v14
 v_mfma_f32_16x16x32_bf16 a[244:247], v[96:99], v[72:75], a[244:247]
 buffer_load_dwordx4 v0, s[36:39], s17 offen offset:0 sc1 lds
 v_mfma_f32_16x16x32_bf16 a[244:247], v[100:103], v[88:91], a[244:247]
 v_mul_f32 v7, v7, v15
 v_cvt_pk_bf16_f32 v62, v4, v5
 v_mfma_f32_16x16x32_bf16 a[84:87], v[100:103], v[92:95], a[84:87]
 v_cvt_pk_bf16_f32 v63, v6, v7
 v_mfma_f32_16x16x32_bf16 a[84:87], v[96:99], v[76:79], a[84:87]
 s_waitcnt lgkmcnt(2)
 v_mfma_f32_16x16x32_bf16 v[248:251], v[104:107], v[64:67], v[248:251]
 ds_read_b128 v[96:99], v2 offset:32768
 v_mfma_f32_16x16x32_bf16 v[248:251], v[108:111], v[80:83], v[248:251]
 ds_read_b128 v[100:103], v2 offset:33792
 v_mfma_f32_16x16x32_bf16 a[184:187], v[108:111], v[84:87], a[184:187]
 v_mfma_f32_16x16x32_bf16 a[184:187], v[104:107], v[68:71], a[184:187]
 v_mfma_f32_16x16x32_bf16 a[248:251], v[104:107], v[72:75], a[248:251]
 buffer_load_dwordx4 v0, s[36:39], s17 offen offset:1024 sc1 lds
 v_mfma_f32_16x16x32_bf16 a[248:251], v[108:111], v[88:91], a[248:251]
 v_mfma_f32_16x16x32_bf16 a[88:91], v[108:111], v[92:95], a[88:91]
 buffer_load_dwordx4 v0, s[36:39], s17 offen offset:2048 sc1 lds
 v_mfma_f32_16x16x32_bf16 a[88:91], v[104:107], v[76:79], a[88:91]
 s_waitcnt lgkmcnt(2)
 v_mfma_f32_16x16x32_bf16 v[252:255], v[112:115], v[64:67], v[252:255]
 ds_read_b128 v[104:107], v2 offset:34816
 v_mfma_f32_16x16x32_bf16 v[252:255], v[116:119], v[80:83], v[252:255]
 ds_read_b128 v[108:111], v2 offset:35840
 v_mfma_f32_16x16x32_bf16 a[188:191], v[116:119], v[84:87], a[188:191]
 v_mfma_f32_16x16x32_bf16 a[188:191], v[112:115], v[68:71], a[188:191]
 v_mfma_f32_16x16x32_bf16 a[252:255], v[112:115], v[72:75], a[252:255]
 buffer_load_dwordx4 v0, s[36:39], s17 offen offset:3072 sc1 lds
 v_mfma_f32_16x16x32_bf16 a[252:255], v[116:119], v[88:91], a[252:255]
 v_mfma_f32_16x16x32_bf16 a[92:95], v[116:119], v[92:95], a[92:95]
 v_mfma_f32_16x16x32_bf16 a[92:95], v[112:115], v[76:79], a[92:95]
 s_waitcnt lgkmcnt(2)
 v_mfma_f32_16x16x32_bf16 v[160:163], v[96:99], v[32:35], v[160:163]
 ds_read_b128 v[112:115], v2 offset:36864
 v_and_b32 v126, 0xf0, v0
 v_mfma_f32_16x16x32_bf16 v[160:163], v[100:103], v[48:51], v[160:163]
 ds_read_b128 v[116:119], v2 offset:37888
 v_lshl_add_u32 v126, v126, 2, s95
 v_mfma_f32_16x16x32_bf16 a[96:99], v[100:103], v[52:55], a[96:99]
 v_min_u32 v126, L_end-L_k3_loop, v126
 v_add_co_u32 v126, vcc, s40, v126
 v_mfma_f32_16x16x32_bf16 a[96:99], v[96:99], v[36:39], a[96:99]
 v_mov_b32 v127, s41
 v_mov_b32 v127, s41
 v_mfma_f32_16x16x32_bf16 v[128:131], v[96:99], v[40:43], v[128:131]
 buffer_load_dwordx4 v[4:7], v0, s[32:35], s28 offen
 v_mfma_f32_16x16x32_bf16 v[128:131], v[100:103], v[56:59], v[128:131]
 s_add_u32 s28, s28, 4096
 v_addc_co_u32 v127, vcc, 0, v127, vcc
 v_mfma_f32_16x16x32_bf16 a[0:3], v[100:103], v[60:63], a[0:3]
 buffer_load_dwordx4 v[8:11], v0, s[32:35], s28 offen
 v_mfma_f32_16x16x32_bf16 a[0:3], v[96:99], v[44:47], a[0:3]
 s_waitcnt lgkmcnt(2)
 v_mfma_f32_16x16x32_bf16 v[164:167], v[104:107], v[32:35], v[164:167]
 s_add_u32 s28, s28, 4096
 ds_read_b128 v[96:99], v2 offset:38912
 v_mfma_f32_16x16x32_bf16 v[164:167], v[108:111], v[48:51], v[164:167]
 ds_read_b128 v[100:103], v2 offset:39936
 v_mfma_f32_16x16x32_bf16 a[100:103], v[108:111], v[52:55], a[100:103]
 buffer_load_dwordx4 v[12:15], v0, s[32:35], s28 offen
 v_mfma_f32_16x16x32_bf16 a[100:103], v[104:107], v[36:39], a[100:103]
 s_add_u32 s28, s28, 4096
 v_mfma_f32_16x16x32_bf16 v[132:135], v[104:107], v[40:43], v[132:135]
 buffer_load_dwordx4 v[120:123], v0, s[32:35], s28 offen
 v_mfma_f32_16x16x32_bf16 v[132:135], v[108:111], v[56:59], v[132:135]
 s_add_u32 s28, s28, 4096
 v_mfma_f32_16x16x32_bf16 a[4:7], v[108:111], v[60:63], a[4:7]
 s_mov_b32 m0, 0x27100
 s_nop 0
 global_load_lds_dword v[126:127], off
 v_mfma_f32_16x16x32_bf16 a[4:7], v[104:107], v[44:47], a[4:7]
 s_waitcnt lgkmcnt(2)
 v_mfma_f32_16x16x32_bf16 v[168:171], v[112:115], v[32:35], v[168:171]
 s_add_u32 s17, s17, 4096
 ds_read_b128 v[104:107], v2 offset:40960
 v_mfma_f32_16x16x32_bf16 v[168:171], v[116:119], v[48:51], v[168:171]
 s_add_u32 m0, s24, 0x2000
 ds_read_b128 v[108:111], v2 offset:41984
 v_mfma_f32_16x16x32_bf16 a[104:107], v[116:119], v[52:55], a[104:107]
 v_mfma_f32_16x16x32_bf16 a[104:107], v[112:115], v[36:39], a[104:107]
 v_mfma_f32_16x16x32_bf16 v[136:139], v[112:115], v[40:43], v[136:139]
 buffer_load_dwordx4 v0, s[36:39], s17 offen offset:0 sc1 lds
 v_mfma_f32_16x16x32_bf16 v[136:139], v[116:119], v[56:59], v[136:139]
 v_mfma_f32_16x16x32_bf16 a[8:11], v[116:119], v[60:63], a[8:11]
 v_mfma_f32_16x16x32_bf16 a[8:11], v[112:115], v[44:47], a[8:11]
 s_waitcnt lgkmcnt(2)
 v_mfma_f32_16x16x32_bf16 v[172:175], v[96:99], v[32:35], v[172:175]
 ds_read_b128 v[112:115], v2 offset:43008
 v_mfma_f32_16x16x32_bf16 v[172:175], v[100:103], v[48:51], v[172:175]
 ds_read_b128 v[116:119], v2 offset:44032
 v_mfma_f32_16x16x32_bf16 a[108:111], v[100:103], v[52:55], a[108:111]
 v_mfma_f32_16x16x32_bf16 a[108:111], v[96:99], v[36:39], a[108:111]
 v_mfma_f32_16x16x32_bf16 v[140:143], v[96:99], v[40:43], v[140:143]
 buffer_load_dwordx4 v0, s[36:39], s17 offen offset:1024 sc1 lds
 v_mfma_f32_16x16x32_bf16 v[140:143], v[100:103], v[56:59], v[140:143]
 v_mfma_f32_16x16x32_bf16 a[12:15], v[100:103], v[60:63], a[12:15]
 v_mfma_f32_16x16x32_bf16 a[12:15], v[96:99], v[44:47], a[12:15]
 s_waitcnt lgkmcnt(2)
 v_mfma_f32_16x16x32_bf16 v[176:179], v[104:107], v[32:35], v[176:179]
 ds_read_b128 v[96:99], v2 offset:45056
 v_mfma_f32_16x16x32_bf16 v[176:179], v[108:111], v[48:51], v[176:179]
 ds_read_b128 v[100:103], v2 offset:46080
 v_mfma_f32_16x16x32_bf16 a[112:115], v[108:111], v[52:55], a[112:115]
 v_mfma_f32_16x16x32_bf16 a[112:115], v[104:107], v[36:39], a[112:115]
 v_mfma_f32_16x16x32_bf16 v[144:147], v[104:107], v[40:43], v[144:147]
 buffer_load_dwordx4 v0, s[36:39], s17 offen offset:2048 sc1 lds
 v_mfma_f32_16x16x32_bf16 v[144:147], v[108:111], v[56:59], v[144:147]
 v_mfma_f32_16x16x32_bf16 a[16:19], v[108:111], v[60:63], a[16:19]
 v_mfma_f32_16x16x32_bf16 a[16:19], v[104:107], v[44:47], a[16:19]
 s_waitcnt lgkmcnt(2)
 v_mfma_f32_16x16x32_bf16 v[180:183], v[112:115], v[32:35], v[180:183]
 ds_read_b128 v[104:107], v2 offset:47104
 v_mfma_f32_16x16x32_bf16 v[180:183], v[116:119], v[48:51], v[180:183]
 ds_read_b128 v[108:111], v2 offset:48128
 v_mfma_f32_16x16x32_bf16 a[116:119], v[116:119], v[52:55], a[116:119]
 s_barrier
 v_mfma_f32_16x16x32_bf16 a[116:119], v[112:115], v[36:39], a[116:119]
 v_mfma_f32_16x16x32_bf16 v[148:151], v[112:115], v[40:43], v[148:151]
 buffer_load_dwordx4 v0, s[36:39], s17 offen offset:3072 sc1 lds
 v_mfma_f32_16x16x32_bf16 v[148:151], v[116:119], v[56:59], v[148:151]
 v_mfma_f32_16x16x32_bf16 a[20:23], v[116:119], v[60:63], a[20:23]
 v_mfma_f32_16x16x32_bf16 a[20:23], v[112:115], v[44:47], a[20:23]
 s_waitcnt lgkmcnt(2)
 v_mfma_f32_16x16x32_bf16 v[184:187], v[96:99], v[32:35], v[184:187]
 s_add_u32 s17, s17, 40960
 ds_read_b128 v[112:115], v2 offset:49152
 v_mfma_f32_16x16x32_bf16 v[184:187], v[100:103], v[48:51], v[184:187]
 s_add_u32 m0, s24, 0xc000
 ds_read_b128 v[116:119], v2 offset:50176
 v_mfma_f32_16x16x32_bf16 a[120:123], v[100:103], v[52:55], a[120:123]
 v_mfma_f32_16x16x32_bf16 a[120:123], v[96:99], v[36:39], a[120:123]
 v_mfma_f32_16x16x32_bf16 v[152:155], v[96:99], v[40:43], v[152:155]
 buffer_load_dwordx4 v0, s[36:39], s17 offen offset:0 sc1 lds
 v_mfma_f32_16x16x32_bf16 v[152:155], v[100:103], v[56:59], v[152:155]
 v_mfma_f32_16x16x32_bf16 a[24:27], v[100:103], v[60:63], a[24:27]
 buffer_load_dwordx4 v0, s[36:39], s17 offen offset:1024 sc1 lds
 v_mfma_f32_16x16x32_bf16 a[24:27], v[96:99], v[44:47], a[24:27]
 s_waitcnt lgkmcnt(2)
 v_mfma_f32_16x16x32_bf16 v[188:191], v[104:107], v[32:35], v[188:191]
 ds_read_b128 v[96:99], v2 offset:51200
 v_mfma_f32_16x16x32_bf16 v[188:191], v[108:111], v[48:51], v[188:191]
 ds_read_b128 v[100:103], v2 offset:52224
 v_mfma_f32_16x16x32_bf16 a[124:127], v[108:111], v[52:55], a[124:127]
 v_mfma_f32_16x16x32_bf16 a[124:127], v[104:107], v[36:39], a[124:127]
 v_mfma_f32_16x16x32_bf16 v[156:159], v[104:107], v[40:43], v[156:159]
 buffer_load_dwordx4 v0, s[36:39], s17 offen offset:2048 sc1 lds
 v_mfma_f32_16x16x32_bf16 v[156:159], v[108:111], v[56:59], v[156:159]
 v_mfma_f32_16x16x32_bf16 a[28:31], v[108:111], v[60:63], a[28:31]
 v_mfma_f32_16x16x32_bf16 a[28:31], v[104:107], v[44:47], a[28:31]
 s_waitcnt lgkmcnt(2)
 v_mfma_f32_16x16x32_bf16 v[192:195], v[112:115], v[32:35], v[192:195]
 ds_read_b128 v[104:107], v2 offset:53248
 v_mfma_f32_16x16x32_bf16 v[192:195], v[116:119], v[48:51], v[192:195]
 ds_read_b128 v[108:111], v2 offset:54272
 v_mfma_f32_16x16x32_bf16 a[128:131], v[116:119], v[52:55], a[128:131]
 v_mfma_f32_16x16x32_bf16 a[128:131], v[112:115], v[36:39], a[128:131]
 v_mfma_f32_16x16x32_bf16 a[192:195], v[112:115], v[40:43], a[192:195]
 buffer_load_dwordx4 v0, s[36:39], s17 offen offset:3072 sc1 lds
 v_mfma_f32_16x16x32_bf16 a[192:195], v[116:119], v[56:59], a[192:195]
 v_mfma_f32_16x16x32_bf16 a[32:35], v[116:119], v[60:63], a[32:35]
 v_mfma_f32_16x16x32_bf16 a[32:35], v[112:115], v[44:47], a[32:35]
 s_waitcnt lgkmcnt(2)
 v_mfma_f32_16x16x32_bf16 v[196:199], v[96:99], v[32:35], v[196:199]
 s_add_u32 s17, s17, 4096
 ds_read_b128 v[112:115], v2 offset:55296
 v_mfma_f32_16x16x32_bf16 v[196:199], v[100:103], v[48:51], v[196:199]
 s_add_u32 m0, s24, 0xd000
 ds_read_b128 v[116:119], v2 offset:56320
 v_mfma_f32_16x16x32_bf16 a[132:135], v[100:103], v[52:55], a[132:135]
 v_mfma_f32_16x16x32_bf16 a[132:135], v[96:99], v[36:39], a[132:135]
 v_mfma_f32_16x16x32_bf16 a[196:199], v[96:99], v[40:43], a[196:199]
 buffer_load_dwordx4 v0, s[36:39], s17 offen offset:0 sc1 lds
 v_mfma_f32_16x16x32_bf16 a[196:199], v[100:103], v[56:59], a[196:199]
 v_mfma_f32_16x16x32_bf16 a[36:39], v[100:103], v[60:63], a[36:39]
 buffer_load_dwordx4 v0, s[36:39], s17 offen offset:1024 sc1 lds
 v_mfma_f32_16x16x32_bf16 a[36:39], v[96:99], v[44:47], a[36:39]
 s_waitcnt lgkmcnt(2)
 v_mfma_f32_16x16x32_bf16 v[200:203], v[104:107], v[32:35], v[200:203]
 ds_read_b128 v[96:99], v2 offset:57344
 v_mfma_f32_16x16x32_bf16 v[200:203], v[108:111], v[48:51], v[200:203]
 ds_read_b128 v[100:103], v2 offset:58368
 v_mfma_f32_16x16x32_bf16 a[136:139], v[108:111], v[52:55], a[136:139]
 v_mfma_f32_16x16x32_bf16 a[136:139], v[104:107], v[36:39], a[136:139]
 v_mfma_f32_16x16x32_bf16 a[200:203], v[104:107], v[40:43], a[200:203]
 buffer_load_dwordx4 v0, s[36:39], s17 offen offset:2048 sc1 lds
 v_mfma_f32_16x16x32_bf16 a[200:203], v[108:111], v[56:59], a[200:203]
 v_mfma_f32_16x16x32_bf16 a[40:43], v[108:111], v[60:63], a[40:43]
 v_mfma_f32_16x16x32_bf16 a[40:43], v[104:107], v[44:47], a[40:43]
 s_waitcnt lgkmcnt(2)
 v_mfma_f32_16x16x32_bf16 v[204:207], v[112:115], v[32:35], v[204:207]
 ds_read_b128 v[104:107], v2 offset:59392
 v_mfma_f32_16x16x32_bf16 v[204:207], v[116:119], v[48:51], v[204:207]
 ds_read_b128 v[108:111], v2 offset:60416
 v_mfma_f32_16x16x32_bf16 a[140:143], v[116:119], v[52:55], a[140:143]
 v_mfma_f32_16x16x32_bf16 a[140:143], v[112:115], v[36:39], a[140:143]
 v_mfma_f32_16x16x32_bf16 a[204:207], v[112:115], v[40:43], a[204:207]
 buffer_load_dwordx4 v0, s[36:39], s17 offen offset:3072 sc1 lds
 v_mfma_f32_16x16x32_bf16 a[204:207], v[116:119], v[56:59], a[204:207]
 v_mfma_f32_16x16x32_bf16 a[44:47], v[116:119], v[60:63], a[44:47]
 v_mfma_f32_16x16x32_bf16 a[44:47], v[112:115], v[44:47], a[44:47]
 s_waitcnt lgkmcnt(2)
 v_mfma_f32_16x16x32_bf16 v[208:211], v[96:99], v[32:35], v[208:211]
 s_add_u32 s17, s17, 4096
 ds_read_b128 v[112:115], v2 offset:61440
 v_mfma_f32_16x16x32_bf16 v[208:211], v[100:103], v[48:51], v[208:211]
 s_add_u32 m0, s24, 0xe000
 ds_read_b128 v[116:119], v2 offset:62464
 v_mfma_f32_16x16x32_bf16 a[144:147], v[100:103], v[52:55], a[144:147]
 v_mfma_f32_16x16x32_bf16 a[144:147], v[96:99], v[36:39], a[144:147]
 v_mfma_f32_16x16x32_bf16 a[208:211], v[96:99], v[40:43], a[208:211]
 buffer_load_dwordx4 v0, s[36:39], s17 offen offset:0 sc1 lds
 v_mfma_f32_16x16x32_bf16 a[208:211], v[100:103], v[56:59], a[208:211]
 v_mfma_f32_16x16x32_bf16 a[48:51], v[100:103], v[60:63], a[48:51]
 buffer_load_dwordx4 v0, s[36:39], s17 offen offset:1024 sc1 lds
 v_mfma_f32_16x16x32_bf16 a[48:51], v[96:99], v[44:47], a[48:51]
 s_waitcnt lgkmcnt(2)
 v_mfma_f32_16x16x32_bf16 v[212:215], v[104:107], v[32:35], v[212:215]
 ds_read_b128 v[96:99], v2 offset:63488
 v_mfma_f32_16x16x32_bf16 v[212:215], v[108:111], v[48:51], v[212:215]
 ds_read_b128 v[100:103], v2 offset:64512
 v_mfma_f32_16x16x32_bf16 a[148:151], v[108:111], v[52:55], a[148:151]
 v_mfma_f32_16x16x32_bf16 a[148:151], v[104:107], v[36:39], a[148:151]
 v_mfma_f32_16x16x32_bf16 a[212:215], v[104:107], v[40:43], a[212:215]
 buffer_load_dwordx4 v0, s[36:39], s17 offen offset:2048 sc1 lds
 v_mfma_f32_16x16x32_bf16 a[212:215], v[108:111], v[56:59], a[212:215]
 v_mfma_f32_16x16x32_bf16 a[52:55], v[108:111], v[60:63], a[52:55]
 v_mfma_f32_16x16x32_bf16 a[52:55], v[104:107], v[44:47], a[52:55]
 s_waitcnt lgkmcnt(2)
 v_mfma_f32_16x16x32_bf16 v[216:219], v[112:115], v[32:35], v[216:219]
 ds_read_b128 v[104:107], v3 offset:0
 v_mfma_f32_16x16x32_bf16 v[216:219], v[116:119], v[48:51], v[216:219]
 ds_read_b128 v[108:111], v3 offset:1024
 v_mfma_f32_16x16x32_bf16 a[152:155], v[116:119], v[52:55], a[152:155]
 v_mfma_f32_16x16x32_bf16 a[152:155], v[112:115], v[36:39], a[152:155]
 v_mfma_f32_16x16x32_bf16 a[216:219], v[112:115], v[40:43], a[216:219]
 buffer_load_dwordx4 v0, s[36:39], s17 offen offset:3072 sc1 lds
 v_mfma_f32_16x16x32_bf16 a[216:219], v[116:119], v[56:59], a[216:219]
 v_mfma_f32_16x16x32_bf16 a[56:59], v[116:119], v[60:63], a[56:59]
 v_mfma_f32_16x16x32_bf16 a[56:59], v[112:115], v[44:47], a[56:59]
 s_waitcnt lgkmcnt(2)
 v_mfma_f32_16x16x32_bf16 v[220:223], v[96:99], v[32:35], v[220:223]
 ds_read_b128 v[112:115], v3 offset:2048
 v_mfma_f32_16x16x32_bf16 v[220:223], v[100:103], v[48:51], v[220:223]
 ds_read_b128 v[116:119], v3 offset:3072
 v_mfma_f32_16x16x32_bf16 a[156:159], v[100:103], v[52:55], a[156:159]
 v_mfma_f32_16x16x32_bf16 a[156:159], v[96:99], v[36:39], a[156:159]
 v_mfma_f32_16x16x32_bf16 a[220:223], v[96:99], v[40:43], a[220:223]
 buffer_load_dwordx4 v[64:67], v0, s[32:35], s28 offen
 v_mfma_f32_16x16x32_bf16 a[220:223], v[100:103], v[56:59], a[220:223]
 s_add_u32 s28, s28, 4096
 v_mfma_f32_16x16x32_bf16 a[60:63], v[100:103], v[60:63], a[60:63]
 v_mfma_f32_16x16x32_bf16 a[60:63], v[96:99], v[44:47], a[60:63]
 s_waitcnt lgkmcnt(2)
 v_mfma_f32_16x16x32_bf16 v[224:227], v[104:107], v[32:35], v[224:227]
 ds_read_b128 v[96:99], v3 offset:4096
 v_mfma_f32_16x16x32_bf16 v[224:227], v[108:111], v[48:51], v[224:227]
 ds_read_b128 v[100:103], v3 offset:5120
 v_mfma_f32_16x16x32_bf16 a[160:163], v[108:111], v[52:55], a[160:163]
 v_mfma_f32_16x16x32_bf16 a[160:163], v[104:107], v[36:39], a[160:163]
 v_mfma_f32_16x16x32_bf16 a[224:227], v[104:107], v[40:43], a[224:227]
 buffer_load_dwordx4 v[68:71], v0, s[32:35], s28 offen
 v_mfma_f32_16x16x32_bf16 a[224:227], v[108:111], v[56:59], a[224:227]
 s_add_u32 s28, s28, 4096
 v_mfma_f32_16x16x32_bf16 a[64:67], v[108:111], v[60:63], a[64:67]
 v_mfma_f32_16x16x32_bf16 a[64:67], v[104:107], v[44:47], a[64:67]
 s_waitcnt lgkmcnt(2)
 v_mfma_f32_16x16x32_bf16 v[228:231], v[112:115], v[32:35], v[228:231]
 ds_read_b128 v[104:107], v3 offset:6144
 v_mfma_f32_16x16x32_bf16 v[228:231], v[116:119], v[48:51], v[228:231]
 ds_read_b128 v[108:111], v3 offset:7168
 v_mfma_f32_16x16x32_bf16 a[164:167], v[116:119], v[52:55], a[164:167]
 v_mfma_f32_16x16x32_bf16 a[164:167], v[112:115], v[36:39], a[164:167]
 v_mfma_f32_16x16x32_bf16 a[228:231], v[112:115], v[40:43], a[228:231]
 buffer_load_dwordx4 v[72:75], v0, s[32:35], s28 offen
 v_mfma_f32_16x16x32_bf16 a[228:231], v[116:119], v[56:59], a[228:231]
 s_add_u32 s28, s28, 4096
 v_mfma_f32_16x16x32_bf16 a[68:71], v[116:119], v[60:63], a[68:71]
 v_mfma_f32_16x16x32_bf16 a[68:71], v[112:115], v[44:47], a[68:71]
 s_waitcnt lgkmcnt(2)
 v_mfma_f32_16x16x32_bf16 v[232:235], v[96:99], v[32:35], v[232:235]
 ds_read_b128 v[112:115], v3 offset:8192
 v_mfma_f32_16x16x32_bf16 v[232:235], v[100:103], v[48:51], v[232:235]
 ds_read_b128 v[116:119], v3 offset:9216
 v_mfma_f32_16x16x32_bf16 a[168:171], v[100:103], v[52:55], a[168:171]
 v_mfma_f32_16x16x32_bf16 a[168:171], v[96:99], v[36:39], a[168:171]
 v_mfma_f32_16x16x32_bf16 a[232:235], v[96:99], v[40:43], a[232:235]
 buffer_load_dwordx4 v[76:79], v0, s[32:35], s28 offen
 v_mfma_f32_16x16x32_bf16 a[232:235], v[100:103], v[56:59], a[232:235]
 s_add_u32 s28, s28, 4096
 v_mfma_f32_16x16x32_bf16 a[72:75], v[100:103], v[60:63], a[72:75]
 v_mfma_f32_16x16x32_bf16 a[72:75], v[96:99], v[44:47], a[72:75]
 s_waitcnt lgkmcnt(2)
 v_mfma_f32_16x16x32_bf16 v[236:239], v[104:107], v[32:35], v[236:239]
 ds_read_b128 v[96:99], v3 offset:10240
 v_mfma_f32_16x16x32_bf16 v[236:239], v[108:111], v[48:51], v[236:239]
 ds_read_b128 v[100:103], v3 offset:11264
 v_mfma_f32_16x16x32_bf16 a[172:175], v[108:111], v[52:55], a[172:175]
 v_mfma_f32_16x16x32_bf16 a[172:175], v[104:107], v[36:39], a[172:175]
 v_mfma_f32_16x16x32_bf16 a[236:239], v[104:107], v[40:43], a[236:239]
 buffer_load_dwordx4 v[80:83], v0, s[32:35], s28 offen
 v_mfma_f32_16x16x32_bf16 a[236:239], v[108:111], v[56:59], a[236:239]
 s_add_u32 s28, s28, 4096
 v_mfma_f32_16x16x32_bf16 a[76:79], v[108:111], v[60:63], a[76:79]
 v_mfma_f32_16x16x32_bf16 a[76:79], v[104:107], v[44:47], a[76:79]
 s_waitcnt lgkmcnt(2)
 v_mfma_f32_16x16x32_bf16 v[240:243], v[112:115], v[32:35], v[240:243]
 ds_read_b128 v[104:107], v3 offset:12288
 v_mfma_f32_16x16x32_bf16 v[240:243], v[116:119], v[48:51], v[240:243]
 ds_read_b128 v[108:111], v3 offset:13312
 v_mfma_f32_16x16x32_bf16 a[176:179], v[116:119], v[52:55], a[176:179]
 v_mfma_f32_16x16x32_bf16 a[176:179], v[112:115], v[36:39], a[176:179]
 v_mfma_f32_16x16x32_bf16 a[240:243], v[112:115], v[40:43], a[240:243]
 buffer_load_dwordx4 v[84:87], v0, s[32:35], s28 offen
 v_mfma_f32_16x16x32_bf16 a[240:243], v[116:119], v[56:59], a[240:243]
 s_add_u32 s28, s28, 4096
 v_mfma_f32_16x16x32_bf16 a[80:83], v[116:119], v[60:63], a[80:83]
 v_mfma_f32_16x16x32_bf16 a[80:83], v[112:115], v[44:47], a[80:83]
 s_waitcnt lgkmcnt(2)
 v_mfma_f32_16x16x32_bf16 v[244:247], v[96:99], v[32:35], v[244:247]
 ds_read_b128 v[112:115], v3 offset:14336
 v_mfma_f32_16x16x32_bf16 v[244:247], v[100:103], v[48:51], v[244:247]
 ds_read_b128 v[116:119], v3 offset:15360
 v_mfma_f32_16x16x32_bf16 a[180:183], v[100:103], v[52:55], a[180:183]
 s_waitcnt vmcnt(18)
 v_mfma_f32_16x16x32_bf16 a[180:183], v[96:99], v[36:39], a[180:183]
 s_barrier
 v_mfma_f32_16x16x32_bf16 a[244:247], v[96:99], v[40:43], a[244:247]
 buffer_load_dwordx4 v[88:91], v0, s[32:35], s28 offen
 v_mfma_f32_16x16x32_bf16 a[244:247], v[100:103], v[56:59], a[244:247]
 s_add_u32 s28, s28, 4096
 v_mfma_f32_16x16x32_bf16 a[84:87], v[100:103], v[60:63], a[84:87]
 v_mfma_f32_16x16x32_bf16 a[84:87], v[96:99], v[44:47], a[84:87]
 s_waitcnt lgkmcnt(2)
 v_mfma_f32_16x16x32_bf16 v[248:251], v[104:107], v[32:35], v[248:251]
 ds_read_b128 v[96:99], v0 offset:0
 v_mfma_f32_16x16x32_bf16 v[248:251], v[108:111], v[48:51], v[248:251]
 ds_read_b128 v[100:103], v0 offset:1024
 v_mfma_f32_16x16x32_bf16 a[184:187], v[108:111], v[52:55], a[184:187]
 v_mfma_f32_16x16x32_bf16 a[184:187], v[104:107], v[36:39], a[184:187]
 v_mfma_f32_16x16x32_bf16 a[248:251], v[104:107], v[40:43], a[248:251]
 buffer_load_dwordx4 v[92:95], v0, s[32:35], s28 offen
 v_mfma_f32_16x16x32_bf16 a[248:251], v[108:111], v[56:59], a[248:251]
 s_add_u32 s28, s28, 4096
 v_mfma_f32_16x16x32_bf16 a[88:91], v[108:111], v[60:63], a[88:91]
 v_mfma_f32_16x16x32_bf16 a[88:91], v[104:107], v[44:47], a[88:91]
 s_waitcnt lgkmcnt(2)
 v_mfma_f32_16x16x32_bf16 v[252:255], v[112:115], v[32:35], v[252:255]
 ds_read_b128 v[104:107], v0 offset:2048
 v_mfma_f32_16x16x32_bf16 v[252:255], v[116:119], v[48:51], v[252:255]
 ds_read_b128 v[108:111], v0 offset:3072
 v_mfma_f32_16x16x32_bf16 a[188:191], v[116:119], v[52:55], a[188:191]
 v_mfma_f32_16x16x32_bf16 a[188:191], v[112:115], v[36:39], a[188:191]
 v_mfma_f32_16x16x32_bf16 a[252:255], v[112:115], v[40:43], a[252:255]
 v_mfma_f32_16x16x32_bf16 a[252:255], v[116:119], v[56:59], a[252:255]
 v_mfma_f32_16x16x32_bf16 a[92:95], v[116:119], v[60:63], a[92:95]
 v_mfma_f32_16x16x32_bf16 a[92:95], v[112:115], v[44:47], a[92:95]
 s_waitcnt lgkmcnt(2)
 s_branch L_k3_enter
 s_nop 0
L_k3_loop:
 v_mfma_f32_16x16x32_bf16 v[160:163], v[96:99], v[32:35], v[160:163]
 ds_read_b128 v[112:115], v2 offset:36864
 v_mfma_f32_16x16x32_bf16 v[160:163], v[100:103], v[48:51], v[160:163]
 ds_read_b128 v[116:119], v2 offset:37888
 v_mfma_f32_16x16x32_bf16 a[96:99], v[100:103], v[52:55], a[96:99]
 v_mfma_f32_16x16x32_bf16 a[96:99], v[96:99], v[36:39], a[96:99]
 v_mfma_f32_16x16x32_bf16 v[128:131], v[96:99], v[40:43], v[128:131]
 v_mfma_f32_16x16x32_bf16 v[128:131], v[100:103], v[56:59], v[128:131]
 v_mfma_f32_16x16x32_bf16 a[0:3], v[100:103], v[60:63], a[0:3]
 v_mfma_f32_16x16x32_bf16 a[0:3], v[96:99], v[44:47], a[0:3]
 s_waitcnt lgkmcnt(2)
 v_mfma_f32_16x16x32_bf16 v[164:167], v[104:107], v[32:35], v[164:167]
 ds_read_b128 v[96:99], v2 offset:38912
 v_mfma_f32_16x16x32_bf16 v[164:167], v[108:111], v[48:51], v[164:167]
 ds_read_b128 v[100:103], v2 offset:39936
 v_mfma_f32_16x16x32_bf16 a[100:103], v[108:111], v[52:55], a[100:103]
 s_waitcnt vmcnt(8)
 v_mfma_f32_16x16x32_bf16 a[100:103], v[104:107], v[36:39], a[100:103]
 s_barrier
 v_mfma_f32_16x16x32_bf16 v[132:135], v[104:107], v[40:43], v[132:135]
 v_mfma_f32_16x16x32_bf16 v[132:135], v[108:111], v[56:59], v[132:135]
 v_mfma_f32_16x16x32_bf16 a[4:7], v[108:111], v[60:63], a[4:7]
 v_mfma_f32_16x16x32_bf16 a[4:7], v[104:107], v[44:47], a[4:7]
 s_waitcnt lgkmcnt(2)
 v_mfma_f32_16x16x32_bf16 v[168:171], v[112:115], v[32:35], v[168:171]
 s_add_u32 s17, s17, 40960
 ds_read_b128 v[104:107], v2 offset:40960
 v_mfma_f32_16x16x32_bf16 v[168:171], v[116:119], v[48:51], v[168:171]
 s_add_u32 m0, s24, 0xc000
 ds_read_b128 v[108:111], v2 offset:41984
 v_mfma_f32_16x16x32_bf16 a[104:107], v[116:119], v[52:55], a[104:107]
 v_mfma_f32_16x16x32_bf16 a[104:107], v[112:115], v[36:39], a[104:107]
 v_mfma_f32_16x16x32_bf16 v[136:139], v[112:115], v[40:43], v[136:139]
 buffer_load_dwordx4 v0, s[36:39], s17 offen offset:0 sc1 lds
 v_mfma_f32_16x16x32_bf16 v[136:139], v[116:119], v[56:59], v[136:139]
 v_mfma_f32_16x16x32_bf16 a[8:11], v[116:119], v[60:63], a[8:11]
 v_mfma_f32_16x16x32_bf16 a[8:11], v[112:115], v[44:47], a[8:11]
 s_waitcnt lgkmcnt(2)
 v_mfma_f32_16x16x32_bf16 v[172:175], v[96:99], v[32:35], v[172:175]
 ds_read_b128 v[112:115], v2 offset:43008
 v_mfma_f32_16x16x32_bf16 v[172:175], v[100:103], v[48:51], v[172:175]
 ds_read_b128 v[116:119], v2 offset:44032
 v_mfma_f32_16x16x32_bf16 a[108:111], v[100:103], v[52:55], a[108:111]
 v_mfma_f32_16x16x32_bf16 a[108:111], v[96:99], v[36:39], a[108:111]
 v_mfma_f32_16x16x32_bf16 v[140:143], v[96:99], v[40:43], v[140:143]
 buffer_load_dwordx4 v0, s[36:39], s17 offen offset:1024 sc1 lds
 v_mfma_f32_16x16x32_bf16 v[140:143], v[100:103], v[56:59], v[140:143]
 v_mfma_f32_16x16x32_bf16 a[12:15], v[100:103], v[60:63], a[12:15]
 v_mfma_f32_16x16x32_bf16 a[12:15], v[96:99], v[44:47], a[12:15]
 s_waitcnt lgkmcnt(2)
 v_mfma_f32_16x16x32_bf16 v[176:179], v[104:107], v[32:35], v[176:179]
 ds_read_b128 v[96:99], v2 offset:45056
 v_mfma_f32_16x16x32_bf16 v[176:179], v[108:111], v[48:51], v[176:179]
 ds_read_b128 v[100:103], v2 offset:46080
 v_mfma_f32_16x16x32_bf16 a[112:115], v[108:111], v[52:55], a[112:115]
 v_mfma_f32_16x16x32_bf16 a[112:115], v[104:107], v[36:39], a[112:115]
 v_mfma_f32_16x16x32_bf16 v[144:147], v[104:107], v[40:43], v[144:147]
 buffer_load_dwordx4 v0, s[36:39], s17 offen offset:2048 sc1 lds
 v_mfma_f32_16x16x32_bf16 v[144:147], v[108:111], v[56:59], v[144:147]
 v_mfma_f32_16x16x32_bf16 a[16:19], v[108:111], v[60:63], a[16:19]
 v_mfma_f32_16x16x32_bf16 a[16:19], v[104:107], v[44:47], a[16:19]
 s_waitcnt lgkmcnt(2)
 v_mfma_f32_16x16x32_bf16 v[180:183], v[112:115], v[32:35], v[180:183]
 ds_read_b128 v[104:107], v2 offset:47104
 v_mfma_f32_16x16x32_bf16 v[180:183], v[116:119], v[48:51], v[180:183]
 ds_read_b128 v[108:111], v2 offset:48128
 v_mfma_f32_16x16x32_bf16 a[116:119], v[116:119], v[52:55], a[116:119]
 v_mfma_f32_16x16x32_bf16 a[116:119], v[112:115], v[36:39], a[116:119]
 v_mfma_f32_16x16x32_bf16 v[148:151], v[112:115], v[40:43], v[148:151]
 buffer_load_dwordx4 v0, s[36:39], s17 offen offset:3072 sc1 lds
 v_mfma_f32_16x16x32_bf16 v[148:151], v[116:119], v[56:59], v[148:151]
 v_mfma_f32_16x16x32_bf16 a[20:23], v[116:119], v[60:63], a[20:23]
 v_mfma_f32_16x16x32_bf16 a[20:23], v[112:115], v[44:47], a[20:23]
 s_waitcnt lgkmcnt(2)
 v_mfma_f32_16x16x32_bf16 v[184:187], v[96:99], v[32:35], v[184:187]
 s_add_u32 s17, s17, 4096
 ds_read_b128 v[112:115], v2 offset:49152
 v_mfma_f32_16x16x32_bf16 v[184:187], v[100:103], v[48:51], v[184:187]
 s_add_u32 m0, s24, 0xd000
 ds_read_b128 v[116:119], v2 offset:50176
 v_mfma_f32_16x16x32_bf16 a[120:123], v[100:103], v[52:55], a[120:123]
 v_mfma_f32_16x16x32_bf16 a[120:123], v[96:99], v[36:39], a[120:123]
 v_mfma_f32_16x16x32_bf16 v[152:155], v[96:99], v[40:43], v[152:155]
 buffer_load_dwordx4 v0, s[36:39], s17 offen offset:0 sc1 lds
 v_mfma_f32_16x16x32_bf16 v[152:155], v[100:103], v[56:59], v[152:155]
 v_mfma_f32_16x16x32_bf16 a[24:27], v[100:103], v[60:63], a[24:27]
 v_mfma_f32_16x16x32_bf16 a[24:27], v[96:99], v[44:47], a[24:27]
 s_waitcnt lgkmcnt(2)
 v_mfma_f32_16x16x32_bf16 v[188:191], v[104:107], v[32:35], v[188:191]
 ds_read_b128 v[96:99], v2 offset:51200
 v_mfma_f32_16x16x32_bf16 v[188:191], v[108:111], v[48:51], v[188:191]
 ds_read_b128 v[100:103], v2 offset:52224
 v_mfma_f32_16x16x32_bf16 a[124:127], v[108:111], v[52:55], a[124:127]
 v_mfma_f32_16x16x32_bf16 a[124:127], v[104:107], v[36:39], a[124:127]
 v_mfma_f32_16x16x32_bf16 v[156:159], v[104:107], v[40:43], v[156:159]
 buffer_load_dwordx4 v0, s[36:39], s17 offen offset:1024 sc1 lds
 v_mfma_f32_16x16x32_bf16 v[156:159], v[108:111], v[56:59], v[156:159]
 v_mfma_f32_16x16x32_bf16 a[28:31], v[108:111], v[60:63], a[28:31]
 v_mfma_f32_16x16x32_bf16 a[28:31], v[104:107], v[44:47], a[28:31]
 s_waitcnt lgkmcnt(2)
 v_mfma_f32_16x16x32_bf16 v[192:195], v[112:115], v[32:35], v[192:195]
 ds_read_b128 v[104:107], v2 offset:53248
 v_mfma_f32_16x16x32_bf16 v[192:195], v[116:119], v[48:51], v[192:195]
 ds_read_b128 v[108:111], v2 offset:54272
 v_mfma_f32_16x16x32_bf16 a[128:131], v[116:119], v[52:55], a[128:131]
 v_mfma_f32_16x16x32_bf16 a[128:131], v[112:115], v[36:39], a[128:131]
 v_mfma_f32_16x16x32_bf16 a[192:195], v[112:115], v[40:43], a[192:195]
 buffer_load_dwordx4 v0, s[36:39], s17 offen offset:2048 sc1 lds
 v_mfma_f32_16x16x32_bf16 a[192:195], v[116:119], v[56:59], a[192:195]
 v_mfma_f32_16x16x32_bf16 a[32:35], v[116:119], v[60:63], a[32:35]
 v_mfma_f32_16x16x32_bf16 a[32:35], v[112:115], v[44:47], a[32:35]
 s_waitcnt lgkmcnt(2)
 v_mfma_f32_16x16x32_bf16 v[196:199], v[96:99], v[32:35], v[196:199]
 ds_read_b128 v[112:115], v2 offset:55296
 v_mfma_f32_16x16x32_bf16 v[196:199], v[100:103], v[48:51], v[196:199]
 ds_read_b128 v[116:119], v2 offset:56320
 v_mfma_f32_16x16x32_bf16 a[132:135], v[100:103], v[52:55], a[132:135]
 v_mfma_f32_16x16x32_bf16 a[132:135], v[96:99], v[36:39], a[132:135]
 v_mfma_f32_16x16x32_bf16 a[196:199], v[96:99], v[40:43], a[196:199]
 buffer_load_dwordx4 v0, s[36:39], s17 offen offset:3072 sc1 lds
 v_mfma_f32_16x16x32_bf16 a[196:199], v[100:103], v[56:59], a[196:199]
 v_mfma_f32_16x16x32_bf16 a[36:39], v[100:103], v[60:63], a[36:39]
 v_mfma_f32_16x16x32_bf16 a[36:39], v[96:99], v[44:47], a[36:39]
 s_waitcnt lgkmcnt(2)
 v_mfma_f32_16x16x32_bf16 v[200:203], v[104:107], v[32:35], v[200:203]
 s_add_u32 s17, s17, 4096
 ds_read_b128 v[96:99], v2 offset:57344
 v_mfma_f32_16x16x32_bf16 v[200:203], v[108:111], v[48:51], v[200:203]
 s_add_u32 m0, s24, 0xe000
 ds_read_b128 v[100:103], v2 offset:58368
 v_mfma_f32_16x16x32_bf16 a[136:139], v[108:111], v[52:55], a[136:139]
 v_mfma_f32_16x16x32_bf16 a[136:139], v[104:107], v[36:39], a[136:139]
 v_mfma_f32_16x16x32_bf16 a[200:203], v[104:107], v[40:43], a[200:203]
 buffer_load_dwordx4 v0, s[36:39], s17 offen offset:0 sc1 lds
 v_mfma_f32_16x16x32_bf16 a[200:203], v[108:111], v[56:59], a[200:203]
 v_mfma_f32_16x16x32_bf16 a[40:43], v[108:111], v[60:63], a[40:43]
 v_mfma_f32_16x16x32_bf16 a[40:43], v[104:107], v[44:47], a[40:43]
 s_waitcnt lgkmcnt(2)
 v_mfma_f32_16x16x32_bf16 v[204:207], v[112:115], v[32:35], v[204:207]
 ds_read_b128 v[104:107], v2 offset:59392
 v_mfma_f32_16x16x32_bf16 v[204:207], v[116:119], v[48:51], v[204:207]
 ds_read_b128 v[108:111], v2 offset:60416
 v_mfma_f32_16x16x32_bf16 a[140:143], v[116:119], v[52:55], a[140:143]
 v_mfma_f32_16x16x32_bf16 a[140:143], v[112:115], v[36:39], a[140:143]
 v_mfma_f32_16x16x32_bf16 a[204:207], v[112:115], v[40:43], a[204:207]
 buffer_load_dwordx4 v0, s[36:39], s17 offen offset:1024 sc1 lds
 v_mfma_f32_16x16x32_bf16 a[204:207], v[116:119], v[56:59], a[204:207]
 v_mfma_f32_16x16x32_bf16 a[44:47], v[116:119], v[60:63], a[44:47]
 v_mfma_f32_16x16x32_bf16 a[44:47], v[112:115], v[44:47], a[44:47]
 s_waitcnt lgkmcnt(2)
 v_mfma_f32_16x16x32_bf16 v[208:211], v[96:99], v[32:35], v[208:211]
 ds_read_b128 v[112:115], v2 offset:61440
 v_mfma_f32_16x16x32_bf16 v[208:211], v[100:103], v[48:51], v[208:211]
 ds_read_b128 v[116:119], v2 offset:62464
 v_mfma_f32_16x16x32_bf16 a[144:147], v[100:103], v[52:55], a[144:147]
 v_mfma_f32_16x16x32_bf16 a[144:147], v[96:99], v[36:39], a[144:147]
 v_mfma_f32_16x16x32_bf16 a[208:211], v[96:99], v[40:43], a[208:211]
 buffer_load_dwordx4 v0, s[36:39], s17 offen offset:2048 sc1 lds
 v_mfma_f32_16x16x32_bf16 a[208:211], v[100:103], v[56:59], a[208:211]
 v_mfma_f32_16x16x32_bf16 a[48:51], v[100:103], v[60:63], a[48:51]
 v_mfma_f32_16x16x32_bf16 a[48:51], v[96:99], v[44:47], a[48:51]
 s_waitcnt lgkmcnt(2)
 v_mfma_f32_16x16x32_bf16 v[212:215], v[104:107], v[32:35], v[212:215]
 ds_read_b128 v[96:99], v2 offset:63488
 v_mfma_f32_16x16x32_bf16 v[212:215], v[108:111], v[48:51], v[212:215]
 ds_read_b128 v[100:103], v2 offset:64512
 v_mfma_f32_16x16x32_bf16 a[148:151], v[108:111], v[52:55], a[148:151]
 v_mfma_f32_16x16x32_bf16 a[148:151], v[104:107], v[36:39], a[148:151]
 v_mfma_f32_16x16x32_bf16 a[212:215], v[104:107], v[40:43], a[212:215]
 buffer_load_dwordx4 v0, s[36:39], s17 offen offset:3072 sc1 lds
 v_mfma_f32_16x16x32_bf16 a[212:215], v[108:111], v[56:59], a[212:215]
 v_mfma_f32_16x16x32_bf16 a[52:55], v[108:111], v[60:63], a[52:55]
 v_mfma_f32_16x16x32_bf16 a[52:55], v[104:107], v[44:47], a[52:55]
 s_waitcnt lgkmcnt(2)
 v_mfma_f32_16x16x32_bf16 v[216:219], v[112:115], v[32:35], v[216:219]
 ds_read_b128 v[104:107], v3 offset:0
 v_mfma_f32_16x16x32_bf16 v[216:219], v[116:119], v[48:51], v[216:219]
 ds_read_b128 v[108:111], v3 offset:1024
 v_mfma_f32_16x16x32_bf16 a[152:155], v[116:119], v[52:55], a[152:155]
 v_mfma_f32_16x16x32_bf16 a[152:155], v[112:115], v[36:39], a[152:155]
 v_mfma_f32_16x16x32_bf16 a[216:219], v[112:115], v[40:43], a[216:219]
 buffer_load_dwordx4 v[64:67], v0, s[32:35], s28 offen
 v_mfma_f32_16x16x32_bf16 a[216:219], v[116:119], v[56:59], a[216:219]
 s_add_u32 s28, s28, 4096
 v_mfma_f32_16x16x32_bf16 a[56:59], v[116:119], v[60:63], a[56:59]
 v_mfma_f32_16x16x32_bf16 a[56:59], v[112:115], v[44:47], a[56:59]
 s_waitcnt lgkmcnt(2)
 v_mfma_f32_16x16x32_bf16 v[220:223], v[96:99], v[32:35], v[220:223]
 ds_read_b128 v[112:115], v3 offset:2048
 v_mfma_f32_16x16x32_bf16 v[220:223], v[100:103], v[48:51], v[220:223]
 ds_read_b128 v[116:119], v3 offset:3072
 v_mfma_f32_16x16x32_bf16 a[156:159], v[100:103], v[52:55], a[156:159]
 v_mfma_f32_16x16x32_bf16 a[156:159], v[96:99], v[36:39], a[156:159]
 v_mfma_f32_16x16x32_bf16 a[220:223], v[96:99], v[40:43], a[220:223]
 buffer_load_dwordx4 v[68:71], v0, s[32:35], s28 offen
 v_mfma_f32_16x16x32_bf16 a[220:223], v[100:103], v[56:59], a[220:223]
 s_add_u32 s28, s28, 4096
 v_mfma_f32_16x16x32_bf16 a[60:63], v[100:103], v[60:63], a[60:63]
 v_mfma_f32_16x16x32_bf16 a[60:63], v[96:99], v[44:47], a[60:63]
 s_waitcnt lgkmcnt(2)
 v_mfma_f32_16x16x32_bf16 v[224:227], v[104:107], v[32:35], v[224:227]
 ds_read_b128 v[96:99], v3 offset:4096
 v_mfma_f32_16x16x32_bf16 v[224:227], v[108:111], v[48:51], v[224:227]
 ds_read_b128 v[100:103], v3 offset:5120
 v_mfma_f32_16x16x32_bf16 a[160:163], v[108:111], v[52:55], a[160:163]
 v_mfma_f32_16x16x32_bf16 a[160:163], v[104:107], v[36:39], a[160:163]
 v_mfma_f32_16x16x32_bf16 a[224:227], v[104:107], v[40:43], a[224:227]
 buffer_load_dwordx4 v[72:75], v0, s[32:35], s28 offen
 v_mfma_f32_16x16x32_bf16 a[224:227], v[108:111], v[56:59], a[224:227]
 s_add_u32 s28, s28, 4096
 v_mfma_f32_16x16x32_bf16 a[64:67], v[108:111], v[60:63], a[64:67]
 v_mfma_f32_16x16x32_bf16 a[64:67], v[104:107], v[44:47], a[64:67]
 s_waitcnt lgkmcnt(2)
 v_mfma_f32_16x16x32_bf16 v[228:231], v[112:115], v[32:35], v[228:231]
 ds_read_b128 v[104:107], v3 offset:6144
 v_mfma_f32_16x16x32_bf16 v[228:231], v[116:119], v[48:51], v[228:231]
 ds_read_b128 v[108:111], v3 offset:7168
 v_mfma_f32_16x16x32_bf16 a[164:167], v[116:119], v[52:55], a[164:167]
 v_mfma_f32_16x16x32_bf16 a[164:167], v[112:115], v[36:39], a[164:167]
 v_mfma_f32_16x16x32_bf16 a[228:231], v[112:115], v[40:43], a[228:231]
 buffer_load_dwordx4 v[76:79], v0, s[32:35], s28 offen
 v_mfma_f32_16x16x32_bf16 a[228:231], v[116:119], v[56:59], a[228:231]
 s_add_u32 s28, s28, 4096
 v_mfma_f32_16x16x32_bf16 a[68:71], v[116:119], v[60:63], a[68:71]
 v_mfma_f32_16x16x32_bf16 a[68:71], v[112:115], v[44:47], a[68:71]
 s_waitcnt lgkmcnt(2)
 v_mfma_f32_16x16x32_bf16 v[232:235], v[96:99], v[32:35], v[232:235]
 ds_read_b128 v[112:115], v3 offset:8192
 v_mfma_f32_16x16x32_bf16 v[232:235], v[100:103], v[48:51], v[232:235]
 ds_read_b128 v[116:119], v3 offset:9216
 v_mfma_f32_16x16x32_bf16 a[168:171], v[100:103], v[52:55], a[168:171]
 v_mfma_f32_16x16x32_bf16 a[168:171], v[96:99], v[36:39], a[168:171]
 v_mfma_f32_16x16x32_bf16 a[232:235], v[96:99], v[40:43], a[232:235]
 buffer_load_dwordx4 v[80:83], v0, s[32:35], s28 offen
 v_mfma_f32_16x16x32_bf16 a[232:235], v[100:103], v[56:59], a[232:235]
 s_add_u32 s28, s28, 4096
 v_mfma_f32_16x16x32_bf16 a[72:75], v[100:103], v[60:63], a[72:75]
 v_mfma_f32_16x16x32_bf16 a[72:75], v[96:99], v[44:47], a[72:75]
 s_waitcnt lgkmcnt(2)
 v_mfma_f32_16x16x32_bf16 v[236:239], v[104:107], v[32:35], v[236:239]
 ds_read_b128 v[96:99], v3 offset:10240
 v_mfma_f32_16x16x32_bf16 v[236:239], v[108:111], v[48:51], v[236:239]
 ds_read_b128 v[100:103], v3 offset:11264
 v_mfma_f32_16x16x32_bf16 a[172:175], v[108:111], v[52:55], a[172:175]
 v_mfma_f32_16x16x32_bf16 a[172:175], v[104:107], v[36:39], a[172:175]
 v_mfma_f32_16x16x32_bf16 a[236:239], v[104:107], v[40:43], a[236:239]
 buffer_load_dwordx4 v[84:87], v0, s[32:35], s28 offen
 v_mfma_f32_16x16x32_bf16 a[236:239], v[108:111], v[56:59], a[236:239]
 s_add_u32 s28, s28, 4096
 v_mfma_f32_16x16x32_bf16 a[76:79], v[108:111], v[60:63], a[76:79]
 v_mfma_f32_16x16x32_bf16 a[76:79], v[104:107], v[44:47], a[76:79]
 s_waitcnt lgkmcnt(2)
 v_mfma_f32_16x16x32_bf16 v[240:243], v[112:115], v[32:35], v[240:243]
 ds_read_b128 v[104:107], v3 offset:12288
 v_mfma_f32_16x16x32_bf16 v[240:243], v[116:119], v[48:51], v[240:243]
 ds_read_b128 v[108:111], v3 offset:13312
 v_mfma_f32_16x16x32_bf16 a[176:179], v[116:119], v[52:55], a[176:179]
 v_mfma_f32_16x16x32_bf16 a[176:179], v[112:115], v[36:39], a[176:179]
 v_mfma_f32_16x16x32_bf16 a[240:243], v[112:115], v[40:43], a[240:243]
 buffer_load_dwordx4 v[88:91], v0, s[32:35], s28 offen
 v_mfma_f32_16x16x32_bf16 a[240:243], v[116:119], v[56:59], a[240:243]
 s_add_u32 s28, s28, 4096
 v_mfma_f32_16x16x32_bf16 a[80:83], v[116:119], v[60:63], a[80:83]
 v_mfma_f32_16x16x32_bf16 a[80:83], v[112:115], v[44:47], a[80:83]
 s_waitcnt lgkmcnt(2)
 v_mfma_f32_16x16x32_bf16 v[244:247], v[96:99], v[32:35], v[244:247]
 ds_read_b128 v[112:115], v3 offset:14336
 v_mfma_f32_16x16x32_bf16 v[244:247], v[100:103], v[48:51], v[244:247]
 ds_read_b128 v[116:119], v3 offset:15360
 v_mfma_f32_16x16x32_bf16 a[180:183], v[100:103], v[52:55], a[180:183]
 v_mfma_f32_16x16x32_bf16 a[180:183], v[96:99], v[36:39], a[180:183]
 v_mfma_f32_16x16x32_bf16 a[244:247], v[96:99], v[40:43], a[244:247]
 buffer_load_dwordx4 v[92:95], v0, s[32:35], s28 offen
 v_mfma_f32_16x16x32_bf16 a[244:247], v[100:103], v[56:59], a[244:247]
 s_add_u32 s28, s28, 4096
 v_mfma_f32_16x16x32_bf16 a[84:87], v[100:103], v[60:63], a[84:87]
 v_mfma_f32_16x16x32_bf16 a[84:87], v[96:99], v[44:47], a[84:87]
 s_waitcnt lgkmcnt(2)
 v_mfma_f32_16x16x32_bf16 v[248:251], v[104:107], v[32:35], v[248:251]
 ds_read_b128 v[96:99], v0 offset:0
 v_mfma_f32_16x16x32_bf16 v[248:251], v[108:111], v[48:51], v[248:251]
 ds_read_b128 v[100:103], v0 offset:1024
 v_mfma_f32_16x16x32_bf16 a[184:187], v[108:111], v[52:55], a[184:187]
 v_mfma_f32_16x16x32_bf16 a[184:187], v[104:107], v[36:39], a[184:187]
 v_mfma_f32_16x16x32_bf16 a[248:251], v[104:107], v[40:43], a[248:251]
 v_mfma_f32_16x16x32_bf16 a[248:251], v[108:111], v[56:59], a[248:251]
 v_mfma_f32_16x16x32_bf16 a[88:91], v[108:111], v[60:63], a[88:91]
 v_mfma_f32_16x16x32_bf16 a[88:91], v[104:107], v[44:47], a[88:91]
 s_waitcnt lgkmcnt(2)
 v_mfma_f32_16x16x32_bf16 v[252:255], v[112:115], v[32:35], v[252:255]
 ds_read_b128 v[104:107], v0 offset:2048
 v_mfma_f32_16x16x32_bf16 v[252:255], v[116:119], v[48:51], v[252:255]
 ds_read_b128 v[108:111], v0 offset:3072
 v_mfma_f32_16x16x32_bf16 a[188:191], v[116:119], v[52:55], a[188:191]
 v_mfma_f32_16x16x32_bf16 a[188:191], v[112:115], v[36:39], a[188:191]
 v_mfma_f32_16x16x32_bf16 a[252:255], v[112:115], v[40:43], a[252:255]
 v_mfma_f32_16x16x32_bf16 a[252:255], v[116:119], v[56:59], a[252:255]
 v_mfma_f32_16x16x32_bf16 a[92:95], v[116:119], v[60:63], a[92:95]
 v_mfma_f32_16x16x32_bf16 a[92:95], v[112:115], v[44:47], a[92:95]
 s_waitcnt vmcnt(20) lgkmcnt(2)
L_k3_enter:
 v_mfma_f32_16x16x32_bf16 v[160:163], v[96:99], v[16:19], v[160:163]
 ds_read_b128 v[112:115], v0 offset:4096
 v_mfma_f32_16x16x32_bf16 v[160:163], v[100:103], v[4:7], v[160:163]
 ds_read_b128 v[116:119], v0 offset:5120
 v_mfma_f32_16x16x32_bf16 a[96:99], v[100:103], v[8:11], a[96:99]
 v_mfma_f32_16x16x32_bf16 a[96:99], v[96:99], v[20:23], a[96:99]
 v_mfma_f32_16x16x32_bf16 v[128:131], v[96:99], v[24:27], v[128:131]
 v_mfma_f32_16x16x32_bf16 v[128:131], v[100:103], v[12:15], v[128:131]
 v_mfma_f32_16x16x32_bf16 a[0:3], v[100:103], v[120:123], a[0:3]
 v_mfma_f32_16x16x32_bf16 a[0:3], v[96:99], v[28:31], a[0:3]
 s_waitcnt lgkmcnt(2)
 v_mfma_f32_16x16x32_bf16 v[164:167], v[104:107], v[16:19], v[164:167]
 ds_read_b128 v[96:99], v0 offset:6144
 v_mfma_f32_16x16x32_bf16 v[164:167], v[108:111], v[4:7], v[164:167]
 ds_read_b128 v[100:103], v0 offset:7168
 v_mfma_f32_16x16x32_bf16 a[100:103], v[108:111], v[8:11], a[100:103]
 s_waitcnt vmcnt(8)
 v_mfma_f32_16x16x32_bf16 a[100:103], v[104:107], v[20:23], a[100:103]
 s_barrier
 v_mfma_f32_16x16x32_bf16 v[132:135], v[104:107], v[24:27], v[132:135]
 v_mfma_f32_16x16x32_bf16 v[132:135], v[108:111], v[12:15], v[132:135]
 v_mfma_f32_16x16x32_bf16 a[4:7], v[108:111], v[120:123], a[4:7]
 v_mfma_f32_16x16x32_bf16 a[4:7], v[104:107], v[28:31], a[4:7]
 s_waitcnt lgkmcnt(2)
 v_mfma_f32_16x16x32_bf16 v[168:171], v[112:115], v[16:19], v[168:171]
 s_add_u32 s17, s17, 40960
 ds_read_b128 v[104:107], v0 offset:8192
 v_mfma_f32_16x16x32_bf16 v[168:171], v[116:119], v[4:7], v[168:171]
 s_add_u32 m0, s24, 0x18000
 ds_read_b128 v[108:111], v0 offset:9216
 v_mfma_f32_16x16x32_bf16 a[104:107], v[116:119], v[8:11], a[104:107]
 v_mfma_f32_16x16x32_bf16 a[104:107], v[112:115], v[20:23], a[104:107]
 v_mfma_f32_16x16x32_bf16 v[136:139], v[112:115], v[24:27], v[136:139]
 buffer_load_dwordx4 v0, s[36:39], s17 offen offset:0 sc1 lds
 v_mfma_f32_16x16x32_bf16 v[136:139], v[116:119], v[12:15], v[136:139]
 v_mfma_f32_16x16x32_bf16 a[8:11], v[116:119], v[120:123], a[8:11]
 v_mfma_f32_16x16x32_bf16 a[8:11], v[112:115], v[28:31], a[8:11]
 s_waitcnt lgkmcnt(2)
 v_mfma_f32_16x16x32_bf16 v[172:175], v[96:99], v[16:19], v[172:175]
 ds_read_b128 v[112:115], v0 offset:10240
 v_mfma_f32_16x16x32_bf16 v[172:175], v[100:103], v[4:7], v[172:175]
 ds_read_b128 v[116:119], v0 offset:11264
 v_mfma_f32_16x16x32_bf16 a[108:111], v[100:103], v[8:11], a[108:111]
 v_mfma_f32_16x16x32_bf16 a[108:111], v[96:99], v[20:23], a[108:111]
 v_mfma_f32_16x16x32_bf16 v[140:143], v[96:99], v[24:27], v[140:143]
 buffer_load_dwordx4 v0, s[36:39], s17 offen offset:1024 sc1 lds
 v_mfma_f32_16x16x32_bf16 v[140:143], v[100:103], v[12:15], v[140:143]
 v_mfma_f32_16x16x32_bf16 a[12:15], v[100:103], v[120:123], a[12:15]
 v_mfma_f32_16x16x32_bf16 a[12:15], v[96:99], v[28:31], a[12:15]
 s_waitcnt lgkmcnt(2)
 v_mfma_f32_16x16x32_bf16 v[176:179], v[104:107], v[16:19], v[176:179]
 ds_read_b128 v[96:99], v0 offset:12288
 v_mfma_f32_16x16x32_bf16 v[176:179], v[108:111], v[4:7], v[176:179]
 ds_read_b128 v[100:103], v0 offset:13312
 v_mfma_f32_16x16x32_bf16 a[112:115], v[108:111], v[8:11], a[112:115]
 v_mfma_f32_16x16x32_bf16 a[112:115], v[104:107], v[20:23], a[112:115]
 v_mfma_f32_16x16x32_bf16 v[144:147], v[104:107], v[24:27], v[144:147]
 buffer_load_dwordx4 v0, s[36:39], s17 offen offset:2048 sc1 lds
 v_mfma_f32_16x16x32_bf16 v[144:147], v[108:111], v[12:15], v[144:147]
 v_mfma_f32_16x16x32_bf16 a[16:19], v[108:111], v[120:123], a[16:19]
 v_mfma_f32_16x16x32_bf16 a[16:19], v[104:107], v[28:31], a[16:19]
 s_waitcnt lgkmcnt(2)
 v_mfma_f32_16x16x32_bf16 v[180:183], v[112:115], v[16:19], v[180:183]
 ds_read_b128 v[104:107], v0 offset:14336
 v_mfma_f32_16x16x32_bf16 v[180:183], v[116:119], v[4:7], v[180:183]
 ds_read_b128 v[108:111], v0 offset:15360
 v_mfma_f32_16x16x32_bf16 a[116:119], v[116:119], v[8:11], a[116:119]
 v_mfma_f32_16x16x32_bf16 a[116:119], v[112:115], v[20:23], a[116:119]
 v_mfma_f32_16x16x32_bf16 v[148:151], v[112:115], v[24:27], v[148:151]
 buffer_load_dwordx4 v0, s[36:39], s17 offen offset:3072 sc1 lds
 v_mfma_f32_16x16x32_bf16 v[148:151], v[116:119], v[12:15], v[148:151]
 v_mfma_f32_16x16x32_bf16 a[20:23], v[116:119], v[120:123], a[20:23]
 v_mfma_f32_16x16x32_bf16 a[20:23], v[112:115], v[28:31], a[20:23]
 s_waitcnt lgkmcnt(2)
 v_mfma_f32_16x16x32_bf16 v[184:187], v[96:99], v[16:19], v[184:187]
 s_add_u32 s17, s17, 4096
 ds_read_b128 v[112:115], v0 offset:16384
 v_mfma_f32_16x16x32_bf16 v[184:187], v[100:103], v[4:7], v[184:187]
 s_add_u32 m0, s24, 0x19000
 ds_read_b128 v[116:119], v0 offset:17408
 v_mfma_f32_16x16x32_bf16 a[120:123], v[100:103], v[8:11], a[120:123]
 v_mfma_f32_16x16x32_bf16 a[120:123], v[96:99], v[20:23], a[120:123]
 v_mfma_f32_16x16x32_bf16 v[152:155], v[96:99], v[24:27], v[152:155]
 buffer_load_dwordx4 v0, s[36:39], s17 offen offset:0 sc1 lds
 v_mfma_f32_16x16x32_bf16 v[152:155], v[100:103], v[12:15], v[152:155]
 v_mfma_f32_16x16x32_bf16 a[24:27], v[100:103], v[120:123], a[24:27]
 v_mfma_f32_16x16x32_bf16 a[24:27], v[96:99], v[28:31], a[24:27]
 s_waitcnt lgkmcnt(2)
 v_mfma_f32_16x16x32_bf16 v[188:191], v[104:107], v[16:19], v[188:191]
 ds_read_b128 v[96:99], v0 offset:18432
 v_mfma_f32_16x16x32_bf16 v[188:191], v[108:111], v[4:7], v[188:191]
 ds_read_b128 v[100:103], v0 offset:19456
 v_mfma_f32_16x16x32_bf16 a[124:127], v[108:111], v[8:11], a[124:127]
 v_mfma_f32_16x16x32_bf16 a[124:127], v[104:107], v[20:23], a[124:127]
 v_mfma_f32_16x16x32_bf16 v[156:159], v[104:107], v[24:27], v[156:159]
 buffer_load_dwordx4 v0, s[36:39], s17 offen offset:1024 sc1 lds
 v_mfma_f32_16x16x32_bf16 v[156:159], v[108:111], v[12:15], v[156:159]
 v_mfma_f32_16x16x32_bf16 a[28:31], v[108:111], v[120:123], a[28:31]
 v_mfma_f32_16x16x32_bf16 a[28:31], v[104:107], v[28:31], a[28:31]
 s_waitcnt lgkmcnt(2)
 v_mfma_f32_16x16x32_bf16 v[192:195], v[112:115], v[16:19], v[192:195]
 ds_read_b128 v[104:107], v0 offset:20480
 v_mfma_f32_16x16x32_bf16 v[192:195], v[116:119], v[4:7], v[192:195]
 ds_read_b128 v[108:111], v0 offset:21504
 v_mfma_f32_16x16x32_bf16 a[128:131], v[116:119], v[8:11], a[128:131]
 v_mfma_f32_16x16x32_bf16 a[128:131], v[112:115], v[20:23], a[128:131]
 v_mfma_f32_16x16x32_bf16 a[192:195], v[112:115], v[24:27], a[192:195]
 buffer_load_dwordx4 v0, s[36:39], s17 offen offset:2048 sc1 lds
 v_mfma_f32_16x16x32_bf16 a[192:195], v[116:119], v[12:15], a[192:195]
 v_mfma_f32_16x16x32_bf16 a[32:35], v[116:119], v[120:123], a[32:35]
 v_mfma_f32_16x16x32_bf16 a[32:35], v[112:115], v[28:31], a[32:35]
 s_waitcnt lgkmcnt(2)
 v_mfma_f32_16x16x32_bf16 v[196:199], v[96:99], v[16:19], v[196:199]
 ds_read_b128 v[112:115], v0 offset:22528
 v_mfma_f32_16x16x32_bf16 v[196:199], v[100:103], v[4:7], v[196:199]
 ds_read_b128 v[116:119], v0 offset:23552
 v_mfma_f32_16x16x32_bf16 a[132:135], v[100:103], v[8:11], a[132:135]
 v_mfma_f32_16x16x32_bf16 a[132:135], v[96:99], v[20:23], a[132:135]
 v_mfma_f32_16x16x32_bf16 a[196:199], v[96:99], v[24:27], a[196:199]
 buffer_load_dwordx4 v0, s[36:39], s17 offen offset:3072 sc1 lds
 v_mfma_f32_16x16x32_bf16 a[196:199], v[100:103], v[12:15], a[196:199]
 v_mfma_f32_16x16x32_bf16 a[36:39], v[100:103], v[120:123], a[36:39]
 v_mfma_f32_16x16x32_bf16 a[36:39], v[96:99], v[28:31], a[36:39]
 s_waitcnt lgkmcnt(2)
 v_mfma_f32_16x16x32_bf16 v[200:203], v[104:107], v[16:19], v[200:203]
 s_add_u32 s17, s17, 4096
 ds_read_b128 v[96:99], v0 offset:24576
 v_mfma_f32_16x16x32_bf16 v[200:203], v[108:111], v[4:7], v[200:203]
 s_add_u32 m0, s24, 0x1a000
 ds_read_b128 v[100:103], v0 offset:25600
 v_mfma_f32_16x16x32_bf16 a[136:139], v[108:111], v[8:11], a[136:139]
 v_mfma_f32_16x16x32_bf16 a[136:139], v[104:107], v[20:23], a[136:139]
 v_mfma_f32_16x16x32_bf16 a[200:203], v[104:107], v[24:27], a[200:203]
 buffer_load_dwordx4 v0, s[36:39], s17 offen offset:0 sc1 lds
 v_mfma_f32_16x16x32_bf16 a[200:203], v[108:111], v[12:15], a[200:203]
 v_mfma_f32_16x16x32_bf16 a[40:43], v[108:111], v[120:123], a[40:43]
 v_mfma_f32_16x16x32_bf16 a[40:43], v[104:107], v[28:31], a[40:43]
 s_waitcnt lgkmcnt(2)
 v_mfma_f32_16x16x32_bf16 v[204:207], v[112:115], v[16:19], v[204:207]
 ds_read_b128 v[104:107], v0 offset:26624
 v_mfma_f32_16x16x32_bf16 v[204:207], v[116:119], v[4:7], v[204:207]
 ds_read_b128 v[108:111], v0 offset:27648
 v_mfma_f32_16x16x32_bf16 a[140:143], v[116:119], v[8:11], a[140:143]
 v_mfma_f32_16x16x32_bf16 a[140:143], v[112:115], v[20:23], a[140:143]
 v_mfma_f32_16x16x32_bf16 a[204:207], v[112:115], v[24:27], a[204:207]
 buffer_load_dwordx4 v0, s[36:39], s17 offen offset:1024 sc1 lds
 v_mfma_f32_16x16x32_bf16 a[204:207], v[116:119], v[12:15], a[204:207]
 v_mfma_f32_16x16x32_bf16 a[44:47], v[116:119], v[120:123], a[44:47]
 v_mfma_f32_16x16x32_bf16 a[44:47], v[112:115], v[28:31], a[44:47]
 s_waitcnt lgkmcnt(2)
 v_mfma_f32_16x16x32_bf16 v[208:211], v[96:99], v[16:19], v[208:211]
 ds_read_b128 v[112:115], v0 offset:28672
 v_mfma_f32_16x16x32_bf16 v[208:211], v[100:103], v[4:7], v[208:211]
 ds_read_b128 v[116:119], v0 offset:29696
 v_mfma_f32_16x16x32_bf16 a[144:147], v[100:103], v[8:11], a[144:147]
 v_mfma_f32_16x16x32_bf16 a[144:147], v[96:99], v[20:23], a[144:147]
 v_mfma_f32_16x16x32_bf16 a[208:211], v[96:99], v[24:27], a[208:211]
 buffer_load_dwordx4 v0, s[36:39], s17 offen offset:2048 sc1 lds
 v_mfma_f32_16x16x32_bf16 a[208:211], v[100:103], v[12:15], a[208:211]
 v_mfma_f32_16x16x32_bf16 a[48:51], v[100:103], v[120:123], a[48:51]
 v_mfma_f32_16x16x32_bf16 a[48:51], v[96:99], v[28:31], a[48:51]
 s_waitcnt lgkmcnt(2)
 v_mfma_f32_16x16x32_bf16 v[212:215], v[104:107], v[16:19], v[212:215]
 ds_read_b128 v[96:99], v0 offset:30720
 v_mfma_f32_16x16x32_bf16 v[212:215], v[108:111], v[4:7], v[212:215]
 ds_read_b128 v[100:103], v0 offset:31744
 v_mfma_f32_16x16x32_bf16 a[148:151], v[108:111], v[8:11], a[148:151]
 v_mfma_f32_16x16x32_bf16 a[148:151], v[104:107], v[20:23], a[148:151]
 v_mfma_f32_16x16x32_bf16 a[212:215], v[104:107], v[24:27], a[212:215]
 buffer_load_dwordx4 v0, s[36:39], s17 offen offset:3072 sc1 lds
 v_mfma_f32_16x16x32_bf16 a[212:215], v[108:111], v[12:15], a[212:215]
 v_mfma_f32_16x16x32_bf16 a[52:55], v[108:111], v[120:123], a[52:55]
 v_mfma_f32_16x16x32_bf16 a[52:55], v[104:107], v[28:31], a[52:55]
 s_waitcnt lgkmcnt(2)
 v_mfma_f32_16x16x32_bf16 v[216:219], v[112:115], v[16:19], v[216:219]
 ds_read_b128 v[104:107], v0 offset:32768
 v_mfma_f32_16x16x32_bf16 v[216:219], v[116:119], v[4:7], v[216:219]
 ds_read_b128 v[108:111], v0 offset:33792
 v_mfma_f32_16x16x32_bf16 a[152:155], v[116:119], v[8:11], a[152:155]
 v_mfma_f32_16x16x32_bf16 a[152:155], v[112:115], v[20:23], a[152:155]
 v_mfma_f32_16x16x32_bf16 a[216:219], v[112:115], v[24:27], a[216:219]
 buffer_load_dwordx4 v[32:35], v0, s[32:35], s28 offen
 v_mfma_f32_16x16x32_bf16 a[216:219], v[116:119], v[12:15], a[216:219]
 s_add_u32 s28, s28, 4096
 v_mfma_f32_16x16x32_bf16 a[56:59], v[116:119], v[120:123], a[56:59]
 v_mfma_f32_16x16x32_bf16 a[56:59], v[112:115], v[28:31], a[56:59]
 s_waitcnt lgkmcnt(2)
 v_mfma_f32_16x16x32_bf16 v[220:223], v[96:99], v[16:19], v[220:223]
 ds_read_b128 v[112:115], v0 offset:34816
 v_mfma_f32_16x16x32_bf16 v[220:223], v[100:103], v[4:7], v[220:223]
 ds_read_b128 v[116:119], v0 offset:35840
 v_mfma_f32_16x16x32_bf16 a[156:159], v[100:103], v[8:11], a[156:159]
 v_mfma_f32_16x16x32_bf16 a[156:159], v[96:99], v[20:23], a[156:159]
 v_mfma_f32_16x16x32_bf16 a[220:223], v[96:99], v[24:27], a[220:223]
 buffer_load_dwordx4 v[36:39], v0, s[32:35], s28 offen
 v_mfma_f32_16x16x32_bf16 a[220:223], v[100:103], v[12:15], a[220:223]
 s_add_u32 s28, s28, 4096
 v_mfma_f32_16x16x32_bf16 a[60:63], v[100:103], v[120:123], a[60:63]
 v_mfma_f32_16x16x32_bf16 a[60:63], v[96:99], v[28:31], a[60:63]
 s_waitcnt lgkmcnt(2)
 v_mfma_f32_16x16x32_bf16 v[224:227], v[104:107], v[16:19], v[224:227]
 ds_read_b128 v[96:99], v0 offset:36864
 v_mfma_f32_16x16x32_bf16 v[224:227], v[108:111], v[4:7], v[224:227]
 ds_read_b128 v[100:103], v0 offset:37888
 v_mfma_f32_16x16x32_bf16 a[160:163], v[108:111], v[8:11], a[160:163]
 v_mfma_f32_16x16x32_bf16 a[160:163], v[104:107], v[20:23], a[160:163]
 v_mfma_f32_16x16x32_bf16 a[224:227], v[104:107], v[24:27], a[224:227]
 buffer_load_dwordx4 v[40:43], v0, s[32:35], s28 offen
 v_mfma_f32_16x16x32_bf16 a[224:227], v[108:111], v[12:15], a[224:227]
 s_add_u32 s28, s28, 4096
 v_mfma_f32_16x16x32_bf16 a[64:67], v[108:111], v[120:123], a[64:67]
 v_mfma_f32_16x16x32_bf16 a[64:67], v[104:107], v[28:31], a[64:67]
 s_waitcnt lgkmcnt(2)
 v_mfma_f32_16x16x32_bf16 v[228:231], v[112:115], v[16:19], v[228:231]
 ds_read_b128 v[104:107], v0 offset:38912
 v_mfma_f32_16x16x32_bf16 v[228:231], v[116:119], v[4:7], v[228:231]
 ds_read_b128 v[108:111], v0 offset:39936
 v_mfma_f32_16x16x32_bf16 a[164:167], v[116:119], v[8:11], a[164:167]
 v_mfma_f32_16x16x32_bf16 a[164:167], v[112:115], v[20:23], a[164:167]
 v_mfma_f32_16x16x32_bf16 a[228:231], v[112:115], v[24:27], a[228:231]
 buffer_load_dwordx4 v[44:47], v0, s[32:35], s28 offen
 v_mfma_f32_16x16x32_bf16 a[228:231], v[116:119], v[12:15], a[228:231]
 s_add_u32 s28, s28, 4096
 v_mfma_f32_16x16x32_bf16 a[68:71], v[116:119], v[120:123], a[68:71]
 v_mfma_f32_16x16x32_bf16 a[68:71], v[112:115], v[28:31], a[68:71]
 s_waitcnt lgkmcnt(2)
 v_mfma_f32_16x16x32_bf16 v[232:235], v[96:99], v[16:19], v[232:235]
 ds_read_b128 v[112:115], v0 offset:40960
 v_mfma_f32_16x16x32_bf16 v[232:235], v[100:103], v[4:7], v[232:235]
 ds_read_b128 v[116:119], v0 offset:41984
 v_mfma_f32_16x16x32_bf16 a[168:171], v[100:103], v[8:11], a[168:171]
 v_mfma_f32_16x16x32_bf16 a[168:171], v[96:99], v[20:23], a[168:171]
 v_mfma_f32_16x16x32_bf16 a[232:235], v[96:99], v[24:27], a[232:235]
 buffer_load_dwordx4 v[48:51], v0, s[32:35], s28 offen
 v_mfma_f32_16x16x32_bf16 a[232:235], v[100:103], v[12:15], a[232:235]
 s_add_u32 s28, s28, 4096
 v_mfma_f32_16x16x32_bf16 a[72:75], v[100:103], v[120:123], a[72:75]
 v_mfma_f32_16x16x32_bf16 a[72:75], v[96:99], v[28:31], a[72:75]
 s_waitcnt lgkmcnt(2)
 v_mfma_f32_16x16x32_bf16 v[236:239], v[104:107], v[16:19], v[236:239]
 ds_read_b128 v[96:99], v0 offset:43008
 v_mfma_f32_16x16x32_bf16 v[236:239], v[108:111], v[4:7], v[236:239]
 ds_read_b128 v[100:103], v0 offset:44032
 v_mfma_f32_16x16x32_bf16 a[172:175], v[108:111], v[8:11], a[172:175]
 v_mfma_f32_16x16x32_bf16 a[172:175], v[104:107], v[20:23], a[172:175]
 v_mfma_f32_16x16x32_bf16 a[236:239], v[104:107], v[24:27], a[236:239]
 buffer_load_dwordx4 v[52:55], v0, s[32:35], s28 offen
 v_mfma_f32_16x16x32_bf16 a[236:239], v[108:111], v[12:15], a[236:239]
 s_add_u32 s28, s28, 4096
 v_mfma_f32_16x16x32_bf16 a[76:79], v[108:111], v[120:123], a[76:79]
 v_mfma_f32_16x16x32_bf16 a[76:79], v[104:107], v[28:31], a[76:79]
 s_waitcnt lgkmcnt(2)
 v_mfma_f32_16x16x32_bf16 v[240:243], v[112:115], v[16:19], v[240:243]
 ds_read_b128 v[104:107], v0 offset:45056
 v_mfma_f32_16x16x32_bf16 v[240:243], v[116:119], v[4:7], v[240:243]
 ds_read_b128 v[108:111], v0 offset:46080
 v_mfma_f32_16x16x32_bf16 a[176:179], v[116:119], v[8:11], a[176:179]
 v_mfma_f32_16x16x32_bf16 a[176:179], v[112:115], v[20:23], a[176:179]
 v_mfma_f32_16x16x32_bf16 a[240:243], v[112:115], v[24:27], a[240:243]
 buffer_load_dwordx4 v[56:59], v0, s[32:35], s28 offen
 v_mfma_f32_16x16x32_bf16 a[240:243], v[116:119], v[12:15], a[240:243]
 s_add_u32 s28, s28, 4096
 v_mfma_f32_16x16x32_bf16 a[80:83], v[116:119], v[120:123], a[80:83]
 v_mfma_f32_16x16x32_bf16 a[80:83], v[112:115], v[28:31], a[80:83]
 s_waitcnt lgkmcnt(2)
 v_mfma_f32_16x16x32_bf16 v[244:247], v[96:99], v[16:19], v[244:247]
 ds_read_b128 v[112:115], v0 offset:47104
 v_mfma_f32_16x16x32_bf16 v[244:247], v[100:103], v[4:7], v[244:247]
 ds_read_b128 v[116:119], v0 offset:48128
 v_mfma_f32_16x16x32_bf16 a[180:183], v[100:103], v[8:11], a[180:183]
 v_mfma_f32_16x16x32_bf16 a[180:183], v[96:99], v[20:23], a[180:183]
 v_mfma_f32_16x16x32_bf16 a[244:247], v[96:99], v[24:27], a[244:247]
 buffer_load_dwordx4 v[60:63], v0, s[32:35], s28 offen
 v_mfma_f32_16x16x32_bf16 a[244:247], v[100:103], v[12:15], a[244:247]
 s_add_u32 s28, s28, 4096
 v_mfma_f32_16x16x32_bf16 a[84:87], v[100:103], v[120:123], a[84:87]
 v_mfma_f32_16x16x32_bf16 a[84:87], v[96:99], v[28:31], a[84:87]
 s_waitcnt lgkmcnt(2)
 v_mfma_f32_16x16x32_bf16 v[248:251], v[104:107], v[16:19], v[248:251]
 s_cmp_eq_u32 s19, 1
 ds_read_b128 v[96:99], v0 offset:49152
 v_mfma_f32_16x16x32_bf16 v[248:251], v[108:111], v[4:7], v[248:251]
 s_cselect_b32 s25, L_end-L_k3_last, 0
 ds_read_b128 v[100:103], v0 offset:50176
 v_mfma_f32_16x16x32_bf16 a[184:187], v[108:111], v[8:11], a[184:187]
 v_mfma_f32_16x16x32_bf16 a[184:187], v[104:107], v[20:23], a[184:187]
 v_mfma_f32_16x16x32_bf16 a[248:251], v[104:107], v[24:27], a[248:251]
 v_mfma_f32_16x16x32_bf16 a[248:251], v[108:111], v[12:15], a[248:251]
 v_mfma_f32_16x16x32_bf16 a[88:91], v[108:111], v[120:123], a[88:91]
 v_mfma_f32_16x16x32_bf16 a[88:91], v[104:107], v[28:31], a[88:91]
 s_waitcnt lgkmcnt(2)
 v_mfma_f32_16x16x32_bf16 v[252:255], v[112:115], v[16:19], v[252:255]
 ds_read_b128 v[104:107], v0 offset:51200
 v_mfma_f32_16x16x32_bf16 v[252:255], v[116:119], v[4:7], v[252:255]
 ds_read_b128 v[108:111], v0 offset:52224
 v_mfma_f32_16x16x32_bf16 a[188:191], v[116:119], v[8:11], a[188:191]
 v_mfma_f32_16x16x32_bf16 a[188:191], v[112:115], v[20:23], a[188:191]
 v_mfma_f32_16x16x32_bf16 a[252:255], v[112:115], v[24:27], a[252:255]
 v_mfma_f32_16x16x32_bf16 a[252:255], v[116:119], v[12:15], a[252:255]
 v_mfma_f32_16x16x32_bf16 a[92:95], v[116:119], v[120:123], a[92:95]
 v_mfma_f32_16x16x32_bf16 a[92:95], v[112:115], v[28:31], a[92:95]
 s_waitcnt vmcnt(20) lgkmcnt(2)
 v_mfma_f32_16x16x32_bf16 v[160:163], v[96:99], v[64:67], v[160:163]
 ds_read_b128 v[112:115], v0 offset:53248
 v_and_b32 v126, 0xf0, v0
 v_mfma_f32_16x16x32_bf16 v[160:163], v[100:103], v[80:83], v[160:163]
 ds_read_b128 v[116:119], v0 offset:54272
 v_lshl_add_u32 v126, v126, 2, s95
 v_mfma_f32_16x16x32_bf16 a[96:99], v[100:103], v[84:87], a[96:99]
 v_min_u32 v126, s25, v126
 v_add_co_u32 v126, vcc, s20, v126
 v_mfma_f32_16x16x32_bf16 a[96:99], v[96:99], v[68:71], a[96:99]
 v_mov_b32 v127, s21
 v_mov_b32 v127, s21
 v_mfma_f32_16x16x32_bf16 v[128:131], v[96:99], v[72:75], v[128:131]
 v_addc_co_u32 v127, vcc, 0, v127, vcc
 v_mfma_f32_16x16x32_bf16 v[128:131], v[100:103], v[88:91], v[128:131]
 v_mfma_f32_16x16x32_bf16 a[0:3], v[100:103], v[92:95], a[0:3]
 v_mfma_f32_16x16x32_bf16 a[0:3], v[96:99], v[76:79], a[0:3]
 s_waitcnt lgkmcnt(2)
 v_mfma_f32_16x16x32_bf16 v[164:167], v[104:107], v[64:67], v[164:167]
 s_mov_b32 m0, 0x27100
 ds_read_b128 v[96:99], v0 offset:55296
 v_mfma_f32_16x16x32_bf16 v[164:167], v[108:111], v[80:83], v[164:167]
 ds_read_b128 v[100:103], v0 offset:56320
 v_mfma_f32_16x16x32_bf16 a[100:103], v[108:111], v[84:87], a[100:103]
 s_waitcnt vmcnt(8)
 v_mfma_f32_16x16x32_bf16 a[100:103], v[104:107], v[68:71], a[100:103]
 s_barrier
 v_mfma_f32_16x16x32_bf16 v[132:135], v[104:107], v[72:75], v[132:135]
 global_load_lds_dword v[126:127], off
 v_mfma_f32_16x16x32_bf16 v[132:135], v[108:111], v[88:91], v[132:135]
 v_mfma_f32_16x16x32_bf16 a[4:7], v[108:111], v[92:95], a[4:7]
 v_mfma_f32_16x16x32_bf16 a[4:7], v[104:107], v[76:79], a[4:7]
 s_waitcnt lgkmcnt(2)
 v_mfma_f32_16x16x32_bf16 v[168:171], v[112:115], v[64:67], v[168:171]
 s_add_u32 s17, s17, 40960
 ds_read_b128 v[104:107], v0 offset:57344
 v_mfma_f32_16x16x32_bf16 v[168:171], v[116:119], v[80:83], v[168:171]
 s_add_u32 m0, s24, 0x0
 ds_read_b128 v[108:111], v0 offset:58368
 v_mfma_f32_16x16x32_bf16 a[104:107], v[116:119], v[84:87], a[104:107]
 v_mfma_f32_16x16x32_bf16 a[104:107], v[112:115], v[68:71], a[104:107]
 v_mfma_f32_16x16x32_bf16 v[136:139], v[112:115], v[72:75], v[136:139]
 buffer_load_dwordx4 v0, s[36:39], s17 offen offset:0 sc1 lds
 v_mfma_f32_16x16x32_bf16 v[136:139], v[116:119], v[88:91], v[136:139]
 v_mfma_f32_16x16x32_bf16 a[8:11], v[116:119], v[92:95], a[8:11]
 v_mfma_f32_16x16x32_bf16 a[8:11], v[112:115], v[76:79], a[8:11]
 s_waitcnt lgkmcnt(2)
 v_mfma_f32_16x16x32_bf16 v[172:175], v[96:99], v[64:67], v[172:175]
 ds_read_b128 v[112:115], v0 offset:59392
 v_mfma_f32_16x16x32_bf16 v[172:175], v[100:103], v[80:83], v[172:175]
 ds_read_b128 v[116:119], v0 offset:60416
 v_mfma_f32_16x16x32_bf16 a[108:111], v[100:103], v[84:87], a[108:111]
 v_mfma_f32_16x16x32_bf16 a[108:111], v[96:99], v[68:71], a[108:111]
 v_mfma_f32_16x16x32_bf16 v[140:143], v[96:99], v[72:75], v[140:143]
 buffer_load_dwordx4 v0, s[36:39], s17 offen offset:1024 sc1 lds
 v_mfma_f32_16x16x32_bf16 v[140:143], v[100:103], v[88:91], v[140:143]
 v_mfma_f32_16x16x32_bf16 a[12:15], v[100:103], v[92:95], a[12:15]
 v_mfma_f32_16x16x32_bf16 a[12:15], v[96:99], v[76:79], a[12:15]
 s_waitcnt lgkmcnt(2)
 v_mfma_f32_16x16x32_bf16 v[176:179], v[104:107], v[64:67], v[176:179]
 ds_read_b128 v[96:99], v0 offset:61440
 v_mfma_f32_16x16x32_bf16 v[176:179], v[108:111], v[80:83], v[176:179]
 ds_read_b128 v[100:103], v0 offset:62464
 v_mfma_f32_16x16x32_bf16 a[112:115], v[108:111], v[84:87], a[112:115]
 v_mfma_f32_16x16x32_bf16 a[112:115], v[104:107], v[68:71], a[112:115]
 v_mfma_f32_16x16x32_bf16 v[144:147], v[104:107], v[72:75], v[144:147]
 buffer_load_dwordx4 v0, s[36:39], s17 offen offset:2048 sc1 lds
 v_mfma_f32_16x16x32_bf16 v[144:147], v[108:111], v[88:91], v[144:147]
 v_mfma_f32_16x16x32_bf16 a[16:19], v[108:111], v[92:95], a[16:19]
 v_mfma_f32_16x16x32_bf16 a[16:19], v[104:107], v[76:79], a[16:19]
 s_waitcnt lgkmcnt(2)
 v_mfma_f32_16x16x32_bf16 v[180:183], v[112:115], v[64:67], v[180:183]
 ds_read_b128 v[104:107], v0 offset:63488
 v_mfma_f32_16x16x32_bf16 v[180:183], v[116:119], v[80:83], v[180:183]
 ds_read_b128 v[108:111], v0 offset:64512
 v_mfma_f32_16x16x32_bf16 a[116:119], v[116:119], v[84:87], a[116:119]
 v_mfma_f32_16x16x32_bf16 a[116:119], v[112:115], v[68:71], a[116:119]
 v_mfma_f32_16x16x32_bf16 v[148:151], v[112:115], v[72:75], v[148:151]
 buffer_load_dwordx4 v0, s[36:39], s17 offen offset:3072 sc1 lds
 v_mfma_f32_16x16x32_bf16 v[148:151], v[116:119], v[88:91], v[148:151]
 v_mfma_f32_16x16x32_bf16 a[20:23], v[116:119], v[92:95], a[20:23]
 v_mfma_f32_16x16x32_bf16 a[20:23], v[112:115], v[76:79], a[20:23]
 s_waitcnt lgkmcnt(2)
 v_mfma_f32_16x16x32_bf16 v[184:187], v[96:99], v[64:67], v[184:187]
 s_add_u32 s17, s17, 4096
 ds_read_b128 v[112:115], v2 offset:0
 v_mfma_f32_16x16x32_bf16 v[184:187], v[100:103], v[80:83], v[184:187]
 s_add_u32 m0, s24, 0x1000
 ds_read_b128 v[116:119], v2 offset:1024
 v_mfma_f32_16x16x32_bf16 a[120:123], v[100:103], v[84:87], a[120:123]
 v_mfma_f32_16x16x32_bf16 a[120:123], v[96:99], v[68:71], a[120:123]
 v_mfma_f32_16x16x32_bf16 v[152:155], v[96:99], v[72:75], v[152:155]
 buffer_load_dwordx4 v0, s[36:39], s17 offen offset:0 sc1 lds
 v_mfma_f32_16x16x32_bf16 v[152:155], v[100:103], v[88:91], v[152:155]
 v_mfma_f32_16x16x32_bf16 a[24:27], v[100:103], v[92:95], a[24:27]
 v_mfma_f32_16x16x32_bf16 a[24:27], v[96:99], v[76:79], a[24:27]
 s_waitcnt lgkmcnt(2)
 v_mfma_f32_16x16x32_bf16 v[188:191], v[104:107], v[64:67], v[188:191]
 ds_read_b128 v[96:99], v2 offset:2048
 v_mfma_f32_16x16x32_bf16 v[188:191], v[108:111], v[80:83], v[188:191]
 ds_read_b128 v[100:103], v2 offset:3072
 v_mfma_f32_16x16x32_bf16 a[124:127], v[108:111], v[84:87], a[124:127]
 v_mfma_f32_16x16x32_bf16 a[124:127], v[104:107], v[68:71], a[124:127]
 v_mfma_f32_16x16x32_bf16 v[156:159], v[104:107], v[72:75], v[156:159]
 buffer_load_dwordx4 v0, s[36:39], s17 offen offset:1024 sc1 lds
 v_mfma_f32_16x16x32_bf16 v[156:159], v[108:111], v[88:91], v[156:159]
 v_mfma_f32_16x16x32_bf16 a[28:31], v[108:111], v[92:95], a[28:31]
 v_mfma_f32_16x16x32_bf16 a[28:31], v[104:107], v[76:79], a[28:31]
 s_waitcnt lgkmcnt(2)
 v_mfma_f32_16x16x32_bf16 v[192:195], v[112:115], v[64:67], v[192:195]
 ds_read_b128 v[104:107], v2 offset:4096
 v_mfma_f32_16x16x32_bf16 v[192:195], v[116:119], v[80:83], v[192:195]
 ds_read_b128 v[108:111], v2 offset:5120
 v_mfma_f32_16x16x32_bf16 a[128:131], v[116:119], v[84:87], a[128:131]
 v_mfma_f32_16x16x32_bf16 a[128:131], v[112:115], v[68:71], a[128:131]
 v_mfma_f32_16x16x32_bf16 a[192:195], v[112:115], v[72:75], a[192:195]
 buffer_load_dwordx4 v0, s[36:39], s17 offen offset:2048 sc1 lds
 v_mfma_f32_16x16x32_bf16 a[192:195], v[116:119], v[88:91], a[192:195]
 v_mfma_f32_16x16x32_bf16 a[32:35], v[116:119], v[92:95], a[32:35]
 v_mfma_f32_16x16x32_bf16 a[32:35], v[112:115], v[76:79], a[32:35]
 s_waitcnt lgkmcnt(2)
 v_mfma_f32_16x16x32_bf16 v[196:199], v[96:99], v[64:67], v[196:199]
 ds_read_b128 v[112:115], v2 offset:6144
 v_mfma_f32_16x16x32_bf16 v[196:199], v[100:103], v[80:83], v[196:199]
 ds_read_b128 v[116:119], v2 offset:7168
 v_mfma_f32_16x16x32_bf16 a[132:135], v[100:103], v[84:87], a[132:135]
 v_mfma_f32_16x16x32_bf16 a[132:135], v[96:99], v[68:71], a[132:135]
 v_mfma_f32_16x16x32_bf16 a[196:199], v[96:99], v[72:75], a[196:199]
 buffer_load_dwordx4 v0, s[36:39], s17 offen offset:3072 sc1 lds
 v_mfma_f32_16x16x32_bf16 a[196:199], v[100:103], v[88:91], a[196:199]
 v_mfma_f32_16x16x32_bf16 a[36:39], v[100:103], v[92:95], a[36:39]
 v_mfma_f32_16x16x32_bf16 a[36:39], v[96:99], v[76:79], a[36:39]
 s_waitcnt lgkmcnt(2)
 v_mfma_f32_16x16x32_bf16 v[200:203], v[104:107], v[64:67], v[200:203]
 s_add_u32 s17, s17, 4096
 ds_read_b128 v[96:99], v2 offset:8192
 v_mfma_f32_16x16x32_bf16 v[200:203], v[108:111], v[80:83], v[200:203]
 s_add_u32 m0, s24, 0x2000
 ds_read_b128 v[100:103], v2 offset:9216
 v_mfma_f32_16x16x32_bf16 a[136:139], v[108:111], v[84:87], a[136:139]
 v_mfma_f32_16x16x32_bf16 a[136:139], v[104:107], v[68:71], a[136:139]
 v_mfma_f32_16x16x32_bf16 a[200:203], v[104:107], v[72:75], a[200:203]
 buffer_load_dwordx4 v0, s[36:39], s17 offen offset:0 sc1 lds
 v_mfma_f32_16x16x32_bf16 a[200:203], v[108:111], v[88:91], a[200:203]
 v_mfma_f32_16x16x32_bf16 a[40:43], v[108:111], v[92:95], a[40:43]
 v_mfma_f32_16x16x32_bf16 a[40:43], v[104:107], v[76:79], a[40:43]
 s_waitcnt lgkmcnt(2)
 v_mfma_f32_16x16x32_bf16 v[204:207], v[112:115], v[64:67], v[204:207]
 ds_read_b128 v[104:107], v2 offset:10240
 v_mfma_f32_16x16x32_bf16 v[204:207], v[116:119], v[80:83], v[204:207]
 ds_read_b128 v[108:111], v2 offset:11264
 v_mfma_f32_16x16x32_bf16 a[140:143], v[116:119], v[84:87], a[140:143]
 v_mfma_f32_16x16x32_bf16 a[140:143], v[112:115], v[68:71], a[140:143]
 v_mfma_f32_16x16x32_bf16 a[204:207], v[112:115], v[72:75], a[204:207]
 buffer_load_dwordx4 v0, s[36:39], s17 offen offset:1024 sc1 lds
 v_mfma_f32_16x16x32_bf16 a[204:207], v[116:119], v[88:91], a[204:207]
 v_mfma_f32_16x16x32_bf16 a[44:47], v[116:119], v[92:95], a[44:47]
 v_mfma_f32_16x16x32_bf16 a[44:47], v[112:115], v[76:79], a[44:47]
 s_waitcnt lgkmcnt(2)
 v_mfma_f32_16x16x32_bf16 v[208:211], v[96:99], v[64:67], v[208:211]
 ds_read_b128 v[112:115], v2 offset:12288
 v_mfma_f32_16x16x32_bf16 v[208:211], v[100:103], v[80:83], v[208:211]
 ds_read_b128 v[116:119], v2 offset:13312
 v_mfma_f32_16x16x32_bf16 a[144:147], v[100:103], v[84:87], a[144:147]
 v_mfma_f32_16x16x32_bf16 a[144:147], v[96:99], v[68:71], a[144:147]
 v_mfma_f32_16x16x32_bf16 a[208:211], v[96:99], v[72:75], a[208:211]
 buffer_load_dwordx4 v0, s[36:39], s17 offen offset:2048 sc1 lds
 v_mfma_f32_16x16x32_bf16 a[208:211], v[100:103], v[88:91], a[208:211]
 v_mfma_f32_16x16x32_bf16 a[48:51], v[100:103], v[92:95], a[48:51]
 v_mfma_f32_16x16x32_bf16 a[48:51], v[96:99], v[76:79], a[48:51]
 s_waitcnt lgkmcnt(2)
 v_mfma_f32_16x16x32_bf16 v[212:215], v[104:107], v[64:67], v[212:215]
 ds_read_b128 v[96:99], v2 offset:14336
 v_mfma_f32_16x16x32_bf16 v[212:215], v[108:111], v[80:83], v[212:215]
 ds_read_b128 v[100:103], v2 offset:15360
 v_mfma_f32_16x16x32_bf16 a[148:151], v[108:111], v[84:87], a[148:151]
 v_mfma_f32_16x16x32_bf16 a[148:151], v[104:107], v[68:71], a[148:151]
 v_mfma_f32_16x16x32_bf16 a[212:215], v[104:107], v[72:75], a[212:215]
 buffer_load_dwordx4 v0, s[36:39], s17 offen offset:3072 sc1 lds
 v_mfma_f32_16x16x32_bf16 a[212:215], v[108:111], v[88:91], a[212:215]
 v_mfma_f32_16x16x32_bf16 a[52:55], v[108:111], v[92:95], a[52:55]
 v_mfma_f32_16x16x32_bf16 a[52:55], v[104:107], v[76:79], a[52:55]
 s_waitcnt lgkmcnt(2)
 v_mfma_f32_16x16x32_bf16 v[216:219], v[112:115], v[64:67], v[216:219]
 ds_read_b128 v[104:107], v2 offset:16384
 v_mfma_f32_16x16x32_bf16 v[216:219], v[116:119], v[80:83], v[216:219]
 ds_read_b128 v[108:111], v2 offset:17408
 v_mfma_f32_16x16x32_bf16 a[152:155], v[116:119], v[84:87], a[152:155]
 v_mfma_f32_16x16x32_bf16 a[152:155], v[112:115], v[68:71], a[152:155]
 v_mfma_f32_16x16x32_bf16 a[216:219], v[112:115], v[72:75], a[216:219]
 buffer_load_dwordx4 v[16:19], v0, s[32:35], s28 offen
 v_mfma_f32_16x16x32_bf16 a[216:219], v[116:119], v[88:91], a[216:219]
 s_add_u32 s28, s28, 4096
 v_mfma_f32_16x16x32_bf16 a[56:59], v[116:119], v[92:95], a[56:59]
 v_mfma_f32_16x16x32_bf16 a[56:59], v[112:115], v[76:79], a[56:59]
 s_waitcnt lgkmcnt(2)
 v_mfma_f32_16x16x32_bf16 v[220:223], v[96:99], v[64:67], v[220:223]
 ds_read_b128 v[112:115], v2 offset:18432
 v_mfma_f32_16x16x32_bf16 v[220:223], v[100:103], v[80:83], v[220:223]
 ds_read_b128 v[116:119], v2 offset:19456
 v_mfma_f32_16x16x32_bf16 a[156:159], v[100:103], v[84:87], a[156:159]
 v_mfma_f32_16x16x32_bf16 a[156:159], v[96:99], v[68:71], a[156:159]
 v_mfma_f32_16x16x32_bf16 a[220:223], v[96:99], v[72:75], a[220:223]
 buffer_load_dwordx4 v[20:23], v0, s[32:35], s28 offen
 v_mfma_f32_16x16x32_bf16 a[220:223], v[100:103], v[88:91], a[220:223]
 s_add_u32 s28, s28, 4096
 v_mfma_f32_16x16x32_bf16 a[60:63], v[100:103], v[92:95], a[60:63]
 v_mfma_f32_16x16x32_bf16 a[60:63], v[96:99], v[76:79], a[60:63]
 s_waitcnt lgkmcnt(2)
 v_mfma_f32_16x16x32_bf16 v[224:227], v[104:107], v[64:67], v[224:227]
 ds_read_b128 v[96:99], v2 offset:20480
 v_mfma_f32_16x16x32_bf16 v[224:227], v[108:111], v[80:83], v[224:227]
 ds_read_b128 v[100:103], v2 offset:21504
 v_mfma_f32_16x16x32_bf16 a[160:163], v[108:111], v[84:87], a[160:163]
 v_mfma_f32_16x16x32_bf16 a[160:163], v[104:107], v[68:71], a[160:163]
 v_mfma_f32_16x16x32_bf16 a[224:227], v[104:107], v[72:75], a[224:227]
 buffer_load_dwordx4 v[24:27], v0, s[32:35], s28 offen
 v_mfma_f32_16x16x32_bf16 a[224:227], v[108:111], v[88:91], a[224:227]
 s_add_u32 s28, s28, 4096
 v_mfma_f32_16x16x32_bf16 a[64:67], v[108:111], v[92:95], a[64:67]
 v_mfma_f32_16x16x32_bf16 a[64:67], v[104:107], v[76:79], a[64:67]
 s_waitcnt lgkmcnt(2)
 v_mfma_f32_16x16x32_bf16 v[228:231], v[112:115], v[64:67], v[228:231]
 ds_read_b128 v[104:107], v2 offset:22528
 v_mfma_f32_16x16x32_bf16 v[228:231], v[116:119], v[80:83], v[228:231]
 ds_read_b128 v[108:111], v2 offset:23552
 v_mfma_f32_16x16x32_bf16 a[164:167], v[116:119], v[84:87], a[164:167]
 v_mfma_f32_16x16x32_bf16 a[164:167], v[112:115], v[68:71], a[164:167]
 v_mfma_f32_16x16x32_bf16 a[228:231], v[112:115], v[72:75], a[228:231]
 buffer_load_dwordx4 v[28:31], v0, s[32:35], s28 offen
 v_mfma_f32_16x16x32_bf16 a[228:231], v[116:119], v[88:91], a[228:231]
 s_add_u32 s28, s28, 4096
 v_mfma_f32_16x16x32_bf16 a[68:71], v[116:119], v[92:95], a[68:71]
 v_mfma_f32_16x16x32_bf16 a[68:71], v[112:115], v[76:79], a[68:71]
 s_waitcnt lgkmcnt(2)
 v_mfma_f32_16x16x32_bf16 v[232:235], v[96:99], v[64:67], v[232:235]
 ds_read_b128 v[112:115], v2 offset:24576
 v_mfma_f32_16x16x32_bf16 v[232:235], v[100:103], v[80:83], v[232:235]
 ds_read_b128 v[116:119], v2 offset:25600
 v_mfma_f32_16x16x32_bf16 a[168:171], v[100:103], v[84:87], a[168:171]
 v_mfma_f32_16x16x32_bf16 a[168:171], v[96:99], v[68:71], a[168:171]
 v_mfma_f32_16x16x32_bf16 a[232:235], v[96:99], v[72:75], a[232:235]
 buffer_load_dwordx4 v[4:7], v0, s[32:35], s28 offen
 v_mfma_f32_16x16x32_bf16 a[232:235], v[100:103], v[88:91], a[232:235]
 s_add_u32 s28, s28, 4096
 v_mfma_f32_16x16x32_bf16 a[72:75], v[100:103], v[92:95], a[72:75]
 v_mfma_f32_16x16x32_bf16 a[72:75], v[96:99], v[76:79], a[72:75]
 s_waitcnt lgkmcnt(2)
 v_mfma_f32_16x16x32_bf16 v[236:239], v[104:107], v[64:67], v[236:239]
 ds_read_b128 v[96:99], v2 offset:26624
 v_mfma_f32_16x16x32_bf16 v[236:239], v[108:111], v[80:83], v[236:239]
 ds_read_b128 v[100:103], v2 offset:27648
 v_mfma_f32_16x16x32_bf16 a[172:175], v[108:111], v[84:87], a[172:175]
 v_mfma_f32_16x16x32_bf16 a[172:175], v[104:107], v[68:71], a[172:175]
 v_mfma_f32_16x16x32_bf16 a[236:239], v[104:107], v[72:75], a[236:239]
 buffer_load_dwordx4 v[8:11], v0, s[32:35], s28 offen
 v_mfma_f32_16x16x32_bf16 a[236:239], v[108:111], v[88:91], a[236:239]
 s_add_u32 s28, s28, 4096
 v_mfma_f32_16x16x32_bf16 a[76:79], v[108:111], v[92:95], a[76:79]
 v_mfma_f32_16x16x32_bf16 a[76:79], v[104:107], v[76:79], a[76:79]
 s_waitcnt lgkmcnt(2)
 v_mfma_f32_16x16x32_bf16 v[240:243], v[112:115], v[64:67], v[240:243]
 ds_read_b128 v[104:107], v2 offset:28672
 v_mfma_f32_16x16x32_bf16 v[240:243], v[116:119], v[80:83], v[240:243]
 ds_read_b128 v[108:111], v2 offset:29696
 v_mfma_f32_16x16x32_bf16 a[176:179], v[116:119], v[84:87], a[176:179]
 v_mfma_f32_16x16x32_bf16 a[176:179], v[112:115], v[68:71], a[176:179]
 v_mfma_f32_16x16x32_bf16 a[240:243], v[112:115], v[72:75], a[240:243]
 buffer_load_dwordx4 v[12:15], v0, s[32:35], s28 offen
 v_mfma_f32_16x16x32_bf16 a[240:243], v[116:119], v[88:91], a[240:243]
 s_add_u32 s28, s28, 4096
 v_mfma_f32_16x16x32_bf16 a[80:83], v[116:119], v[92:95], a[80:83]
 v_mfma_f32_16x16x32_bf16 a[80:83], v[112:115], v[76:79], a[80:83]
 s_waitcnt lgkmcnt(2)
 v_mfma_f32_16x16x32_bf16 v[244:247], v[96:99], v[64:67], v[244:247]
 ds_read_b128 v[112:115], v2 offset:30720
 v_mfma_f32_16x16x32_bf16 v[244:247], v[100:103], v[80:83], v[244:247]
 ds_read_b128 v[116:119], v2 offset:31744
 v_mfma_f32_16x16x32_bf16 a[180:183], v[100:103], v[84:87], a[180:183]
 v_mfma_f32_16x16x32_bf16 a[180:183], v[96:99], v[68:71], a[180:183]
 v_mfma_f32_16x16x32_bf16 a[244:247], v[96:99], v[72:75], a[244:247]
 buffer_load_dwordx4 v[120:123], v0, s[32:35], s28 offen
 v_mfma_f32_16x16x32_bf16 a[244:247], v[100:103], v[88:91], a[244:247]
 s_add_u32 s28, s28, 4096
 v_mfma_f32_16x16x32_bf16 a[84:87], v[100:103], v[92:95], a[84:87]
 v_mfma_f32_16x16x32_bf16 a[84:87], v[96:99], v[76:79], a[84:87]
 s_waitcnt lgkmcnt(2)
 v_mfma_f32_16x16x32_bf16 v[248:251], v[104:107], v[64:67], v[248:251]
 s_sub_u32 s19, s19, 1
 ds_read_b128 v[96:99], v2 offset:32768
 v_mfma_f32_16x16x32_bf16 v[248:251], v[108:111], v[80:83], v[248:251]
 s_cmp_lg_u32 s19, 0
 ds_read_b128 v[100:103], v2 offset:33792
 v_mfma_f32_16x16x32_bf16 a[184:187], v[108:111], v[84:87], a[184:187]
 v_mfma_f32_16x16x32_bf16 a[184:187], v[104:107], v[68:71], a[184:187]
 v_mfma_f32_16x16x32_bf16 a[248:251], v[104:107], v[72:75], a[248:251]
 v_mfma_f32_16x16x32_bf16 a[248:251], v[108:111], v[88:91], a[248:251]
 v_mfma_f32_16x16x32_bf16 a[88:91], v[108:111], v[92:95], a[88:91]
 v_mfma_f32_16x16x32_bf16 a[88:91], v[104:107], v[76:79], a[88:91]
 s_waitcnt lgkmcnt(2)
 v_mfma_f32_16x16x32_bf16 v[252:255], v[112:115], v[64:67], v[252:255]
 ds_read_b128 v[104:107], v2 offset:34816
 v_mfma_f32_16x16x32_bf16 v[252:255], v[116:119], v[80:83], v[252:255]
 ds_read_b128 v[108:111], v2 offset:35840
 v_mfma_f32_16x16x32_bf16 a[188:191], v[116:119], v[84:87], a[188:191]
 v_mfma_f32_16x16x32_bf16 a[188:191], v[112:115], v[68:71], a[188:191]
 v_mfma_f32_16x16x32_bf16 a[252:255], v[112:115], v[72:75], a[252:255]
 v_mfma_f32_16x16x32_bf16 a[252:255], v[116:119], v[88:91], a[252:255]
 v_mfma_f32_16x16x32_bf16 a[92:95], v[116:119], v[92:95], a[92:95]
 v_mfma_f32_16x16x32_bf16 a[92:95], v[112:115], v[76:79], a[92:95]
 s_waitcnt vmcnt(21) lgkmcnt(2)
 s_cbranch_scc1 L_k3_loop
L_k3_last:
 v_mfma_f32_16x16x32_bf16 v[160:163], v[96:99], v[32:35], v[160:163]
 ds_read_b128 v[112:115], v2 offset:36864
 ds_read_b128 v[116:119], v2 offset:37888
 v_mfma_f32_16x16x32_bf16 v[160:163], v[100:103], v[48:51], v[160:163]
 v_and_b32 v126, 0xf0, v0
 v_lshl_add_u32 v126, v126, 2, s95
 v_mfma_f32_16x16x32_bf16 v[128:131], v[100:103], v[56:59], v[128:131]
 v_min_u32 v126, L_end-L_k3_last, v126
 v_add_co_u32 v126, vcc, s20, v126
 v_mfma_f32_16x16x32_bf16 v[128:131], v[96:99], v[40:43], v[128:131]
 s_waitcnt lgkmcnt(2)
 v_mov_b32 v127, s21
 v_mov_b32 v127, s21
 v_mfma_f32_16x16x32_bf16 v[164:167], v[104:107], v[32:35], v[164:167]
 ds_read_b128 v[96:99], v2 offset:38912
 ds_read_b128 v[100:103], v2 offset:39936
 v_mfma_f32_16x16x32_bf16 v[164:167], v[108:111], v[48:51], v[164:167]
 v_addc_co_u32 v127, vcc, 0, v127, vcc
 v_mfma_f32_16x16x32_bf16 v[132:135], v[108:111], v[56:59], v[132:135]
 v_mfma_f32_16x16x32_bf16 v[132:135], v[104:107], v[40:43], v[132:135]
 s_waitcnt lgkmcnt(2)
 v_mfma_f32_16x16x32_bf16 v[168:171], v[112:115], v[32:35], v[168:171]
 ds_read_b128 v[104:107], v2 offset:40960
 ds_read_b128 v[108:111], v2 offset:41984
 v_mfma_f32_16x16x32_bf16 v[168:171], v[116:119], v[48:51], v[168:171]
 v_mfma_f32_16x16x32_bf16 v[136:139], v[116:119], v[56:59], v[136:139]
 v_mfma_f32_16x16x32_bf16 v[136:139], v[112:115], v[40:43], v[136:139]
 s_waitcnt vmcnt(8) lgkmcnt(2)
 v_mfma_f32_16x16x32_bf16 v[172:175], v[96:99], v[32:35], v[172:175]
 ds_read_b128 v[112:115], v2 offset:43008
 ds_read_b128 v[116:119], v2 offset:44032
 v_mfma_f32_16x16x32_bf16 v[172:175], v[100:103], v[48:51], v[172:175]
 s_barrier
 v_mfma_f32_16x16x32_bf16 v[140:143], v[100:103], v[56:59], v[140:143]
 v_mfma_f32_16x16x32_bf16 v[140:143], v[96:99], v[40:43], v[140:143]
 s_waitcnt lgkmcnt(2)
 v_mfma_f32_16x16x32_bf16 v[176:179], v[104:107], v[32:35], v[176:179]
 s_add_u32 s17, s23, 0x348000
 ds_read_b128 v[96:99], v2 offset:45056
 ds_read_b128 v[100:103], v2 offset:46080
 v_mfma_f32_16x16x32_bf16 v[176:179], v[108:111], v[48:51], v[176:179]
 s_add_u32 m0, s23, 0xc000
 v_mfma_f32_16x16x32_bf16 v[144:147], v[108:111], v[56:59], v[144:147]
 buffer_load_dwordx4 v0, s[36:39], s17 offen offset:0 sc1 lds
 v_mfma_f32_16x16x32_bf16 v[144:147], v[104:107], v[40:43], v[144:147]
 s_waitcnt lgkmcnt(2)
 v_mfma_f32_16x16x32_bf16 v[180:183], v[112:115], v[32:35], v[180:183]
 ds_read_b128 v[104:107], v2 offset:47104
 ds_read_b128 v[108:111], v2 offset:48128
 v_mfma_f32_16x16x32_bf16 v[180:183], v[116:119], v[48:51], v[180:183]
 v_mfma_f32_16x16x32_bf16 v[148:151], v[116:119], v[56:59], v[148:151]
 buffer_load_dwordx4 v0, s[36:39], s17 offen offset:1024 sc1 lds
 v_mfma_f32_16x16x32_bf16 v[148:151], v[112:115], v[40:43], v[148:151]
 s_waitcnt lgkmcnt(2)
 v_mfma_f32_16x16x32_bf16 v[184:187], v[96:99], v[32:35], v[184:187]
 ds_read_b128 v[112:115], v2 offset:49152
 ds_read_b128 v[116:119], v2 offset:50176
 v_mfma_f32_16x16x32_bf16 v[184:187], v[100:103], v[48:51], v[184:187]
 v_mfma_f32_16x16x32_bf16 v[152:155], v[100:103], v[56:59], v[152:155]
 buffer_load_dwordx4 v0, s[36:39], s17 offen offset:2048 sc1 lds
 v_mfma_f32_16x16x32_bf16 v[152:155], v[96:99], v[40:43], v[152:155]
 s_waitcnt lgkmcnt(2)
 v_mfma_f32_16x16x32_bf16 v[188:191], v[104:107], v[32:35], v[188:191]
 s_add_u32 s17, s23, 0x34b000
 ds_read_b128 v[96:99], v2 offset:51200
 ds_read_b128 v[100:103], v2 offset:52224
 v_mfma_f32_16x16x32_bf16 v[188:191], v[108:111], v[48:51], v[188:191]
 s_add_u32 m0, s23, 0xf000
 v_mfma_f32_16x16x32_bf16 v[156:159], v[108:111], v[56:59], v[156:159]
 buffer_load_dwordx4 v0, s[36:39], s17 offen offset:0 sc1 lds
 v_mfma_f32_16x16x32_bf16 v[156:159], v[104:107], v[40:43], v[156:159]
 s_waitcnt lgkmcnt(2)
 v_mfma_f32_16x16x32_bf16 v[192:195], v[112:115], v[32:35], v[192:195]
 ds_read_b128 v[104:107], v2 offset:53248
 ds_read_b128 v[108:111], v2 offset:54272
 v_mfma_f32_16x16x32_bf16 v[192:195], v[116:119], v[48:51], v[192:195]
 v_mfma_f32_16x16x32_bf16 a[192:195], v[116:119], v[56:59], a[192:195]
 buffer_load_dwordx4 v0, s[36:39], s17 offen offset:1024 sc1 lds
 v_mfma_f32_16x16x32_bf16 a[192:195], v[112:115], v[40:43], a[192:195]
 s_waitcnt lgkmcnt(2)
 v_mfma_f32_16x16x32_bf16 v[196:199], v[96:99], v[32:35], v[196:199]
 ds_read_b128 v[112:115], v2 offset:55296
 ds_read_b128 v[116:119], v2 offset:56320
 v_mfma_f32_16x16x32_bf16 v[196:199], v[100:103], v[48:51], v[196:199]
 v_mfma_f32_16x16x32_bf16 a[196:199], v[100:103], v[56:59], a[196:199]
 buffer_load_dwordx4 v0, s[36:39], s17 offen offset:2048 sc1 lds
 v_mfma_f32_16x16x32_bf16 a[196:199], v[96:99], v[40:43], a[196:199]
 s_waitcnt lgkmcnt(2)
 v_mfma_f32_16x16x32_bf16 v[200:203], v[104:107], v[32:35], v[200:203]
 s_add_u32 s28, s26, 0xa8000
 ds_read_b128 v[96:99], v2 offset:57344
 ds_read_b128 v[100:103], v2 offset:58368
 v_mfma_f32_16x16x32_bf16 v[200:203], v[108:111], v[48:51], v[200:203]
 v_mfma_f32_16x16x32_bf16 a[200:203], v[108:111], v[56:59], a[200:203]
 buffer_load_dwordx4 v[64:67], v0, s[32:35], s28 offen
 v_mfma_f32_16x16x32_bf16 a[200:203], v[104:107], v[40:43], a[200:203]
 s_waitcnt lgkmcnt(2)
 v_mfma_f32_16x16x32_bf16 v[204:207], v[112:115], v[32:35], v[204:207]
 ds_read_b128 v[104:107], v2 offset:59392
 ds_read_b128 v[108:111], v2 offset:60416
 v_mfma_f32_16x16x32_bf16 v[204:207], v[116:119], v[48:51], v[204:207]
 v_mfma_f32_16x16x32_bf16 a[204:207], v[116:119], v[56:59], a[204:207]
 v_mfma_f32_16x16x32_bf16 a[204:207], v[112:115], v[40:43], a[204:207]
 s_waitcnt lgkmcnt(2)
 v_mfma_f32_16x16x32_bf16 v[208:211], v[96:99], v[32:35], v[208:211]
 s_add_u32 s28, s26, 0xac000
 ds_read_b128 v[112:115], v2 offset:61440
 ds_read_b128 v[116:119], v2 offset:62464
 v_mfma_f32_16x16x32_bf16 v[208:211], v[100:103], v[48:51], v[208:211]
 v_mfma_f32_16x16x32_bf16 a[208:211], v[100:103], v[56:59], a[208:211]
 buffer_load_dwordx4 v[80:83], v0, s[32:35], s28 offen
 v_mfma_f32_16x16x32_bf16 a[208:211], v[96:99], v[40:43], a[208:211]
 s_waitcnt lgkmcnt(2)
 v_mfma_f32_16x16x32_bf16 v[212:215], v[104:107], v[32:35], v[212:215]
 ds_read_b128 v[96:99], v2 offset:63488
 ds_read_b128 v[100:103], v2 offset:64512
 v_mfma_f32_16x16x32_bf16 v[212:215], v[108:111], v[48:51], v[212:215]
 v_mfma_f32_16x16x32_bf16 a[212:215], v[108:111], v[56:59], a[212:215]
 v_mfma_f32_16x16x32_bf16 a[212:215], v[104:107], v[40:43], a[212:215]
 s_waitcnt lgkmcnt(2)
 v_mfma_f32_16x16x32_bf16 v[216:219], v[112:115], v[32:35], v[216:219]
 s_add_u32 s28, s26, 0xaa000
 ds_read_b128 v[104:107], v3 offset:0
 ds_read_b128 v[108:111], v3 offset:1024
 v_mfma_f32_16x16x32_bf16 v[216:219], v[116:119], v[48:51], v[216:219]
 v_mfma_f32_16x16x32_bf16 a[216:219], v[116:119], v[56:59], a[216:219]
 buffer_load_dwordx4 v[72:75], v0, s[32:35], s28 offen
 v_mfma_f32_16x16x32_bf16 a[216:219], v[112:115], v[40:43], a[216:219]
 s_waitcnt lgkmcnt(2)
 v_mfma_f32_16x16x32_bf16 v[220:223], v[96:99], v[32:35], v[220:223]
 ds_read_b128 v[112:115], v3 offset:2048
 ds_read_b128 v[116:119], v3 offset:3072
 v_mfma_f32_16x16x32_bf16 v[220:223], v[100:103], v[48:51], v[220:223]
 v_mfma_f32_16x16x32_bf16 a[220:223], v[100:103], v[56:59], a[220:223]
 v_mfma_f32_16x16x32_bf16 a[220:223], v[96:99], v[40:43], a[220:223]
 s_waitcnt lgkmcnt(2)
 v_mfma_f32_16x16x32_bf16 v[224:227], v[104:107], v[32:35], v[224:227]
 s_add_u32 s28, s26, 0xae000
 ds_read_b128 v[96:99], v3 offset:4096
 ds_read_b128 v[100:103], v3 offset:5120
 v_mfma_f32_16x16x32_bf16 v[224:227], v[108:111], v[48:51], v[224:227]
 v_mfma_f32_16x16x32_bf16 a[224:227], v[108:111], v[56:59], a[224:227]
 buffer_load_dwordx4 v[88:91], v0, s[32:35], s28 offen
 v_mfma_f32_16x16x32_bf16 a[224:227], v[104:107], v[40:43], a[224:227]
 s_waitcnt lgkmcnt(2)
 v_mfma_f32_16x16x32_bf16 v[228:231], v[112:115], v[32:35], v[228:231]
 ds_read_b128 v[104:107], v3 offset:6144
 ds_read_b128 v[108:111], v3 offset:7168
 v_mfma_f32_16x16x32_bf16 v[228:231], v[116:119], v[48:51], v[228:231]
 v_mfma_f32_16x16x32_bf16 a[228:231], v[116:119], v[56:59], a[228:231]
 v_mfma_f32_16x16x32_bf16 a[228:231], v[112:115], v[40:43], a[228:231]
 s_waitcnt lgkmcnt(2)
 v_mfma_f32_16x16x32_bf16 v[232:235], v[96:99], v[32:35], v[232:235]
 s_add_u32 s17, s23, 0x34e000
 ds_read_b128 v[112:115], v3 offset:8192
 ds_read_b128 v[116:119], v3 offset:9216
 v_mfma_f32_16x16x32_bf16 v[232:235], v[100:103], v[48:51], v[232:235]
 s_add_u32 m0, s23, 0x12000
 v_mfma_f32_16x16x32_bf16 a[232:235], v[100:103], v[56:59], a[232:235]
 buffer_load_dwordx4 v0, s[36:39], s17 offen offset:0 sc1 lds
 v_mfma_f32_16x16x32_bf16 a[232:235], v[96:99], v[40:43], a[232:235]
 s_waitcnt lgkmcnt(2)
 v_mfma_f32_16x16x32_bf16 v[236:239], v[104:107], v[32:35], v[236:239]
 ds_read_b128 v[96:99], v3 offset:10240
 ds_read_b128 v[100:103], v3 offset:11264
 v_mfma_f32_16x16x32_bf16 v[236:239], v[108:111], v[48:51], v[236:239]
 v_mfma_f32_16x16x32_bf16 a[236:239], v[108:111], v[56:59], a[236:239]
 buffer_load_dwordx4 v0, s[36:39], s17 offen offset:1024 sc1 lds
 v_mfma_f32_16x16x32_bf16 a[236:239], v[104:107], v[40:43], a[236:239]
 s_waitcnt lgkmcnt(2)
 v_mfma_f32_16x16x32_bf16 v[240:243], v[112:115], v[32:35], v[240:243]
 ds_read_b128 v[104:107], v3 offset:12288
 ds_read_b128 v[108:111], v3 offset:13312
 v_mfma_f32_16x16x32_bf16 v[240:243], v[116:119], v[48:51], v[240:243]
 v_mfma_f32_16x16x32_bf16 a[240:243], v[116:119], v[56:59], a[240:243]
 buffer_load_dwordx4 v0, s[36:39], s17 offen offset:2048 sc1 lds
 v_mfma_f32_16x16x32_bf16 a[240:243], v[112:115], v[40:43], a[240:243]
 s_waitcnt lgkmcnt(2)
 v_mfma_f32_16x16x32_bf16 v[244:247], v[96:99], v[32:35], v[244:247]
 s_add_u32 s17, s23, 0x351000
 ds_read_b128 v[112:115], v3 offset:14336
 ds_read_b128 v[116:119], v3 offset:15360
 v_mfma_f32_16x16x32_bf16 v[244:247], v[100:103], v[48:51], v[244:247]
 s_add_u32 m0, s23, 0x15000
 v_mfma_f32_16x16x32_bf16 a[244:247], v[100:103], v[56:59], a[244:247]
 buffer_load_dwordx4 v0, s[36:39], s17 offen offset:0 sc1 lds
 v_mfma_f32_16x16x32_bf16 a[244:247], v[96:99], v[40:43], a[244:247]
 s_waitcnt lgkmcnt(2)
 v_mfma_f32_16x16x32_bf16 v[248:251], v[104:107], v[32:35], v[248:251]
 ds_read_b128 v[96:99], v2 offset:32768
 ds_read_b128 v[100:103], v2 offset:33792
 v_mfma_f32_16x16x32_bf16 v[248:251], v[108:111], v[48:51], v[248:251]
 v_mfma_f32_16x16x32_bf16 a[248:251], v[108:111], v[56:59], a[248:251]
 buffer_load_dwordx4 v0, s[36:39], s17 offen offset:1024 sc1 lds
 v_mfma_f32_16x16x32_bf16 a[248:251], v[104:107], v[40:43], a[248:251]
 s_waitcnt lgkmcnt(2)
 v_mfma_f32_16x16x32_bf16 v[252:255], v[112:115], v[32:35], v[252:255]
 ds_read_b128 v[104:107], v2 offset:34816
 ds_read_b128 v[108:111], v2 offset:35840
 v_mfma_f32_16x16x32_bf16 v[252:255], v[116:119], v[48:51], v[252:255]
 v_mfma_f32_16x16x32_bf16 a[252:255], v[116:119], v[56:59], a[252:255]
 buffer_load_dwordx4 v0, s[36:39], s17 offen offset:2048 sc1 lds
 v_mfma_f32_16x16x32_bf16 a[252:255], v[112:115], v[40:43], a[252:255]
 s_waitcnt lgkmcnt(2)
 v_mfma_f32_16x16x32_bf16 a[96:99], v[96:99], v[36:39], a[96:99]
 s_add_u32 s28, s26, 0xb0000
 ds_read_b128 v[112:115], v2 offset:36864
 ds_read_b128 v[116:119], v2 offset:37888
 v_mfma_f32_16x16x32_bf16 a[96:99], v[100:103], v[52:55], a[96:99]
 v_mfma_f32_16x16x32_bf16 a[0:3], v[100:103], v[60:63], a[0:3]
 buffer_load_dwordx4 v[32:35], v0, s[32:35], s28 offen
 v_mfma_f32_16x16x32_bf16 a[0:3], v[96:99], v[44:47], a[0:3]
 s_waitcnt lgkmcnt(2)
 v_mfma_f32_16x16x32_bf16 a[100:103], v[104:107], v[36:39], a[100:103]
 ds_read_b128 v[96:99], v2 offset:38912
 ds_read_b128 v[100:103], v2 offset:39936
 v_mfma_f32_16x16x32_bf16 a[100:103], v[108:111], v[52:55], a[100:103]
 v_mfma_f32_16x16x32_bf16 a[4:7], v[108:111], v[60:63], a[4:7]
 v_mfma_f32_16x16x32_bf16 a[4:7], v[104:107], v[44:47], a[4:7]
 s_waitcnt lgkmcnt(2)
 v_mfma_f32_16x16x32_bf16 a[104:107], v[112:115], v[36:39], a[104:107]
 s_add_u32 s28, s26, 0xb4000
 ds_read_b128 v[104:107], v2 offset:40960
 ds_read_b128 v[108:111], v2 offset:41984
 v_mfma_f32_16x16x32_bf16 a[104:107], v[116:119], v[52:55], a[104:107]
 v_mfma_f32_16x16x32_bf16 a[8:11], v[116:119], v[60:63], a[8:11]
 buffer_load_dwordx4 v[48:51], v0, s[32:35], s28 offen
 v_mfma_f32_16x16x32_bf16 a[8:11], v[112:115], v[44:47], a[8:11]
 s_waitcnt lgkmcnt(2)
 v_mfma_f32_16x16x32_bf16 a[108:111], v[96:99], v[36:39], a[108:111]
 ds_read_b128 v[112:115], v2 offset:43008
 ds_read_b128 v[116:119], v2 offset:44032
 v_mfma_f32_16x16x32_bf16 a[108:111], v[100:103], v[52:55], a[108:111]
 v_mfma_f32_16x16x32_bf16 a[12:15], v[100:103], v[60:63], a[12:15]
 v_mfma_f32_16x16x32_bf16 a[12:15], v[96:99], v[44:47], a[12:15]
 s_waitcnt lgkmcnt(2)
 v_mfma_f32_16x16x32_bf16 a[112:115], v[104:107], v[36:39], a[112:115]
 s_add_u32 s28, s26, 0xb2000
 ds_read_b128 v[96:99], v2 offset:45056
 ds_read_b128 v[100:103], v2 offset:46080
 v_mfma_f32_16x16x32_bf16 a[112:115], v[108:111], v[52:55], a[112:115]
 v_mfma_f32_16x16x32_bf16 a[16:19], v[108:111], v[60:63], a[16:19]
 buffer_load_dwordx4 v[40:43], v0, s[32:35], s28 offen
 v_mfma_f32_16x16x32_bf16 a[16:19], v[104:107], v[44:47], a[16:19]
 s_waitcnt lgkmcnt(2)
 v_mfma_f32_16x16x32_bf16 a[116:119], v[112:115], v[36:39], a[116:119]
 ds_read_b128 v[104:107], v2 offset:47104
 ds_read_b128 v[108:111], v2 offset:48128
 v_mfma_f32_16x16x32_bf16 a[116:119], v[116:119], v[52:55], a[116:119]
 v_mfma_f32_16x16x32_bf16 a[20:23], v[116:119], v[60:63], a[20:23]
 v_mfma_f32_16x16x32_bf16 a[20:23], v[112:115], v[44:47], a[20:23]
 s_waitcnt lgkmcnt(2)
 v_mfma_f32_16x16x32_bf16 a[120:123], v[96:99], v[36:39], a[120:123]
 s_add_u32 s28, s26, 0xb6000
 ds_read_b128 v[112:115], v2 offset:49152
 ds_read_b128 v[116:119], v2 offset:50176
 v_mfma_f32_16x16x32_bf16 a[120:123], v[100:103], v[52:55], a[120:123]
 s_barrier
 v_mfma_f32_16x16x32_bf16 a[24:27], v[100:103], v[60:63], a[24:27]
 buffer_load_dwordx4 v[56:59], v0, s[32:35], s28 offen
 v_mfma_f32_16x16x32_bf16 a[24:27], v[96:99], v[44:47], a[24:27]
 s_waitcnt lgkmcnt(2)
 v_mfma_f32_16x16x32_bf16 a[124:127], v[104:107], v[36:39], a[124:127]
 s_add_u32 s17, s23, 0x354000
 ds_read_b128 v[96:99], v2 offset:51200
 ds_read_b128 v[100:103], v2 offset:52224
 v_mfma_f32_16x16x32_bf16 a[124:127], v[108:111], v[52:55], a[124:127]
 s_add_u32 m0, s23, 0x18000
 v_mfma_f32_16x16x32_bf16 a[28:31], v[108:111], v[60:63], a[28:31]
 buffer_load_dwordx4 v0, s[36:39], s17 offen offset:0 sc1 lds
 v_mfma_f32_16x16x32_bf16 a[28:31], v[104:107], v[44:47], a[28:31]
 s_waitcnt lgkmcnt(2)
 v_mfma_f32_16x16x32_bf16 a[128:131], v[112:115], v[36:39], a[128:131]
 ds_read_b128 v[104:107], v2 offset:53248
 ds_read_b128 v[108:111], v2 offset:54272
 v_mfma_f32_16x16x32_bf16 a[128:131], v[116:119], v[52:55], a[128:131]
 v_mfma_f32_16x16x32_bf16 a[32:35], v[116:119], v[60:63], a[32:35]
 buffer_load_dwordx4 v0, s[36:39], s17 offen offset:1024 sc1 lds
 v_mfma_f32_16x16x32_bf16 a[32:35], v[112:115], v[44:47], a[32:35]
 s_waitcnt lgkmcnt(2)
 v_mfma_f32_16x16x32_bf16 a[132:135], v[96:99], v[36:39], a[132:135]
 ds_read_b128 v[112:115], v2 offset:55296
 ds_read_b128 v[116:119], v2 offset:56320
 v_mfma_f32_16x16x32_bf16 a[132:135], v[100:103], v[52:55], a[132:135]
 v_mfma_f32_16x16x32_bf16 a[36:39], v[100:103], v[60:63], a[36:39]
 buffer_load_dwordx4 v0, s[36:39], s17 offen offset:2048 sc1 lds
 v_mfma_f32_16x16x32_bf16 a[36:39], v[96:99], v[44:47], a[36:39]
 s_waitcnt lgkmcnt(2)
 v_mfma_f32_16x16x32_bf16 a[136:139], v[104:107], v[36:39], a[136:139]
 s_add_u32 s28, s26, 0xa9000
 ds_read_b128 v[96:99], v2 offset:57344
 ds_read_b128 v[100:103], v2 offset:58368
 v_mfma_f32_16x16x32_bf16 a[136:139], v[108:111], v[52:55], a[136:139]
 v_mfma_f32_16x16x32_bf16 a[40:43], v[108:111], v[60:63], a[40:43]
 buffer_load_dwordx4 v[68:71], v0, s[32:35], s28 offen
 v_mfma_f32_16x16x32_bf16 a[40:43], v[104:107], v[44:47], a[40:43]
 s_waitcnt lgkmcnt(2)
 v_mfma_f32_16x16x32_bf16 a[140:143], v[112:115], v[36:39], a[140:143]
 ds_read_b128 v[104:107], v2 offset:59392
 ds_read_b128 v[108:111], v2 offset:60416
 v_mfma_f32_16x16x32_bf16 a[140:143], v[116:119], v[52:55], a[140:143]
 v_mfma_f32_16x16x32_bf16 a[44:47], v[116:119], v[60:63], a[44:47]
 v_mfma_f32_16x16x32_bf16 a[44:47], v[112:115], v[44:47], a[44:47]
 s_waitcnt lgkmcnt(2)
 v_mfma_f32_16x16x32_bf16 a[144:147], v[96:99], v[36:39], a[144:147]
 s_add_u32 s28, s26, 0xad000
 ds_read_b128 v[112:115], v2 offset:61440
 ds_read_b128 v[116:119], v2 offset:62464
 v_mfma_f32_16x16x32_bf16 a[144:147], v[100:103], v[52:55], a[144:147]
 s_barrier
 v_mfma_f32_16x16x32_bf16 a[48:51], v[100:103], v[60:63], a[48:51]
 buffer_load_dwordx4 v[84:87], v0, s[32:35], s28 offen
 v_mfma_f32_16x16x32_bf16 a[48:51], v[96:99], v[44:47], a[48:51]
 s_waitcnt lgkmcnt(2)
 v_mfma_f32_16x16x32_bf16 a[148:151], v[104:107], v[36:39], a[148:151]
 s_add_u32 s17, s23, 0x357000
 ds_read_b128 v[96:99], v2 offset:63488
 ds_read_b128 v[100:103], v2 offset:64512
 v_mfma_f32_16x16x32_bf16 a[148:151], v[108:111], v[52:55], a[148:151]
 s_add_u32 m0, s23, 0x1b000
 v_mfma_f32_16x16x32_bf16 a[52:55], v[108:111], v[60:63], a[52:55]
 buffer_load_dwordx4 v0, s[36:39], s17 offen offset:0 sc1 lds
 v_mfma_f32_16x16x32_bf16 a[52:55], v[104:107], v[44:47], a[52:55]
 s_waitcnt lgkmcnt(2)
 v_mfma_f32_16x16x32_bf16 a[152:155], v[112:115], v[36:39], a[152:155]
 ds_read_b128 v[104:107], v3 offset:0
 ds_read_b128 v[108:111], v3 offset:1024
 v_mfma_f32_16x16x32_bf16 a[152:155], v[116:119], v[52:55], a[152:155]
 v_mfma_f32_16x16x32_bf16 a[56:59], v[116:119], v[60:63], a[56:59]
 buffer_load_dwordx4 v0, s[36:39], s17 offen offset:1024 sc1 lds
 v_mfma_f32_16x16x32_bf16 a[56:59], v[112:115], v[44:47], a[56:59]
 s_waitcnt lgkmcnt(2)
 v_mfma_f32_16x16x32_bf16 a[156:159], v[96:99], v[36:39], a[156:159]
 ds_read_b128 v[112:115], v3 offset:2048
 ds_read_b128 v[116:119], v3 offset:3072
 v_mfma_f32_16x16x32_bf16 a[156:159], v[100:103], v[52:55], a[156:159]
 v_mfma_f32_16x16x32_bf16 a[60:63], v[100:103], v[60:63], a[60:63]
 buffer_load_dwordx4 v0, s[36:39], s17 offen offset:2048 sc1 lds
 v_mfma_f32_16x16x32_bf16 a[60:63], v[96:99], v[44:47], a[60:63]
 s_waitcnt lgkmcnt(2)
 v_mfma_f32_16x16x32_bf16 a[160:163], v[104:107], v[36:39], a[160:163]
 s_add_u32 s28, s26, 0xab000
 ds_read_b128 v[96:99], v3 offset:4096
 ds_read_b128 v[100:103], v3 offset:5120
 v_mfma_f32_16x16x32_bf16 a[160:163], v[108:111], v[52:55], a[160:163]
 v_mfma_f32_16x16x32_bf16 a[64:67], v[108:111], v[60:63], a[64:67]
 buffer_load_dwordx4 v[76:79], v0, s[32:35], s28 offen
 v_mfma_f32_16x16x32_bf16 a[64:67], v[104:107], v[44:47], a[64:67]
 s_waitcnt lgkmcnt(2)
 v_mfma_f32_16x16x32_bf16 a[164:167], v[112:115], v[36:39], a[164:167]
 ds_read_b128 v[104:107], v3 offset:6144
 ds_read_b128 v[108:111], v3 offset:7168
 v_mfma_f32_16x16x32_bf16 a[164:167], v[116:119], v[52:55], a[164:167]
 v_mfma_f32_16x16x32_bf16 a[68:71], v[116:119], v[60:63], a[68:71]
 v_mfma_f32_16x16x32_bf16 a[68:71], v[112:115], v[44:47], a[68:71]
 s_waitcnt lgkmcnt(2)
 v_mfma_f32_16x16x32_bf16 a[168:171], v[96:99], v[36:39], a[168:171]
 s_add_u32 s28, s26, 0xaf000
 ds_read_b128 v[112:115], v3 offset:8192
 ds_read_b128 v[116:119], v3 offset:9216
 v_mfma_f32_16x16x32_bf16 a[168:171], v[100:103], v[52:55], a[168:171]
 s_barrier
 v_mfma_f32_16x16x32_bf16 a[72:75], v[100:103], v[60:63], a[72:75]
 buffer_load_dwordx4 v[92:95], v0, s[32:35], s28 offen
 v_mfma_f32_16x16x32_bf16 a[72:75], v[96:99], v[44:47], a[72:75]
 s_waitcnt lgkmcnt(2)
 v_mfma_f32_16x16x32_bf16 a[172:175], v[104:107], v[36:39], a[172:175]
 s_add_u32 s17, s23, 0x35a000
 ds_read_b128 v[96:99], v3 offset:10240
 ds_read_b128 v[100:103], v3 offset:11264
 v_mfma_f32_16x16x32_bf16 a[172:175], v[108:111], v[52:55], a[172:175]
 s_add_u32 m0, s23, 0x1e000
 v_mfma_f32_16x16x32_bf16 a[76:79], v[108:111], v[60:63], a[76:79]
 buffer_load_dwordx4 v0, s[36:39], s17 offen offset:0 sc1 lds
 v_mfma_f32_16x16x32_bf16 a[76:79], v[104:107], v[44:47], a[76:79]
 s_waitcnt lgkmcnt(2)
 v_mfma_f32_16x16x32_bf16 a[176:179], v[112:115], v[36:39], a[176:179]
 ds_read_b128 v[104:107], v3 offset:12288
 ds_read_b128 v[108:111], v3 offset:13312
 v_mfma_f32_16x16x32_bf16 a[176:179], v[116:119], v[52:55], a[176:179]
 v_mfma_f32_16x16x32_bf16 a[80:83], v[116:119], v[60:63], a[80:83]
 buffer_load_dwordx4 v0, s[36:39], s17 offen offset:1024 sc1 lds
 v_mfma_f32_16x16x32_bf16 a[80:83], v[112:115], v[44:47], a[80:83]
 s_waitcnt lgkmcnt(2)
 v_mfma_f32_16x16x32_bf16 a[180:183], v[96:99], v[36:39], a[180:183]
 ds_read_b128 v[112:115], v3 offset:14336
 ds_read_b128 v[116:119], v3 offset:15360
 v_mfma_f32_16x16x32_bf16 a[180:183], v[100:103], v[52:55], a[180:183]
 v_mfma_f32_16x16x32_bf16 a[84:87], v[100:103], v[60:63], a[84:87]
 buffer_load_dwordx4 v0, s[36:39], s17 offen offset:2048 sc1 lds
 v_mfma_f32_16x16x32_bf16 a[84:87], v[96:99], v[44:47], a[84:87]
 s_waitcnt vmcnt(10) lgkmcnt(2)
 v_mfma_f32_16x16x32_bf16 a[184:187], v[104:107], v[36:39], a[184:187]
 ds_read_b128 v[96:99], v0 offset:0
 ds_read_b128 v[100:103], v0 offset:1024
 v_mfma_f32_16x16x32_bf16 a[184:187], v[108:111], v[52:55], a[184:187]
 s_barrier
 v_mfma_f32_16x16x32_bf16 a[88:91], v[108:111], v[60:63], a[88:91]
 v_mfma_f32_16x16x32_bf16 a[88:91], v[104:107], v[44:47], a[88:91]
 s_waitcnt lgkmcnt(2)
 v_mfma_f32_16x16x32_bf16 a[188:191], v[112:115], v[36:39], a[188:191]
 s_mov_b32 m0, 0x27100
 ds_read_b128 v[104:107], v0 offset:49152
 ds_read_b128 v[108:111], v0 offset:50176
 v_mfma_f32_16x16x32_bf16 a[188:191], v[116:119], v[52:55], a[188:191]
 v_mfma_f32_16x16x32_bf16 a[92:95], v[116:119], v[60:63], a[92:95]
 global_load_lds_dword v[126:127], off
 v_mfma_f32_16x16x32_bf16 a[92:95], v[112:115], v[44:47], a[92:95]
 s_waitcnt lgkmcnt(2)
 v_mfma_f32_16x16x32_bf16 v[160:163], v[96:99], v[16:19], v[160:163]
 s_add_u32 s28, s26, 0xb1000
 ds_read_b128 v[112:115], v2 offset:32768
 ds_read_b128 v[116:119], v2 offset:33792
 v_mfma_f32_16x16x32_bf16 v[160:163], v[100:103], v[4:7], v[160:163]
 v_mfma_f32_16x16x32_bf16 v[128:131], v[100:103], v[12:15], v[128:131]
 buffer_load_dwordx4 v[36:39], v0, s[32:35], s28 offen
 v_mfma_f32_16x16x32_bf16 v[128:131], v[96:99], v[24:27], v[128:131]
 s_waitcnt lgkmcnt(2)
 v_mfma_f32_16x16x32_bf16 v[128:131], v[104:107], v[72:75], v[128:131]
 s_add_u32 s28, s26, 0xb5000
 ds_read_b128 v[96:99], v0 offset:2048
 ds_read_b128 v[100:103], v0 offset:3072
 v_mfma_f32_16x16x32_bf16 v[128:131], v[108:111], v[88:91], v[128:131]
 v_mfma_f32_16x16x32_bf16 v[160:163], v[108:111], v[80:83], v[160:163]
 buffer_load_dwordx4 v[52:55], v0, s[32:35], s28 offen
 v_mfma_f32_16x16x32_bf16 v[160:163], v[104:107], v[64:67], v[160:163]
 s_waitcnt lgkmcnt(2)
 v_mfma_f32_16x16x32_bf16 v[160:163], v[112:115], v[32:35], v[160:163]
 s_add_u32 s28, s26, 0xb3000
 ds_read_b128 v[104:107], v0 offset:51200
 ds_read_b128 v[108:111], v0 offset:52224
 v_mfma_f32_16x16x32_bf16 v[160:163], v[116:119], v[48:51], v[160:163]
 v_mfma_f32_16x16x32_bf16 v[128:131], v[116:119], v[56:59], v[128:131]
 buffer_load_dwordx4 v[44:47], v0, s[32:35], s28 offen
 v_mfma_f32_16x16x32_bf16 v[128:131], v[112:115], v[40:43], v[128:131]
 s_waitcnt lgkmcnt(2)
 v_mfma_f32_16x16x32_bf16 v[164:167], v[96:99], v[16:19], v[164:167]
 s_add_u32 s28, s26, 0xb7000
 ds_read_b128 v[112:115], v2 offset:34816
 ds_read_b128 v[116:119], v2 offset:35840
 v_mfma_f32_16x16x32_bf16 v[164:167], v[100:103], v[4:7], v[164:167]
 s_barrier
 v_mfma_f32_16x16x32_bf16 v[132:135], v[100:103], v[12:15], v[132:135]
 buffer_load_dwordx4 v[60:63], v0, s[32:35], s28 offen
 v_mfma_f32_16x16x32_bf16 v[132:135], v[96:99], v[24:27], v[132:135]
 s_waitcnt lgkmcnt(2)
 v_mfma_f32_16x16x32_bf16 v[132:135], v[104:107], v[72:75], v[132:135]
 s_add_u32 s17, s23, 0x35d000
 ds_read_b128 v[96:99], v0 offset:4096
 ds_read_b128 v[100:103], v0 offset:5120
 v_mfma_f32_16x16x32_bf16 v[132:135], v[108:111], v[88:91], v[132:135]
 s_add_u32 m0, s23, 0x21000
 v_mfma_f32_16x16x32_bf16 v[164:167], v[108:111], v[80:83], v[164:167]
 buffer_load_dwordx4 v0, s[36:39], s17 offen offset:0 sc1 lds
 v_mfma_f32_16x16x32_bf16 v[164:167], v[104:107], v[64:67], v[164:167]
 s_waitcnt lgkmcnt(2)
 v_mfma_f32_16x16x32_bf16 v[164:167], v[112:115], v[32:35], v[164:167]
 ds_read_b128 v[104:107], v0 offset:53248
 ds_read_b128 v[108:111], v0 offset:54272
 v_mfma_f32_16x16x32_bf16 v[164:167], v[116:119], v[48:51], v[164:167]
 v_mfma_f32_16x16x32_bf16 v[132:135], v[116:119], v[56:59], v[132:135]
 buffer_load_dwordx4 v0, s[36:39], s17 offen offset:1024 sc1 lds
 v_mfma_f32_16x16x32_bf16 v[132:135], v[112:115], v[40:43], v[132:135]
 s_waitcnt lgkmcnt(2)
 v_mfma_f32_16x16x32_bf16 v[168:171], v[96:99], v[16:19], v[168:171]
 ds_read_b128 v[112:115], v2 offset:36864
 ds_read_b128 v[116:119], v2 offset:37888
 v_mfma_f32_16x16x32_bf16 v[168:171], v[100:103], v[4:7], v[168:171]
 v_mfma_f32_16x16x32_bf16 v[136:139], v[100:103], v[12:15], v[136:139]
 buffer_load_dwordx4 v0, s[36:39], s17 offen offset:2048 sc1 lds
 v_mfma_f32_16x16x32_bf16 v[136:139], v[96:99], v[24:27], v[136:139]
 s_waitcnt lgkmcnt(2)
 v_mfma_f32_16x16x32_bf16 v[136:139], v[104:107], v[72:75], v[136:139]
 ds_read_b128 v[96:99], v0 offset:6144
 ds_read_b128 v[100:103], v0 offset:7168
 v_mfma_f32_16x16x32_bf16 v[136:139], v[108:111], v[88:91], v[136:139]
 v_mfma_f32_16x16x32_bf16 v[168:171], v[108:111], v[80:83], v[168:171]
 v_mfma_f32_16x16x32_bf16 v[168:171], v[104:107], v[64:67], v[168:171]
 s_waitcnt lgkmcnt(2)
 v_mfma_f32_16x16x32_bf16 v[168:171], v[112:115], v[32:35], v[168:171]
 ds_read_b128 v[104:107], v0 offset:55296
 ds_read_b128 v[108:111], v0 offset:56320
 v_mfma_f32_16x16x32_bf16 v[168:171], v[116:119], v[48:51], v[168:171]
 v_cvt_pk_bf16_f32 v160, v160, v161
 v_cvt_pk_bf16_f32 v161, v162, v163
 v_mfma_f32_16x16x32_bf16 v[136:139], v[116:119], v[56:59], v[136:139]
 v_cvt_pk_bf16_f32 v162, v164, v165
 v_cvt_pk_bf16_f32 v163, v166, v167
 v_mfma_f32_16x16x32_bf16 v[136:139], v[112:115], v[40:43], v[136:139]
 s_waitcnt lgkmcnt(2)
 buffer_store_dwordx4 v[160:163], v1, s[44:47], s60 offen offset:0 sc1
 v_mfma_f32_16x16x32_bf16 v[172:175], v[96:99], v[16:19], v[172:175]
 ds_read_b128 v[112:115], v2 offset:38912
 ds_read_b128 v[116:119], v2 offset:39936
 v_mfma_f32_16x16x32_bf16 v[172:175], v[100:103], v[4:7], v[172:175]
 v_cvt_pk_bf16_f32 v128, v128, v129
 v_cvt_pk_bf16_f32 v129, v130, v131
 v_mfma_f32_16x16x32_bf16 v[140:143], v[100:103], v[12:15], v[140:143]
 v_cvt_pk_bf16_f32 v130, v132, v133
 v_cvt_pk_bf16_f32 v131, v134, v135
 v_mfma_f32_16x16x32_bf16 v[140:143], v[96:99], v[24:27], v[140:143]
 s_waitcnt lgkmcnt(2)
 buffer_store_dwordx4 v[128:131], v1, s[44:47], s62 offen offset:0 sc1
 v_mfma_f32_16x16x32_bf16 v[140:143], v[104:107], v[72:75], v[140:143]
 ds_read_b128 v[96:99], v0 offset:8192
 ds_read_b128 v[100:103], v0 offset:9216
 v_mfma_f32_16x16x32_bf16 v[140:143], v[108:111], v[88:91], v[140:143]
 ds_read_b128 v[164:167], v124 offset:6144
 ds_read_b128 v[160:163], v124 offset:6160
 v_mfma_f32_16x16x32_bf16 v[172:175], v[108:111], v[80:83], v[172:175]
 v_mfma_f32_16x16x32_bf16 v[172:175], v[104:107], v[64:67], v[172:175]
 s_waitcnt lgkmcnt(4)
 v_mfma_f32_16x16x32_bf16 v[172:175], v[112:115], v[32:35], v[172:175]
 ds_read_b128 v[104:107], v0 offset:57344
 ds_read_b128 v[108:111], v0 offset:58368
 v_mfma_f32_16x16x32_bf16 v[172:175], v[116:119], v[48:51], v[172:175]
 v_mfma_f32_16x16x32_bf16 v[140:143], v[116:119], v[56:59], v[140:143]
 v_mfma_f32_16x16x32_bf16 v[140:143], v[112:115], v[40:43], v[140:143]
 s_waitcnt lgkmcnt(4)
 v_mfma_f32_16x16x32_bf16 v[176:179], v[96:99], v[16:19], v[176:179]
 ds_read_b128 v[112:115], v2 offset:40960
 ds_read_b128 v[116:119], v2 offset:41984
 v_mfma_f32_16x16x32_bf16 v[176:179], v[100:103], v[4:7], v[176:179]
 v_mfma_f32_16x16x32_bf16 v[144:147], v[100:103], v[12:15], v[144:147]
 v_mfma_f32_16x16x32_bf16 v[144:147], v[96:99], v[24:27], v[144:147]
 s_waitcnt lgkmcnt(2)
 v_mfma_f32_16x16x32_bf16 v[144:147], v[104:107], v[72:75], v[144:147]
 ds_read_b128 v[96:99], v0 offset:10240
 ds_read_b128 v[100:103], v0 offset:11264
 v_mfma_f32_16x16x32_bf16 v[144:147], v[108:111], v[88:91], v[144:147]
 v_mfma_f32_16x16x32_bf16 v[176:179], v[108:111], v[80:83], v[176:179]
 v_mfma_f32_16x16x32_bf16 v[176:179], v[104:107], v[64:67], v[176:179]
 s_waitcnt lgkmcnt(2)
 v_mfma_f32_16x16x32_bf16 v[176:179], v[112:115], v[32:35], v[176:179]
 ds_read_b128 v[104:107], v0 offset:59392
 ds_read_b128 v[108:111], v0 offset:60416
 v_mfma_f32_16x16x32_bf16 v[176:179], v[116:119], v[48:51], v[176:179]
 v_cvt_pk_bf16_f32 v168, v168, v169
 v_cvt_pk_bf16_f32 v169, v170, v171
 v_mfma_f32_16x16x32_bf16 v[144:147], v[116:119], v[56:59], v[144:147]
 v_cvt_pk_bf16_f32 v170, v172, v173
 v_cvt_pk_bf16_f32 v171, v174, v175
 v_mfma_f32_16x16x32_bf16 v[144:147], v[112:115], v[40:43], v[144:147]
 s_waitcnt vmcnt(15) lgkmcnt(2)
 buffer_store_dwordx4 v[168:171], v1, s[44:47], s60 offen offset:64 sc1
 v_mfma_f32_16x16x32_bf16 v[180:183], v[96:99], v[16:19], v[180:183]
 ds_read_b128 v[112:115], v2 offset:43008
 ds_read_b128 v[116:119], v2 offset:44032
 v_mfma_f32_16x16x32_bf16 v[180:183], v[100:103], v[4:7], v[180:183]
 s_barrier
 v_mfma_f32_16x16x32_bf16 v[148:151], v[100:103], v[12:15], v[148:151]
 v_cvt_pk_bf16_f32 v136, v136, v137
 v_cvt_pk_bf16_f32 v137, v138, v139
 v_mfma_f32_16x16x32_bf16 v[148:151], v[96:99], v[24:27], v[148:151]
 s_waitcnt lgkmcnt(2)
 v_cvt_pk_bf16_f32 v138, v140, v141
 v_cvt_pk_bf16_f32 v139, v142, v143
 v_mfma_f32_16x16x32_bf16 v[148:151], v[104:107], v[72:75], v[148:151]
 ds_read_b128 v[96:99], v0 offset:0
 ds_read_b128 v[100:103], v0 offset:1024
 v_mfma_f32_16x16x32_bf16 v[148:151], v[108:111], v[88:91], v[148:151]
 buffer_store_dwordx4 v[136:139], v1, s[44:47], s62 offen offset:64 sc1
 v_mfma_f32_16x16x32_bf16 v[180:183], v[108:111], v[80:83], v[180:183]
 v_mfma_f32_16x16x32_bf16 v[180:183], v[104:107], v[64:67], v[180:183]
 s_waitcnt lgkmcnt(2)
 v_mfma_f32_16x16x32_bf16 v[180:183], v[112:115], v[32:35], v[180:183]
 ds_read_b128 v[104:107], v0 offset:49152
 ds_read_b128 v[108:111], v0 offset:50176
 v_mfma_f32_16x16x32_bf16 v[180:183], v[116:119], v[48:51], v[180:183]
 v_mfma_f32_16x16x32_bf16 v[148:151], v[116:119], v[56:59], v[148:151]
 v_mfma_f32_16x16x32_bf16 v[148:151], v[112:115], v[40:43], v[148:151]
 s_waitcnt vmcnt(15) lgkmcnt(2)
 v_mfma_f32_16x16x32_bf16 a[96:99], v[96:99], v[20:23], a[96:99]
 ds_read_b128 v[112:115], v2 offset:32768
 ds_read_b128 v[116:119], v2 offset:33792
 v_mfma_f32_16x16x32_bf16 a[96:99], v[100:103], v[8:11], a[96:99]
 v_mfma_f32_16x16x32_bf16 a[0:3], v[100:103], v[120:123], a[0:3]
 v_mfma_f32_16x16x32_bf16 a[0:3], v[96:99], v[28:31], a[0:3]
 s_waitcnt lgkmcnt(2)
 v_mfma_f32_16x16x32_bf16 a[0:3], v[104:107], v[76:79], a[0:3]
 ds_read_b128 v[96:99], v0 offset:2048
 ds_read_b128 v[100:103], v0 offset:3072
 v_mfma_f32_16x16x32_bf16 a[0:3], v[108:111], v[92:95], a[0:3]
 v_mfma_f32_16x16x32_bf16 a[96:99], v[108:111], v[84:87], a[96:99]
 v_mfma_f32_16x16x32_bf16 a[96:99], v[104:107], v[68:71], a[96:99]
 s_waitcnt vmcnt(4) lgkmcnt(2)
 v_mfma_f32_16x16x32_bf16 a[96:99], v[112:115], v[36:39], a[96:99]
 ds_read_b128 v[104:107], v0 offset:51200
 ds_read_b128 v[108:111], v0 offset:52224
 v_mfma_f32_16x16x32_bf16 a[96:99], v[116:119], v[52:55], a[96:99]
 s_barrier
 v_mfma_f32_16x16x32_bf16 a[0:3], v[116:119], v[60:63], a[0:3]
 v_cvt_pk_bf16_f32 v176, v176, v177
 v_cvt_pk_bf16_f32 v177, v178, v179
 v_mfma_f32_16x16x32_bf16 a[0:3], v[112:115], v[44:47], a[0:3]
 s_waitcnt lgkmcnt(2)
 v_cvt_pk_bf16_f32 v178, v180, v181
 v_cvt_pk_bf16_f32 v179, v182, v183
 v_mfma_f32_16x16x32_bf16 a[100:103], v[96:99], v[20:23], a[100:103]
 ds_read_b128 v[112:115], v2 offset:34816
 ds_read_b128 v[116:119], v2 offset:35840
 v_mfma_f32_16x16x32_bf16 a[100:103], v[100:103], v[8:11], a[100:103]
 buffer_store_dwordx4 v[176:179], v1, s[44:47], s60 offen offset:128 sc1
 v_mfma_f32_16x16x32_bf16 a[4:7], v[100:103], v[120:123], a[4:7]
 v_cvt_pk_bf16_f32 v144, v144, v145
 v_cvt_pk_bf16_f32 v145, v146, v147
 v_mfma_f32_16x16x32_bf16 a[4:7], v[96:99], v[28:31], a[4:7]
 s_waitcnt lgkmcnt(2)
 v_cvt_pk_bf16_f32 v146, v148, v149
 v_cvt_pk_bf16_f32 v147, v150, v151
 v_mfma_f32_16x16x32_bf16 a[4:7], v[104:107], v[76:79], a[4:7]
 ds_read_b128 v[96:99], v0 offset:4096
 ds_read_b128 v[100:103], v0 offset:5120
 v_mfma_f32_16x16x32_bf16 a[4:7], v[108:111], v[92:95], a[4:7]
 buffer_store_dwordx4 v[144:147], v1, s[44:47], s62 offen offset:128 sc1
 v_mfma_f32_16x16x32_bf16 a[100:103], v[108:111], v[84:87], a[100:103]
 ds_read_b128 v[132:135], v124 offset:6272
 ds_read_b128 v[128:131], v124 offset:6288
 v_mfma_f32_16x16x32_bf16 a[100:103], v[104:107], v[68:71], a[100:103]
 s_waitcnt lgkmcnt(4)
 v_mfma_f32_16x16x32_bf16 a[100:103], v[112:115], v[36:39], a[100:103]
 ds_read_b128 v[104:107], v0 offset:53248
 ds_read_b128 v[108:111], v0 offset:54272
 v_mfma_f32_16x16x32_bf16 a[100:103], v[116:119], v[52:55], a[100:103]
 v_mfma_f32_16x16x32_bf16 a[4:7], v[116:119], v[60:63], a[4:7]
 v_mfma_f32_16x16x32_bf16 a[4:7], v[112:115], v[44:47], a[4:7]
 s_waitcnt lgkmcnt(4)
 v_mfma_f32_16x16x32_bf16 a[104:107], v[96:99], v[20:23], a[104:107]
 ds_read_b128 v[112:115], v2 offset:36864
 ds_read_b128 v[116:119], v2 offset:37888
 v_mfma_f32_16x16x32_bf16 a[104:107], v[100:103], v[8:11], a[104:107]
 v_mfma_f32_16x16x32_bf16 a[8:11], v[100:103], v[120:123], a[8:11]
 v_mfma_f32_16x16x32_bf16 a[8:11], v[96:99], v[28:31], a[8:11]
 s_waitcnt lgkmcnt(2)
 v_mfma_f32_16x16x32_bf16 a[8:11], v[104:107], v[76:79], a[8:11]
 ds_read_b128 v[96:99], v0 offset:6144
 ds_read_b128 v[100:103], v0 offset:7168
 v_mfma_f32_16x16x32_bf16 a[8:11], v[108:111], v[92:95], a[8:11]
 v_mfma_f32_16x16x32_bf16 a[104:107], v[108:111], v[84:87], a[104:107]
 v_mfma_f32_16x16x32_bf16 a[104:107], v[104:107], v[68:71], a[104:107]
 s_waitcnt lgkmcnt(2)
 v_mfma_f32_16x16x32_bf16 a[104:107], v[112:115], v[36:39], a[104:107]
 ds_read_b128 v[104:107], v0 offset:55296
 ds_read_b128 v[108:111], v0 offset:56320
 v_mfma_f32_16x16x32_bf16 a[104:107], v[116:119], v[52:55], a[104:107]
 v_accvgpr_read_b32 v172, a96
 v_accvgpr_read_b32 v173, a97
 v_mfma_f32_16x16x32_bf16 a[8:11], v[116:119], v[60:63], a[8:11]
 v_accvgpr_read_b32 v174, a98
 v_accvgpr_read_b32 v175, a99
 v_mfma_f32_16x16x32_bf16 a[8:11], v[112:115], v[44:47], a[8:11]
 s_waitcnt lgkmcnt(2)
 v_accvgpr_read_b32 v168, a100
 v_accvgpr_read_b32 v169, a101
 v_mfma_f32_16x16x32_bf16 a[108:111], v[96:99], v[20:23], a[108:111]
 ds_read_b128 v[112:115], v2 offset:38912
 ds_read_b128 v[116:119], v2 offset:39936
 v_mfma_f32_16x16x32_bf16 a[108:111], v[100:103], v[8:11], a[108:111]
 v_accvgpr_read_b32 v170, a102
 v_accvgpr_read_b32 v171, a103
 v_mfma_f32_16x16x32_bf16 a[12:15], v[100:103], v[120:123], a[12:15]
 v_add_f32 v172, v172, v164
 v_add_f32 v173, v173, v165
 v_mfma_f32_16x16x32_bf16 a[12:15], v[96:99], v[28:31], a[12:15]
 s_waitcnt lgkmcnt(2)
 v_add_f32 v174, v174, v166
 v_add_f32 v175, v175, v167
 v_mfma_f32_16x16x32_bf16 a[12:15], v[104:107], v[76:79], a[12:15]
 ds_read_b128 v[96:99], v0 offset:8192
 ds_read_b128 v[100:103], v0 offset:9216
 v_mfma_f32_16x16x32_bf16 a[12:15], v[108:111], v[92:95], a[12:15]
 v_add_f32 v168, v168, v160
 v_add_f32 v169, v169, v161
 v_mfma_f32_16x16x32_bf16 a[108:111], v[108:111], v[84:87], a[108:111]
 v_add_f32 v170, v170, v162
 v_add_f32 v171, v171, v163
 v_mfma_f32_16x16x32_bf16 a[108:111], v[104:107], v[68:71], a[108:111]
 s_waitcnt lgkmcnt(2)
 v_cvt_pk_bf16_f32 v172, v172, v173
 v_cvt_pk_bf16_f32 v173, v174, v175
 v_mfma_f32_16x16x32_bf16 a[108:111], v[112:115], v[36:39], a[108:111]
 ds_read_b128 v[104:107], v0 offset:57344
 ds_read_b128 v[108:111], v0 offset:58368
 v_mfma_f32_16x16x32_bf16 a[108:111], v[116:119], v[52:55], a[108:111]
 v_cvt_pk_bf16_f32 v174, v168, v169
 v_cvt_pk_bf16_f32 v175, v170, v171
 v_mfma_f32_16x16x32_bf16 a[12:15], v[116:119], v[60:63], a[12:15]
 buffer_store_dwordx4 v[172:175], v1, s[44:47], s61 offen offset:0 sc1
 v_mfma_f32_16x16x32_bf16 a[12:15], v[112:115], v[44:47], a[12:15]
 s_waitcnt lgkmcnt(2)
 v_accvgpr_read_b32 v140, a0
 v_accvgpr_read_b32 v141, a1
 v_mfma_f32_16x16x32_bf16 a[112:115], v[96:99], v[20:23], a[112:115]
 ds_read_b128 v[112:115], v2 offset:40960
 ds_read_b128 v[116:119], v2 offset:41984
 v_mfma_f32_16x16x32_bf16 a[112:115], v[100:103], v[8:11], a[112:115]
 v_accvgpr_read_b32 v142, a2
 v_accvgpr_read_b32 v143, a3
 v_mfma_f32_16x16x32_bf16 a[16:19], v[100:103], v[120:123], a[16:19]
 v_accvgpr_read_b32 v136, a4
 v_accvgpr_read_b32 v137, a5
 v_mfma_f32_16x16x32_bf16 a[16:19], v[96:99], v[28:31], a[16:19]
 s_waitcnt lgkmcnt(2)
 v_accvgpr_read_b32 v138, a6
 v_accvgpr_read_b32 v139, a7
 v_mfma_f32_16x16x32_bf16 a[16:19], v[104:107], v[76:79], a[16:19]
 ds_read_b128 v[96:99], v0 offset:10240
 ds_read_b128 v[100:103], v0 offset:11264
 v_mfma_f32_16x16x32_bf16 a[16:19], v[108:111], v[92:95], a[16:19]
 v_add_f32 v140, v140, v164
 v_add_f32 v141, v141, v165
 v_mfma_f32_16x16x32_bf16 a[112:115], v[108:111], v[84:87], a[112:115]
 v_add_f32 v142, v142, v166
 v_add_f32 v143, v143, v167
 v_mfma_f32_16x16x32_bf16 a[112:115], v[104:107], v[68:71], a[112:115]
 s_waitcnt lgkmcnt(2)
 v_add_f32 v136, v136, v160
 v_add_f32 v137, v137, v161
 v_mfma_f32_16x16x32_bf16 a[112:115], v[112:115], v[36:39], a[112:115]
 ds_read_b128 v[104:107], v0 offset:59392
 ds_read_b128 v[108:111], v0 offset:60416
 v_mfma_f32_16x16x32_bf16 a[112:115], v[116:119], v[52:55], a[112:115]
 v_add_f32 v138, v138, v162
 v_add_f32 v139, v139, v163
 v_mfma_f32_16x16x32_bf16 a[16:19], v[116:119], v[60:63], a[16:19]
 v_cvt_pk_bf16_f32 v140, v140, v141
 v_cvt_pk_bf16_f32 v141, v142, v143
 v_mfma_f32_16x16x32_bf16 a[16:19], v[112:115], v[44:47], a[16:19]
 s_waitcnt lgkmcnt(2)
 v_cvt_pk_bf16_f32 v142, v136, v137
 v_cvt_pk_bf16_f32 v143, v138, v139
 v_mfma_f32_16x16x32_bf16 a[116:119], v[96:99], v[20:23], a[116:119]
 ds_read_b128 v[112:115], v2 offset:43008
 ds_read_b128 v[116:119], v2 offset:44032
 v_mfma_f32_16x16x32_bf16 a[116:119], v[100:103], v[8:11], a[116:119]
 buffer_store_dwordx4 v[140:143], v1, s[44:47], s63 offen offset:0 sc1
 v_mfma_f32_16x16x32_bf16 a[20:23], v[100:103], v[120:123], a[20:23]
 ds_read_b128 v[180:183], v124 offset:6400
 ds_read_b128 v[176:179], v124 offset:6416
 v_mfma_f32_16x16x32_bf16 a[20:23], v[96:99], v[28:31], a[20:23]
 s_waitcnt lgkmcnt(4)
 v_accvgpr_read_b32 v148, a104
 v_accvgpr_read_b32 v149, a105
 v_mfma_f32_16x16x32_bf16 a[20:23], v[104:107], v[76:79], a[20:23]
 ds_read_b128 v[96:99], v0 offset:12288
 ds_read_b128 v[100:103], v0 offset:13312
 v_mfma_f32_16x16x32_bf16 a[20:23], v[108:111], v[92:95], a[20:23]
 v_accvgpr_read_b32 v150, a106
 v_accvgpr_read_b32 v151, a107
 v_mfma_f32_16x16x32_bf16 a[116:119], v[108:111], v[84:87], a[116:119]
 v_accvgpr_read_b32 v144, a108
 v_accvgpr_read_b32 v145, a109
 v_mfma_f32_16x16x32_bf16 a[116:119], v[104:107], v[68:71], a[116:119]
 s_waitcnt lgkmcnt(4)
 v_accvgpr_read_b32 v146, a110
 v_accvgpr_read_b32 v147, a111
 v_mfma_f32_16x16x32_bf16 a[116:119], v[112:115], v[36:39], a[116:119]
 ds_read_b128 v[104:107], v0 offset:61440
 ds_read_b128 v[108:111], v0 offset:62464
 v_mfma_f32_16x16x32_bf16 a[116:119], v[116:119], v[52:55], a[116:119]
 v_add_f32 v148, v148, v132
 v_add_f32 v149, v149, v133
 v_mfma_f32_16x16x32_bf16 a[20:23], v[116:119], v[60:63], a[20:23]
 v_add_f32 v150, v150, v134
 v_add_f32 v151, v151, v135
 v_mfma_f32_16x16x32_bf16 a[20:23], v[112:115], v[44:47], a[20:23]
 s_waitcnt lgkmcnt(2)
 v_add_f32 v144, v144, v128
 v_add_f32 v145, v145, v129
 v_mfma_f32_16x16x32_bf16 v[184:187], v[96:99], v[16:19], v[184:187]
 ds_read_b128 v[112:115], v2 offset:45056
 v_add_f32 v146, v146, v130
 v_mfma_f32_16x16x32_bf16 v[184:187], v[100:103], v[4:7], v[184:187]
 ds_read_b128 v[116:119], v2 offset:46080
 v_add_f32 v147, v147, v131
 v_mfma_f32_16x16x32_bf16 a[120:123], v[100:103], v[8:11], a[120:123]
 v_cvt_pk_bf16_f32 v148, v148, v149
 v_cvt_pk_bf16_f32 v149, v150, v151
 v_mfma_f32_16x16x32_bf16 a[120:123], v[96:99], v[20:23], a[120:123]
 v_mfma_f32_16x16x32_bf16 v[152:155], v[96:99], v[24:27], v[152:155]
 v_cvt_pk_bf16_f32 v150, v144, v145
 v_cvt_pk_bf16_f32 v151, v146, v147
 v_mfma_f32_16x16x32_bf16 v[152:155], v[100:103], v[12:15], v[152:155]
 buffer_store_dwordx4 v[148:151], v1, s[44:47], s61 offen offset:64 sc1
 v_mfma_f32_16x16x32_bf16 a[24:27], v[100:103], v[120:123], a[24:27]
 v_accvgpr_read_b32 v168, a8
 v_accvgpr_read_b32 v169, a9
 v_mfma_f32_16x16x32_bf16 a[24:27], v[96:99], v[28:31], a[24:27]
 s_waitcnt lgkmcnt(2)
 v_accvgpr_read_b32 v170, a10
 v_accvgpr_read_b32 v171, a11
 v_mfma_f32_16x16x32_bf16 a[24:27], v[104:107], v[76:79], a[24:27]
 ds_read_b128 v[96:99], v0 offset:14336
 v_accvgpr_read_b32 v172, a12
 v_mfma_f32_16x16x32_bf16 a[24:27], v[108:111], v[92:95], a[24:27]
 ds_read_b128 v[100:103], v0 offset:15360
 v_accvgpr_read_b32 v173, a13
 v_mfma_f32_16x16x32_bf16 v[152:155], v[108:111], v[88:91], v[152:155]
 v_accvgpr_read_b32 v174, a14
 v_accvgpr_read_b32 v175, a15
 v_mfma_f32_16x16x32_bf16 v[152:155], v[104:107], v[72:75], v[152:155]
 v_add_f32 v168, v168, v132
 v_add_f32 v169, v169, v133
 v_mfma_f32_16x16x32_bf16 a[120:123], v[104:107], v[68:71], a[120:123]
 v_add_f32 v170, v170, v134
 v_add_f32 v171, v171, v135
 v_mfma_f32_16x16x32_bf16 a[120:123], v[108:111], v[84:87], a[120:123]
 v_add_f32 v172, v172, v128
 v_add_f32 v173, v173, v129
 v_mfma_f32_16x16x32_bf16 v[184:187], v[108:111], v[80:83], v[184:187]
 v_add_f32 v174, v174, v130
 v_add_f32 v175, v175, v131
 v_mfma_f32_16x16x32_bf16 v[184:187], v[104:107], v[64:67], v[184:187]
 s_waitcnt lgkmcnt(2)
 v_cvt_pk_bf16_f32 v168, v168, v169
 v_cvt_pk_bf16_f32 v169, v170, v171
 v_mfma_f32_16x16x32_bf16 v[184:187], v[112:115], v[32:35], v[184:187]
 ds_read_b128 v[104:107], v0 offset:63488
 v_cvt_pk_bf16_f32 v170, v172, v173
 v_mfma_f32_16x16x32_bf16 v[184:187], v[116:119], v[48:51], v[184:187]
 ds_read_b128 v[108:111], v0 offset:64512
 v_cvt_pk_bf16_f32 v171, v174, v175
 v_mfma_f32_16x16x32_bf16 a[120:123], v[116:119], v[52:55], a[120:123]
 buffer_store_dwordx4 v[168:171], v1, s[44:47], s63 offen offset:64 sc1
 v_mfma_f32_16x16x32_bf16 a[120:123], v[112:115], v[36:39], a[120:123]
 ds_read_b128 v[136:139], v124 offset:6528
 ds_read_b128 v[140:143], v124 offset:6544
 v_mfma_f32_16x16x32_bf16 v[152:155], v[112:115], v[40:43], v[152:155]
 v_accvgpr_read_b32 v164, a112
 v_accvgpr_read_b32 v165, a113
 v_mfma_f32_16x16x32_bf16 v[152:155], v[116:119], v[56:59], v[152:155]
 v_accvgpr_read_b32 v166, a114
 v_accvgpr_read_b32 v167, a115
 v_mfma_f32_16x16x32_bf16 a[24:27], v[116:119], v[60:63], a[24:27]
 v_accvgpr_read_b32 v160, a116
 v_accvgpr_read_b32 v161, a117
 v_mfma_f32_16x16x32_bf16 a[24:27], v[112:115], v[44:47], a[24:27]
 s_waitcnt lgkmcnt(4)
 v_accvgpr_read_b32 v162, a118
 v_accvgpr_read_b32 v163, a119
 v_mfma_f32_16x16x32_bf16 v[188:191], v[96:99], v[16:19], v[188:191]
 ds_read_b128 v[112:115], v2 offset:47104
 v_add_f32 v164, v164, v180
 v_mfma_f32_16x16x32_bf16 v[188:191], v[100:103], v[4:7], v[188:191]
 ds_read_b128 v[116:119], v2 offset:48128
 v_add_f32 v165, v165, v181
 v_mfma_f32_16x16x32_bf16 a[124:127], v[100:103], v[8:11], a[124:127]
 v_add_f32 v166, v166, v182
 v_add_f32 v167, v167, v183
 v_mfma_f32_16x16x32_bf16 a[124:127], v[96:99], v[20:23], a[124:127]
 v_add_f32 v160, v160, v176
 v_add_f32 v161, v161, v177
 v_mfma_f32_16x16x32_bf16 v[156:159], v[96:99], v[24:27], v[156:159]
 v_add_f32 v162, v162, v178
 v_add_f32 v163, v163, v179
 v_mfma_f32_16x16x32_bf16 v[156:159], v[100:103], v[12:15], v[156:159]
 v_cvt_pk_bf16_f32 v164, v164, v165
 v_cvt_pk_bf16_f32 v165, v166, v167
 v_mfma_f32_16x16x32_bf16 a[28:31], v[100:103], v[120:123], a[28:31]
 v_cvt_pk_bf16_f32 v166, v160, v161
 v_cvt_pk_bf16_f32 v167, v162, v163
 v_mfma_f32_16x16x32_bf16 a[28:31], v[96:99], v[28:31], a[28:31]
 s_waitcnt lgkmcnt(4)
 buffer_store_dwordx4 v[164:167], v1, s[44:47], s61 offen offset:128 sc1
 v_mfma_f32_16x16x32_bf16 a[28:31], v[104:107], v[76:79], a[28:31]
 ds_read_b128 v[96:99], v0 offset:16384
 v_accvgpr_read_b32 v144, a16
 v_mfma_f32_16x16x32_bf16 a[28:31], v[108:111], v[92:95], a[28:31]
 ds_read_b128 v[100:103], v0 offset:17408
 v_accvgpr_read_b32 v145, a17
 v_mfma_f32_16x16x32_bf16 v[156:159], v[108:111], v[88:91], v[156:159]
 v_accvgpr_read_b32 v146, a18
 v_accvgpr_read_b32 v147, a19
 v_mfma_f32_16x16x32_bf16 v[156:159], v[104:107], v[72:75], v[156:159]
 v_accvgpr_read_b32 v148, a20
 v_accvgpr_read_b32 v149, a21
 v_mfma_f32_16x16x32_bf16 a[124:127], v[104:107], v[68:71], a[124:127]
 v_accvgpr_read_b32 v150, a22
 v_accvgpr_read_b32 v151, a23
 v_mfma_f32_16x16x32_bf16 a[124:127], v[108:111], v[84:87], a[124:127]
 v_add_f32 v144, v144, v180
 v_add_f32 v145, v145, v181
 v_mfma_f32_16x16x32_bf16 v[188:191], v[108:111], v[80:83], v[188:191]
 v_add_f32 v146, v146, v182
 v_add_f32 v147, v147, v183
 v_mfma_f32_16x16x32_bf16 v[188:191], v[104:107], v[64:67], v[188:191]
 s_waitcnt lgkmcnt(2)
 v_add_f32 v148, v148, v176
 v_add_f32 v149, v149, v177
 v_mfma_f32_16x16x32_bf16 v[188:191], v[112:115], v[32:35], v[188:191]
 ds_read_b128 v[104:107], v2 offset:0
 v_add_f32 v150, v150, v178
 v_mfma_f32_16x16x32_bf16 v[188:191], v[116:119], v[48:51], v[188:191]
 ds_read_b128 v[108:111], v2 offset:1024
 v_add_f32 v151, v151, v179
 v_mfma_f32_16x16x32_bf16 a[124:127], v[116:119], v[52:55], a[124:127]
 v_cvt_pk_bf16_f32 v144, v144, v145
 v_cvt_pk_bf16_f32 v145, v146, v147
 v_mfma_f32_16x16x32_bf16 a[124:127], v[112:115], v[36:39], a[124:127]
 v_cvt_pk_bf16_f32 v146, v148, v149
 v_cvt_pk_bf16_f32 v147, v150, v151
 v_mfma_f32_16x16x32_bf16 v[156:159], v[112:115], v[40:43], v[156:159]
 buffer_store_dwordx4 v[144:147], v1, s[44:47], s63 offen offset:128 sc1
 v_mfma_f32_16x16x32_bf16 v[156:159], v[116:119], v[56:59], v[156:159]
 v_mfma_f32_16x16x32_bf16 a[28:31], v[116:119], v[60:63], a[28:31]
 v_mfma_f32_16x16x32_bf16 a[28:31], v[112:115], v[44:47], a[28:31]
 s_waitcnt lgkmcnt(2)
 v_mfma_f32_16x16x32_bf16 v[192:195], v[96:99], v[16:19], v[192:195]
 ds_read_b128 v[112:115], v2 offset:49152
 v_mfma_f32_16x16x32_bf16 v[192:195], v[100:103], v[4:7], v[192:195]
 ds_read_b128 v[116:119], v2 offset:50176
 v_mfma_f32_16x16x32_bf16 a[128:131], v[100:103], v[8:11], a[128:131]
 v_mfma_f32_16x16x32_bf16 a[128:131], v[96:99], v[20:23], a[128:131]
 v_mfma_f32_16x16x32_bf16 a[192:195], v[96:99], v[24:27], a[192:195]
 v_mfma_f32_16x16x32_bf16 a[192:195], v[100:103], v[12:15], a[192:195]
 v_mfma_f32_16x16x32_bf16 a[32:35], v[100:103], v[120:123], a[32:35]
 v_mfma_f32_16x16x32_bf16 a[32:35], v[96:99], v[28:31], a[32:35]
 s_waitcnt lgkmcnt(2)
 v_mfma_f32_16x16x32_bf16 a[32:35], v[104:107], v[76:79], a[32:35]
 ds_read_b128 v[96:99], v0 offset:18432
 v_cvt_pk_bf16_f32 v184, v184, v185
 v_mfma_f32_16x16x32_bf16 a[32:35], v[108:111], v[92:95], a[32:35]
 ds_read_b128 v[100:103], v0 offset:19456
 v_cvt_pk_bf16_f32 v185, v186, v187
 v_mfma_f32_16x16x32_bf16 a[192:195], v[108:111], v[88:91], a[192:195]
 v_cvt_pk_bf16_f32 v186, v188, v189
 v_cvt_pk_bf16_f32 v187, v190, v191
 v_mfma_f32_16x16x32_bf16 a[192:195], v[104:107], v[72:75], a[192:195]
 buffer_store_dwordx4 v[184:187], v1, s[44:47], s60 offen offset:192 sc1
 v_mfma_f32_16x16x32_bf16 a[128:131], v[104:107], v[68:71], a[128:131]
 v_cvt_pk_bf16_f32 v152, v152, v153
 v_cvt_pk_bf16_f32 v153, v154, v155
 v_mfma_f32_16x16x32_bf16 a[128:131], v[108:111], v[84:87], a[128:131]
 v_cvt_pk_bf16_f32 v154, v156, v157
 v_cvt_pk_bf16_f32 v155, v158, v159
 v_mfma_f32_16x16x32_bf16 v[192:195], v[108:111], v[80:83], v[192:195]
 buffer_store_dwordx4 v[152:155], v1, s[44:47], s62 offen offset:192 sc1
 v_mfma_f32_16x16x32_bf16 v[192:195], v[104:107], v[64:67], v[192:195]
 s_waitcnt lgkmcnt(2)
 ds_read_b128 v[172:175], v124 offset:6656
 ds_read_b128 v[168:171], v124 offset:6672
 v_mfma_f32_16x16x32_bf16 v[192:195], v[112:115], v[32:35], v[192:195]
 ds_read_b128 v[104:107], v2 offset:2048
 v_accvgpr_read_b32 v132, a120
 v_mfma_f32_16x16x32_bf16 v[192:195], v[116:119], v[48:51], v[192:195]
 ds_read_b128 v[108:111], v2 offset:3072
 v_accvgpr_read_b32 v133, a121
 v_mfma_f32_16x16x32_bf16 a[128:131], v[116:119], v[52:55], a[128:131]
 v_accvgpr_read_b32 v134, a122
 v_accvgpr_read_b32 v135, a123
 v_mfma_f32_16x16x32_bf16 a[128:131], v[112:115], v[36:39], a[128:131]
 v_accvgpr_read_b32 v128, a124
 v_accvgpr_read_b32 v129, a125
 v_mfma_f32_16x16x32_bf16 a[192:195], v[112:115], v[40:43], a[192:195]
 v_accvgpr_read_b32 v130, a126
 v_accvgpr_read_b32 v131, a127
 v_mfma_f32_16x16x32_bf16 a[192:195], v[116:119], v[56:59], a[192:195]
 v_add_f32 v132, v132, v136
 v_add_f32 v133, v133, v137
 v_mfma_f32_16x16x32_bf16 a[32:35], v[116:119], v[60:63], a[32:35]
 v_add_f32 v134, v134, v138
 v_add_f32 v135, v135, v139
 v_mfma_f32_16x16x32_bf16 a[32:35], v[112:115], v[44:47], a[32:35]
 s_waitcnt lgkmcnt(4)
 v_add_f32 v128, v128, v140
 v_add_f32 v129, v129, v141
 v_mfma_f32_16x16x32_bf16 v[196:199], v[96:99], v[16:19], v[196:199]
 ds_read_b128 v[112:115], v2 offset:51200
 v_add_f32 v130, v130, v142
 v_mfma_f32_16x16x32_bf16 v[196:199], v[100:103], v[4:7], v[196:199]
 ds_read_b128 v[116:119], v2 offset:52224
 v_add_f32 v131, v131, v143
 v_mfma_f32_16x16x32_bf16 a[132:135], v[100:103], v[8:11], a[132:135]
 v_cvt_pk_bf16_f32 v132, v132, v133
 v_cvt_pk_bf16_f32 v133, v134, v135
 v_mfma_f32_16x16x32_bf16 a[132:135], v[96:99], v[20:23], a[132:135]
 v_cvt_pk_bf16_f32 v134, v128, v129
 v_cvt_pk_bf16_f32 v135, v130, v131
 v_mfma_f32_16x16x32_bf16 a[196:199], v[96:99], v[24:27], a[196:199]
 buffer_store_dwordx4 v[132:135], v1, s[44:47], s61 offen offset:192 sc1
 v_mfma_f32_16x16x32_bf16 a[196:199], v[100:103], v[12:15], a[196:199]
 v_accvgpr_read_b32 v160, a24
 v_accvgpr_read_b32 v161, a25
 v_mfma_f32_16x16x32_bf16 a[36:39], v[100:103], v[120:123], a[36:39]
 v_accvgpr_read_b32 v162, a26
 v_accvgpr_read_b32 v163, a27
 v_mfma_f32_16x16x32_bf16 a[36:39], v[96:99], v[28:31], a[36:39]
 s_waitcnt lgkmcnt(2)
 v_accvgpr_read_b32 v164, a28
 v_accvgpr_read_b32 v165, a29
 v_mfma_f32_16x16x32_bf16 a[36:39], v[104:107], v[76:79], a[36:39]
 ds_read_b128 v[96:99], v0 offset:20480
 v_accvgpr_read_b32 v166, a30
 v_mfma_f32_16x16x32_bf16 a[36:39], v[108:111], v[92:95], a[36:39]
 ds_read_b128 v[100:103], v0 offset:21504
 v_accvgpr_read_b32 v167, a31
 v_mfma_f32_16x16x32_bf16 a[196:199], v[108:111], v[88:91], a[196:199]
 v_add_f32 v160, v160, v136
 v_add_f32 v161, v161, v137
 v_mfma_f32_16x16x32_bf16 a[196:199], v[104:107], v[72:75], a[196:199]
 v_add_f32 v162, v162, v138
 v_add_f32 v163, v163, v139
 v_mfma_f32_16x16x32_bf16 a[132:135], v[104:107], v[68:71], a[132:135]
 v_add_f32 v164, v164, v140
 v_add_f32 v165, v165, v141
 v_mfma_f32_16x16x32_bf16 a[132:135], v[108:111], v[84:87], a[132:135]
 v_add_f32 v166, v166, v142
 v_add_f32 v167, v167, v143
 v_mfma_f32_16x16x32_bf16 v[196:199], v[108:111], v[80:83], v[196:199]
 v_cvt_pk_bf16_f32 v160, v160, v161
 v_cvt_pk_bf16_f32 v161, v162, v163
 v_mfma_f32_16x16x32_bf16 v[196:199], v[104:107], v[64:67], v[196:199]
 s_waitcnt lgkmcnt(2)
 v_cvt_pk_bf16_f32 v162, v164, v165
 v_cvt_pk_bf16_f32 v163, v166, v167
 v_mfma_f32_16x16x32_bf16 v[196:199], v[112:115], v[32:35], v[196:199]
 ds_read_b128 v[104:107], v2 offset:4096
 v_mfma_f32_16x16x32_bf16 v[196:199], v[116:119], v[48:51], v[196:199]
 ds_read_b128 v[108:111], v2 offset:5120
 v_mfma_f32_16x16x32_bf16 a[132:135], v[116:119], v[52:55], a[132:135]
 buffer_store_dwordx4 v[160:163], v1, s[44:47], s63 offen offset:192 sc1
 v_mfma_f32_16x16x32_bf16 a[132:135], v[112:115], v[36:39], a[132:135]
 v_mfma_f32_16x16x32_bf16 a[196:199], v[112:115], v[40:43], a[196:199]
 v_mfma_f32_16x16x32_bf16 a[196:199], v[116:119], v[56:59], a[196:199]
 v_mfma_f32_16x16x32_bf16 a[36:39], v[116:119], v[60:63], a[36:39]
 v_mfma_f32_16x16x32_bf16 a[36:39], v[112:115], v[44:47], a[36:39]
 s_waitcnt lgkmcnt(2)
 v_mfma_f32_16x16x32_bf16 v[200:203], v[96:99], v[16:19], v[200:203]
 ds_read_b128 v[112:115], v2 offset:53248
 v_mfma_f32_16x16x32_bf16 v[200:203], v[100:103], v[4:7], v[200:203]
 ds_read_b128 v[116:119], v2 offset:54272
 v_mfma_f32_16x16x32_bf16 a[136:139], v[100:103], v[8:11], a[136:139]
 v_mfma_f32_16x16x32_bf16 a[136:139], v[96:99], v[20:23], a[136:139]
 v_mfma_f32_16x16x32_bf16 a[200:203], v[96:99], v[24:27], a[200:203]
 v_mfma_f32_16x16x32_bf16 a[200:203], v[100:103], v[12:15], a[200:203]
 v_mfma_f32_16x16x32_bf16 a[40:43], v[100:103], v[120:123], a[40:43]
 v_mfma_f32_16x16x32_bf16 a[40:43], v[96:99], v[28:31], a[40:43]
 s_waitcnt lgkmcnt(2)
 v_mfma_f32_16x16x32_bf16 a[40:43], v[104:107], v[76:79], a[40:43]
 ds_read_b128 v[96:99], v0 offset:22528
 v_cvt_pk_bf16_f32 v192, v192, v193
 v_mfma_f32_16x16x32_bf16 a[40:43], v[108:111], v[92:95], a[40:43]
 ds_read_b128 v[100:103], v0 offset:23552
 v_cvt_pk_bf16_f32 v193, v194, v195
 v_mfma_f32_16x16x32_bf16 a[200:203], v[108:111], v[88:91], a[200:203]
 v_cvt_pk_bf16_f32 v194, v196, v197
 v_cvt_pk_bf16_f32 v195, v198, v199
 v_mfma_f32_16x16x32_bf16 a[200:203], v[104:107], v[72:75], a[200:203]
 buffer_store_dwordx4 v[192:195], v1, s[44:47], s60 offen offset:256 sc1
 v_mfma_f32_16x16x32_bf16 a[136:139], v[104:107], v[68:71], a[136:139]
 ds_read_b128 v[148:151], v124 offset:6784
 ds_read_b128 v[144:147], v124 offset:6800
 v_mfma_f32_16x16x32_bf16 a[136:139], v[108:111], v[84:87], a[136:139]
 v_accvgpr_read_b32 v180, a128
 v_accvgpr_read_b32 v181, a129
 v_mfma_f32_16x16x32_bf16 v[200:203], v[108:111], v[80:83], v[200:203]
 v_accvgpr_read_b32 v182, a130
 v_accvgpr_read_b32 v183, a131
 v_mfma_f32_16x16x32_bf16 v[200:203], v[104:107], v[64:67], v[200:203]
 s_waitcnt lgkmcnt(4)
 v_accvgpr_read_b32 v176, a132
 v_accvgpr_read_b32 v177, a133
 v_mfma_f32_16x16x32_bf16 v[200:203], v[112:115], v[32:35], v[200:203]
 ds_read_b128 v[104:107], v2 offset:6144
 v_accvgpr_read_b32 v178, a134
 v_mfma_f32_16x16x32_bf16 v[200:203], v[116:119], v[48:51], v[200:203]
 ds_read_b128 v[108:111], v2 offset:7168
 v_accvgpr_read_b32 v179, a135
 v_mfma_f32_16x16x32_bf16 a[136:139], v[116:119], v[52:55], a[136:139]
 v_add_f32 v180, v180, v172
 v_add_f32 v181, v181, v173
 v_mfma_f32_16x16x32_bf16 a[136:139], v[112:115], v[36:39], a[136:139]
 v_add_f32 v182, v182, v174
 v_add_f32 v183, v183, v175
 v_mfma_f32_16x16x32_bf16 a[200:203], v[112:115], v[40:43], a[200:203]
 v_add_f32 v176, v176, v168
 v_add_f32 v177, v177, v169
 v_mfma_f32_16x16x32_bf16 a[200:203], v[116:119], v[56:59], a[200:203]
 v_add_f32 v178, v178, v170
 v_add_f32 v179, v179, v171
 v_mfma_f32_16x16x32_bf16 a[40:43], v[116:119], v[60:63], a[40:43]
 v_cvt_pk_bf16_f32 v180, v180, v181
 v_cvt_pk_bf16_f32 v181, v182, v183
 v_mfma_f32_16x16x32_bf16 a[40:43], v[112:115], v[44:47], a[40:43]
 s_waitcnt lgkmcnt(4)
 v_cvt_pk_bf16_f32 v182, v176, v177
 v_cvt_pk_bf16_f32 v183, v178, v179
 v_mfma_f32_16x16x32_bf16 v[204:207], v[96:99], v[16:19], v[204:207]
 ds_read_b128 v[112:115], v2 offset:55296
 v_mfma_f32_16x16x32_bf16 v[204:207], v[100:103], v[4:7], v[204:207]
 ds_read_b128 v[116:119], v2 offset:56320
 v_mfma_f32_16x16x32_bf16 a[140:143], v[100:103], v[8:11], a[140:143]
 buffer_store_dwordx4 v[180:183], v1, s[44:47], s61 offen offset:256 sc1
 v_mfma_f32_16x16x32_bf16 a[140:143], v[96:99], v[20:23], a[140:143]
 v_accvgpr_read_b32 v188, a192
 v_accvgpr_read_b32 v189, a193
 v_mfma_f32_16x16x32_bf16 a[204:207], v[96:99], v[24:27], a[204:207]
 v_accvgpr_read_b32 v190, a194
 v_accvgpr_read_b32 v191, a195
 v_mfma_f32_16x16x32_bf16 a[204:207], v[100:103], v[12:15], a[204:207]
 v_accvgpr_read_b32 v184, a196
 v_accvgpr_read_b32 v185, a197
 v_mfma_f32_16x16x32_bf16 a[44:47], v[100:103], v[120:123], a[44:47]
 v_accvgpr_read_b32 v186, a198
 v_accvgpr_read_b32 v187, a199
 v_mfma_f32_16x16x32_bf16 a[44:47], v[96:99], v[28:31], a[44:47]
 s_waitcnt lgkmcnt(2)
 v_add_f32 v188, v188, v172
 v_add_f32 v189, v189, v173
 v_mfma_f32_16x16x32_bf16 a[44:47], v[104:107], v[76:79], a[44:47]
 ds_read_b128 v[96:99], v0 offset:24576
 v_add_f32 v190, v190, v174
 v_mfma_f32_16x16x32_bf16 a[44:47], v[108:111], v[92:95], a[44:47]
 ds_read_b128 v[100:103], v0 offset:25600
 v_add_f32 v191, v191, v175
 v_mfma_f32_16x16x32_bf16 a[204:207], v[108:111], v[88:91], a[204:207]
 v_add_f32 v184, v184, v168
 v_add_f32 v185, v185, v169
 v_mfma_f32_16x16x32_bf16 a[204:207], v[104:107], v[72:75], a[204:207]
 v_add_f32 v186, v186, v170
 v_add_f32 v187, v187, v171
 v_mfma_f32_16x16x32_bf16 a[140:143], v[104:107], v[68:71], a[140:143]
 v_cvt_pk_bf16_f32 v188, v188, v189
 v_cvt_pk_bf16_f32 v189, v190, v191
 v_mfma_f32_16x16x32_bf16 a[140:143], v[108:111], v[84:87], a[140:143]
 v_cvt_pk_bf16_f32 v190, v184, v185
 v_cvt_pk_bf16_f32 v191, v186, v187
 v_mfma_f32_16x16x32_bf16 v[204:207], v[108:111], v[80:83], v[204:207]
 buffer_store_dwordx4 v[188:191], v1, s[44:47], s62 offen offset:256 sc1
 v_mfma_f32_16x16x32_bf16 v[204:207], v[104:107], v[64:67], v[204:207]
 s_waitcnt lgkmcnt(2)
 v_accvgpr_read_b32 v156, a32
 v_accvgpr_read_b32 v157, a33
 v_mfma_f32_16x16x32_bf16 v[204:207], v[112:115], v[32:35], v[204:207]
 ds_read_b128 v[104:107], v2 offset:8192
 v_accvgpr_read_b32 v158, a34
 v_mfma_f32_16x16x32_bf16 v[204:207], v[116:119], v[48:51], v[204:207]
 ds_read_b128 v[108:111], v2 offset:9216
 v_accvgpr_read_b32 v159, a35
 v_mfma_f32_16x16x32_bf16 a[140:143], v[116:119], v[52:55], a[140:143]
 v_accvgpr_read_b32 v152, a36
 v_accvgpr_read_b32 v153, a37
 v_mfma_f32_16x16x32_bf16 a[140:143], v[112:115], v[36:39], a[140:143]
 v_accvgpr_read_b32 v154, a38
 v_accvgpr_read_b32 v155, a39
 v_mfma_f32_16x16x32_bf16 a[204:207], v[112:115], v[40:43], a[204:207]
 v_add_f32 v156, v156, v172
 v_add_f32 v157, v157, v173
 v_mfma_f32_16x16x32_bf16 a[204:207], v[116:119], v[56:59], a[204:207]
 v_add_f32 v158, v158, v174
 v_add_f32 v159, v159, v175
 v_mfma_f32_16x16x32_bf16 a[44:47], v[116:119], v[60:63], a[44:47]
 v_add_f32 v152, v152, v168
 v_add_f32 v153, v153, v169
 v_mfma_f32_16x16x32_bf16 a[44:47], v[112:115], v[44:47], a[44:47]
 s_waitcnt lgkmcnt(2)
 v_add_f32 v154, v154, v170
 v_add_f32 v155, v155, v171
 v_mfma_f32_16x16x32_bf16 v[208:211], v[96:99], v[16:19], v[208:211]
 ds_read_b128 v[112:115], v2 offset:57344
 v_cvt_pk_bf16_f32 v156, v156, v157
 v_mfma_f32_16x16x32_bf16 v[208:211], v[100:103], v[4:7], v[208:211]
 ds_read_b128 v[116:119], v2 offset:58368
 v_cvt_pk_bf16_f32 v157, v158, v159
 v_mfma_f32_16x16x32_bf16 a[144:147], v[100:103], v[8:11], a[144:147]
 v_cvt_pk_bf16_f32 v158, v152, v153
 v_cvt_pk_bf16_f32 v159, v154, v155
 v_mfma_f32_16x16x32_bf16 a[144:147], v[96:99], v[20:23], a[144:147]
 buffer_store_dwordx4 v[156:159], v1, s[44:47], s63 offen offset:256 sc1
 v_mfma_f32_16x16x32_bf16 a[208:211], v[96:99], v[24:27], a[208:211]
 v_mfma_f32_16x16x32_bf16 a[208:211], v[100:103], v[12:15], a[208:211]
 v_mfma_f32_16x16x32_bf16 a[48:51], v[100:103], v[120:123], a[48:51]
 v_mfma_f32_16x16x32_bf16 a[48:51], v[96:99], v[28:31], a[48:51]
 s_waitcnt lgkmcnt(2)
 v_mfma_f32_16x16x32_bf16 a[48:51], v[104:107], v[76:79], a[48:51]
 ds_read_b128 v[96:99], v0 offset:26624
 v_cvt_pk_bf16_f32 v200, v200, v201
 v_mfma_f32_16x16x32_bf16 a[48:51], v[108:111], v[92:95], a[48:51]
 ds_read_b128 v[100:103], v0 offset:27648
 v_cvt_pk_bf16_f32 v201, v202, v203
 v_mfma_f32_16x16x32_bf16 a[208:211], v[108:111], v[88:91], a[208:211]
 v_cvt_pk_bf16_f32 v202, v204, v205
 v_cvt_pk_bf16_f32 v203, v206, v207
 v_mfma_f32_16x16x32_bf16 a[208:211], v[104:107], v[72:75], a[208:211]
 buffer_store_dwordx4 v[200:203], v1, s[44:47], s60 offen offset:320 sc1
 v_mfma_f32_16x16x32_bf16 a[144:147], v[104:107], v[68:71], a[144:147]
 ds_read_b128 v[128:131], v124 offset:6912
 ds_read_b128 v[132:135], v124 offset:6928
 v_mfma_f32_16x16x32_bf16 a[144:147], v[108:111], v[84:87], a[144:147]
 v_accvgpr_read_b32 v164, a136
 v_accvgpr_read_b32 v165, a137
 v_mfma_f32_16x16x32_bf16 v[208:211], v[108:111], v[80:83], v[208:211]
 v_accvgpr_read_b32 v166, a138
 v_accvgpr_read_b32 v167, a139
 v_mfma_f32_16x16x32_bf16 v[208:211], v[104:107], v[64:67], v[208:211]
 s_waitcnt lgkmcnt(4)
 v_accvgpr_read_b32 v160, a140
 v_accvgpr_read_b32 v161, a141
 v_mfma_f32_16x16x32_bf16 v[208:211], v[112:115], v[32:35], v[208:211]
 ds_read_b128 v[104:107], v2 offset:10240
 v_accvgpr_read_b32 v162, a142
 v_mfma_f32_16x16x32_bf16 v[208:211], v[116:119], v[48:51], v[208:211]
 ds_read_b128 v[108:111], v2 offset:11264
 v_accvgpr_read_b32 v163, a143
 v_mfma_f32_16x16x32_bf16 a[144:147], v[116:119], v[52:55], a[144:147]
 v_add_f32 v164, v164, v148
 v_add_f32 v165, v165, v149
 v_mfma_f32_16x16x32_bf16 a[144:147], v[112:115], v[36:39], a[144:147]
 v_add_f32 v166, v166, v150
 v_add_f32 v167, v167, v151
 v_mfma_f32_16x16x32_bf16 a[208:211], v[112:115], v[40:43], a[208:211]
 v_add_f32 v160, v160, v144
 v_add_f32 v161, v161, v145
 v_mfma_f32_16x16x32_bf16 a[208:211], v[116:119], v[56:59], a[208:211]
 v_add_f32 v162, v162, v146
 v_add_f32 v163, v163, v147
 v_mfma_f32_16x16x32_bf16 a[48:51], v[116:119], v[60:63], a[48:51]
 v_cvt_pk_bf16_f32 v164, v164, v165
 v_cvt_pk_bf16_f32 v165, v166, v167
 v_mfma_f32_16x16x32_bf16 a[48:51], v[112:115], v[44:47], a[48:51]
 s_waitcnt lgkmcnt(4)
 v_cvt_pk_bf16_f32 v166, v160, v161
 v_cvt_pk_bf16_f32 v167, v162, v163
 v_mfma_f32_16x16x32_bf16 v[212:215], v[96:99], v[16:19], v[212:215]
 ds_read_b128 v[112:115], v2 offset:59392
 v_mfma_f32_16x16x32_bf16 v[212:215], v[100:103], v[4:7], v[212:215]
 ds_read_b128 v[116:119], v2 offset:60416
 v_mfma_f32_16x16x32_bf16 a[148:151], v[100:103], v[8:11], a[148:151]
 buffer_store_dwordx4 v[164:167], v1, s[44:47], s61 offen offset:320 sc1
 v_mfma_f32_16x16x32_bf16 a[148:151], v[96:99], v[20:23], a[148:151]
 v_accvgpr_read_b32 v136, a200
 v_accvgpr_read_b32 v137, a201
 v_mfma_f32_16x16x32_bf16 a[212:215], v[96:99], v[24:27], a[212:215]
 v_accvgpr_read_b32 v138, a202
 v_accvgpr_read_b32 v139, a203
 v_mfma_f32_16x16x32_bf16 a[212:215], v[100:103], v[12:15], a[212:215]
 v_accvgpr_read_b32 v140, a204
 v_accvgpr_read_b32 v141, a205
 v_mfma_f32_16x16x32_bf16 a[52:55], v[100:103], v[120:123], a[52:55]
 v_accvgpr_read_b32 v142, a206
 v_accvgpr_read_b32 v143, a207
 v_mfma_f32_16x16x32_bf16 a[52:55], v[96:99], v[28:31], a[52:55]
 s_waitcnt lgkmcnt(2)
 v_add_f32 v136, v136, v148
 v_add_f32 v137, v137, v149
 v_mfma_f32_16x16x32_bf16 a[52:55], v[104:107], v[76:79], a[52:55]
 ds_read_b128 v[96:99], v0 offset:28672
 v_add_f32 v138, v138, v150
 v_mfma_f32_16x16x32_bf16 a[52:55], v[108:111], v[92:95], a[52:55]
 ds_read_b128 v[100:103], v0 offset:29696
 v_add_f32 v139, v139, v151
 v_mfma_f32_16x16x32_bf16 a[212:215], v[108:111], v[88:91], a[212:215]
 v_add_f32 v140, v140, v144
 v_add_f32 v141, v141, v145
 v_mfma_f32_16x16x32_bf16 a[212:215], v[104:107], v[72:75], a[212:215]
 v_add_f32 v142, v142, v146
 v_add_f32 v143, v143, v147
 v_mfma_f32_16x16x32_bf16 a[148:151], v[104:107], v[68:71], a[148:151]
 v_cvt_pk_bf16_f32 v136, v136, v137
 v_cvt_pk_bf16_f32 v137, v138, v139
 v_mfma_f32_16x16x32_bf16 a[148:151], v[108:111], v[84:87], a[148:151]
 v_cvt_pk_bf16_f32 v138, v140, v141
 v_cvt_pk_bf16_f32 v139, v142, v143
 v_mfma_f32_16x16x32_bf16 v[212:215], v[108:111], v[80:83], v[212:215]
 buffer_store_dwordx4 v[136:139], v1, s[44:47], s62 offen offset:320 sc1
 v_mfma_f32_16x16x32_bf16 v[212:215], v[104:107], v[64:67], v[212:215]
 s_waitcnt lgkmcnt(2)
 v_accvgpr_read_b32 v196, a40
 v_accvgpr_read_b32 v197, a41
 v_mfma_f32_16x16x32_bf16 v[212:215], v[112:115], v[32:35], v[212:215]
 ds_read_b128 v[104:107], v2 offset:12288
 v_accvgpr_read_b32 v198, a42
 v_mfma_f32_16x16x32_bf16 v[212:215], v[116:119], v[48:51], v[212:215]
 ds_read_b128 v[108:111], v2 offset:13312
 v_accvgpr_read_b32 v199, a43
 v_mfma_f32_16x16x32_bf16 a[148:151], v[116:119], v[52:55], a[148:151]
 v_accvgpr_read_b32 v192, a44
 v_accvgpr_read_b32 v193, a45
 v_mfma_f32_16x16x32_bf16 a[148:151], v[112:115], v[36:39], a[148:151]
 v_accvgpr_read_b32 v194, a46
 v_accvgpr_read_b32 v195, a47
 v_mfma_f32_16x16x32_bf16 a[212:215], v[112:115], v[40:43], a[212:215]
 v_add_f32 v196, v196, v148
 v_add_f32 v197, v197, v149
 v_mfma_f32_16x16x32_bf16 a[212:215], v[116:119], v[56:59], a[212:215]
 v_add_f32 v198, v198, v150
 v_add_f32 v199, v199, v151
 v_mfma_f32_16x16x32_bf16 a[52:55], v[116:119], v[60:63], a[52:55]
 v_add_f32 v192, v192, v144
 v_add_f32 v193, v193, v145
 v_mfma_f32_16x16x32_bf16 a[52:55], v[112:115], v[44:47], a[52:55]
 s_waitcnt lgkmcnt(2)
 v_add_f32 v194, v194, v146
 v_add_f32 v195, v195, v147
 v_mfma_f32_16x16x32_bf16 v[216:219], v[96:99], v[16:19], v[216:219]
 ds_read_b128 v[112:115], v2 offset:61440
 v_cvt_pk_bf16_f32 v196, v196, v197
 v_mfma_f32_16x16x32_bf16 v[216:219], v[100:103], v[4:7], v[216:219]
 ds_read_b128 v[116:119], v2 offset:62464
 v_cvt_pk_bf16_f32 v197, v198, v199
 v_mfma_f32_16x16x32_bf16 a[152:155], v[100:103], v[8:11], a[152:155]
 v_cvt_pk_bf16_f32 v198, v192, v193
 v_cvt_pk_bf16_f32 v199, v194, v195
 v_mfma_f32_16x16x32_bf16 a[152:155], v[96:99], v[20:23], a[152:155]
 buffer_store_dwordx4 v[196:199], v1, s[44:47], s63 offen offset:320 sc1
 v_mfma_f32_16x16x32_bf16 a[216:219], v[96:99], v[24:27], a[216:219]
 v_mfma_f32_16x16x32_bf16 a[216:219], v[100:103], v[12:15], a[216:219]
 v_mfma_f32_16x16x32_bf16 a[56:59], v[100:103], v[120:123], a[56:59]
 v_mfma_f32_16x16x32_bf16 a[56:59], v[96:99], v[28:31], a[56:59]
 s_waitcnt lgkmcnt(2)
 v_mfma_f32_16x16x32_bf16 a[56:59], v[104:107], v[76:79], a[56:59]
 ds_read_b128 v[96:99], v0 offset:30720
 v_cvt_pk_bf16_f32 v208, v208, v209
 v_mfma_f32_16x16x32_bf16 a[56:59], v[108:111], v[92:95], a[56:59]
 ds_read_b128 v[100:103], v0 offset:31744
 v_cvt_pk_bf16_f32 v209, v210, v211
 v_mfma_f32_16x16x32_bf16 a[216:219], v[108:111], v[88:91], a[216:219]
 v_cvt_pk_bf16_f32 v210, v212, v213
 v_cvt_pk_bf16_f32 v211, v214, v215
 v_mfma_f32_16x16x32_bf16 a[216:219], v[104:107], v[72:75], a[216:219]
 buffer_store_dwordx4 v[208:211], v1, s[44:47], s60 offen offset:384 sc1
 v_mfma_f32_16x16x32_bf16 a[152:155], v[104:107], v[68:71], a[152:155]
 ds_read_b128 v[176:179], v124 offset:7040
 ds_read_b128 v[180:183], v124 offset:7056
 v_mfma_f32_16x16x32_bf16 a[152:155], v[108:111], v[84:87], a[152:155]
 v_accvgpr_read_b32 v184, a144
 v_accvgpr_read_b32 v185, a145
 v_mfma_f32_16x16x32_bf16 v[216:219], v[108:111], v[80:83], v[216:219]
 v_accvgpr_read_b32 v186, a146
 v_accvgpr_read_b32 v187, a147
 v_mfma_f32_16x16x32_bf16 v[216:219], v[104:107], v[64:67], v[216:219]
 s_waitcnt lgkmcnt(4)
 v_accvgpr_read_b32 v188, a148
 v_accvgpr_read_b32 v189, a149
 v_mfma_f32_16x16x32_bf16 v[216:219], v[112:115], v[32:35], v[216:219]
 ds_read_b128 v[104:107], v2 offset:14336
 v_accvgpr_read_b32 v190, a150
 v_mfma_f32_16x16x32_bf16 v[216:219], v[116:119], v[48:51], v[216:219]
 ds_read_b128 v[108:111], v2 offset:15360
 v_accvgpr_read_b32 v191, a151
 v_mfma_f32_16x16x32_bf16 a[152:155], v[116:119], v[52:55], a[152:155]
 v_add_f32 v184, v184, v128
 v_add_f32 v185, v185, v129
 v_mfma_f32_16x16x32_bf16 a[152:155], v[112:115], v[36:39], a[152:155]
 v_add_f32 v186, v186, v130
 v_add_f32 v187, v187, v131
 v_mfma_f32_16x16x32_bf16 a[216:219], v[112:115], v[40:43], a[216:219]
 v_add_f32 v188, v188, v132
 v_add_f32 v189, v189, v133
 v_mfma_f32_16x16x32_bf16 a[216:219], v[116:119], v[56:59], a[216:219]
 v_add_f32 v190, v190, v134
 v_add_f32 v191, v191, v135
 v_mfma_f32_16x16x32_bf16 a[56:59], v[116:119], v[60:63], a[56:59]
 v_cvt_pk_bf16_f32 v184, v184, v185
 v_cvt_pk_bf16_f32 v185, v186, v187
 v_mfma_f32_16x16x32_bf16 a[56:59], v[112:115], v[44:47], a[56:59]
 s_waitcnt lgkmcnt(4)
 v_cvt_pk_bf16_f32 v186, v188, v189
 v_cvt_pk_bf16_f32 v187, v190, v191
 v_mfma_f32_16x16x32_bf16 v[220:223], v[96:99], v[16:19], v[220:223]
 ds_read_b128 v[112:115], v2 offset:63488
 v_mfma_f32_16x16x32_bf16 v[220:223], v[100:103], v[4:7], v[220:223]
 ds_read_b128 v[116:119], v2 offset:64512
 v_mfma_f32_16x16x32_bf16 a[156:159], v[100:103], v[8:11], a[156:159]
 buffer_store_dwordx4 v[184:187], v1, s[44:47], s61 offen offset:384 sc1
 v_mfma_f32_16x16x32_bf16 a[156:159], v[96:99], v[20:23], a[156:159]
 v_accvgpr_read_b32 v152, a208
 v_accvgpr_read_b32 v153, a209
 v_mfma_f32_16x16x32_bf16 a[220:223], v[96:99], v[24:27], a[220:223]
 v_accvgpr_read_b32 v154, a210
 v_accvgpr_read_b32 v155, a211
 v_mfma_f32_16x16x32_bf16 a[220:223], v[100:103], v[12:15], a[220:223]
 v_accvgpr_read_b32 v156, a212
 v_accvgpr_read_b32 v157, a213
 v_mfma_f32_16x16x32_bf16 a[60:63], v[100:103], v[120:123], a[60:63]
 v_accvgpr_read_b32 v158, a214
 v_accvgpr_read_b32 v159, a215
 v_mfma_f32_16x16x32_bf16 a[60:63], v[96:99], v[28:31], a[60:63]
 s_waitcnt lgkmcnt(2)
 v_add_f32 v152, v152, v128
 v_add_f32 v153, v153, v129
 v_mfma_f32_16x16x32_bf16 a[60:63], v[104:107], v[76:79], a[60:63]
 ds_read_b128 v[96:99], v0 offset:32768
 v_add_f32 v154, v154, v130
 v_mfma_f32_16x16x32_bf16 a[60:63], v[108:111], v[92:95], a[60:63]
 ds_read_b128 v[100:103], v0 offset:33792
 v_add_f32 v155, v155, v131
 v_mfma_f32_16x16x32_bf16 a[220:223], v[108:111], v[88:91], a[220:223]
 v_add_f32 v156, v156, v132
 v_add_f32 v157, v157, v133
 v_mfma_f32_16x16x32_bf16 a[220:223], v[104:107], v[72:75], a[220:223]
 v_add_f32 v158, v158, v134
 v_add_f32 v159, v159, v135
 v_mfma_f32_16x16x32_bf16 a[156:159], v[104:107], v[68:71], a[156:159]
 v_cvt_pk_bf16_f32 v152, v152, v153
 v_cvt_pk_bf16_f32 v153, v154, v155
 v_mfma_f32_16x16x32_bf16 a[156:159], v[108:111], v[84:87], a[156:159]
 v_cvt_pk_bf16_f32 v154, v156, v157
 v_cvt_pk_bf16_f32 v155, v158, v159
 v_mfma_f32_16x16x32_bf16 v[220:223], v[108:111], v[80:83], v[220:223]
 buffer_store_dwordx4 v[152:155], v1, s[44:47], s62 offen offset:384 sc1
 v_mfma_f32_16x16x32_bf16 v[220:223], v[104:107], v[64:67], v[220:223]
 s_waitcnt lgkmcnt(2)
 v_accvgpr_read_b32 v172, a48
 v_accvgpr_read_b32 v173, a49
 v_mfma_f32_16x16x32_bf16 v[220:223], v[112:115], v[32:35], v[220:223]
 ds_read_b128 v[104:107], v2 offset:16384
 v_accvgpr_read_b32 v174, a50
 v_mfma_f32_16x16x32_bf16 v[220:223], v[116:119], v[48:51], v[220:223]
 ds_read_b128 v[108:111], v2 offset:17408
 v_accvgpr_read_b32 v175, a51
 v_mfma_f32_16x16x32_bf16 a[156:159], v[116:119], v[52:55], a[156:159]
 v_accvgpr_read_b32 v168, a52
 v_accvgpr_read_b32 v169, a53
 v_mfma_f32_16x16x32_bf16 a[156:159], v[112:115], v[36:39], a[156:159]
 v_accvgpr_read_b32 v170, a54
 v_accvgpr_read_b32 v171, a55
 v_mfma_f32_16x16x32_bf16 a[220:223], v[112:115], v[40:43], a[220:223]
 v_add_f32 v172, v172, v128
 v_add_f32 v173, v173, v129
 v_mfma_f32_16x16x32_bf16 a[220:223], v[116:119], v[56:59], a[220:223]
 v_add_f32 v174, v174, v130
 v_add_f32 v175, v175, v131
 v_mfma_f32_16x16x32_bf16 a[60:63], v[116:119], v[60:63], a[60:63]
 v_add_f32 v168, v168, v132
 v_add_f32 v169, v169, v133
 v_mfma_f32_16x16x32_bf16 a[60:63], v[112:115], v[44:47], a[60:63]
 s_waitcnt lgkmcnt(2)
 v_add_f32 v170, v170, v134
 v_add_f32 v171, v171, v135
 v_mfma_f32_16x16x32_bf16 v[224:227], v[96:99], v[16:19], v[224:227]
 ds_read_b128 v[112:115], v3 offset:0
 v_cvt_pk_bf16_f32 v172, v172, v173
 v_mfma_f32_16x16x32_bf16 v[224:227], v[100:103], v[4:7], v[224:227]
 ds_read_b128 v[116:119], v3 offset:1024
 v_cvt_pk_bf16_f32 v173, v174, v175
 v_mfma_f32_16x16x32_bf16 a[160:163], v[100:103], v[8:11], a[160:163]
 v_cvt_pk_bf16_f32 v174, v168, v169
 v_cvt_pk_bf16_f32 v175, v170, v171
 v_mfma_f32_16x16x32_bf16 a[160:163], v[96:99], v[20:23], a[160:163]
 buffer_store_dwordx4 v[172:175], v1, s[44:47], s63 offen offset:384 sc1
 v_mfma_f32_16x16x32_bf16 a[224:227], v[96:99], v[24:27], a[224:227]
 v_mfma_f32_16x16x32_bf16 a[224:227], v[100:103], v[12:15], a[224:227]
 v_mfma_f32_16x16x32_bf16 a[64:67], v[100:103], v[120:123], a[64:67]
 v_mfma_f32_16x16x32_bf16 a[64:67], v[96:99], v[28:31], a[64:67]
 s_waitcnt lgkmcnt(2)
 v_mfma_f32_16x16x32_bf16 a[64:67], v[104:107], v[76:79], a[64:67]
 ds_read_b128 v[96:99], v0 offset:34816
 v_cvt_pk_bf16_f32 v216, v216, v217
 v_mfma_f32_16x16x32_bf16 a[64:67], v[108:111], v[92:95], a[64:67]
 ds_read_b128 v[100:103], v0 offset:35840
 v_cvt_pk_bf16_f32 v217, v218, v219
 v_mfma_f32_16x16x32_bf16 a[224:227], v[108:111], v[88:91], a[224:227]
 v_cvt_pk_bf16_f32 v218, v220, v221
 v_cvt_pk_bf16_f32 v219, v222, v223
 v_mfma_f32_16x16x32_bf16 a[224:227], v[104:107], v[72:75], a[224:227]
 buffer_store_dwordx4 v[216:219], v1, s[44:47], s60 offen offset:448 sc1
 v_mfma_f32_16x16x32_bf16 a[160:163], v[104:107], v[68:71], a[160:163]
 ds_read_b128 v[204:207], v124 offset:7168
 ds_read_b128 v[200:203], v124 offset:7184
 v_mfma_f32_16x16x32_bf16 a[160:163], v[108:111], v[84:87], a[160:163]
 v_accvgpr_read_b32 v160, a152
 v_accvgpr_read_b32 v161, a153
 v_mfma_f32_16x16x32_bf16 v[224:227], v[108:111], v[80:83], v[224:227]
 v_accvgpr_read_b32 v162, a154
 v_accvgpr_read_b32 v163, a155
 v_mfma_f32_16x16x32_bf16 v[224:227], v[104:107], v[64:67], v[224:227]
 s_waitcnt lgkmcnt(4)
 v_accvgpr_read_b32 v164, a156
 v_accvgpr_read_b32 v165, a157
 v_mfma_f32_16x16x32_bf16 v[224:227], v[112:115], v[32:35], v[224:227]
 ds_read_b128 v[104:107], v2 offset:18432
 v_accvgpr_read_b32 v166, a158
 v_mfma_f32_16x16x32_bf16 v[224:227], v[116:119], v[48:51], v[224:227]
 ds_read_b128 v[108:111], v2 offset:19456
 v_accvgpr_read_b32 v167, a159
 v_mfma_f32_16x16x32_bf16 a[160:163], v[116:119], v[52:55], a[160:163]
 v_add_f32 v160, v160, v176
 v_add_f32 v161, v161, v177
 v_mfma_f32_16x16x32_bf16 a[160:163], v[112:115], v[36:39], a[160:163]
 v_add_f32 v162, v162, v178
 v_add_f32 v163, v163, v179
 v_mfma_f32_16x16x32_bf16 a[224:227], v[112:115], v[40:43], a[224:227]
 v_add_f32 v164, v164, v180
 v_add_f32 v165, v165, v181
 v_mfma_f32_16x16x32_bf16 a[224:227], v[116:119], v[56:59], a[224:227]
 v_add_f32 v166, v166, v182
 v_add_f32 v167, v167, v183
 v_mfma_f32_16x16x32_bf16 a[64:67], v[116:119], v[60:63], a[64:67]
 v_cvt_pk_bf16_f32 v160, v160, v161
 v_cvt_pk_bf16_f32 v161, v162, v163
 v_mfma_f32_16x16x32_bf16 a[64:67], v[112:115], v[44:47], a[64:67]
 s_waitcnt lgkmcnt(4)
 v_cvt_pk_bf16_f32 v162, v164, v165
 v_cvt_pk_bf16_f32 v163, v166, v167
 v_mfma_f32_16x16x32_bf16 v[228:231], v[96:99], v[16:19], v[228:231]
 ds_read_b128 v[112:115], v3 offset:2048
 v_mfma_f32_16x16x32_bf16 v[228:231], v[100:103], v[4:7], v[228:231]
 ds_read_b128 v[116:119], v3 offset:3072
 v_mfma_f32_16x16x32_bf16 a[164:167], v[100:103], v[8:11], a[164:167]
 buffer_store_dwordx4 v[160:163], v1, s[44:47], s61 offen offset:448 sc1
 v_mfma_f32_16x16x32_bf16 a[164:167], v[96:99], v[20:23], a[164:167]
 v_accvgpr_read_b32 v140, a216
 v_accvgpr_read_b32 v141, a217
 v_mfma_f32_16x16x32_bf16 a[228:231], v[96:99], v[24:27], a[228:231]
 v_accvgpr_read_b32 v142, a218
 v_accvgpr_read_b32 v143, a219
 v_mfma_f32_16x16x32_bf16 a[228:231], v[100:103], v[12:15], a[228:231]
 v_accvgpr_read_b32 v136, a220
 v_accvgpr_read_b32 v137, a221
 v_mfma_f32_16x16x32_bf16 a[68:71], v[100:103], v[120:123], a[68:71]
 v_accvgpr_read_b32 v138, a222
 v_accvgpr_read_b32 v139, a223
 v_mfma_f32_16x16x32_bf16 a[68:71], v[96:99], v[28:31], a[68:71]
 s_waitcnt lgkmcnt(2)
 v_add_f32 v140, v140, v176
 v_add_f32 v141, v141, v177
 v_mfma_f32_16x16x32_bf16 a[68:71], v[104:107], v[76:79], a[68:71]
 ds_read_b128 v[96:99], v0 offset:36864
 v_add_f32 v142, v142, v178
 v_mfma_f32_16x16x32_bf16 a[68:71], v[108:111], v[92:95], a[68:71]
 ds_read_b128 v[100:103], v0 offset:37888
 v_add_f32 v143, v143, v179
 v_mfma_f32_16x16x32_bf16 a[228:231], v[108:111], v[88:91], a[228:231]
 v_add_f32 v136, v136, v180
 v_add_f32 v137, v137, v181
 v_mfma_f32_16x16x32_bf16 a[228:231], v[104:107], v[72:75], a[228:231]
 v_add_f32 v138, v138, v182
 v_add_f32 v139, v139, v183
 v_mfma_f32_16x16x32_bf16 a[164:167], v[104:107], v[68:71], a[164:167]
 v_cvt_pk_bf16_f32 v140, v140, v141
 v_cvt_pk_bf16_f32 v141, v142, v143
 v_mfma_f32_16x16x32_bf16 a[164:167], v[108:111], v[84:87], a[164:167]
 v_cvt_pk_bf16_f32 v142, v136, v137
 v_cvt_pk_bf16_f32 v143, v138, v139
 v_mfma_f32_16x16x32_bf16 v[228:231], v[108:111], v[80:83], v[228:231]
 buffer_store_dwordx4 v[140:143], v1, s[44:47], s62 offen offset:448 sc1
 v_mfma_f32_16x16x32_bf16 v[228:231], v[104:107], v[64:67], v[228:231]
 s_waitcnt lgkmcnt(2)
 v_accvgpr_read_b32 v192, a56
 v_accvgpr_read_b32 v193, a57
 v_mfma_f32_16x16x32_bf16 v[228:231], v[112:115], v[32:35], v[228:231]
 ds_read_b128 v[104:107], v2 offset:20480
 v_accvgpr_read_b32 v194, a58
 v_mfma_f32_16x16x32_bf16 v[228:231], v[116:119], v[48:51], v[228:231]
 ds_read_b128 v[108:111], v2 offset:21504
 v_accvgpr_read_b32 v195, a59
 v_mfma_f32_16x16x32_bf16 a[164:167], v[116:119], v[52:55], a[164:167]
 v_accvgpr_read_b32 v196, a60
 v_accvgpr_read_b32 v197, a61
 v_mfma_f32_16x16x32_bf16 a[164:167], v[112:115], v[36:39], a[164:167]
 v_accvgpr_read_b32 v198, a62
 v_accvgpr_read_b32 v199, a63
 v_mfma_f32_16x16x32_bf16 a[228:231], v[112:115], v[40:43], a[228:231]
 v_add_f32 v192, v192, v176
 v_add_f32 v193, v193, v177
 v_mfma_f32_16x16x32_bf16 a[228:231], v[116:119], v[56:59], a[228:231]
 v_add_f32 v194, v194, v178
 v_add_f32 v195, v195, v179
 v_mfma_f32_16x16x32_bf16 a[68:71], v[116:119], v[60:63], a[68:71]
 v_add_f32 v196, v196, v180
 v_add_f32 v197, v197, v181
 v_mfma_f32_16x16x32_bf16 a[68:71], v[112:115], v[44:47], a[68:71]
 s_waitcnt lgkmcnt(2)
 v_add_f32 v198, v198, v182
 v_add_f32 v199, v199, v183
 v_mfma_f32_16x16x32_bf16 v[232:235], v[96:99], v[16:19], v[232:235]
 ds_read_b128 v[112:115], v3 offset:4096
 v_cvt_pk_bf16_f32 v192, v192, v193
 v_mfma_f32_16x16x32_bf16 v[232:235], v[100:103], v[4:7], v[232:235]
 ds_read_b128 v[116:119], v3 offset:5120
 v_cvt_pk_bf16_f32 v193, v194, v195
 v_mfma_f32_16x16x32_bf16 a[168:171], v[100:103], v[8:11], a[168:171]
 v_cvt_pk_bf16_f32 v194, v196, v197
 v_cvt_pk_bf16_f32 v195, v198, v199
 v_mfma_f32_16x16x32_bf16 a[168:171], v[96:99], v[20:23], a[168:171]
 buffer_store_dwordx4 v[192:195], v1, s[44:47], s63 offen offset:448 sc1
 v_mfma_f32_16x16x32_bf16 a[232:235], v[96:99], v[24:27], a[232:235]
 v_mfma_f32_16x16x32_bf16 a[232:235], v[100:103], v[12:15], a[232:235]
 v_mfma_f32_16x16x32_bf16 a[72:75], v[100:103], v[120:123], a[72:75]
 v_mfma_f32_16x16x32_bf16 a[72:75], v[96:99], v[28:31], a[72:75]
 s_waitcnt lgkmcnt(2)
 v_mfma_f32_16x16x32_bf16 a[72:75], v[104:107], v[76:79], a[72:75]
 ds_read_b128 v[96:99], v0 offset:38912
 v_cvt_pk_bf16_f32 v224, v224, v225
 v_mfma_f32_16x16x32_bf16 a[72:75], v[108:111], v[92:95], a[72:75]
 ds_read_b128 v[100:103], v0 offset:39936
 v_cvt_pk_bf16_f32 v225, v226, v227
 v_mfma_f32_16x16x32_bf16 a[232:235], v[108:111], v[88:91], a[232:235]
 v_cvt_pk_bf16_f32 v226, v228, v229
 v_cvt_pk_bf16_f32 v227, v230, v231
 v_mfma_f32_16x16x32_bf16 a[232:235], v[104:107], v[72:75], a[232:235]
 buffer_store_dwordx4 v[224:227], v1, s[44:47], s60 offen offset:512 sc1
 v_mfma_f32_16x16x32_bf16 a[168:171], v[104:107], v[68:71], a[168:171]
 ds_read_b128 v[148:151], v124 offset:7296
 ds_read_b128 v[144:147], v124 offset:7312
 v_mfma_f32_16x16x32_bf16 a[168:171], v[108:111], v[84:87], a[168:171]
 v_accvgpr_read_b32 v212, a160
 v_accvgpr_read_b32 v213, a161
 v_mfma_f32_16x16x32_bf16 v[232:235], v[108:111], v[80:83], v[232:235]
 v_accvgpr_read_b32 v214, a162
 v_accvgpr_read_b32 v215, a163
 v_mfma_f32_16x16x32_bf16 v[232:235], v[104:107], v[64:67], v[232:235]
 s_waitcnt lgkmcnt(4)
 v_accvgpr_read_b32 v208, a164
 v_accvgpr_read_b32 v209, a165
 v_mfma_f32_16x16x32_bf16 v[232:235], v[112:115], v[32:35], v[232:235]
 ds_read_b128 v[104:107], v2 offset:22528
 v_accvgpr_read_b32 v210, a166
 v_mfma_f32_16x16x32_bf16 v[232:235], v[116:119], v[48:51], v[232:235]
 ds_read_b128 v[108:111], v2 offset:23552
 v_accvgpr_read_b32 v211, a167
 v_mfma_f32_16x16x32_bf16 a[168:171], v[116:119], v[52:55], a[168:171]
 v_add_f32 v212, v212, v204
 v_add_f32 v213, v213, v205
 v_mfma_f32_16x16x32_bf16 a[168:171], v[112:115], v[36:39], a[168:171]
 v_add_f32 v214, v214, v206
 v_add_f32 v215, v215, v207
 v_mfma_f32_16x16x32_bf16 a[232:235], v[112:115], v[40:43], a[232:235]
 v_add_f32 v208, v208, v200
 v_add_f32 v209, v209, v201
 v_mfma_f32_16x16x32_bf16 a[232:235], v[116:119], v[56:59], a[232:235]
 v_add_f32 v210, v210, v202
 v_add_f32 v211, v211, v203
 v_mfma_f32_16x16x32_bf16 a[72:75], v[116:119], v[60:63], a[72:75]
 v_cvt_pk_bf16_f32 v212, v212, v213
 v_cvt_pk_bf16_f32 v213, v214, v215
 v_mfma_f32_16x16x32_bf16 a[72:75], v[112:115], v[44:47], a[72:75]
 s_waitcnt lgkmcnt(4)
 v_cvt_pk_bf16_f32 v214, v208, v209
 v_cvt_pk_bf16_f32 v215, v210, v211
 v_mfma_f32_16x16x32_bf16 v[236:239], v[96:99], v[16:19], v[236:239]
 ds_read_b128 v[112:115], v3 offset:6144
 v_mfma_f32_16x16x32_bf16 v[236:239], v[100:103], v[4:7], v[236:239]
 ds_read_b128 v[116:119], v3 offset:7168
 v_mfma_f32_16x16x32_bf16 a[172:175], v[100:103], v[8:11], a[172:175]
 buffer_store_dwordx4 v[212:215], v1, s[44:47], s61 offen offset:512 sc1
 v_mfma_f32_16x16x32_bf16 a[172:175], v[96:99], v[20:23], a[172:175]
 v_accvgpr_read_b32 v188, a224
 v_accvgpr_read_b32 v189, a225
 v_mfma_f32_16x16x32_bf16 a[236:239], v[96:99], v[24:27], a[236:239]
 v_accvgpr_read_b32 v190, a226
 v_accvgpr_read_b32 v191, a227
 v_mfma_f32_16x16x32_bf16 a[236:239], v[100:103], v[12:15], a[236:239]
 v_accvgpr_read_b32 v184, a228
 v_accvgpr_read_b32 v185, a229
 v_mfma_f32_16x16x32_bf16 a[76:79], v[100:103], v[120:123], a[76:79]
 v_accvgpr_read_b32 v186, a230
 v_accvgpr_read_b32 v187, a231
 v_mfma_f32_16x16x32_bf16 a[76:79], v[96:99], v[28:31], a[76:79]
 s_waitcnt lgkmcnt(2)
 v_add_f32 v188, v188, v204
 v_add_f32 v189, v189, v205
 v_mfma_f32_16x16x32_bf16 a[76:79], v[104:107], v[76:79], a[76:79]
 ds_read_b128 v[96:99], v0 offset:40960
 v_add_f32 v190, v190, v206
 v_mfma_f32_16x16x32_bf16 a[76:79], v[108:111], v[92:95], a[76:79]
 ds_read_b128 v[100:103], v0 offset:41984
 v_add_f32 v191, v191, v207
 v_mfma_f32_16x16x32_bf16 a[236:239], v[108:111], v[88:91], a[236:239]
 v_add_f32 v184, v184, v200
 v_add_f32 v185, v185, v201
 v_mfma_f32_16x16x32_bf16 a[236:239], v[104:107], v[72:75], a[236:239]
 v_add_f32 v186, v186, v202
 v_add_f32 v187, v187, v203
 v_mfma_f32_16x16x32_bf16 a[172:175], v[104:107], v[68:71], a[172:175]
 v_cvt_pk_bf16_f32 v188, v188, v189
 v_cvt_pk_bf16_f32 v189, v190, v191
 v_mfma_f32_16x16x32_bf16 a[172:175], v[108:111], v[84:87], a[172:175]
 v_cvt_pk_bf16_f32 v190, v184, v185
 v_cvt_pk_bf16_f32 v191, v186, v187
 v_mfma_f32_16x16x32_bf16 v[236:239], v[108:111], v[80:83], v[236:239]
 buffer_store_dwordx4 v[188:191], v1, s[44:47], s62 offen offset:512 sc1
 v_mfma_f32_16x16x32_bf16 v[236:239], v[104:107], v[64:67], v[236:239]
 s_waitcnt lgkmcnt(2)
 v_accvgpr_read_b32 v156, a64
 v_accvgpr_read_b32 v157, a65
 v_mfma_f32_16x16x32_bf16 v[236:239], v[112:115], v[32:35], v[236:239]
 ds_read_b128 v[104:107], v2 offset:24576
 v_accvgpr_read_b32 v158, a66
 v_mfma_f32_16x16x32_bf16 v[236:239], v[116:119], v[48:51], v[236:239]
 ds_read_b128 v[108:111], v2 offset:25600
 v_accvgpr_read_b32 v159, a67
 v_mfma_f32_16x16x32_bf16 a[172:175], v[116:119], v[52:55], a[172:175]
 v_accvgpr_read_b32 v152, a68
 v_accvgpr_read_b32 v153, a69
 v_mfma_f32_16x16x32_bf16 a[172:175], v[112:115], v[36:39], a[172:175]
 v_accvgpr_read_b32 v154, a70
 v_accvgpr_read_b32 v155, a71
 v_mfma_f32_16x16x32_bf16 a[236:239], v[112:115], v[40:43], a[236:239]
 v_add_f32 v156, v156, v204
 v_add_f32 v157, v157, v205
 v_mfma_f32_16x16x32_bf16 a[236:239], v[116:119], v[56:59], a[236:239]
 v_add_f32 v158, v158, v206
 v_add_f32 v159, v159, v207
 v_mfma_f32_16x16x32_bf16 a[76:79], v[116:119], v[60:63], a[76:79]
 v_add_f32 v152, v152, v200
 v_add_f32 v153, v153, v201
 v_mfma_f32_16x16x32_bf16 a[76:79], v[112:115], v[44:47], a[76:79]
 s_waitcnt lgkmcnt(2)
 v_add_f32 v154, v154, v202
 v_add_f32 v155, v155, v203
 v_mfma_f32_16x16x32_bf16 v[240:243], v[96:99], v[16:19], v[240:243]
 ds_read_b128 v[112:115], v3 offset:8192
 v_cvt_pk_bf16_f32 v156, v156, v157
 v_mfma_f32_16x16x32_bf16 v[240:243], v[100:103], v[4:7], v[240:243]
 ds_read_b128 v[116:119], v3 offset:9216
 v_cvt_pk_bf16_f32 v157, v158, v159
 v_mfma_f32_16x16x32_bf16 a[176:179], v[100:103], v[8:11], a[176:179]
 v_cvt_pk_bf16_f32 v158, v152, v153
 v_cvt_pk_bf16_f32 v159, v154, v155
 v_mfma_f32_16x16x32_bf16 a[176:179], v[96:99], v[20:23], a[176:179]
 buffer_store_dwordx4 v[156:159], v1, s[44:47], s63 offen offset:512 sc1
 v_mfma_f32_16x16x32_bf16 a[240:243], v[96:99], v[24:27], a[240:243]
 v_mfma_f32_16x16x32_bf16 a[240:243], v[100:103], v[12:15], a[240:243]
 v_mfma_f32_16x16x32_bf16 a[80:83], v[100:103], v[120:123], a[80:83]
 v_mfma_f32_16x16x32_bf16 a[80:83], v[96:99], v[28:31], a[80:83]
 s_waitcnt lgkmcnt(2)
 v_mfma_f32_16x16x32_bf16 a[80:83], v[104:107], v[76:79], a[80:83]
 ds_read_b128 v[96:99], v0 offset:43008
 v_cvt_pk_bf16_f32 v232, v232, v233
 v_mfma_f32_16x16x32_bf16 a[80:83], v[108:111], v[92:95], a[80:83]
 ds_read_b128 v[100:103], v0 offset:44032
 v_cvt_pk_bf16_f32 v233, v234, v235
 v_mfma_f32_16x16x32_bf16 a[240:243], v[108:111], v[88:91], a[240:243]
 v_cvt_pk_bf16_f32 v234, v236, v237
 v_cvt_pk_bf16_f32 v235, v238, v239
 v_mfma_f32_16x16x32_bf16 a[240:243], v[104:107], v[72:75], a[240:243]
 buffer_store_dwordx4 v[232:235], v1, s[44:47], s60 offen offset:576 sc1
 v_mfma_f32_16x16x32_bf16 a[176:179], v[104:107], v[68:71], a[176:179]
 ds_read_b128 v[168:171], v124 offset:7424
 ds_read_b128 v[172:175], v124 offset:7440
 v_mfma_f32_16x16x32_bf16 a[176:179], v[108:111], v[84:87], a[176:179]
 v_accvgpr_read_b32 v128, a168
 v_accvgpr_read_b32 v129, a169
 v_mfma_f32_16x16x32_bf16 v[240:243], v[108:111], v[80:83], v[240:243]
 v_accvgpr_read_b32 v130, a170
 v_accvgpr_read_b32 v131, a171
 v_mfma_f32_16x16x32_bf16 v[240:243], v[104:107], v[64:67], v[240:243]
 s_waitcnt lgkmcnt(4)
 v_accvgpr_read_b32 v132, a172
 v_accvgpr_read_b32 v133, a173
 v_mfma_f32_16x16x32_bf16 v[240:243], v[112:115], v[32:35], v[240:243]
 ds_read_b128 v[104:107], v2 offset:26624
 v_accvgpr_read_b32 v134, a174
 v_mfma_f32_16x16x32_bf16 v[240:243], v[116:119], v[48:51], v[240:243]
 ds_read_b128 v[108:111], v2 offset:27648
 v_accvgpr_read_b32 v135, a175
 v_mfma_f32_16x16x32_bf16 a[176:179], v[116:119], v[52:55], a[176:179]
 v_add_f32 v128, v128, v148
 v_add_f32 v129, v129, v149
 v_mfma_f32_16x16x32_bf16 a[176:179], v[112:115], v[36:39], a[176:179]
 v_add_f32 v130, v130, v150
 v_add_f32 v131, v131, v151
 v_mfma_f32_16x16x32_bf16 a[240:243], v[112:115], v[40:43], a[240:243]
 v_add_f32 v132, v132, v144
 v_add_f32 v133, v133, v145
 v_mfma_f32_16x16x32_bf16 a[240:243], v[116:119], v[56:59], a[240:243]
 v_add_f32 v134, v134, v146
 v_add_f32 v135, v135, v147
 v_mfma_f32_16x16x32_bf16 a[80:83], v[116:119], v[60:63], a[80:83]
 v_cvt_pk_bf16_f32 v128, v128, v129
 v_cvt_pk_bf16_f32 v129, v130, v131
 v_mfma_f32_16x16x32_bf16 a[80:83], v[112:115], v[44:47], a[80:83]
 s_waitcnt lgkmcnt(4)
 v_cvt_pk_bf16_f32 v130, v132, v133
 v_cvt_pk_bf16_f32 v131, v134, v135
 v_mfma_f32_16x16x32_bf16 v[244:247], v[96:99], v[16:19], v[244:247]
 ds_read_b128 v[112:115], v3 offset:10240
 v_mfma_f32_16x16x32_bf16 v[244:247], v[100:103], v[4:7], v[244:247]
 ds_read_b128 v[116:119], v3 offset:11264
 v_mfma_f32_16x16x32_bf16 a[180:183], v[100:103], v[8:11], a[180:183]
 buffer_store_dwordx4 v[128:131], v1, s[44:47], s61 offen offset:576 sc1
 v_mfma_f32_16x16x32_bf16 a[180:183], v[96:99], v[20:23], a[180:183]
 v_accvgpr_read_b32 v220, a232
 v_accvgpr_read_b32 v221, a233
 v_mfma_f32_16x16x32_bf16 a[244:247], v[96:99], v[24:27], a[244:247]
 v_accvgpr_read_b32 v222, a234
 v_accvgpr_read_b32 v223, a235
 v_mfma_f32_16x16x32_bf16 a[244:247], v[100:103], v[12:15], a[244:247]
 v_accvgpr_read_b32 v216, a236
 v_accvgpr_read_b32 v217, a237
 v_mfma_f32_16x16x32_bf16 a[84:87], v[100:103], v[120:123], a[84:87]
 v_accvgpr_read_b32 v218, a238
 v_accvgpr_read_b32 v219, a239
 v_mfma_f32_16x16x32_bf16 a[84:87], v[96:99], v[28:31], a[84:87]
 s_waitcnt lgkmcnt(2)
 v_add_f32 v220, v220, v148
 v_add_f32 v221, v221, v149
 v_mfma_f32_16x16x32_bf16 a[84:87], v[104:107], v[76:79], a[84:87]
 ds_read_b128 v[96:99], v0 offset:45056
 v_add_f32 v222, v222, v150
 v_mfma_f32_16x16x32_bf16 a[84:87], v[108:111], v[92:95], a[84:87]
 ds_read_b128 v[100:103], v0 offset:46080
 v_add_f32 v223, v223, v151
 v_mfma_f32_16x16x32_bf16 a[244:247], v[108:111], v[88:91], a[244:247]
 v_add_f32 v216, v216, v144
 v_add_f32 v217, v217, v145
 v_mfma_f32_16x16x32_bf16 a[244:247], v[104:107], v[72:75], a[244:247]
 v_add_f32 v218, v218, v146
 v_add_f32 v219, v219, v147
 v_mfma_f32_16x16x32_bf16 a[180:183], v[104:107], v[68:71], a[180:183]
 v_cvt_pk_bf16_f32 v220, v220, v221
 v_cvt_pk_bf16_f32 v221, v222, v223
 v_mfma_f32_16x16x32_bf16 a[180:183], v[108:111], v[84:87], a[180:183]
 v_cvt_pk_bf16_f32 v222, v216, v217
 v_cvt_pk_bf16_f32 v223, v218, v219
 v_mfma_f32_16x16x32_bf16 v[244:247], v[108:111], v[80:83], v[244:247]
 buffer_store_dwordx4 v[220:223], v1, s[44:47], s62 offen offset:576 sc1
 v_mfma_f32_16x16x32_bf16 v[244:247], v[104:107], v[64:67], v[244:247]
 s_waitcnt lgkmcnt(2)
 v_accvgpr_read_b32 v164, a72
 v_accvgpr_read_b32 v165, a73
 v_mfma_f32_16x16x32_bf16 v[244:247], v[112:115], v[32:35], v[244:247]
 ds_read_b128 v[104:107], v2 offset:28672
 v_accvgpr_read_b32 v166, a74
 v_mfma_f32_16x16x32_bf16 v[244:247], v[116:119], v[48:51], v[244:247]
 ds_read_b128 v[108:111], v2 offset:29696
 v_accvgpr_read_b32 v167, a75
 v_mfma_f32_16x16x32_bf16 a[180:183], v[116:119], v[52:55], a[180:183]
 v_accvgpr_read_b32 v160, a76
 v_accvgpr_read_b32 v161, a77
 v_mfma_f32_16x16x32_bf16 a[180:183], v[112:115], v[36:39], a[180:183]
 v_accvgpr_read_b32 v162, a78
 v_accvgpr_read_b32 v163, a79
 v_mfma_f32_16x16x32_bf16 a[244:247], v[112:115], v[40:43], a[244:247]
 v_add_f32 v164, v164, v148
 v_add_f32 v165, v165, v149
 v_mfma_f32_16x16x32_bf16 a[244:247], v[116:119], v[56:59], a[244:247]
 v_add_f32 v166, v166, v150
 v_add_f32 v167, v167, v151
 v_mfma_f32_16x16x32_bf16 a[84:87], v[116:119], v[60:63], a[84:87]
 v_add_f32 v160, v160, v144
 v_add_f32 v161, v161, v145
 v_mfma_f32_16x16x32_bf16 a[84:87], v[112:115], v[44:47], a[84:87]
 s_waitcnt lgkmcnt(2)
 v_add_f32 v162, v162, v146
 v_add_f32 v163, v163, v147
 v_mfma_f32_16x16x32_bf16 v[248:251], v[96:99], v[16:19], v[248:251]
 ds_read_b128 v[112:115], v3 offset:12288
 v_cvt_pk_bf16_f32 v164, v164, v165
 v_mfma_f32_16x16x32_bf16 v[248:251], v[100:103], v[4:7], v[248:251]
 ds_read_b128 v[116:119], v3 offset:13312
 v_cvt_pk_bf16_f32 v165, v166, v167
 v_mfma_f32_16x16x32_bf16 a[184:187], v[100:103], v[8:11], a[184:187]
 v_cvt_pk_bf16_f32 v166, v160, v161
 v_cvt_pk_bf16_f32 v167, v162, v163
 v_mfma_f32_16x16x32_bf16 a[184:187], v[96:99], v[20:23], a[184:187]
 buffer_store_dwordx4 v[164:167], v1, s[44:47], s63 offen offset:576 sc1
 v_mfma_f32_16x16x32_bf16 a[248:251], v[96:99], v[24:27], a[248:251]
 v_mfma_f32_16x16x32_bf16 a[248:251], v[100:103], v[12:15], a[248:251]
 v_mfma_f32_16x16x32_bf16 a[88:91], v[100:103], v[120:123], a[88:91]
 v_mfma_f32_16x16x32_bf16 a[88:91], v[96:99], v[28:31], a[88:91]
 s_waitcnt lgkmcnt(2)
 v_mfma_f32_16x16x32_bf16 a[88:91], v[104:107], v[76:79], a[88:91]
 ds_read_b128 v[96:99], v0 offset:47104
 v_cvt_pk_bf16_f32 v240, v240, v241
 v_mfma_f32_16x16x32_bf16 a[88:91], v[108:111], v[92:95], a[88:91]
 ds_read_b128 v[100:103], v0 offset:48128
 v_cvt_pk_bf16_f32 v241, v242, v243
 v_mfma_f32_16x16x32_bf16 a[248:251], v[108:111], v[88:91], a[248:251]
 v_cvt_pk_bf16_f32 v242, v244, v245
 v_cvt_pk_bf16_f32 v243, v246, v247
 v_mfma_f32_16x16x32_bf16 a[248:251], v[104:107], v[72:75], a[248:251]
 buffer_store_dwordx4 v[240:243], v1, s[44:47], s60 offen offset:640 sc1
 v_mfma_f32_16x16x32_bf16 a[184:187], v[104:107], v[68:71], a[184:187]
 ds_read_b128 v[136:139], v124 offset:7552
 ds_read_b128 v[140:143], v124 offset:7568
 v_mfma_f32_16x16x32_bf16 a[184:187], v[108:111], v[84:87], a[184:187]
 v_accvgpr_read_b32 v196, a176
 v_accvgpr_read_b32 v197, a177
 v_mfma_f32_16x16x32_bf16 v[248:251], v[108:111], v[80:83], v[248:251]
 v_accvgpr_read_b32 v198, a178
 v_accvgpr_read_b32 v199, a179
 v_mfma_f32_16x16x32_bf16 v[248:251], v[104:107], v[64:67], v[248:251]
 s_waitcnt lgkmcnt(4)
 v_accvgpr_read_b32 v192, a180
 v_accvgpr_read_b32 v193, a181
 v_mfma_f32_16x16x32_bf16 v[248:251], v[112:115], v[32:35], v[248:251]
 ds_read_b128 v[104:107], v2 offset:30720
 v_accvgpr_read_b32 v194, a182
 v_mfma_f32_16x16x32_bf16 v[248:251], v[116:119], v[48:51], v[248:251]
 ds_read_b128 v[108:111], v2 offset:31744
 v_accvgpr_read_b32 v195, a183
 v_mfma_f32_16x16x32_bf16 a[184:187], v[116:119], v[52:55], a[184:187]
 v_add_f32 v196, v196, v168
 v_add_f32 v197, v197, v169
 v_mfma_f32_16x16x32_bf16 a[184:187], v[112:115], v[36:39], a[184:187]
 v_add_f32 v198, v198, v170
 v_add_f32 v199, v199, v171
 v_mfma_f32_16x16x32_bf16 a[248:251], v[112:115], v[40:43], a[248:251]
 v_add_f32 v192, v192, v172
 v_add_f32 v193, v193, v173
 v_mfma_f32_16x16x32_bf16 a[248:251], v[116:119], v[56:59], a[248:251]
 v_add_f32 v194, v194, v174
 v_add_f32 v195, v195, v175
 v_mfma_f32_16x16x32_bf16 a[88:91], v[116:119], v[60:63], a[88:91]
 v_cvt_pk_bf16_f32 v196, v196, v197
 v_cvt_pk_bf16_f32 v197, v198, v199
 v_mfma_f32_16x16x32_bf16 a[88:91], v[112:115], v[44:47], a[88:91]
 s_waitcnt lgkmcnt(4)
 v_cvt_pk_bf16_f32 v198, v192, v193
 v_cvt_pk_bf16_f32 v199, v194, v195
 v_mfma_f32_16x16x32_bf16 v[252:255], v[96:99], v[16:19], v[252:255]
 ds_read_b128 v[112:115], v3 offset:14336
 v_mfma_f32_16x16x32_bf16 v[252:255], v[100:103], v[4:7], v[252:255]
 ds_read_b128 v[116:119], v3 offset:15360
 v_mfma_f32_16x16x32_bf16 a[188:191], v[100:103], v[8:11], a[188:191]
 buffer_store_dwordx4 v[196:199], v1, s[44:47], s61 offen offset:640 sc1
 v_mfma_f32_16x16x32_bf16 a[188:191], v[96:99], v[20:23], a[188:191]
 v_accvgpr_read_b32 v176, a240
 v_accvgpr_read_b32 v177, a241
 v_mfma_f32_16x16x32_bf16 a[252:255], v[96:99], v[24:27], a[252:255]
 v_accvgpr_read_b32 v178, a242
 v_accvgpr_read_b32 v179, a243
 v_mfma_f32_16x16x32_bf16 a[252:255], v[100:103], v[12:15], a[252:255]
 v_accvgpr_read_b32 v180, a244
 v_accvgpr_read_b32 v181, a245
 v_mfma_f32_16x16x32_bf16 a[92:95], v[100:103], v[120:123], a[92:95]
 v_accvgpr_read_b32 v182, a246
 v_accvgpr_read_b32 v183, a247
 v_mfma_f32_16x16x32_bf16 a[92:95], v[96:99], v[28:31], a[92:95]
 s_waitcnt lgkmcnt(2)
 v_add_f32 v176, v176, v168
 v_add_f32 v177, v177, v169
 v_mfma_f32_16x16x32_bf16 a[92:95], v[104:107], v[76:79], a[92:95]
 v_add_f32 v178, v178, v170
 v_add_f32 v179, v179, v171
 v_mfma_f32_16x16x32_bf16 a[92:95], v[108:111], v[92:95], a[92:95]
 v_add_f32 v180, v180, v172
 v_add_f32 v181, v181, v173
 v_mfma_f32_16x16x32_bf16 a[252:255], v[108:111], v[88:91], a[252:255]
 v_add_f32 v182, v182, v174
 v_add_f32 v183, v183, v175
 v_mfma_f32_16x16x32_bf16 a[252:255], v[104:107], v[72:75], a[252:255]
 v_cvt_pk_bf16_f32 v176, v176, v177
 v_cvt_pk_bf16_f32 v177, v178, v179
 v_mfma_f32_16x16x32_bf16 a[188:191], v[104:107], v[68:71], a[188:191]
 v_cvt_pk_bf16_f32 v178, v180, v181
 v_cvt_pk_bf16_f32 v179, v182, v183
 v_mfma_f32_16x16x32_bf16 a[188:191], v[108:111], v[84:87], a[188:191]
 buffer_store_dwordx4 v[176:179], v1, s[44:47], s62 offen offset:640 sc1
 v_mfma_f32_16x16x32_bf16 v[252:255], v[108:111], v[80:83], v[252:255]
 v_accvgpr_read_b32 v228, a80
 v_accvgpr_read_b32 v229, a81
 v_mfma_f32_16x16x32_bf16 v[252:255], v[104:107], v[64:67], v[252:255]
 s_waitcnt lgkmcnt(0)
 v_accvgpr_read_b32 v230, a82
 v_accvgpr_read_b32 v231, a83
 v_mfma_f32_16x16x32_bf16 v[252:255], v[112:115], v[32:35], v[252:255]
 v_accvgpr_read_b32 v224, a84
 v_accvgpr_read_b32 v225, a85
 v_mfma_f32_16x16x32_bf16 v[252:255], v[116:119], v[48:51], v[252:255]
 v_accvgpr_read_b32 v226, a86
 v_accvgpr_read_b32 v227, a87
 v_mfma_f32_16x16x32_bf16 a[188:191], v[116:119], v[52:55], a[188:191]
 v_add_f32 v228, v228, v168
 v_add_f32 v229, v229, v169
 v_mfma_f32_16x16x32_bf16 a[188:191], v[112:115], v[36:39], a[188:191]
 v_add_f32 v230, v230, v170
 v_add_f32 v231, v231, v171
 v_mfma_f32_16x16x32_bf16 a[252:255], v[112:115], v[40:43], a[252:255]
 v_add_f32 v224, v224, v172
 v_add_f32 v225, v225, v173
 v_mfma_f32_16x16x32_bf16 a[252:255], v[116:119], v[56:59], a[252:255]
 v_add_f32 v226, v226, v174
 v_add_f32 v227, v227, v175
 v_mfma_f32_16x16x32_bf16 a[92:95], v[116:119], v[60:63], a[92:95]
 v_cvt_pk_bf16_f32 v228, v228, v229
 v_cvt_pk_bf16_f32 v229, v230, v231
 v_mfma_f32_16x16x32_bf16 a[92:95], v[112:115], v[44:47], a[92:95]
 v_cvt_pk_bf16_f32 v230, v224, v225
 v_cvt_pk_bf16_f32 v231, v226, v227
 s_nop 7
 buffer_store_dwordx4 v[228:231], v1, s[44:47], s63 offen offset:640 sc1
 v_cvt_pk_bf16_f32 v248, v248, v249
 v_cvt_pk_bf16_f32 v249, v250, v251
 v_cvt_pk_bf16_f32 v250, v252, v253
 v_cvt_pk_bf16_f32 v251, v254, v255
 buffer_store_dwordx4 v[248:251], v1, s[44:47], s60 offen offset:704 sc1
 v_accvgpr_read_b32 v208, a184
 v_accvgpr_read_b32 v209, a185
 v_accvgpr_read_b32 v210, a186
 v_accvgpr_read_b32 v211, a187
 v_accvgpr_read_b32 v212, a188
 v_accvgpr_read_b32 v213, a189
 v_accvgpr_read_b32 v214, a190
 v_accvgpr_read_b32 v215, a191
 v_add_f32 v208, v208, v136
 v_add_f32 v209, v209, v137
 v_add_f32 v210, v210, v138
 v_add_f32 v211, v211, v139
 v_add_f32 v212, v212, v140
 v_add_f32 v213, v213, v141
 v_add_f32 v214, v214, v142
 v_add_f32 v215, v215, v143
 v_cvt_pk_bf16_f32 v208, v208, v209
 v_cvt_pk_bf16_f32 v209, v210, v211
 v_cvt_pk_bf16_f32 v210, v212, v213
 v_cvt_pk_bf16_f32 v211, v214, v215
 buffer_store_dwordx4 v[208:211], v1, s[44:47], s61 offen offset:704 sc1
 v_accvgpr_read_b32 v184, a248
 v_accvgpr_read_b32 v185, a249
 v_accvgpr_read_b32 v186, a250
 v_accvgpr_read_b32 v187, a251
 v_accvgpr_read_b32 v188, a252
 v_accvgpr_read_b32 v189, a253
 v_accvgpr_read_b32 v190, a254
 v_accvgpr_read_b32 v191, a255
 v_add_f32 v184, v184, v136
 v_add_f32 v185, v185, v137
 v_add_f32 v186, v186, v138
 v_add_f32 v187, v187, v139
 v_add_f32 v188, v188, v140
 v_add_f32 v189, v189, v141
 v_add_f32 v190, v190, v142
 v_add_f32 v191, v191, v143
 v_cvt_pk_bf16_f32 v184, v184, v185
 v_cvt_pk_bf16_f32 v185, v186, v187
 v_cvt_pk_bf16_f32 v186, v188, v189
 v_cvt_pk_bf16_f32 v187, v190, v191
 buffer_store_dwordx4 v[184:187], v1, s[44:47], s62 offen offset:704 sc1
 v_accvgpr_read_b32 v152, a88
 v_accvgpr_read_b32 v153, a89
 v_accvgpr_read_b32 v154, a90
 v_accvgpr_read_b32 v155, a91
 v_accvgpr_read_b32 v156, a92
 v_accvgpr_read_b32 v157, a93
 v_accvgpr_read_b32 v158, a94
 v_accvgpr_read_b32 v159, a95
 v_add_f32 v152, v152, v136
 v_add_f32 v153, v153, v137
 v_add_f32 v154, v154, v138
 v_add_f32 v155, v155, v139
 v_add_f32 v156, v156, v140
 v_add_f32 v157, v157, v141
 v_add_f32 v158, v158, v142
 v_add_f32 v159, v159, v143
 v_cvt_pk_bf16_f32 v152, v152, v153
 v_cvt_pk_bf16_f32 v153, v154, v155
 v_cvt_pk_bf16_f32 v154, v156, v157
 v_cvt_pk_bf16_f32 v155, v158, v159
 buffer_store_dwordx4 v[152:155], v1, s[44:47], s63 offen offset:704 sc1
L_end:
 s_endpgm
.section .rodata,"a"
.p2align 6
.amdhsa_kernel standalone__modern_conv_block_slak__vision_kernel
  .amdhsa_next_free_vgpr 512
  .amdhsa_next_free_sgpr 102
  .amdhsa_accum_offset 256
  .amdhsa_group_segment_fixed_size 0
  .amdhsa_kernarg_size 72
  .amdhsa_user_sgpr_count 2
  .amdhsa_user_sgpr_kernarg_segment_ptr 1
  .amdhsa_system_sgpr_workgroup_id_x 1
.end_amdhsa_kernel
```
